```python
import torch

def _softmax(x, axis=-1):
    return torch.softmax(x, dim=axis)

def _gelu(x):
    return torch.nn.functional.gelu(x, approximate='tanh')

def _silu(x):
    return torch.nn.functional.silu(x)

def _sigmoid(x):
    return torch.sigmoid(x)

def _layernorm(x, axis=-1, eps=1e-05):
    m = x.mean(dim=axis, keepdim=True)
    v = x.var(dim=axis, keepdim=True, unbiased=False)
    return (x - m) / torch.sqrt(v + eps)

def _scatter_add(tgt, idx, src, axis=0):
    return tgt.clone().index_add_(axis, idx, src)

def _segment_sum(src, seg, n):
    out = torch.zeros((n,) + src.shape[1:], dtype=src.dtype)
    return out.index_add_(0, seg, src)

def _pad(x, pw):
    flat = tuple((v for pair in reversed(pw) for v in pair))
    return torch.nn.functional.pad(x, flat)
kernel_name = 'adaLN_cond__mha_block_cached__geglu_ffn__prompt'

def setup_inputs():

    _w = lambda a: (lambda t: t.to(torch.bfloat16) if t.is_floating_point() else t)(torch.as_tensor(a))

    def _A_setup():
        B, Sq, D = (1, 2048, 1024)
        H, Sk, Dh = (32, 2048, 128)
        return {'x': _w((lambda *s: torch.randn(*s, dtype=torch.bfloat16) * 0.05)(B, Sq, D)), 'k_cache': _w((lambda *s: torch.randn(*s, dtype=torch.bfloat16) * 3.2)(B, H, Sk, Dh)), 'v_cache': _w((lambda *s: torch.randn(*s, dtype=torch.bfloat16) * 0.4)(B, H, Sk, Dh)), 'wq': _w((lambda *s: torch.randn(*s, dtype=torch.bfloat16) * 3.2)(D, H * Dh) * D ** (-0.5)), 'wo': _w((lambda *s: torch.randn(*s, dtype=torch.bfloat16) * 0.4)(H * Dh, D) * (H * Dh) ** (-0.5))}
    _A_in = _A_setup()

    def _B_setup():
        B, S, D, F = (1, 2048, 1024, 3584)
        return {'x': _w((lambda *s: torch.randn(*s, dtype=torch.bfloat16) * 0.05)(B, S, D)), 'w_gate': _w((lambda *s: torch.randn(*s, dtype=torch.bfloat16) * 0.05)(D, F)), 'w_up': _w((lambda *s: torch.randn(*s, dtype=torch.bfloat16) * 0.05)(D, F)), 'w_down': _w((lambda *s: torch.randn(*s, dtype=torch.bfloat16) * 0.05)(F, D))}
    _B_in = _B_setup()
    return {'A_x': _A_in['x'], 'A_k_cache': _A_in['k_cache'], 'A_v_cache': _A_in['v_cache'], 'A_wq': _A_in['wq'], 'A_wo': _A_in['wo'], 'B_x': _B_in['x'], 'B_w_gate': _B_in['w_gate'], 'B_w_up': _B_in['w_up'], 'B_w_down': _B_in['w_down'], 'c': _w((lambda *s: torch.randn(*s, dtype=torch.bfloat16) * 0.1)(1, 1024) * 8.0), 'w_mod': _w((lambda *s: torch.randn(*s, dtype=torch.bfloat16) * 0.1)(1024, 6 * 1024) * 1024 ** (-0.5) * 8.0)}

def reference(A_x, A_k_cache, A_v_cache, A_wq, A_wo, B_x, B_w_gate, B_w_up, B_w_down, c, w_mod):

    def _A_ref(x, k_cache, v_cache, wq, wo):
        B, Sq, D = x.shape
        H, Dh = (32, 128)
        q = (lambda x, *d: x.permute(*d))((x @ wq).reshape(B, Sq, H, Dh), 0, 2, 1, 3)
        scores = torch.einsum('bhqd,bhkd->bhqk', q, k_cache) * Dh ** (-0.5)
        p = _softmax(scores, axis=-1)
        o = torch.einsum('bhqk,bhkd->bhqd', p, v_cache)
        return (lambda x, *d: x.permute(*d))(o, 0, 2, 1, 3).reshape(B, Sq, H * Dh) @ wo

    def _B_ref(x, w_gate, w_up, w_down):
        return _gelu(x @ w_gate) * (x @ w_up) @ w_down
    x = A_x
    mod = (_silu(c) @ w_mod).reshape(c.shape[0], 6, 1, -1)
    sa, ca, ga, sb, cb, gb = (mod[:, 0].clone(), mod[:, 1].clone(), mod[:, 2].clone(), mod[:, 3].clone(), mod[:, 4].clone(), mod[:, 5].clone())
    h = _layernorm(x, axis=-1) * (1 + ca) + sa
    x = x + ga * _A_ref(h, A_k_cache, A_v_cache, A_wq, A_wo)
    h = _layernorm(x, axis=-1) * (1 + cb) + sb
    x = x + gb * _B_ref(h, B_w_gate, B_w_up, B_w_down)
    return x
```

```asm
; @launch kernel=mod_kernel grid=(128,1,1) block=(256,1,1) lds=8192
; @launch kernel=lna_kernel grid=(256,1,1) block=(512,1,1) lds=8704
; @launch kernel=attn_kernel grid=(256,1,1) block=(256,1,1) lds=163840
; @launch kernel=oproj_kernel grid=(256,1,1) block=(256,1,1) lds=65536
; @launch kernel=lnb_kernel grid=(256,1,1) block=(512,1,1) lds=8704
; @launch kernel=gateup_kernel grid=(256,1,1) block=(256,1,1) lds=143360
; @launch kernel=down_kernel grid=(256,1,1) block=(256,1,1) lds=65536
.amdgcn_target "amdgcn-amd-amdhsa--gfx950"
.text
.globl mod_kernel
.p2align 8
.type mod_kernel,@function
mod_kernel:
s_cmp_ge_u32 s2, 128
s_cbranch_scc1 L_mod_end
s_load_dwordx4 s[4:7], s[0:1], 72
s_load_dwordx2 s[8:9], s[0:1], 104
v_and_b32 v1, 63, v0
v_lshrrev_b32 v2, 6, v0
v_lshrrev_b32 v3, 3, v1
v_and_b32 v4, 7, v1
s_and_b32 s30, s2, 3
s_lshr_b32 s31, s2, 2
s_lshl_b32 s32, s30, 8
v_lshl_add_u32 v5, v2, 6, v3
v_add_u32 v5, s32, v5
s_movk_i32 s24, 12288
v_mul_lo_u32 v6, v5, s24
v_lshl_add_u32 v6, v4, 4, v6
v_lshlrev_b32 v7, 1, v5
s_lshl_b32 s25, s31, 7
s_waitcnt lgkmcnt(0)
s_mov_b32 s16, s6
s_and_b32 s17, s7, 0xffff
s_mov_b32 s18, 12582912
s_mov_b32 s19, 0x20000
buffer_load_dwordx4 v[16:19], v6, s[16:19], s25 offen nt
s_add_u32 s25, s25, 98304
s_mov_b32 s12, s4
s_and_b32 s13, s5, 0xffff
s_mov_b32 s14, 2048
s_mov_b32 s15, 0x20000
buffer_load_ushort v8, v7, s[12:15], 0 offen offset:0
buffer_load_ushort v9, v7, s[12:15], 0 offen offset:16
buffer_load_ushort v10, v7, s[12:15], 0 offen offset:32
buffer_load_ushort v11, v7, s[12:15], 0 offen offset:48
buffer_load_ushort v12, v7, s[12:15], 0 offen offset:64
buffer_load_ushort v13, v7, s[12:15], 0 offen offset:80
buffer_load_ushort v14, v7, s[12:15], 0 offen offset:96
buffer_load_ushort v15, v7, s[12:15], 0 offen offset:112
buffer_load_dwordx4 v[20:23], v6, s[16:19], s25 offen nt
s_add_u32 s25, s25, 98304
buffer_load_dwordx4 v[24:27], v6, s[16:19], s25 offen nt
s_add_u32 s25, s25, 98304
buffer_load_dwordx4 v[28:31], v6, s[16:19], s25 offen nt
s_add_u32 s25, s25, 98304
buffer_load_dwordx4 v[32:35], v6, s[16:19], s25 offen nt
s_add_u32 s25, s25, 98304
buffer_load_dwordx4 v[36:39], v6, s[16:19], s25 offen nt
s_add_u32 s25, s25, 98304
buffer_load_dwordx4 v[40:43], v6, s[16:19], s25 offen nt
s_add_u32 s25, s25, 98304
buffer_load_dwordx4 v[44:47], v6, s[16:19], s25 offen nt
s_add_u32 s20, s8, 65536
s_addc_u32 s21, s9, 0
s_and_b32 s21, s21, 0xffff
s_mov_b32 s22, 98304
s_mov_b32 s23, 0x20000
s_load_dwordx2 s[40:41], s[0:1], 0
v_lshlrev_b32 v64, 7, v0
v_and_b32 v66, 127, v0
v_lshlrev_b32 v66, 7, v66
v_lshrrev_b32 v64, 7, v0
v_lshl_add_u32 v64, v64, 21, v66
s_lshl_b32 s44, s2, 14
s_waitcnt lgkmcnt(0)
s_mov_b32 s40, s40
s_and_b32 s41, s41, 0xffff
s_mov_b32 s42, 4194304
s_mov_b32 s43, 0x20000
buffer_load_dword v65, v64, s[40:43], s44 offen
s_getpc_b64 s[40:41]
L_mod_pc:
s_sub_u32 s40, s40, L_mod_pc-mod_kernel
s_subb_u32 s41, s41, 0
s_and_b32 s41, s41, 0xffff
s_mov_b32 s42, L_text_end-mod_kernel
s_mov_b32 s43, 0x20000
s_lshr_b32 s44, s2, 3
s_lshl_b32 s44, s44, 14
v_lshlrev_b32 v64, 6, v0
buffer_load_dword v65, v64, s[40:43], s44 offen
s_waitcnt vmcnt(9)
s_mov_b32 s26, 0xbfb8aa3b
v_lshlrev_b32 v8, 16, v8
v_lshlrev_b32 v9, 16, v9
v_lshlrev_b32 v10, 16, v10
v_lshlrev_b32 v11, 16, v11
v_lshlrev_b32 v12, 16, v12
v_lshlrev_b32 v13, 16, v13
v_lshlrev_b32 v14, 16, v14
v_lshlrev_b32 v15, 16, v15
v_mul_f32 v56, s26, v8
v_mul_f32 v57, s26, v9
v_mul_f32 v58, s26, v10
v_mul_f32 v59, s26, v11
v_mul_f32 v60, s26, v12
v_mul_f32 v61, s26, v13
v_mul_f32 v62, s26, v14
v_mul_f32 v63, s26, v15
v_exp_f32 v56, v56
v_exp_f32 v57, v57
v_exp_f32 v58, v58
v_exp_f32 v59, v59
v_exp_f32 v60, v60
v_exp_f32 v61, v61
v_exp_f32 v62, v62
v_exp_f32 v63, v63
v_add_f32 v56, 1.0, v56
v_add_f32 v57, 1.0, v57
v_add_f32 v58, 1.0, v58
v_add_f32 v59, 1.0, v59
v_add_f32 v60, 1.0, v60
v_add_f32 v61, 1.0, v61
v_add_f32 v62, 1.0, v62
v_add_f32 v63, 1.0, v63
v_rcp_f32 v56, v56
v_rcp_f32 v57, v57
v_rcp_f32 v58, v58
v_rcp_f32 v59, v59
v_rcp_f32 v60, v60
v_rcp_f32 v61, v61
v_rcp_f32 v62, v62
v_rcp_f32 v63, v63
v_mul_f32 v8, v8, v56
v_mul_f32 v9, v9, v57
v_mul_f32 v10, v10, v58
v_mul_f32 v11, v11, v59
v_mul_f32 v12, v12, v60
v_mul_f32 v13, v13, v61
v_mul_f32 v14, v14, v62
v_mul_f32 v15, v15, v63
v_cvt_pk_bf16_f32 v8, 0, v8
v_cvt_pk_bf16_f32 v9, 0, v9
v_cvt_pk_bf16_f32 v10, 0, v10
v_cvt_pk_bf16_f32 v11, 0, v11
v_cvt_pk_bf16_f32 v12, 0, v12
v_cvt_pk_bf16_f32 v13, 0, v13
v_cvt_pk_bf16_f32 v14, 0, v14
v_cvt_pk_bf16_f32 v15, 0, v15
v_mov_b32 v48, 0
v_mov_b32 v49, 0
v_mov_b32 v50, 0
v_mov_b32 v51, 0
v_mov_b32 v52, 0
v_mov_b32 v53, 0
v_mov_b32 v54, 0
v_mov_b32 v55, 0
s_mov_b32 s27, 0xffff0000
v_lshl_add_u32 v58, v2, 3, v3
v_lshlrev_b32 v58, 8, v58
v_lshl_add_u32 v58, v4, 5, v58
v_lshlrev_b32 v59, 11, v2
v_lshl_add_u32 v59, v1, 2, v59
v_lshlrev_b32 v60, 8, v2
v_lshl_add_u32 v60, v1, 2, v60
v_lshlrev_b32 v61, 2, v1
v_lshlrev_b32 v56, 16, v16
v_and_b32 v57, s27, v16
v_fmac_f32 v48, v8, v56
v_fmac_f32 v49, v8, v57
v_lshlrev_b32 v56, 16, v17
v_and_b32 v57, s27, v17
v_fmac_f32 v50, v8, v56
v_fmac_f32 v51, v8, v57
v_lshlrev_b32 v56, 16, v18
v_and_b32 v57, s27, v18
v_fmac_f32 v52, v8, v56
v_fmac_f32 v53, v8, v57
v_lshlrev_b32 v56, 16, v19
v_and_b32 v57, s27, v19
v_fmac_f32 v54, v8, v56
v_fmac_f32 v55, v8, v57
s_waitcnt vmcnt(8)
v_lshlrev_b32 v56, 16, v20
v_and_b32 v57, s27, v20
v_fmac_f32 v48, v9, v56
v_fmac_f32 v49, v9, v57
v_lshlrev_b32 v56, 16, v21
v_and_b32 v57, s27, v21
v_fmac_f32 v50, v9, v56
v_fmac_f32 v51, v9, v57
v_lshlrev_b32 v56, 16, v22
v_and_b32 v57, s27, v22
v_fmac_f32 v52, v9, v56
v_fmac_f32 v53, v9, v57
v_lshlrev_b32 v56, 16, v23
v_and_b32 v57, s27, v23
v_fmac_f32 v54, v9, v56
v_fmac_f32 v55, v9, v57
s_waitcnt vmcnt(7)
v_lshlrev_b32 v56, 16, v24
v_and_b32 v57, s27, v24
v_fmac_f32 v48, v10, v56
v_fmac_f32 v49, v10, v57
v_lshlrev_b32 v56, 16, v25
v_and_b32 v57, s27, v25
v_fmac_f32 v50, v10, v56
v_fmac_f32 v51, v10, v57
v_lshlrev_b32 v56, 16, v26
v_and_b32 v57, s27, v26
v_fmac_f32 v52, v10, v56
v_fmac_f32 v53, v10, v57
v_lshlrev_b32 v56, 16, v27
v_and_b32 v57, s27, v27
v_fmac_f32 v54, v10, v56
v_fmac_f32 v55, v10, v57
s_waitcnt vmcnt(6)
v_lshlrev_b32 v56, 16, v28
v_and_b32 v57, s27, v28
v_fmac_f32 v48, v11, v56
v_fmac_f32 v49, v11, v57
v_lshlrev_b32 v56, 16, v29
v_and_b32 v57, s27, v29
v_fmac_f32 v50, v11, v56
v_fmac_f32 v51, v11, v57
v_lshlrev_b32 v56, 16, v30
v_and_b32 v57, s27, v30
v_fmac_f32 v52, v11, v56
v_fmac_f32 v53, v11, v57
v_lshlrev_b32 v56, 16, v31
v_and_b32 v57, s27, v31
v_fmac_f32 v54, v11, v56
v_fmac_f32 v55, v11, v57
s_waitcnt vmcnt(5)
v_lshlrev_b32 v56, 16, v32
v_and_b32 v57, s27, v32
v_fmac_f32 v48, v12, v56
v_fmac_f32 v49, v12, v57
v_lshlrev_b32 v56, 16, v33
v_and_b32 v57, s27, v33
v_fmac_f32 v50, v12, v56
v_fmac_f32 v51, v12, v57
v_lshlrev_b32 v56, 16, v34
v_and_b32 v57, s27, v34
v_fmac_f32 v52, v12, v56
v_fmac_f32 v53, v12, v57
v_lshlrev_b32 v56, 16, v35
v_and_b32 v57, s27, v35
v_fmac_f32 v54, v12, v56
v_fmac_f32 v55, v12, v57
s_waitcnt vmcnt(4)
v_lshlrev_b32 v56, 16, v36
v_and_b32 v57, s27, v36
v_fmac_f32 v48, v13, v56
v_fmac_f32 v49, v13, v57
v_lshlrev_b32 v56, 16, v37
v_and_b32 v57, s27, v37
v_fmac_f32 v50, v13, v56
v_fmac_f32 v51, v13, v57
v_lshlrev_b32 v56, 16, v38
v_and_b32 v57, s27, v38
v_fmac_f32 v52, v13, v56
v_fmac_f32 v53, v13, v57
v_lshlrev_b32 v56, 16, v39
v_and_b32 v57, s27, v39
v_fmac_f32 v54, v13, v56
v_fmac_f32 v55, v13, v57
s_waitcnt vmcnt(3)
v_lshlrev_b32 v56, 16, v40
v_and_b32 v57, s27, v40
v_fmac_f32 v48, v14, v56
v_fmac_f32 v49, v14, v57
v_lshlrev_b32 v56, 16, v41
v_and_b32 v57, s27, v41
v_fmac_f32 v50, v14, v56
v_fmac_f32 v51, v14, v57
v_lshlrev_b32 v56, 16, v42
v_and_b32 v57, s27, v42
v_fmac_f32 v52, v14, v56
v_fmac_f32 v53, v14, v57
v_lshlrev_b32 v56, 16, v43
v_and_b32 v57, s27, v43
v_fmac_f32 v54, v14, v56
v_fmac_f32 v55, v14, v57
s_waitcnt vmcnt(2)
v_lshlrev_b32 v56, 16, v44
v_and_b32 v57, s27, v44
v_fmac_f32 v48, v15, v56
v_fmac_f32 v49, v15, v57
v_lshlrev_b32 v56, 16, v45
v_and_b32 v57, s27, v45
v_fmac_f32 v50, v15, v56
v_fmac_f32 v51, v15, v57
v_lshlrev_b32 v56, 16, v46
v_and_b32 v57, s27, v46
v_fmac_f32 v52, v15, v56
v_fmac_f32 v53, v15, v57
v_lshlrev_b32 v56, 16, v47
v_and_b32 v57, s27, v47
v_fmac_f32 v54, v15, v56
v_fmac_f32 v55, v15, v57
ds_write_b128 v58, v[48:51]
ds_write_b128 v58, v[52:55] offset:16
s_waitcnt lgkmcnt(0)
s_barrier
v_readfirstlane_b32 s28, v2
s_cmp_lg_u32 s28, 0
s_cbranch_scc1 L_mod_end
ds_read_b32 v16, v61 offset:0
ds_read_b32 v17, v61 offset:256
ds_read_b32 v18, v61 offset:512
ds_read_b32 v19, v61 offset:768
ds_read_b32 v20, v61 offset:1024
ds_read_b32 v21, v61 offset:1280
ds_read_b32 v22, v61 offset:1536
ds_read_b32 v23, v61 offset:1792
ds_read_b32 v24, v61 offset:2048
ds_read_b32 v25, v61 offset:2304
ds_read_b32 v26, v61 offset:2560
ds_read_b32 v27, v61 offset:2816
ds_read_b32 v28, v61 offset:3072
ds_read_b32 v29, v61 offset:3328
ds_read_b32 v30, v61 offset:3584
ds_read_b32 v31, v61 offset:3840
ds_read_b32 v32, v61 offset:4096
ds_read_b32 v33, v61 offset:4352
ds_read_b32 v34, v61 offset:4608
ds_read_b32 v35, v61 offset:4864
ds_read_b32 v36, v61 offset:5120
ds_read_b32 v37, v61 offset:5376
ds_read_b32 v38, v61 offset:5632
ds_read_b32 v39, v61 offset:5888
ds_read_b32 v40, v61 offset:6144
ds_read_b32 v41, v61 offset:6400
ds_read_b32 v42, v61 offset:6656
ds_read_b32 v43, v61 offset:6912
ds_read_b32 v44, v61 offset:7168
ds_read_b32 v45, v61 offset:7424
ds_read_b32 v46, v61 offset:7680
ds_read_b32 v47, v61 offset:7936
s_waitcnt lgkmcnt(0)
v_add_f32 v16, v16, v20
v_add_f32 v17, v17, v21
v_add_f32 v18, v18, v22
v_add_f32 v19, v19, v23
v_add_f32 v16, v16, v24
v_add_f32 v17, v17, v25
v_add_f32 v18, v18, v26
v_add_f32 v19, v19, v27
v_add_f32 v16, v16, v28
v_add_f32 v17, v17, v29
v_add_f32 v18, v18, v30
v_add_f32 v19, v19, v31
v_add_f32 v16, v16, v32
v_add_f32 v17, v17, v33
v_add_f32 v18, v18, v34
v_add_f32 v19, v19, v35
v_add_f32 v16, v16, v36
v_add_f32 v17, v17, v37
v_add_f32 v18, v18, v38
v_add_f32 v19, v19, v39
v_add_f32 v16, v16, v40
v_add_f32 v17, v17, v41
v_add_f32 v18, v18, v42
v_add_f32 v19, v19, v43
v_add_f32 v16, v16, v44
v_add_f32 v17, v17, v45
v_add_f32 v18, v18, v46
v_add_f32 v19, v19, v47
v_add_f32 v16, v16, v17
v_add_f32 v18, v18, v19
v_add_f32 v16, v16, v18
s_mul_i32 s25, s30, 24576
s_lshl_b32 s26, s31, 8
s_add_u32 s25, s25, s26
buffer_store_dword v16, v61, s[20:23], s25 offen sc1
s_add_u32 s32, s8, 196608
s_addc_u32 s33, s9, 0
s_and_b32 s33, s33, 0xffff
s_mov_b32 s34, 65536
s_mov_b32 s35, 0x20000
v_mov_b32 v63, 0
v_lshrrev_b32 v62, 2, v1
v_lshlrev_b32 v62, 7, v62
v_and_b32 v60, 3, v1
v_lshl_add_u32 v62, v60, 2, v62
s_lshl_b32 s25, s2, 11
buffer_store_dword v63, v62, s[32:35], s25 offen sc1
L_mod_end:
s_endpgm
.text
.globl lna_kernel
.p2align 8
.type lna_kernel,@function
lna_kernel:
s_cmp_ge_u32 s2, 256
s_cbranch_scc1 L_lna_end
s_load_dwordx2 s[4:5], s[0:1], 0
s_load_dwordx2 s[8:9], s[0:1], 104
v_and_b32 v1, 63, v0
v_lshrrev_b32 v2, 6, v0
v_and_b32 v3, 7, v1
v_lshrrev_b32 v4, 3, v1
s_lshr_b32 s24, s2, 2
s_lshl_b32 s24, s24, 16
s_and_b32 s25, s2, 3
s_lshl_b32 s25, s25, 7
s_add_u32 s24, s24, s25
v_lshrrev_b32 v6, 1, v4
v_lshl_add_u32 v6, v2, 3, v6
v_lshlrev_b32 v5, 10, v6
v_and_b32 v6, 1, v4
v_lshl_add_u32 v5, v6, 9, v5
v_lshl_add_u32 v5, v3, 4, v5
s_add_u32 s29, s24, 4096
v_lshl_add_u32 v7, v2, 4, v4
s_lshl_b32 s26, s2, 14
v_lshlrev_b32 v9, 11, v3
v_lshl_add_u32 v8, v7, 4, v9
v_lshlrev_b32 v10, 4, v0
s_waitcnt lgkmcnt(0)
s_mov_b32 s12, s4
s_and_b32 s13, s5, 0xffff
s_mov_b32 s14, 4194304
s_mov_b32 s15, 0x20000
buffer_load_dwordx4 v[16:19], v8, s[12:15], s26 offen offset:0
buffer_load_dwordx4 v[20:23], v8, s[12:15], s26 offen offset:128
buffer_load_ushort v11, v9, s[12:15], s26 offen
s_add_u32 s16, s8, 65536
s_addc_u32 s17, s9, 0
s_and_b32 s17, s17, 0xffff
s_mov_b32 s18, 98304
s_mov_b32 s19, 0x20000
s_movk_i32 s30, 24576
s_mov_b32 s31, 49152
s_mov_b32 s32, 73728
buffer_load_dwordx4 v[64:67], v10, s[16:19], 0 offen
buffer_load_dwordx4 v[68:71], v10, s[16:19], s30 offen
buffer_load_dwordx4 v[72:75], v10, s[16:19], s31 offen
buffer_load_dwordx4 v[76:79], v10, s[16:19], s32 offen
s_load_dwordx2 s[40:41], s[0:1], 24
v_lshrrev_b32 v12, 4, v0
v_lshlrev_b32 v12, 13, v12
v_and_b32 v6, 15, v0
v_lshl_add_u32 v12, v6, 6, v12
s_and_b32 s33, s2, 7
s_lshl_b32 s33, s33, 10
s_lshr_b32 s35, s2, 3
s_lshl_b32 s35, s35, 18
s_add_u32 s33, s33, s35
s_waitcnt lgkmcnt(0)
s_mov_b32 s36, s40
s_and_b32 s37, s41, 0xffff
s_mov_b32 s38, 8388608
s_mov_b32 s39, 0x20000
buffer_load_dword v159, v12, s[36:39], s33 offen nt
s_add_u32 s20, s8, 1048576
s_addc_u32 s21, s9, 0
s_and_b32 s21, s21, 0xffff
s_mov_b32 s22, 4194304
s_mov_b32 s23, 0x20000
s_mov_b32 s34, 0xffff0000
v_lshlrev_b32 v13, 6, v3
v_lshl_add_u32 v14, v2, 3, v13
v_lshlrev_b32 v15, 5, v7
v_cmp_lt_u32 vcc, 255, v0
s_waitcnt vmcnt(5)
v_lshlrev_b32 v11, 16, v11
v_lshlrev_b32 v32, 16, v16
v_and_b32 v33, s34, v16
v_lshlrev_b32 v34, 16, v17
v_and_b32 v35, s34, v17
v_lshlrev_b32 v36, 16, v18
v_and_b32 v37, s34, v18
v_lshlrev_b32 v38, 16, v19
v_and_b32 v39, s34, v19
v_lshlrev_b32 v40, 16, v20
v_and_b32 v41, s34, v20
v_lshlrev_b32 v42, 16, v21
v_and_b32 v43, s34, v21
v_lshlrev_b32 v44, 16, v22
v_and_b32 v45, s34, v22
v_lshlrev_b32 v46, 16, v23
v_and_b32 v47, s34, v23
v_sub_f32 v48, v32, v11
v_sub_f32 v49, v33, v11
v_sub_f32 v50, v34, v11
v_sub_f32 v51, v35, v11
v_sub_f32 v52, v36, v11
v_sub_f32 v53, v37, v11
v_sub_f32 v54, v38, v11
v_sub_f32 v55, v39, v11
v_sub_f32 v56, v40, v11
v_sub_f32 v57, v41, v11
v_sub_f32 v58, v42, v11
v_sub_f32 v59, v43, v11
v_sub_f32 v60, v44, v11
v_sub_f32 v61, v45, v11
v_sub_f32 v62, v46, v11
v_sub_f32 v63, v47, v11
v_add_f32 v24, v48, v49
v_add_f32 v25, v50, v51
v_mul_f32 v26, v48, v48
v_mul_f32 v27, v49, v49
v_fmac_f32 v26, v50, v50
v_fmac_f32 v27, v51, v51
v_fmac_f32 v26, v52, v52
v_fmac_f32 v27, v53, v53
v_fmac_f32 v26, v54, v54
v_fmac_f32 v27, v55, v55
v_fmac_f32 v26, v56, v56
v_fmac_f32 v27, v57, v57
v_fmac_f32 v26, v58, v58
v_fmac_f32 v27, v59, v59
v_fmac_f32 v26, v60, v60
v_fmac_f32 v27, v61, v61
v_fmac_f32 v26, v62, v62
v_fmac_f32 v27, v63, v63
v_add_f32 v24, v24, v52
v_add_f32 v25, v25, v53
v_add_f32 v24, v24, v54
v_add_f32 v25, v25, v55
v_add_f32 v24, v24, v56
v_add_f32 v25, v25, v57
v_add_f32 v24, v24, v58
v_add_f32 v25, v25, v59
v_add_f32 v24, v24, v60
v_add_f32 v25, v25, v61
v_add_f32 v24, v24, v62
v_add_f32 v25, v25, v63
v_add_f32 v24, v24, v25
v_add_f32 v25, v26, v27
s_nop 1
v_add_f32_dpp v24, v24, v24 row_ror:8 row_mask:0xf bank_mask:0xf
v_add_f32_dpp v25, v25, v25 row_ror:8 row_mask:0xf bank_mask:0xf
v_mov_b32 v26, v24
v_mov_b32 v27, v25
s_nop 1
v_permlane16_swap_b32 v24, v26
v_permlane16_swap_b32 v25, v27
s_nop 1
v_add_f32 v24, v24, v26
v_add_f32 v25, v25, v27
v_mov_b32 v26, v24
v_mov_b32 v27, v25
s_nop 1
v_permlane32_swap_b32 v24, v26
v_permlane32_swap_b32 v25, v27
s_nop 1
v_add_f32 v24, v24, v26
v_add_f32 v25, v25, v27
ds_write_b64 v14, v[24:25] offset:8192
s_waitcnt vmcnt(1)
v_add_f32 v64, v64, v68
v_add_f32 v72, v72, v76
v_add_f32 v65, v65, v69
v_add_f32 v73, v73, v77
v_add_f32 v66, v66, v70
v_add_f32 v74, v74, v78
v_add_f32 v67, v67, v71
v_add_f32 v75, v75, v79
v_add_f32 v64, v64, v72
v_add_f32 v65, v65, v73
v_add_f32 v66, v66, v74
v_add_f32 v67, v67, v75
v_cvt_pk_bf16_f32 v64, 0, v64
v_cvt_pk_bf16_f32 v65, 0, v65
v_cvt_pk_bf16_f32 v66, 0, v66
v_cvt_pk_bf16_f32 v67, 0, v67
v_add_f32 v68, 1.0, v64
v_add_f32 v69, 1.0, v65
v_add_f32 v70, 1.0, v66
v_add_f32 v71, 1.0, v67
v_cvt_pk_bf16_f32 v68, 0, v68
v_cvt_pk_bf16_f32 v69, 0, v69
v_cvt_pk_bf16_f32 v70, 0, v70
v_cvt_pk_bf16_f32 v71, 0, v71
v_cndmask_b32 v64, v64, v68, vcc
v_cndmask_b32 v65, v65, v69, vcc
v_cndmask_b32 v66, v66, v70, vcc
v_cndmask_b32 v67, v67, v71, vcc
ds_write_b128 v10, v[64:67]
s_waitcnt lgkmcnt(0)
s_barrier
ds_read_b128 v[48:51], v13 offset:8192
ds_read_b128 v[52:55], v13 offset:8208
ds_read_b128 v[56:59], v13 offset:8224
ds_read_b128 v[60:63], v13 offset:8240
ds_read_b128 v[112:115], v15 offset:4096
ds_read_b128 v[96:99], v15 offset:0
ds_read_b128 v[116:119], v15 offset:4112
ds_read_b128 v[100:103], v15 offset:16
ds_read_b128 v[120:123], v15 offset:4352
ds_read_b128 v[104:107], v15 offset:256
ds_read_b128 v[124:127], v15 offset:4368
ds_read_b128 v[108:111], v15 offset:272
s_waitcnt lgkmcnt(8)
v_add_f32 v48, v48, v52
v_add_f32 v49, v49, v53
v_add_f32 v50, v50, v54
v_add_f32 v51, v51, v55
v_add_f32 v48, v48, v56
v_add_f32 v49, v49, v57
v_add_f32 v50, v50, v58
v_add_f32 v51, v51, v59
v_add_f32 v48, v48, v60
v_add_f32 v49, v49, v61
v_add_f32 v50, v50, v62
v_add_f32 v51, v51, v63
v_add_f32 v48, v48, v50
v_add_f32 v49, v49, v51
v_mul_f32 v48, 0x3a800000, v48
v_mul_f32 v49, 0x3a800000, v49
v_fma_f32 v49, -v48, v48, v49
v_max_f32 v49, 0, v49
v_add_f32 v48, v48, v11
v_cvt_pk_bf16_f32 v49, 0, v49
v_add_f32 v49, 0x3727c5ac, v49
v_cvt_pk_bf16_f32 v49, 0, v49
v_sqrt_f32 v49, v49
v_cvt_pk_bf16_f32 v48, 0, v48
v_cvt_pk_bf16_f32 v49, 0, v49
v_rcp_f32 v49, v49
v_sub_f32 v32, v32, v48
v_sub_f32 v33, v33, v48
v_sub_f32 v34, v34, v48
v_sub_f32 v35, v35, v48
v_sub_f32 v36, v36, v48
v_sub_f32 v37, v37, v48
v_sub_f32 v38, v38, v48
v_sub_f32 v39, v39, v48
v_sub_f32 v40, v40, v48
v_sub_f32 v41, v41, v48
v_sub_f32 v42, v42, v48
v_sub_f32 v43, v43, v48
v_sub_f32 v44, v44, v48
v_sub_f32 v45, v45, v48
v_sub_f32 v46, v46, v48
v_sub_f32 v47, v47, v48
v_cvt_pk_bf16_f32 v32, 0, v32
v_cvt_pk_bf16_f32 v33, 0, v33
v_cvt_pk_bf16_f32 v34, 0, v34
v_cvt_pk_bf16_f32 v35, 0, v35
v_cvt_pk_bf16_f32 v36, 0, v36
v_cvt_pk_bf16_f32 v37, 0, v37
v_cvt_pk_bf16_f32 v38, 0, v38
v_cvt_pk_bf16_f32 v39, 0, v39
v_cvt_pk_bf16_f32 v40, 0, v40
v_cvt_pk_bf16_f32 v41, 0, v41
v_cvt_pk_bf16_f32 v42, 0, v42
v_cvt_pk_bf16_f32 v43, 0, v43
v_cvt_pk_bf16_f32 v44, 0, v44
v_cvt_pk_bf16_f32 v45, 0, v45
v_cvt_pk_bf16_f32 v46, 0, v46
v_cvt_pk_bf16_f32 v47, 0, v47
v_mul_f32 v32, v32, v49
v_mul_f32 v33, v33, v49
v_mul_f32 v34, v34, v49
v_mul_f32 v35, v35, v49
v_mul_f32 v36, v36, v49
v_mul_f32 v37, v37, v49
v_mul_f32 v38, v38, v49
v_mul_f32 v39, v39, v49
v_mul_f32 v40, v40, v49
v_mul_f32 v41, v41, v49
v_mul_f32 v42, v42, v49
v_mul_f32 v43, v43, v49
v_mul_f32 v44, v44, v49
v_mul_f32 v45, v45, v49
v_mul_f32 v46, v46, v49
v_mul_f32 v47, v47, v49
v_cvt_pk_bf16_f32 v32, 0, v32
v_cvt_pk_bf16_f32 v33, 0, v33
v_cvt_pk_bf16_f32 v34, 0, v34
v_cvt_pk_bf16_f32 v35, 0, v35
v_cvt_pk_bf16_f32 v36, 0, v36
v_cvt_pk_bf16_f32 v37, 0, v37
v_cvt_pk_bf16_f32 v38, 0, v38
v_cvt_pk_bf16_f32 v39, 0, v39
v_cvt_pk_bf16_f32 v40, 0, v40
v_cvt_pk_bf16_f32 v41, 0, v41
v_cvt_pk_bf16_f32 v42, 0, v42
v_cvt_pk_bf16_f32 v43, 0, v43
v_cvt_pk_bf16_f32 v44, 0, v44
v_cvt_pk_bf16_f32 v45, 0, v45
v_cvt_pk_bf16_f32 v46, 0, v46
v_cvt_pk_bf16_f32 v47, 0, v47
s_waitcnt lgkmcnt(0)
v_mul_f32 v32, v32, v112
v_mul_f32 v33, v33, v113
v_mul_f32 v34, v34, v114
v_mul_f32 v35, v35, v115
v_mul_f32 v36, v36, v116
v_mul_f32 v37, v37, v117
v_mul_f32 v38, v38, v118
v_mul_f32 v39, v39, v119
v_mul_f32 v40, v40, v120
v_mul_f32 v41, v41, v121
v_mul_f32 v42, v42, v122
v_mul_f32 v43, v43, v123
v_mul_f32 v44, v44, v124
v_mul_f32 v45, v45, v125
v_mul_f32 v46, v46, v126
v_mul_f32 v47, v47, v127
v_cvt_pk_bf16_f32 v32, 0, v32
v_cvt_pk_bf16_f32 v33, 0, v33
v_cvt_pk_bf16_f32 v34, 0, v34
v_cvt_pk_bf16_f32 v35, 0, v35
v_cvt_pk_bf16_f32 v36, 0, v36
v_cvt_pk_bf16_f32 v37, 0, v37
v_cvt_pk_bf16_f32 v38, 0, v38
v_cvt_pk_bf16_f32 v39, 0, v39
v_cvt_pk_bf16_f32 v40, 0, v40
v_cvt_pk_bf16_f32 v41, 0, v41
v_cvt_pk_bf16_f32 v42, 0, v42
v_cvt_pk_bf16_f32 v43, 0, v43
v_cvt_pk_bf16_f32 v44, 0, v44
v_cvt_pk_bf16_f32 v45, 0, v45
v_cvt_pk_bf16_f32 v46, 0, v46
v_cvt_pk_bf16_f32 v47, 0, v47
v_add_f32 v32, v32, v96
v_add_f32 v33, v33, v97
v_add_f32 v34, v34, v98
v_add_f32 v35, v35, v99
v_add_f32 v36, v36, v100
v_add_f32 v37, v37, v101
v_add_f32 v38, v38, v102
v_add_f32 v39, v39, v103
v_add_f32 v40, v40, v104
v_add_f32 v41, v41, v105
v_add_f32 v42, v42, v106
v_add_f32 v43, v43, v107
v_add_f32 v44, v44, v108
v_add_f32 v45, v45, v109
v_add_f32 v46, v46, v110
v_add_f32 v47, v47, v111
v_cvt_pk_bf16_f32 v128, v32, v33
v_cvt_pk_bf16_f32 v129, v34, v35
v_cvt_pk_bf16_f32 v130, v36, v37
v_cvt_pk_bf16_f32 v131, v38, v39
v_cvt_pk_bf16_f32 v132, v40, v41
v_cvt_pk_bf16_f32 v133, v42, v43
v_cvt_pk_bf16_f32 v134, v44, v45
v_cvt_pk_bf16_f32 v135, v46, v47
buffer_store_dwordx4 v[128:131], v5, s[20:23], s24 offen sc1
buffer_store_dwordx4 v[132:135], v5, s[20:23], s29 offen sc1
L_lna_end:
s_endpgm
.text
.globl attn_kernel
.p2align 8
.type attn_kernel,@function
attn_kernel:
s_cmp_ge_u32 s2, 256
s_cbranch_scc1 L_attn_end
s_load_dwordx4 s[4:7], s[0:1], 8
s_load_dwordx2 s[8:9], s[0:1], 24
s_load_dwordx2 s[10:11], s[0:1], 104
v_and_b32 v179, 63, v0
v_lshrrev_b32 v188, 6, v0
v_lshlrev_b32 v178, 4, v179
v_readfirstlane_b32 s33, v188
s_and_b32 s30, s2, 7
s_lshr_b32 s31, s2, 3
s_lshl_b32 s34, s30, 2
s_lshr_b32 s36, s31, 3
s_add_u32 s34, s34, s36
s_and_b32 s35, s31, 7
s_lshl_b32 s37, s35, 3
s_lshl_b32 s36, s33, 1
s_add_u32 s37, s37, s36
s_lshl_b32 s40, s37, 16
s_add_u32 s41, s40, 65536
s_lshl_b32 s42, s34, 8
s_lshl_b32 s36, s33, 17
s_add_u32 s42, s42, s36
s_lshl_b32 s43, s33, 12
s_mov_b32 s38, s43
s_mov_b32 s44, s38
s_mov_b32 s45, s38
v_lshrrev_b32 v188, 4, v179
v_and_b32 v183, 15, v179
v_lshlrev_b32 v183, 4, v183
v_lshl_add_u32 v183, v188, 9, v183
v_lshrrev_b32 v188, 4, v179
v_and_b32 v189, 15, v179
v_lshlrev_b32 v190, 1, v188
v_xor_b32 v190, v190, v189
v_lshlrev_b32 v190, 4, v190
v_lshl_add_u32 v170, v188, 13, v190
v_add_u32 v171, 31744, v170
v_xor_b32 v172, 128, v170
v_add_u32 v173, 95232, v172
v_add_u32 v172, 63488, v172
s_waitcnt lgkmcnt(0)
s_mov_b32 s20, s8
s_and_b32 s21, s9, 0xffff
s_mov_b32 s22, 8388608
s_mov_b32 s23, 0x20000
s_add_u32 s24, s10, 1048576
s_addc_u32 s25, s11, 0
s_and_b32 s25, s25, 0xffff
s_mov_b32 s26, 4194304
s_mov_b32 s27, 0x20000
s_add_u32 m0, s43, 98304
s_nop 0
buffer_load_dwordx4 v170, s[20:23], s42 offen offset:0 nt lds
buffer_load_dwordx4 v171, s[20:23], s42 offen offset:1024 nt lds
buffer_load_dwordx4 v172, s[20:23], s42 offen offset:2048 nt lds
buffer_load_dwordx4 v173, s[20:23], s42 offen offset:3072 nt lds
s_add_u32 s42, s42, 524288
buffer_load_dwordx4 a[0:3], v183, s[24:27], s40 offen offset:0
buffer_load_dwordx4 a[4:7], v183, s[24:27], s40 offen offset:256
buffer_load_dwordx4 a[8:11], v183, s[24:27], s41 offen offset:0
buffer_load_dwordx4 a[12:15], v183, s[24:27], s41 offen offset:256
buffer_load_dwordx4 a[16:19], v183, s[24:27], s40 offen offset:2048
buffer_load_dwordx4 a[20:23], v183, s[24:27], s40 offen offset:2304
s_add_u32 s40, s40, 4096
buffer_load_dwordx4 a[24:27], v183, s[24:27], s41 offen offset:2048
buffer_load_dwordx4 a[28:31], v183, s[24:27], s41 offen offset:2304
s_add_u32 s41, s41, 4096
s_load_dwordx2 s[84:85], s[0:1], 32
s_load_dwordx4 s[56:59], s[0:1], 48
s_load_dwordx2 s[52:53], s[0:1], 64
s_load_dwordx4 s[88:91], s[0:1], 72
s_lshl_b32 s36, s34, 19
s_add_u32 s12, s4, s36
s_addc_u32 s13, s5, 0
s_and_b32 s13, s13, 0xffff
s_mov_b32 s14, 524288
s_mov_b32 s15, 0x20000
s_add_u32 s16, s6, s36
s_addc_u32 s17, s7, 0
s_and_b32 s17, s17, 0xffff
s_mov_b32 s18, 524288
s_mov_b32 s19, 0x20000
s_add_u32 s48, s10, 8388608
s_addc_u32 s49, s11, 0
s_and_b32 s49, s49, 0xffff
s_mov_b32 s50, 16842752
s_mov_b32 s51, 0x20000
v_or_b32 v190, 0, v188
v_xor_b32 v190, v190, v189
v_lshlrev_b32 v190, 4, v190
v_lshl_add_u32 v164, v188, 8, v190
v_or_b32 v190, 4, v188
v_xor_b32 v190, v190, v189
v_lshlrev_b32 v190, 4, v190
v_lshl_add_u32 v165, v188, 8, v190
v_or_b32 v190, 8, v188
v_xor_b32 v190, v190, v189
v_lshlrev_b32 v190, 4, v190
v_lshl_add_u32 v166, v188, 8, v190
v_or_b32 v190, 12, v188
v_xor_b32 v190, v190, v189
v_lshlrev_b32 v190, 4, v190
v_lshl_add_u32 v167, v188, 8, v190
v_or_b32 v190, 0, v188
v_lshlrev_b32 v190, 1, v190
v_xor_b32 v190, v190, v189
v_lshlrev_b32 v190, 4, v190
v_lshl_add_u32 v168, v188, 8, v190
v_or_b32 v190, 4, v188
v_lshlrev_b32 v190, 1, v190
v_xor_b32 v190, v190, v189
v_lshlrev_b32 v190, 4, v190
v_lshl_add_u32 v169, v188, 8, v190
v_and_b32 v190, 1, v188
v_lshlrev_b32 v190, 1, v190
v_lshrrev_b32 v191, 1, v188
v_or_b32 v190, v190, v191
v_xor_b32 v190, v190, v189
v_xor_b32 v191, 0, v190
v_lshlrev_b32 v191, 4, v191
v_lshl_add_u32 v152, v189, 8, v191
v_xor_b32 v191, 4, v190
v_lshlrev_b32 v191, 4, v191
v_lshl_add_u32 v153, v189, 8, v191
v_xor_b32 v191, 8, v190
v_lshlrev_b32 v191, 4, v191
v_lshl_add_u32 v154, v189, 8, v191
v_xor_b32 v191, 12, v190
v_lshlrev_b32 v191, 4, v191
v_lshl_add_u32 v155, v189, 8, v191
v_lshrrev_b32 v190, 2, v179
v_and_b32 v191, 7, v190
v_and_b32 v192, 3, v179
v_lshlrev_b32 v192, 3, v192
v_lshl_add_u32 v192, v190, 8, v192
v_add_u32 v192, 65536, v192
v_xor_b32 v193, 0, v191
v_lshl_add_u32 v156, v193, 5, v192
v_xor_b32 v193, 1, v191
v_lshl_add_u32 v157, v193, 5, v192
v_xor_b32 v193, 2, v191
v_lshl_add_u32 v158, v193, 5, v192
v_xor_b32 v193, 3, v191
v_lshl_add_u32 v159, v193, 5, v192
v_xor_b32 v193, 4, v191
v_lshl_add_u32 v160, v193, 5, v192
v_xor_b32 v193, 5, v191
v_lshl_add_u32 v161, v193, 5, v192
v_xor_b32 v193, 6, v191
v_lshl_add_u32 v162, v193, 5, v192
v_xor_b32 v193, 7, v191
v_lshl_add_u32 v163, v193, 5, v192
v_lshrrev_b32 v188, 4, v179
v_bfe_u32 v189, v179, 2, 2
v_lshl_add_u32 v190, v188, 3, v189
v_and_b32 v191, 3, v179
v_lshlrev_b32 v191, 3, v191
v_lshl_add_u32 v190, v190, 8, v191
v_add_u32 v190, 98304, v190
v_bfe_u32 v191, v179, 2, 3
v_xor_b32 v192, 0, v191
v_lshl_add_u32 v200, v192, 5, v190
v_xor_b32 v192, 1, v191
v_lshl_add_u32 v201, v192, 5, v190
v_xor_b32 v192, 2, v191
v_lshl_add_u32 v202, v192, 5, v190
v_xor_b32 v192, 3, v191
v_lshl_add_u32 v203, v192, 5, v190
v_xor_b32 v192, 4, v191
v_lshl_add_u32 v204, v192, 5, v190
v_xor_b32 v192, 5, v191
v_lshl_add_u32 v205, v192, 5, v190
v_xor_b32 v192, 6, v191
v_lshl_add_u32 v206, v192, 5, v190
v_xor_b32 v192, 7, v191
v_lshl_add_u32 v207, v192, 5, v190
s_waitcnt lgkmcnt(0)
s_cmp_eq_u32 s33, 1
s_cselect_b32 s84, s56, s84
s_cselect_b32 s85, s57, s85
s_cmp_eq_u32 s33, 2
s_cselect_b32 s84, s58, s84
s_cselect_b32 s85, s59, s85
s_cmp_eq_u32 s33, 3
s_cselect_b32 s84, s52, s84
s_cselect_b32 s85, s53, s85
s_and_b32 s85, s85, 0xffff
s_cmp_eq_u32 s33, 0
s_mov_b32 s36, 7340032
s_cselect_b32 s86, 8388608, s36
s_mov_b32 s87, 0x20000
v_lshrrev_b32 v182, 2, v179
v_lshlrev_b32 v182, 7, v182
s_lshl_b32 s69, s2, 11
s_mov_b32 s56, s88
s_and_b32 s57, s89, 0xffff
s_mov_b32 s58, 2048
s_mov_b32 s59, 0x20000
s_mov_b32 s60, s90
s_and_b32 s61, s91, 0xffff
s_mov_b32 s62, 12582912
s_mov_b32 s63, 0x20000
s_mov_b32 s64, 0x3e0293ee
s_mov_b32 s55, 0
v_mov_b32 v128, 0
v_mov_b32 v129, 0
v_mov_b32 v130, 0
v_mov_b32 v131, 0
v_mov_b32 v132, 0
v_mov_b32 v133, 0
v_mov_b32 v134, 0
v_mov_b32 v135, 0
v_mov_b32 v136, 0
v_mov_b32 v137, 0
v_mov_b32 v138, 0
v_mov_b32 v139, 0
v_mov_b32 v140, 0
v_mov_b32 v141, 0
v_mov_b32 v142, 0
v_mov_b32 v143, 0
v_and_b32 v188, 3, v179
v_cmp_eq_u32 vcc, 0, v188
v_mov_b32 v189, 0x3f803f80
s_nop 0
v_cndmask_b32 v188, 0, v189, vcc
v_accvgpr_write_b32 a240, v188
v_accvgpr_write_b32 a241, v188
v_accvgpr_write_b32 a242, v188
v_accvgpr_write_b32 a243, v188
s_waitcnt vmcnt(8)
s_barrier
ds_read_b64_tr_b16 a[192:193], v200 offset:0
ds_read_b64_tr_b16 a[194:195], v200 offset:1024
ds_read_b64_tr_b16 a[196:197], v201 offset:0
ds_read_b64_tr_b16 a[198:199], v201 offset:1024
ds_read_b64_tr_b16 a[200:201], v202 offset:0
ds_read_b64_tr_b16 a[202:203], v202 offset:1024
ds_read_b64_tr_b16 a[204:205], v203 offset:0
ds_read_b64_tr_b16 a[206:207], v203 offset:1024
ds_read_b64_tr_b16 a[208:209], v204 offset:0
ds_read_b64_tr_b16 a[210:211], v204 offset:1024
ds_read_b64_tr_b16 a[212:213], v205 offset:0
ds_read_b64_tr_b16 a[214:215], v205 offset:1024
s_waitcnt vmcnt(4) lgkmcnt(8)
v_mfma_f32_16x16x32_bf16 v[0:3], a[192:195], a[0:3], 0
ds_read_b64_tr_b16 a[216:217], v206 offset:0
v_mfma_f32_16x16x32_bf16 v[32:35], a[192:195], a[4:7], 0
buffer_load_dwordx4 a[32:35], v183, s[24:27], s40 offen offset:0
v_mfma_f32_16x16x32_bf16 v[64:67], a[192:195], a[8:11], 0
ds_read_b64_tr_b16 a[218:219], v206 offset:1024
v_mfma_f32_16x16x32_bf16 v[96:99], a[192:195], a[12:15], 0
s_add_u32 m0, s43, 114688
v_mfma_f32_16x16x32_bf16 v[4:7], a[196:199], a[0:3], 0
ds_read_b64_tr_b16 a[220:221], v207 offset:0
v_mfma_f32_16x16x32_bf16 v[36:39], a[196:199], a[4:7], 0
buffer_load_dwordx4 v170, s[20:23], s42 offen offset:0 nt lds
v_mfma_f32_16x16x32_bf16 v[68:71], a[196:199], a[8:11], 0
ds_read_b64_tr_b16 a[222:223], v207 offset:1024
v_mfma_f32_16x16x32_bf16 v[100:103], a[196:199], a[12:15], 0
s_waitcnt lgkmcnt(8)
v_mfma_f32_16x16x32_bf16 v[8:11], a[200:203], a[0:3], 0
ds_read_b64_tr_b16 a[192:193], v200 offset:8192
v_mfma_f32_16x16x32_bf16 v[40:43], a[200:203], a[4:7], 0
buffer_load_dwordx4 v171, s[20:23], s42 offen offset:1024 nt lds
v_mfma_f32_16x16x32_bf16 v[72:75], a[200:203], a[8:11], 0
ds_read_b64_tr_b16 a[194:195], v200 offset:9216
v_mfma_f32_16x16x32_bf16 v[104:107], a[200:203], a[12:15], 0
v_mfma_f32_16x16x32_bf16 v[12:15], a[204:207], a[0:3], 0
ds_read_b64_tr_b16 a[196:197], v201 offset:8192
v_mfma_f32_16x16x32_bf16 v[44:47], a[204:207], a[4:7], 0
buffer_load_dwordx4 v172, s[20:23], s42 offen offset:2048 nt lds
v_mfma_f32_16x16x32_bf16 v[76:79], a[204:207], a[8:11], 0
ds_read_b64_tr_b16 a[198:199], v201 offset:9216
v_mfma_f32_16x16x32_bf16 v[108:111], a[204:207], a[12:15], 0
s_waitcnt lgkmcnt(8)
v_mfma_f32_16x16x32_bf16 v[16:19], a[208:211], a[0:3], 0
ds_read_b64_tr_b16 a[200:201], v202 offset:8192
v_mfma_f32_16x16x32_bf16 v[48:51], a[208:211], a[4:7], 0
buffer_load_dwordx4 v173, s[20:23], s42 offen offset:3072 nt lds
v_mfma_f32_16x16x32_bf16 v[80:83], a[208:211], a[8:11], 0
ds_read_b64_tr_b16 a[202:203], v202 offset:9216
v_mfma_f32_16x16x32_bf16 v[112:115], a[208:211], a[12:15], 0
s_add_u32 s42, s42, 524288
v_mfma_f32_16x16x32_bf16 v[20:23], a[212:215], a[0:3], 0
ds_read_b64_tr_b16 a[204:205], v203 offset:8192
v_mfma_f32_16x16x32_bf16 v[52:55], a[212:215], a[4:7], 0
buffer_load_dwordx4 a[36:39], v183, s[24:27], s40 offen offset:256
v_mfma_f32_16x16x32_bf16 v[84:87], a[212:215], a[8:11], 0
ds_read_b64_tr_b16 a[206:207], v203 offset:9216
v_mfma_f32_16x16x32_bf16 v[116:119], a[212:215], a[12:15], 0
s_waitcnt lgkmcnt(8)
v_mfma_f32_16x16x32_bf16 v[24:27], a[216:219], a[0:3], 0
ds_read_b64_tr_b16 a[208:209], v204 offset:8192
v_mfma_f32_16x16x32_bf16 v[56:59], a[216:219], a[4:7], 0
buffer_load_dwordx4 a[40:43], v183, s[24:27], s41 offen offset:0
v_mfma_f32_16x16x32_bf16 v[88:91], a[216:219], a[8:11], 0
ds_read_b64_tr_b16 a[210:211], v204 offset:9216
v_mfma_f32_16x16x32_bf16 v[120:123], a[216:219], a[12:15], 0
v_mfma_f32_16x16x32_bf16 v[28:31], a[220:223], a[0:3], 0
ds_read_b64_tr_b16 a[212:213], v205 offset:8192
v_mfma_f32_16x16x32_bf16 v[60:63], a[220:223], a[4:7], 0
buffer_load_dwordx4 a[44:47], v183, s[24:27], s41 offen offset:256
v_mfma_f32_16x16x32_bf16 v[92:95], a[220:223], a[8:11], 0
ds_read_b64_tr_b16 a[214:215], v205 offset:9216
v_mfma_f32_16x16x32_bf16 v[124:127], a[220:223], a[12:15], 0
s_waitcnt vmcnt(8) lgkmcnt(8)
v_mfma_f32_16x16x32_bf16 v[0:3], a[192:195], a[16:19], v[0:3]
ds_read_b64_tr_b16 a[216:217], v206 offset:8192
v_mfma_f32_16x16x32_bf16 v[32:35], a[192:195], a[20:23], v[32:35]
buffer_load_dwordx4 a[48:51], v183, s[24:27], s40 offen offset:2048
v_mfma_f32_16x16x32_bf16 v[64:67], a[192:195], a[24:27], v[64:67]
ds_read_b64_tr_b16 a[218:219], v206 offset:9216
v_mfma_f32_16x16x32_bf16 v[96:99], a[192:195], a[28:31], v[96:99]
v_mfma_f32_16x16x32_bf16 v[4:7], a[196:199], a[16:19], v[4:7]
ds_read_b64_tr_b16 a[220:221], v207 offset:8192
v_mfma_f32_16x16x32_bf16 v[36:39], a[196:199], a[20:23], v[36:39]
buffer_load_dwordx4 a[52:55], v183, s[24:27], s40 offen offset:2304
v_mfma_f32_16x16x32_bf16 v[68:71], a[196:199], a[24:27], v[68:71]
ds_read_b64_tr_b16 a[222:223], v207 offset:9216
v_mfma_f32_16x16x32_bf16 v[100:103], a[196:199], a[28:31], v[100:103]
s_waitcnt lgkmcnt(8)
s_waitcnt vmcnt(5)
s_barrier
s_add_u32 s40, s40, 4096
v_mfma_f32_16x16x32_bf16 v[8:11], a[200:203], a[16:19], v[8:11]
ds_read_b64_tr_b16 a[192:193], v200 offset:16384
v_mfma_f32_16x16x32_bf16 v[40:43], a[200:203], a[20:23], v[40:43]
buffer_load_dwordx4 a[56:59], v183, s[24:27], s41 offen offset:2048
v_mfma_f32_16x16x32_bf16 v[72:75], a[200:203], a[24:27], v[72:75]
ds_read_b64_tr_b16 a[194:195], v200 offset:17408
v_mfma_f32_16x16x32_bf16 v[104:107], a[200:203], a[28:31], v[104:107]
v_mfma_f32_16x16x32_bf16 v[12:15], a[204:207], a[16:19], v[12:15]
ds_read_b64_tr_b16 a[196:197], v201 offset:16384
v_mfma_f32_16x16x32_bf16 v[44:47], a[204:207], a[20:23], v[44:47]
buffer_load_dwordx4 a[60:63], v183, s[24:27], s41 offen offset:2304
v_mfma_f32_16x16x32_bf16 v[76:79], a[204:207], a[24:27], v[76:79]
ds_read_b64_tr_b16 a[198:199], v201 offset:17408
v_mfma_f32_16x16x32_bf16 v[108:111], a[204:207], a[28:31], v[108:111]
s_waitcnt lgkmcnt(8)
s_add_u32 s41, s41, 4096
s_add_u32 m0, s43, 131072
v_mfma_f32_16x16x32_bf16 v[16:19], a[208:211], a[16:19], v[16:19]
ds_read_b64_tr_b16 a[200:201], v202 offset:16384
v_mfma_f32_16x16x32_bf16 v[48:51], a[208:211], a[20:23], v[48:51]
buffer_load_dwordx4 v170, s[20:23], s42 offen offset:0 nt lds
v_mfma_f32_16x16x32_bf16 v[80:83], a[208:211], a[24:27], v[80:83]
ds_read_b64_tr_b16 a[202:203], v202 offset:17408
v_mfma_f32_16x16x32_bf16 v[112:115], a[208:211], a[28:31], v[112:115]
v_mfma_f32_16x16x32_bf16 v[20:23], a[212:215], a[16:19], v[20:23]
ds_read_b64_tr_b16 a[204:205], v203 offset:16384
v_mfma_f32_16x16x32_bf16 v[52:55], a[212:215], a[20:23], v[52:55]
buffer_load_dwordx4 v171, s[20:23], s42 offen offset:1024 nt lds
v_mfma_f32_16x16x32_bf16 v[84:87], a[212:215], a[24:27], v[84:87]
ds_read_b64_tr_b16 a[206:207], v203 offset:17408
v_mfma_f32_16x16x32_bf16 v[116:119], a[212:215], a[28:31], v[116:119]
s_waitcnt lgkmcnt(8)
v_mfma_f32_16x16x32_bf16 v[24:27], a[216:219], a[16:19], v[24:27]
ds_read_b64_tr_b16 a[208:209], v204 offset:16384
v_mfma_f32_16x16x32_bf16 v[56:59], a[216:219], a[20:23], v[56:59]
buffer_load_dwordx4 v172, s[20:23], s42 offen offset:2048 nt lds
v_mfma_f32_16x16x32_bf16 v[88:91], a[216:219], a[24:27], v[88:91]
ds_read_b64_tr_b16 a[210:211], v204 offset:17408
v_mfma_f32_16x16x32_bf16 v[120:123], a[216:219], a[28:31], v[120:123]
v_mfma_f32_16x16x32_bf16 v[28:31], a[220:223], a[16:19], v[28:31]
ds_read_b64_tr_b16 a[212:213], v205 offset:16384
v_mfma_f32_16x16x32_bf16 v[60:63], a[220:223], a[20:23], v[60:63]
buffer_load_dwordx4 v173, s[20:23], s42 offen offset:3072 nt lds
v_mfma_f32_16x16x32_bf16 v[92:95], a[220:223], a[24:27], v[92:95]
ds_read_b64_tr_b16 a[214:215], v205 offset:17408
v_mfma_f32_16x16x32_bf16 v[124:127], a[220:223], a[28:31], v[124:127]
s_waitcnt vmcnt(8) lgkmcnt(8)
s_add_u32 s42, s42, 524288
v_mfma_f32_16x16x32_bf16 v[0:3], a[192:195], a[32:35], v[0:3]
ds_read_b64_tr_b16 a[216:217], v206 offset:16384
v_mfma_f32_16x16x32_bf16 v[32:35], a[192:195], a[36:39], v[32:35]
buffer_load_dwordx4 a[64:67], v183, s[24:27], s40 offen offset:0
v_mfma_f32_16x16x32_bf16 v[64:67], a[192:195], a[40:43], v[64:67]
ds_read_b64_tr_b16 a[218:219], v206 offset:17408
v_mfma_f32_16x16x32_bf16 v[96:99], a[192:195], a[44:47], v[96:99]
v_mfma_f32_16x16x32_bf16 v[4:7], a[196:199], a[32:35], v[4:7]
ds_read_b64_tr_b16 a[220:221], v207 offset:16384
v_mfma_f32_16x16x32_bf16 v[36:39], a[196:199], a[36:39], v[36:39]
buffer_load_dwordx4 a[68:71], v183, s[24:27], s40 offen offset:256
v_mfma_f32_16x16x32_bf16 v[68:71], a[196:199], a[40:43], v[68:71]
ds_read_b64_tr_b16 a[222:223], v207 offset:17408
v_mfma_f32_16x16x32_bf16 v[100:103], a[196:199], a[44:47], v[100:103]
s_waitcnt lgkmcnt(8)
v_mfma_f32_16x16x32_bf16 v[8:11], a[200:203], a[32:35], v[8:11]
ds_read_b64_tr_b16 a[192:193], v200 offset:24576
v_mfma_f32_16x16x32_bf16 v[40:43], a[200:203], a[36:39], v[40:43]
buffer_load_dwordx4 a[72:75], v183, s[24:27], s41 offen offset:0
v_mfma_f32_16x16x32_bf16 v[72:75], a[200:203], a[40:43], v[72:75]
ds_read_b64_tr_b16 a[194:195], v200 offset:25600
v_mfma_f32_16x16x32_bf16 v[104:107], a[200:203], a[44:47], v[104:107]
v_mfma_f32_16x16x32_bf16 v[12:15], a[204:207], a[32:35], v[12:15]
ds_read_b64_tr_b16 a[196:197], v201 offset:24576
v_mfma_f32_16x16x32_bf16 v[44:47], a[204:207], a[36:39], v[44:47]
buffer_load_dwordx4 a[76:79], v183, s[24:27], s41 offen offset:256
v_mfma_f32_16x16x32_bf16 v[76:79], a[204:207], a[40:43], v[76:79]
ds_read_b64_tr_b16 a[198:199], v201 offset:25600
v_mfma_f32_16x16x32_bf16 v[108:111], a[204:207], a[44:47], v[108:111]
s_waitcnt lgkmcnt(8)
v_mfma_f32_16x16x32_bf16 v[16:19], a[208:211], a[32:35], v[16:19]
ds_read_b64_tr_b16 a[200:201], v202 offset:24576
v_mfma_f32_16x16x32_bf16 v[48:51], a[208:211], a[36:39], v[48:51]
buffer_load_dwordx4 a[80:83], v183, s[24:27], s40 offen offset:2048
v_mfma_f32_16x16x32_bf16 v[80:83], a[208:211], a[40:43], v[80:83]
ds_read_b64_tr_b16 a[202:203], v202 offset:25600
v_mfma_f32_16x16x32_bf16 v[112:115], a[208:211], a[44:47], v[112:115]
v_mfma_f32_16x16x32_bf16 v[20:23], a[212:215], a[32:35], v[20:23]
ds_read_b64_tr_b16 a[204:205], v203 offset:24576
v_mfma_f32_16x16x32_bf16 v[52:55], a[212:215], a[36:39], v[52:55]
buffer_load_dwordx4 a[84:87], v183, s[24:27], s40 offen offset:2304
v_mfma_f32_16x16x32_bf16 v[84:87], a[212:215], a[40:43], v[84:87]
ds_read_b64_tr_b16 a[206:207], v203 offset:25600
v_mfma_f32_16x16x32_bf16 v[116:119], a[212:215], a[44:47], v[116:119]
s_waitcnt lgkmcnt(8)
s_add_u32 s40, s40, 4096
v_mfma_f32_16x16x32_bf16 v[24:27], a[216:219], a[32:35], v[24:27]
ds_read_b64_tr_b16 a[208:209], v204 offset:24576
v_mfma_f32_16x16x32_bf16 v[56:59], a[216:219], a[36:39], v[56:59]
buffer_load_dwordx4 a[88:91], v183, s[24:27], s41 offen offset:2048
v_mfma_f32_16x16x32_bf16 v[88:91], a[216:219], a[40:43], v[88:91]
ds_read_b64_tr_b16 a[210:211], v204 offset:25600
v_mfma_f32_16x16x32_bf16 v[120:123], a[216:219], a[44:47], v[120:123]
v_mfma_f32_16x16x32_bf16 v[28:31], a[220:223], a[32:35], v[28:31]
ds_read_b64_tr_b16 a[212:213], v205 offset:24576
v_mfma_f32_16x16x32_bf16 v[60:63], a[220:223], a[36:39], v[60:63]
buffer_load_dwordx4 a[92:95], v183, s[24:27], s41 offen offset:2304
v_mfma_f32_16x16x32_bf16 v[92:95], a[220:223], a[40:43], v[92:95]
ds_read_b64_tr_b16 a[214:215], v205 offset:25600
v_mfma_f32_16x16x32_bf16 v[124:127], a[220:223], a[44:47], v[124:127]
s_waitcnt vmcnt(12) lgkmcnt(8)
s_add_u32 s41, s41, 4096
s_add_u32 m0, s43, 147456
v_mfma_f32_16x16x32_bf16 v[0:3], a[192:195], a[48:51], v[0:3]
ds_read_b64_tr_b16 a[216:217], v206 offset:24576
v_mfma_f32_16x16x32_bf16 v[32:35], a[192:195], a[52:55], v[32:35]
buffer_load_dwordx4 v170, s[20:23], s42 offen offset:0 nt lds
v_mfma_f32_16x16x32_bf16 v[64:67], a[192:195], a[56:59], v[64:67]
ds_read_b64_tr_b16 a[218:219], v206 offset:25600
v_mfma_f32_16x16x32_bf16 v[96:99], a[192:195], a[60:63], v[96:99]
v_mfma_f32_16x16x32_bf16 v[4:7], a[196:199], a[48:51], v[4:7]
ds_read_b64_tr_b16 a[220:221], v207 offset:24576
v_mfma_f32_16x16x32_bf16 v[36:39], a[196:199], a[52:55], v[36:39]
buffer_load_dwordx4 v171, s[20:23], s42 offen offset:1024 nt lds
v_mfma_f32_16x16x32_bf16 v[68:71], a[196:199], a[56:59], v[68:71]
ds_read_b64_tr_b16 a[222:223], v207 offset:25600
v_mfma_f32_16x16x32_bf16 v[100:103], a[196:199], a[60:63], v[100:103]
s_waitcnt lgkmcnt(8)
s_waitcnt vmcnt(10)
s_barrier
v_mfma_f32_16x16x32_bf16 v[8:11], a[200:203], a[48:51], v[8:11]
ds_read_b64_tr_b16 a[192:193], v200 offset:32768
v_mfma_f32_16x16x32_bf16 v[40:43], a[200:203], a[52:55], v[40:43]
buffer_load_dwordx4 v172, s[20:23], s42 offen offset:2048 nt lds
v_mfma_f32_16x16x32_bf16 v[72:75], a[200:203], a[56:59], v[72:75]
ds_read_b64_tr_b16 a[194:195], v200 offset:33792
v_mfma_f32_16x16x32_bf16 v[104:107], a[200:203], a[60:63], v[104:107]
v_mfma_f32_16x16x32_bf16 v[12:15], a[204:207], a[48:51], v[12:15]
ds_read_b64_tr_b16 a[196:197], v201 offset:32768
v_mfma_f32_16x16x32_bf16 v[44:47], a[204:207], a[52:55], v[44:47]
buffer_load_dwordx4 v173, s[20:23], s42 offen offset:3072 nt lds
v_mfma_f32_16x16x32_bf16 v[76:79], a[204:207], a[56:59], v[76:79]
ds_read_b64_tr_b16 a[198:199], v201 offset:33792
v_mfma_f32_16x16x32_bf16 v[108:111], a[204:207], a[60:63], v[108:111]
s_waitcnt lgkmcnt(8)
s_add_u32 s42, s42, 524288
v_mfma_f32_16x16x32_bf16 v[16:19], a[208:211], a[48:51], v[16:19]
ds_read_b64_tr_b16 a[200:201], v202 offset:32768
v_mfma_f32_16x16x32_bf16 v[48:51], a[208:211], a[52:55], v[48:51]
buffer_load_dwordx4 a[96:99], v183, s[24:27], s40 offen offset:0
v_mfma_f32_16x16x32_bf16 v[80:83], a[208:211], a[56:59], v[80:83]
ds_read_b64_tr_b16 a[202:203], v202 offset:33792
v_mfma_f32_16x16x32_bf16 v[112:115], a[208:211], a[60:63], v[112:115]
v_mfma_f32_16x16x32_bf16 v[20:23], a[212:215], a[48:51], v[20:23]
ds_read_b64_tr_b16 a[204:205], v203 offset:32768
v_mfma_f32_16x16x32_bf16 v[52:55], a[212:215], a[52:55], v[52:55]
buffer_load_dwordx4 a[100:103], v183, s[24:27], s40 offen offset:256
v_mfma_f32_16x16x32_bf16 v[84:87], a[212:215], a[56:59], v[84:87]
ds_read_b64_tr_b16 a[206:207], v203 offset:33792
v_mfma_f32_16x16x32_bf16 v[116:119], a[212:215], a[60:63], v[116:119]
s_waitcnt lgkmcnt(8)
v_mfma_f32_16x16x32_bf16 v[24:27], a[216:219], a[48:51], v[24:27]
ds_read_b64_tr_b16 a[208:209], v204 offset:32768
v_mfma_f32_16x16x32_bf16 v[56:59], a[216:219], a[52:55], v[56:59]
buffer_load_dwordx4 a[104:107], v183, s[24:27], s41 offen offset:0
v_mfma_f32_16x16x32_bf16 v[88:91], a[216:219], a[56:59], v[88:91]
ds_read_b64_tr_b16 a[210:211], v204 offset:33792
v_mfma_f32_16x16x32_bf16 v[120:123], a[216:219], a[60:63], v[120:123]
v_mfma_f32_16x16x32_bf16 v[28:31], a[220:223], a[48:51], v[28:31]
ds_read_b64_tr_b16 a[212:213], v205 offset:32768
v_mfma_f32_16x16x32_bf16 v[60:63], a[220:223], a[52:55], v[60:63]
buffer_load_dwordx4 a[108:111], v183, s[24:27], s41 offen offset:256
v_mfma_f32_16x16x32_bf16 v[92:95], a[220:223], a[56:59], v[92:95]
ds_read_b64_tr_b16 a[214:215], v205 offset:33792
v_mfma_f32_16x16x32_bf16 v[124:127], a[220:223], a[60:63], v[124:127]
s_waitcnt vmcnt(12) lgkmcnt(8)
v_mfma_f32_16x16x32_bf16 v[0:3], a[192:195], a[64:67], v[0:3]
ds_read_b64_tr_b16 a[216:217], v206 offset:32768
v_mfma_f32_16x16x32_bf16 v[32:35], a[192:195], a[68:71], v[32:35]
buffer_load_dwordx4 a[112:115], v183, s[24:27], s40 offen offset:2048
v_mfma_f32_16x16x32_bf16 v[64:67], a[192:195], a[72:75], v[64:67]
ds_read_b64_tr_b16 a[218:219], v206 offset:33792
v_mfma_f32_16x16x32_bf16 v[96:99], a[192:195], a[76:79], v[96:99]
v_mfma_f32_16x16x32_bf16 v[4:7], a[196:199], a[64:67], v[4:7]
ds_read_b64_tr_b16 a[220:221], v207 offset:32768
v_mfma_f32_16x16x32_bf16 v[36:39], a[196:199], a[68:71], v[36:39]
buffer_load_dwordx4 a[116:119], v183, s[24:27], s40 offen offset:2304
v_mfma_f32_16x16x32_bf16 v[68:71], a[196:199], a[72:75], v[68:71]
ds_read_b64_tr_b16 a[222:223], v207 offset:33792
v_mfma_f32_16x16x32_bf16 v[100:103], a[196:199], a[76:79], v[100:103]
s_waitcnt lgkmcnt(8)
s_add_u32 s40, s40, 4096
v_mfma_f32_16x16x32_bf16 v[8:11], a[200:203], a[64:67], v[8:11]
ds_read_b64_tr_b16 a[192:193], v200 offset:40960
v_mfma_f32_16x16x32_bf16 v[40:43], a[200:203], a[68:71], v[40:43]
buffer_load_dwordx4 a[120:123], v183, s[24:27], s41 offen offset:2048
v_mfma_f32_16x16x32_bf16 v[72:75], a[200:203], a[72:75], v[72:75]
ds_read_b64_tr_b16 a[194:195], v200 offset:41984
v_mfma_f32_16x16x32_bf16 v[104:107], a[200:203], a[76:79], v[104:107]
v_mfma_f32_16x16x32_bf16 v[12:15], a[204:207], a[64:67], v[12:15]
ds_read_b64_tr_b16 a[196:197], v201 offset:40960
v_mfma_f32_16x16x32_bf16 v[44:47], a[204:207], a[68:71], v[44:47]
buffer_load_dwordx4 a[124:127], v183, s[24:27], s41 offen offset:2304
v_mfma_f32_16x16x32_bf16 v[76:79], a[204:207], a[72:75], v[76:79]
ds_read_b64_tr_b16 a[198:199], v201 offset:41984
v_mfma_f32_16x16x32_bf16 v[108:111], a[204:207], a[76:79], v[108:111]
s_waitcnt lgkmcnt(8)
s_add_u32 s41, s41, 4096
s_add_u32 m0, s43, 98304
v_mfma_f32_16x16x32_bf16 v[16:19], a[208:211], a[64:67], v[16:19]
ds_read_b64_tr_b16 a[200:201], v202 offset:40960
v_mfma_f32_16x16x32_bf16 v[48:51], a[208:211], a[68:71], v[48:51]
buffer_load_dwordx4 v170, s[20:23], s42 offen offset:0 nt lds
v_mfma_f32_16x16x32_bf16 v[80:83], a[208:211], a[72:75], v[80:83]
ds_read_b64_tr_b16 a[202:203], v202 offset:41984
v_mfma_f32_16x16x32_bf16 v[112:115], a[208:211], a[76:79], v[112:115]
v_mfma_f32_16x16x32_bf16 v[20:23], a[212:215], a[64:67], v[20:23]
ds_read_b64_tr_b16 a[204:205], v203 offset:40960
v_mfma_f32_16x16x32_bf16 v[52:55], a[212:215], a[68:71], v[52:55]
buffer_load_dwordx4 v171, s[20:23], s42 offen offset:1024 nt lds
v_mfma_f32_16x16x32_bf16 v[84:87], a[212:215], a[72:75], v[84:87]
ds_read_b64_tr_b16 a[206:207], v203 offset:41984
v_mfma_f32_16x16x32_bf16 v[116:119], a[212:215], a[76:79], v[116:119]
s_waitcnt lgkmcnt(8)
v_mfma_f32_16x16x32_bf16 v[24:27], a[216:219], a[64:67], v[24:27]
ds_read_b64_tr_b16 a[208:209], v204 offset:40960
v_mfma_f32_16x16x32_bf16 v[56:59], a[216:219], a[68:71], v[56:59]
buffer_load_dwordx4 v172, s[20:23], s42 offen offset:2048 nt lds
v_mfma_f32_16x16x32_bf16 v[88:91], a[216:219], a[72:75], v[88:91]
ds_read_b64_tr_b16 a[210:211], v204 offset:41984
v_mfma_f32_16x16x32_bf16 v[120:123], a[216:219], a[76:79], v[120:123]
v_mfma_f32_16x16x32_bf16 v[28:31], a[220:223], a[64:67], v[28:31]
ds_read_b64_tr_b16 a[212:213], v205 offset:40960
v_mfma_f32_16x16x32_bf16 v[60:63], a[220:223], a[68:71], v[60:63]
buffer_load_dwordx4 v173, s[20:23], s42 offen offset:3072 nt lds
v_mfma_f32_16x16x32_bf16 v[92:95], a[220:223], a[72:75], v[92:95]
ds_read_b64_tr_b16 a[214:215], v205 offset:41984
v_mfma_f32_16x16x32_bf16 v[124:127], a[220:223], a[76:79], v[124:127]
s_waitcnt vmcnt(16) lgkmcnt(8)
s_add_u32 s42, s42, 524288
v_mfma_f32_16x16x32_bf16 v[0:3], a[192:195], a[80:83], v[0:3]
ds_read_b64_tr_b16 a[216:217], v206 offset:40960
v_mfma_f32_16x16x32_bf16 v[32:35], a[192:195], a[84:87], v[32:35]
buffer_load_dwordx4 a[0:3], v183, s[24:27], s40 offen offset:0
v_mfma_f32_16x16x32_bf16 v[64:67], a[192:195], a[88:91], v[64:67]
ds_read_b64_tr_b16 a[218:219], v206 offset:41984
v_mfma_f32_16x16x32_bf16 v[96:99], a[192:195], a[92:95], v[96:99]
v_mfma_f32_16x16x32_bf16 v[4:7], a[196:199], a[80:83], v[4:7]
ds_read_b64_tr_b16 a[220:221], v207 offset:40960
v_mfma_f32_16x16x32_bf16 v[36:39], a[196:199], a[84:87], v[36:39]
buffer_load_dwordx4 a[4:7], v183, s[24:27], s40 offen offset:256
v_mfma_f32_16x16x32_bf16 v[68:71], a[196:199], a[88:91], v[68:71]
ds_read_b64_tr_b16 a[222:223], v207 offset:41984
v_mfma_f32_16x16x32_bf16 v[100:103], a[196:199], a[92:95], v[100:103]
s_waitcnt lgkmcnt(8)
s_waitcnt vmcnt(14)
s_barrier
v_mfma_f32_16x16x32_bf16 v[8:11], a[200:203], a[80:83], v[8:11]
ds_read_b64_tr_b16 a[192:193], v200 offset:49152
v_mfma_f32_16x16x32_bf16 v[40:43], a[200:203], a[84:87], v[40:43]
buffer_load_dwordx4 a[8:11], v183, s[24:27], s41 offen offset:0
v_mfma_f32_16x16x32_bf16 v[72:75], a[200:203], a[88:91], v[72:75]
ds_read_b64_tr_b16 a[194:195], v200 offset:50176
v_mfma_f32_16x16x32_bf16 v[104:107], a[200:203], a[92:95], v[104:107]
v_mfma_f32_16x16x32_bf16 v[12:15], a[204:207], a[80:83], v[12:15]
ds_read_b64_tr_b16 a[196:197], v201 offset:49152
v_mfma_f32_16x16x32_bf16 v[44:47], a[204:207], a[84:87], v[44:47]
buffer_load_dwordx4 a[12:15], v183, s[24:27], s41 offen offset:256
v_mfma_f32_16x16x32_bf16 v[76:79], a[204:207], a[88:91], v[76:79]
ds_read_b64_tr_b16 a[198:199], v201 offset:50176
v_mfma_f32_16x16x32_bf16 v[108:111], a[204:207], a[92:95], v[108:111]
s_waitcnt lgkmcnt(8)
v_mfma_f32_16x16x32_bf16 v[16:19], a[208:211], a[80:83], v[16:19]
ds_read_b64_tr_b16 a[200:201], v202 offset:49152
v_mfma_f32_16x16x32_bf16 v[48:51], a[208:211], a[84:87], v[48:51]
buffer_load_dwordx4 a[16:19], v183, s[24:27], s40 offen offset:2048
v_mfma_f32_16x16x32_bf16 v[80:83], a[208:211], a[88:91], v[80:83]
ds_read_b64_tr_b16 a[202:203], v202 offset:50176
v_mfma_f32_16x16x32_bf16 v[112:115], a[208:211], a[92:95], v[112:115]
v_mfma_f32_16x16x32_bf16 v[20:23], a[212:215], a[80:83], v[20:23]
ds_read_b64_tr_b16 a[204:205], v203 offset:49152
v_mfma_f32_16x16x32_bf16 v[52:55], a[212:215], a[84:87], v[52:55]
buffer_load_dwordx4 a[20:23], v183, s[24:27], s40 offen offset:2304
v_mfma_f32_16x16x32_bf16 v[84:87], a[212:215], a[88:91], v[84:87]
ds_read_b64_tr_b16 a[206:207], v203 offset:50176
v_mfma_f32_16x16x32_bf16 v[116:119], a[212:215], a[92:95], v[116:119]
s_waitcnt lgkmcnt(8)
s_add_u32 s40, s40, 4096
v_mfma_f32_16x16x32_bf16 v[24:27], a[216:219], a[80:83], v[24:27]
ds_read_b64_tr_b16 a[208:209], v204 offset:49152
v_mfma_f32_16x16x32_bf16 v[56:59], a[216:219], a[84:87], v[56:59]
buffer_load_dwordx4 a[24:27], v183, s[24:27], s41 offen offset:2048
v_mfma_f32_16x16x32_bf16 v[88:91], a[216:219], a[88:91], v[88:91]
ds_read_b64_tr_b16 a[210:211], v204 offset:50176
v_mfma_f32_16x16x32_bf16 v[120:123], a[216:219], a[92:95], v[120:123]
v_mfma_f32_16x16x32_bf16 v[28:31], a[220:223], a[80:83], v[28:31]
ds_read_b64_tr_b16 a[212:213], v205 offset:49152
v_mfma_f32_16x16x32_bf16 v[60:63], a[220:223], a[84:87], v[60:63]
buffer_load_dwordx4 a[28:31], v183, s[24:27], s41 offen offset:2304
v_mfma_f32_16x16x32_bf16 v[92:95], a[220:223], a[88:91], v[92:95]
ds_read_b64_tr_b16 a[214:215], v205 offset:50176
v_mfma_f32_16x16x32_bf16 v[124:127], a[220:223], a[92:95], v[124:127]
s_waitcnt vmcnt(16) lgkmcnt(8)
s_add_u32 s41, s41, 4096
s_add_u32 m0, s43, 114688
v_mfma_f32_16x16x32_bf16 v[0:3], a[192:195], a[96:99], v[0:3]
ds_read_b64_tr_b16 a[216:217], v206 offset:49152
v_mfma_f32_16x16x32_bf16 v[32:35], a[192:195], a[100:103], v[32:35]
buffer_load_dwordx4 v170, s[20:23], s42 offen offset:0 nt lds
v_mfma_f32_16x16x32_bf16 v[64:67], a[192:195], a[104:107], v[64:67]
ds_read_b64_tr_b16 a[218:219], v206 offset:50176
v_mfma_f32_16x16x32_bf16 v[96:99], a[192:195], a[108:111], v[96:99]
v_mfma_f32_16x16x32_bf16 v[4:7], a[196:199], a[96:99], v[4:7]
ds_read_b64_tr_b16 a[220:221], v207 offset:49152
v_mfma_f32_16x16x32_bf16 v[36:39], a[196:199], a[100:103], v[36:39]
buffer_load_dwordx4 v171, s[20:23], s42 offen offset:1024 nt lds
v_mfma_f32_16x16x32_bf16 v[68:71], a[196:199], a[104:107], v[68:71]
ds_read_b64_tr_b16 a[222:223], v207 offset:50176
v_mfma_f32_16x16x32_bf16 v[100:103], a[196:199], a[108:111], v[100:103]
s_waitcnt lgkmcnt(8)
v_mfma_f32_16x16x32_bf16 v[8:11], a[200:203], a[96:99], v[8:11]
ds_read_b64_tr_b16 a[192:193], v200 offset:57344
v_mfma_f32_16x16x32_bf16 v[40:43], a[200:203], a[100:103], v[40:43]
buffer_load_dwordx4 v172, s[20:23], s42 offen offset:2048 nt lds
v_mfma_f32_16x16x32_bf16 v[72:75], a[200:203], a[104:107], v[72:75]
ds_read_b64_tr_b16 a[194:195], v200 offset:58368
v_mfma_f32_16x16x32_bf16 v[104:107], a[200:203], a[108:111], v[104:107]
v_mfma_f32_16x16x32_bf16 v[12:15], a[204:207], a[96:99], v[12:15]
ds_read_b64_tr_b16 a[196:197], v201 offset:57344
v_mfma_f32_16x16x32_bf16 v[44:47], a[204:207], a[100:103], v[44:47]
buffer_load_dwordx4 v173, s[20:23], s42 offen offset:3072 nt lds
v_mfma_f32_16x16x32_bf16 v[76:79], a[204:207], a[104:107], v[76:79]
ds_read_b64_tr_b16 a[198:199], v201 offset:58368
v_mfma_f32_16x16x32_bf16 v[108:111], a[204:207], a[108:111], v[108:111]
s_waitcnt lgkmcnt(8)
s_add_u32 s42, s42, 524288
v_mfma_f32_16x16x32_bf16 v[16:19], a[208:211], a[96:99], v[16:19]
ds_read_b64_tr_b16 a[200:201], v202 offset:57344
v_mfma_f32_16x16x32_bf16 v[48:51], a[208:211], a[100:103], v[48:51]
buffer_load_dwordx4 a[32:35], v183, s[24:27], s40 offen offset:0
v_mfma_f32_16x16x32_bf16 v[80:83], a[208:211], a[104:107], v[80:83]
ds_read_b64_tr_b16 a[202:203], v202 offset:58368
v_mfma_f32_16x16x32_bf16 v[112:115], a[208:211], a[108:111], v[112:115]
v_mfma_f32_16x16x32_bf16 v[20:23], a[212:215], a[96:99], v[20:23]
ds_read_b64_tr_b16 a[204:205], v203 offset:57344
v_mfma_f32_16x16x32_bf16 v[52:55], a[212:215], a[100:103], v[52:55]
buffer_load_dwordx4 a[36:39], v183, s[24:27], s40 offen offset:256
v_mfma_f32_16x16x32_bf16 v[84:87], a[212:215], a[104:107], v[84:87]
ds_read_b64_tr_b16 a[206:207], v203 offset:58368
v_mfma_f32_16x16x32_bf16 v[116:119], a[212:215], a[108:111], v[116:119]
s_waitcnt lgkmcnt(8)
v_mfma_f32_16x16x32_bf16 v[24:27], a[216:219], a[96:99], v[24:27]
ds_read_b64_tr_b16 a[208:209], v204 offset:57344
v_mfma_f32_16x16x32_bf16 v[56:59], a[216:219], a[100:103], v[56:59]
buffer_load_dwordx4 a[40:43], v183, s[24:27], s41 offen offset:0
v_mfma_f32_16x16x32_bf16 v[88:91], a[216:219], a[104:107], v[88:91]
ds_read_b64_tr_b16 a[210:211], v204 offset:58368
v_mfma_f32_16x16x32_bf16 v[120:123], a[216:219], a[108:111], v[120:123]
v_mfma_f32_16x16x32_bf16 v[28:31], a[220:223], a[96:99], v[28:31]
ds_read_b64_tr_b16 a[212:213], v205 offset:57344
v_mfma_f32_16x16x32_bf16 v[60:63], a[220:223], a[100:103], v[60:63]
buffer_load_dwordx4 a[44:47], v183, s[24:27], s41 offen offset:256
v_mfma_f32_16x16x32_bf16 v[92:95], a[220:223], a[104:107], v[92:95]
ds_read_b64_tr_b16 a[214:215], v205 offset:58368
v_mfma_f32_16x16x32_bf16 v[124:127], a[220:223], a[108:111], v[124:127]
s_waitcnt vmcnt(20) lgkmcnt(8)
v_mfma_f32_16x16x32_bf16 v[0:3], a[192:195], a[112:115], v[0:3]
ds_read_b64_tr_b16 a[216:217], v206 offset:57344
v_mfma_f32_16x16x32_bf16 v[32:35], a[192:195], a[116:119], v[32:35]
v_mfma_f32_16x16x32_bf16 v[64:67], a[192:195], a[120:123], v[64:67]
ds_read_b64_tr_b16 a[218:219], v206 offset:58368
v_mfma_f32_16x16x32_bf16 v[96:99], a[192:195], a[124:127], v[96:99]
v_mfma_f32_16x16x32_bf16 v[4:7], a[196:199], a[112:115], v[4:7]
ds_read_b64_tr_b16 a[220:221], v207 offset:57344
v_mfma_f32_16x16x32_bf16 v[36:39], a[196:199], a[116:119], v[36:39]
buffer_load_dwordx4 a[48:51], v183, s[24:27], s40 offen offset:2048
v_mfma_f32_16x16x32_bf16 v[68:71], a[196:199], a[120:123], v[68:71]
ds_read_b64_tr_b16 a[222:223], v207 offset:58368
v_mfma_f32_16x16x32_bf16 v[100:103], a[196:199], a[124:127], v[100:103]
s_waitcnt lgkmcnt(8)
s_waitcnt vmcnt(17)
s_barrier
v_mfma_f32_16x16x32_bf16 v[8:11], a[200:203], a[112:115], v[8:11]
ds_read_b64_tr_b16 a[192:193], v200 offset:0
v_mfma_f32_16x16x32_bf16 v[40:43], a[200:203], a[116:119], v[40:43]
buffer_load_dwordx4 a[52:55], v183, s[24:27], s40 offen offset:2304
v_mfma_f32_16x16x32_bf16 v[72:75], a[200:203], a[120:123], v[72:75]
ds_read_b64_tr_b16 a[194:195], v200 offset:1024
v_mfma_f32_16x16x32_bf16 v[104:107], a[200:203], a[124:127], v[104:107]
s_add_u32 s40, s40, 4096
v_mfma_f32_16x16x32_bf16 v[12:15], a[204:207], a[112:115], v[12:15]
ds_read_b64_tr_b16 a[196:197], v201 offset:0
v_mfma_f32_16x16x32_bf16 v[44:47], a[204:207], a[116:119], v[44:47]
buffer_load_dwordx4 a[56:59], v183, s[24:27], s41 offen offset:2048
v_mfma_f32_16x16x32_bf16 v[76:79], a[204:207], a[120:123], v[76:79]
ds_read_b64_tr_b16 a[198:199], v201 offset:1024
v_mfma_f32_16x16x32_bf16 v[108:111], a[204:207], a[124:127], v[108:111]
s_waitcnt lgkmcnt(8)
v_mfma_f32_16x16x32_bf16 v[16:19], a[208:211], a[112:115], v[16:19]
ds_read_b64_tr_b16 a[200:201], v202 offset:0
v_mfma_f32_16x16x32_bf16 v[48:51], a[208:211], a[116:119], v[48:51]
buffer_load_dwordx4 a[60:63], v183, s[24:27], s41 offen offset:2304
v_mfma_f32_16x16x32_bf16 v[80:83], a[208:211], a[120:123], v[80:83]
ds_read_b64_tr_b16 a[202:203], v202 offset:1024
v_mfma_f32_16x16x32_bf16 v[112:115], a[208:211], a[124:127], v[112:115]
s_add_u32 s41, s41, 4096
s_add_u32 m0, s43, 131072
v_mfma_f32_16x16x32_bf16 v[20:23], a[212:215], a[112:115], v[20:23]
ds_read_b64_tr_b16 a[204:205], v203 offset:0
v_mfma_f32_16x16x32_bf16 v[52:55], a[212:215], a[116:119], v[52:55]
buffer_load_dwordx4 v170, s[20:23], s42 offen offset:0 nt lds
v_mfma_f32_16x16x32_bf16 v[84:87], a[212:215], a[120:123], v[84:87]
ds_read_b64_tr_b16 a[206:207], v203 offset:1024
v_mfma_f32_16x16x32_bf16 v[116:119], a[212:215], a[124:127], v[116:119]
s_waitcnt lgkmcnt(8)
v_mfma_f32_16x16x32_bf16 v[24:27], a[216:219], a[112:115], v[24:27]
ds_read_b64_tr_b16 a[208:209], v204 offset:0
v_mfma_f32_16x16x32_bf16 v[56:59], a[216:219], a[116:119], v[56:59]
buffer_load_dwordx4 v171, s[20:23], s42 offen offset:1024 nt lds
v_mfma_f32_16x16x32_bf16 v[88:91], a[216:219], a[120:123], v[88:91]
ds_read_b64_tr_b16 a[210:211], v204 offset:1024
v_mfma_f32_16x16x32_bf16 v[120:123], a[216:219], a[124:127], v[120:123]
v_mfma_f32_16x16x32_bf16 v[28:31], a[220:223], a[112:115], v[28:31]
ds_read_b64_tr_b16 a[212:213], v205 offset:0
v_mfma_f32_16x16x32_bf16 v[60:63], a[220:223], a[116:119], v[60:63]
buffer_load_dwordx4 v172, s[20:23], s42 offen offset:2048 nt lds
v_mfma_f32_16x16x32_bf16 v[92:95], a[220:223], a[120:123], v[92:95]
ds_read_b64_tr_b16 a[214:215], v205 offset:1024
v_mfma_f32_16x16x32_bf16 v[124:127], a[220:223], a[124:127], v[124:127]
s_waitcnt vmcnt(19) lgkmcnt(8)
v_mfma_f32_16x16x32_bf16 v[0:3], a[192:195], a[0:3], v[0:3]
ds_read_b64_tr_b16 a[216:217], v206 offset:0
v_mfma_f32_16x16x32_bf16 v[32:35], a[192:195], a[4:7], v[32:35]
buffer_load_dwordx4 v173, s[20:23], s42 offen offset:3072 nt lds
v_mfma_f32_16x16x32_bf16 v[64:67], a[192:195], a[8:11], v[64:67]
ds_read_b64_tr_b16 a[218:219], v206 offset:1024
v_mfma_f32_16x16x32_bf16 v[96:99], a[192:195], a[12:15], v[96:99]
s_add_u32 s42, s42, 524288
v_mfma_f32_16x16x32_bf16 v[4:7], a[196:199], a[0:3], v[4:7]
ds_read_b64_tr_b16 a[220:221], v207 offset:0
v_mfma_f32_16x16x32_bf16 v[36:39], a[196:199], a[4:7], v[36:39]
buffer_load_dwordx4 a[64:67], v183, s[24:27], s40 offen offset:0
v_mfma_f32_16x16x32_bf16 v[68:71], a[196:199], a[8:11], v[68:71]
ds_read_b64_tr_b16 a[222:223], v207 offset:1024
v_mfma_f32_16x16x32_bf16 v[100:103], a[196:199], a[12:15], v[100:103]
s_waitcnt lgkmcnt(8)
v_mfma_f32_16x16x32_bf16 v[8:11], a[200:203], a[0:3], v[8:11]
ds_read_b64_tr_b16 a[192:193], v200 offset:8192
v_mfma_f32_16x16x32_bf16 v[40:43], a[200:203], a[4:7], v[40:43]
buffer_load_dwordx4 a[68:71], v183, s[24:27], s40 offen offset:256
v_mfma_f32_16x16x32_bf16 v[72:75], a[200:203], a[8:11], v[72:75]
ds_read_b64_tr_b16 a[194:195], v200 offset:9216
v_mfma_f32_16x16x32_bf16 v[104:107], a[200:203], a[12:15], v[104:107]
v_mfma_f32_16x16x32_bf16 v[12:15], a[204:207], a[0:3], v[12:15]
ds_read_b64_tr_b16 a[196:197], v201 offset:8192
v_mfma_f32_16x16x32_bf16 v[44:47], a[204:207], a[4:7], v[44:47]
buffer_load_dwordx4 a[72:75], v183, s[24:27], s41 offen offset:0
v_mfma_f32_16x16x32_bf16 v[76:79], a[204:207], a[8:11], v[76:79]
ds_read_b64_tr_b16 a[198:199], v201 offset:9216
v_mfma_f32_16x16x32_bf16 v[108:111], a[204:207], a[12:15], v[108:111]
s_waitcnt lgkmcnt(8)
v_mfma_f32_16x16x32_bf16 v[16:19], a[208:211], a[0:3], v[16:19]
ds_read_b64_tr_b16 a[200:201], v202 offset:8192
v_mfma_f32_16x16x32_bf16 v[48:51], a[208:211], a[4:7], v[48:51]
buffer_load_dwordx4 a[76:79], v183, s[24:27], s41 offen offset:256
v_mfma_f32_16x16x32_bf16 v[80:83], a[208:211], a[8:11], v[80:83]
ds_read_b64_tr_b16 a[202:203], v202 offset:9216
v_mfma_f32_16x16x32_bf16 v[112:115], a[208:211], a[12:15], v[112:115]
v_mfma_f32_16x16x32_bf16 v[20:23], a[212:215], a[0:3], v[20:23]
ds_read_b64_tr_b16 a[204:205], v203 offset:8192
v_mfma_f32_16x16x32_bf16 v[52:55], a[212:215], a[4:7], v[52:55]
v_mfma_f32_16x16x32_bf16 v[84:87], a[212:215], a[8:11], v[84:87]
ds_read_b64_tr_b16 a[206:207], v203 offset:9216
v_mfma_f32_16x16x32_bf16 v[116:119], a[212:215], a[12:15], v[116:119]
s_waitcnt lgkmcnt(8)
v_mfma_f32_16x16x32_bf16 v[24:27], a[216:219], a[0:3], v[24:27]
ds_read_b64_tr_b16 a[208:209], v204 offset:8192
v_mfma_f32_16x16x32_bf16 v[56:59], a[216:219], a[4:7], v[56:59]
v_mfma_f32_16x16x32_bf16 v[88:91], a[216:219], a[8:11], v[88:91]
ds_read_b64_tr_b16 a[210:211], v204 offset:9216
v_mfma_f32_16x16x32_bf16 v[120:123], a[216:219], a[12:15], v[120:123]
v_mfma_f32_16x16x32_bf16 v[28:31], a[220:223], a[0:3], v[28:31]
ds_read_b64_tr_b16 a[212:213], v205 offset:8192
v_mfma_f32_16x16x32_bf16 v[60:63], a[220:223], a[4:7], v[60:63]
v_mfma_f32_16x16x32_bf16 v[92:95], a[220:223], a[8:11], v[92:95]
ds_read_b64_tr_b16 a[214:215], v205 offset:9216
v_mfma_f32_16x16x32_bf16 v[124:127], a[220:223], a[12:15], v[124:127]
s_waitcnt vmcnt(20) lgkmcnt(8)
v_mfma_f32_16x16x32_bf16 v[0:3], a[192:195], a[16:19], v[0:3]
ds_read_b64_tr_b16 a[216:217], v206 offset:8192
v_mfma_f32_16x16x32_bf16 v[32:35], a[192:195], a[20:23], v[32:35]
v_mfma_f32_16x16x32_bf16 v[64:67], a[192:195], a[24:27], v[64:67]
ds_read_b64_tr_b16 a[218:219], v206 offset:9216
v_mfma_f32_16x16x32_bf16 v[96:99], a[192:195], a[28:31], v[96:99]
v_mfma_f32_16x16x32_bf16 v[4:7], a[196:199], a[16:19], v[4:7]
ds_read_b64_tr_b16 a[220:221], v207 offset:8192
v_mfma_f32_16x16x32_bf16 v[36:39], a[196:199], a[20:23], v[36:39]
buffer_load_dwordx4 a[80:83], v183, s[24:27], s40 offen offset:2048
v_mfma_f32_16x16x32_bf16 v[68:71], a[196:199], a[24:27], v[68:71]
ds_read_b64_tr_b16 a[222:223], v207 offset:9216
v_mfma_f32_16x16x32_bf16 v[100:103], a[196:199], a[28:31], v[100:103]
s_waitcnt lgkmcnt(8)
s_waitcnt vmcnt(17)
s_barrier
v_mfma_f32_16x16x32_bf16 v[8:11], a[200:203], a[16:19], v[8:11]
ds_read_b64_tr_b16 a[192:193], v200 offset:16384
v_mfma_f32_16x16x32_bf16 v[40:43], a[200:203], a[20:23], v[40:43]
buffer_load_dwordx4 a[84:87], v183, s[24:27], s40 offen offset:2304
v_mfma_f32_16x16x32_bf16 v[72:75], a[200:203], a[24:27], v[72:75]
ds_read_b64_tr_b16 a[194:195], v200 offset:17408
v_mfma_f32_16x16x32_bf16 v[104:107], a[200:203], a[28:31], v[104:107]
s_add_u32 s40, s40, 4096
v_mfma_f32_16x16x32_bf16 v[12:15], a[204:207], a[16:19], v[12:15]
ds_read_b64_tr_b16 a[196:197], v201 offset:16384
v_mfma_f32_16x16x32_bf16 v[44:47], a[204:207], a[20:23], v[44:47]
buffer_load_dwordx4 a[88:91], v183, s[24:27], s41 offen offset:2048
v_mfma_f32_16x16x32_bf16 v[76:79], a[204:207], a[24:27], v[76:79]
ds_read_b64_tr_b16 a[198:199], v201 offset:17408
v_mfma_f32_16x16x32_bf16 v[108:111], a[204:207], a[28:31], v[108:111]
s_waitcnt lgkmcnt(8)
v_mfma_f32_16x16x32_bf16 v[16:19], a[208:211], a[16:19], v[16:19]
ds_read_b64_tr_b16 a[200:201], v202 offset:16384
v_mfma_f32_16x16x32_bf16 v[48:51], a[208:211], a[20:23], v[48:51]
buffer_load_dwordx4 a[92:95], v183, s[24:27], s41 offen offset:2304
v_mfma_f32_16x16x32_bf16 v[80:83], a[208:211], a[24:27], v[80:83]
ds_read_b64_tr_b16 a[202:203], v202 offset:17408
v_mfma_f32_16x16x32_bf16 v[112:115], a[208:211], a[28:31], v[112:115]
s_add_u32 s41, s41, 4096
s_add_u32 m0, s43, 147456
v_mfma_f32_16x16x32_bf16 v[20:23], a[212:215], a[16:19], v[20:23]
ds_read_b64_tr_b16 a[204:205], v203 offset:16384
v_mfma_f32_16x16x32_bf16 v[52:55], a[212:215], a[20:23], v[52:55]
buffer_load_dwordx4 v170, s[20:23], s42 offen offset:0 nt lds
v_mfma_f32_16x16x32_bf16 v[84:87], a[212:215], a[24:27], v[84:87]
ds_read_b64_tr_b16 a[206:207], v203 offset:17408
v_mfma_f32_16x16x32_bf16 v[116:119], a[212:215], a[28:31], v[116:119]
s_waitcnt lgkmcnt(8)
v_mfma_f32_16x16x32_bf16 v[24:27], a[216:219], a[16:19], v[24:27]
ds_read_b64_tr_b16 a[208:209], v204 offset:16384
v_mfma_f32_16x16x32_bf16 v[56:59], a[216:219], a[20:23], v[56:59]
buffer_load_dwordx4 v171, s[20:23], s42 offen offset:1024 nt lds
v_mfma_f32_16x16x32_bf16 v[88:91], a[216:219], a[24:27], v[88:91]
ds_read_b64_tr_b16 a[210:211], v204 offset:17408
v_mfma_f32_16x16x32_bf16 v[120:123], a[216:219], a[28:31], v[120:123]
v_mfma_f32_16x16x32_bf16 v[28:31], a[220:223], a[16:19], v[28:31]
ds_read_b64_tr_b16 a[212:213], v205 offset:16384
v_mfma_f32_16x16x32_bf16 v[60:63], a[220:223], a[20:23], v[60:63]
buffer_load_dwordx4 v172, s[20:23], s42 offen offset:2048 nt lds
v_mfma_f32_16x16x32_bf16 v[92:95], a[220:223], a[24:27], v[92:95]
ds_read_b64_tr_b16 a[214:215], v205 offset:17408
v_mfma_f32_16x16x32_bf16 v[124:127], a[220:223], a[28:31], v[124:127]
s_waitcnt vmcnt(19) lgkmcnt(8)
v_mfma_f32_16x16x32_bf16 v[0:3], a[192:195], a[32:35], v[0:3]
ds_read_b64_tr_b16 a[216:217], v206 offset:16384
v_mfma_f32_16x16x32_bf16 v[32:35], a[192:195], a[36:39], v[32:35]
buffer_load_dwordx4 v173, s[20:23], s42 offen offset:3072 nt lds
v_mfma_f32_16x16x32_bf16 v[64:67], a[192:195], a[40:43], v[64:67]
ds_read_b64_tr_b16 a[218:219], v206 offset:17408
v_mfma_f32_16x16x32_bf16 v[96:99], a[192:195], a[44:47], v[96:99]
s_add_u32 s42, s42, 524288
v_mfma_f32_16x16x32_bf16 v[4:7], a[196:199], a[32:35], v[4:7]
ds_read_b64_tr_b16 a[220:221], v207 offset:16384
v_mfma_f32_16x16x32_bf16 v[36:39], a[196:199], a[36:39], v[36:39]
buffer_load_dwordx4 a[96:99], v183, s[24:27], s40 offen offset:0
v_mfma_f32_16x16x32_bf16 v[68:71], a[196:199], a[40:43], v[68:71]
ds_read_b64_tr_b16 a[222:223], v207 offset:17408
v_mfma_f32_16x16x32_bf16 v[100:103], a[196:199], a[44:47], v[100:103]
s_waitcnt lgkmcnt(8)
v_mfma_f32_16x16x32_bf16 v[8:11], a[200:203], a[32:35], v[8:11]
ds_read_b64_tr_b16 a[192:193], v200 offset:24576
v_mfma_f32_16x16x32_bf16 v[40:43], a[200:203], a[36:39], v[40:43]
buffer_load_dwordx4 a[100:103], v183, s[24:27], s40 offen offset:256
v_mfma_f32_16x16x32_bf16 v[72:75], a[200:203], a[40:43], v[72:75]
ds_read_b64_tr_b16 a[194:195], v200 offset:25600
v_mfma_f32_16x16x32_bf16 v[104:107], a[200:203], a[44:47], v[104:107]
v_mfma_f32_16x16x32_bf16 v[12:15], a[204:207], a[32:35], v[12:15]
ds_read_b64_tr_b16 a[196:197], v201 offset:24576
v_mfma_f32_16x16x32_bf16 v[44:47], a[204:207], a[36:39], v[44:47]
buffer_load_dwordx4 a[104:107], v183, s[24:27], s41 offen offset:0
v_mfma_f32_16x16x32_bf16 v[76:79], a[204:207], a[40:43], v[76:79]
ds_read_b64_tr_b16 a[198:199], v201 offset:25600
v_mfma_f32_16x16x32_bf16 v[108:111], a[204:207], a[44:47], v[108:111]
s_waitcnt lgkmcnt(8)
v_mfma_f32_16x16x32_bf16 v[16:19], a[208:211], a[32:35], v[16:19]
ds_read_b64_tr_b16 a[200:201], v202 offset:24576
v_mfma_f32_16x16x32_bf16 v[48:51], a[208:211], a[36:39], v[48:51]
buffer_load_dwordx4 a[108:111], v183, s[24:27], s41 offen offset:256
v_mfma_f32_16x16x32_bf16 v[80:83], a[208:211], a[40:43], v[80:83]
ds_read_b64_tr_b16 a[202:203], v202 offset:25600
v_mfma_f32_16x16x32_bf16 v[112:115], a[208:211], a[44:47], v[112:115]
v_mfma_f32_16x16x32_bf16 v[20:23], a[212:215], a[32:35], v[20:23]
ds_read_b64_tr_b16 a[204:205], v203 offset:24576
v_mfma_f32_16x16x32_bf16 v[52:55], a[212:215], a[36:39], v[52:55]
v_mfma_f32_16x16x32_bf16 v[84:87], a[212:215], a[40:43], v[84:87]
ds_read_b64_tr_b16 a[206:207], v203 offset:25600
v_mfma_f32_16x16x32_bf16 v[116:119], a[212:215], a[44:47], v[116:119]
s_waitcnt lgkmcnt(8)
v_mfma_f32_16x16x32_bf16 v[24:27], a[216:219], a[32:35], v[24:27]
ds_read_b64_tr_b16 a[208:209], v204 offset:24576
v_mfma_f32_16x16x32_bf16 v[56:59], a[216:219], a[36:39], v[56:59]
v_mfma_f32_16x16x32_bf16 v[88:91], a[216:219], a[40:43], v[88:91]
ds_read_b64_tr_b16 a[210:211], v204 offset:25600
v_mfma_f32_16x16x32_bf16 v[120:123], a[216:219], a[44:47], v[120:123]
v_mfma_f32_16x16x32_bf16 v[28:31], a[220:223], a[32:35], v[28:31]
ds_read_b64_tr_b16 a[212:213], v205 offset:24576
v_mfma_f32_16x16x32_bf16 v[60:63], a[220:223], a[36:39], v[60:63]
v_mfma_f32_16x16x32_bf16 v[92:95], a[220:223], a[40:43], v[92:95]
ds_read_b64_tr_b16 a[214:215], v205 offset:25600
v_mfma_f32_16x16x32_bf16 v[124:127], a[220:223], a[44:47], v[124:127]
s_waitcnt vmcnt(20) lgkmcnt(8)
v_mfma_f32_16x16x32_bf16 v[0:3], a[192:195], a[48:51], v[0:3]
ds_read_b64_tr_b16 a[216:217], v206 offset:24576
v_mfma_f32_16x16x32_bf16 v[32:35], a[192:195], a[52:55], v[32:35]
v_mfma_f32_16x16x32_bf16 v[64:67], a[192:195], a[56:59], v[64:67]
ds_read_b64_tr_b16 a[218:219], v206 offset:25600
v_mfma_f32_16x16x32_bf16 v[96:99], a[192:195], a[60:63], v[96:99]
v_mfma_f32_16x16x32_bf16 v[4:7], a[196:199], a[48:51], v[4:7]
ds_read_b64_tr_b16 a[220:221], v207 offset:24576
v_mfma_f32_16x16x32_bf16 v[36:39], a[196:199], a[52:55], v[36:39]
buffer_load_dwordx4 a[112:115], v183, s[24:27], s40 offen offset:2048
v_mfma_f32_16x16x32_bf16 v[68:71], a[196:199], a[56:59], v[68:71]
ds_read_b64_tr_b16 a[222:223], v207 offset:25600
v_mfma_f32_16x16x32_bf16 v[100:103], a[196:199], a[60:63], v[100:103]
s_waitcnt lgkmcnt(8)
s_waitcnt vmcnt(17)
s_barrier
v_mfma_f32_16x16x32_bf16 v[8:11], a[200:203], a[48:51], v[8:11]
ds_read_b64_tr_b16 a[192:193], v200 offset:32768
v_mfma_f32_16x16x32_bf16 v[40:43], a[200:203], a[52:55], v[40:43]
buffer_load_dwordx4 a[116:119], v183, s[24:27], s40 offen offset:2304
v_mfma_f32_16x16x32_bf16 v[72:75], a[200:203], a[56:59], v[72:75]
ds_read_b64_tr_b16 a[194:195], v200 offset:33792
v_mfma_f32_16x16x32_bf16 v[104:107], a[200:203], a[60:63], v[104:107]
s_add_u32 s40, s40, 4096
v_mfma_f32_16x16x32_bf16 v[12:15], a[204:207], a[48:51], v[12:15]
ds_read_b64_tr_b16 a[196:197], v201 offset:32768
v_mfma_f32_16x16x32_bf16 v[44:47], a[204:207], a[52:55], v[44:47]
buffer_load_dwordx4 a[120:123], v183, s[24:27], s41 offen offset:2048
v_mfma_f32_16x16x32_bf16 v[76:79], a[204:207], a[56:59], v[76:79]
ds_read_b64_tr_b16 a[198:199], v201 offset:33792
v_mfma_f32_16x16x32_bf16 v[108:111], a[204:207], a[60:63], v[108:111]
s_waitcnt lgkmcnt(8)
v_mfma_f32_16x16x32_bf16 v[16:19], a[208:211], a[48:51], v[16:19]
ds_read_b64_tr_b16 a[200:201], v202 offset:32768
v_mfma_f32_16x16x32_bf16 v[48:51], a[208:211], a[52:55], v[48:51]
buffer_load_dwordx4 a[124:127], v183, s[24:27], s41 offen offset:2304
v_mfma_f32_16x16x32_bf16 v[80:83], a[208:211], a[56:59], v[80:83]
ds_read_b64_tr_b16 a[202:203], v202 offset:33792
v_mfma_f32_16x16x32_bf16 v[112:115], a[208:211], a[60:63], v[112:115]
s_add_u32 s41, s41, 4096
s_add_u32 m0, s43, 98304
v_mfma_f32_16x16x32_bf16 v[20:23], a[212:215], a[48:51], v[20:23]
ds_read_b64_tr_b16 a[204:205], v203 offset:32768
v_mfma_f32_16x16x32_bf16 v[52:55], a[212:215], a[52:55], v[52:55]
buffer_load_dwordx4 v170, s[20:23], s42 offen offset:0 nt lds
v_mfma_f32_16x16x32_bf16 v[84:87], a[212:215], a[56:59], v[84:87]
ds_read_b64_tr_b16 a[206:207], v203 offset:33792
v_mfma_f32_16x16x32_bf16 v[116:119], a[212:215], a[60:63], v[116:119]
s_waitcnt lgkmcnt(8)
v_mfma_f32_16x16x32_bf16 v[24:27], a[216:219], a[48:51], v[24:27]
ds_read_b64_tr_b16 a[208:209], v204 offset:32768
v_mfma_f32_16x16x32_bf16 v[56:59], a[216:219], a[52:55], v[56:59]
buffer_load_dwordx4 v171, s[20:23], s42 offen offset:1024 nt lds
v_mfma_f32_16x16x32_bf16 v[88:91], a[216:219], a[56:59], v[88:91]
ds_read_b64_tr_b16 a[210:211], v204 offset:33792
v_mfma_f32_16x16x32_bf16 v[120:123], a[216:219], a[60:63], v[120:123]
v_mfma_f32_16x16x32_bf16 v[28:31], a[220:223], a[48:51], v[28:31]
ds_read_b64_tr_b16 a[212:213], v205 offset:32768
v_mfma_f32_16x16x32_bf16 v[60:63], a[220:223], a[52:55], v[60:63]
buffer_load_dwordx4 v172, s[20:23], s42 offen offset:2048 nt lds
v_mfma_f32_16x16x32_bf16 v[92:95], a[220:223], a[56:59], v[92:95]
ds_read_b64_tr_b16 a[214:215], v205 offset:33792
v_mfma_f32_16x16x32_bf16 v[124:127], a[220:223], a[60:63], v[124:127]
s_waitcnt vmcnt(19) lgkmcnt(8)
v_mfma_f32_16x16x32_bf16 v[0:3], a[192:195], a[64:67], v[0:3]
ds_read_b64_tr_b16 a[216:217], v206 offset:32768
v_mfma_f32_16x16x32_bf16 v[32:35], a[192:195], a[68:71], v[32:35]
buffer_load_dwordx4 v173, s[20:23], s42 offen offset:3072 nt lds
v_mfma_f32_16x16x32_bf16 v[64:67], a[192:195], a[72:75], v[64:67]
ds_read_b64_tr_b16 a[218:219], v206 offset:33792
v_mfma_f32_16x16x32_bf16 v[96:99], a[192:195], a[76:79], v[96:99]
s_add_u32 s42, s42, 524288
v_mfma_f32_16x16x32_bf16 v[4:7], a[196:199], a[64:67], v[4:7]
ds_read_b64_tr_b16 a[220:221], v207 offset:32768
v_mfma_f32_16x16x32_bf16 v[36:39], a[196:199], a[68:71], v[36:39]
buffer_load_dwordx4 a[0:3], v183, s[24:27], s40 offen offset:0
v_mfma_f32_16x16x32_bf16 v[68:71], a[196:199], a[72:75], v[68:71]
ds_read_b64_tr_b16 a[222:223], v207 offset:33792
v_mfma_f32_16x16x32_bf16 v[100:103], a[196:199], a[76:79], v[100:103]
s_waitcnt lgkmcnt(8)
v_mfma_f32_16x16x32_bf16 v[8:11], a[200:203], a[64:67], v[8:11]
ds_read_b64_tr_b16 a[192:193], v200 offset:40960
v_mfma_f32_16x16x32_bf16 v[40:43], a[200:203], a[68:71], v[40:43]
buffer_load_dwordx4 a[4:7], v183, s[24:27], s40 offen offset:256
v_mfma_f32_16x16x32_bf16 v[72:75], a[200:203], a[72:75], v[72:75]
ds_read_b64_tr_b16 a[194:195], v200 offset:41984
v_mfma_f32_16x16x32_bf16 v[104:107], a[200:203], a[76:79], v[104:107]
v_mfma_f32_16x16x32_bf16 v[12:15], a[204:207], a[64:67], v[12:15]
ds_read_b64_tr_b16 a[196:197], v201 offset:40960
v_mfma_f32_16x16x32_bf16 v[44:47], a[204:207], a[68:71], v[44:47]
buffer_load_dwordx4 a[8:11], v183, s[24:27], s41 offen offset:0
v_mfma_f32_16x16x32_bf16 v[76:79], a[204:207], a[72:75], v[76:79]
ds_read_b64_tr_b16 a[198:199], v201 offset:41984
v_mfma_f32_16x16x32_bf16 v[108:111], a[204:207], a[76:79], v[108:111]
s_waitcnt lgkmcnt(8)
v_mfma_f32_16x16x32_bf16 v[16:19], a[208:211], a[64:67], v[16:19]
ds_read_b64_tr_b16 a[200:201], v202 offset:40960
v_mfma_f32_16x16x32_bf16 v[48:51], a[208:211], a[68:71], v[48:51]
buffer_load_dwordx4 a[12:15], v183, s[24:27], s41 offen offset:256
v_mfma_f32_16x16x32_bf16 v[80:83], a[208:211], a[72:75], v[80:83]
ds_read_b64_tr_b16 a[202:203], v202 offset:41984
v_mfma_f32_16x16x32_bf16 v[112:115], a[208:211], a[76:79], v[112:115]
v_mfma_f32_16x16x32_bf16 v[20:23], a[212:215], a[64:67], v[20:23]
ds_read_b64_tr_b16 a[204:205], v203 offset:40960
v_mfma_f32_16x16x32_bf16 v[52:55], a[212:215], a[68:71], v[52:55]
v_mfma_f32_16x16x32_bf16 v[84:87], a[212:215], a[72:75], v[84:87]
ds_read_b64_tr_b16 a[206:207], v203 offset:41984
v_mfma_f32_16x16x32_bf16 v[116:119], a[212:215], a[76:79], v[116:119]
s_waitcnt lgkmcnt(8)
v_mfma_f32_16x16x32_bf16 v[24:27], a[216:219], a[64:67], v[24:27]
ds_read_b64_tr_b16 a[208:209], v204 offset:40960
v_mfma_f32_16x16x32_bf16 v[56:59], a[216:219], a[68:71], v[56:59]
v_mfma_f32_16x16x32_bf16 v[88:91], a[216:219], a[72:75], v[88:91]
ds_read_b64_tr_b16 a[210:211], v204 offset:41984
v_mfma_f32_16x16x32_bf16 v[120:123], a[216:219], a[76:79], v[120:123]
v_mfma_f32_16x16x32_bf16 v[28:31], a[220:223], a[64:67], v[28:31]
ds_read_b64_tr_b16 a[212:213], v205 offset:40960
v_mfma_f32_16x16x32_bf16 v[60:63], a[220:223], a[68:71], v[60:63]
v_mfma_f32_16x16x32_bf16 v[92:95], a[220:223], a[72:75], v[92:95]
ds_read_b64_tr_b16 a[214:215], v205 offset:41984
v_mfma_f32_16x16x32_bf16 v[124:127], a[220:223], a[76:79], v[124:127]
s_waitcnt vmcnt(20) lgkmcnt(8)
v_mfma_f32_16x16x32_bf16 v[0:3], a[192:195], a[80:83], v[0:3]
ds_read_b64_tr_b16 a[216:217], v206 offset:40960
v_mfma_f32_16x16x32_bf16 v[32:35], a[192:195], a[84:87], v[32:35]
v_mfma_f32_16x16x32_bf16 v[64:67], a[192:195], a[88:91], v[64:67]
ds_read_b64_tr_b16 a[218:219], v206 offset:41984
v_mfma_f32_16x16x32_bf16 v[96:99], a[192:195], a[92:95], v[96:99]
v_mfma_f32_16x16x32_bf16 v[4:7], a[196:199], a[80:83], v[4:7]
ds_read_b64_tr_b16 a[220:221], v207 offset:40960
v_mfma_f32_16x16x32_bf16 v[36:39], a[196:199], a[84:87], v[36:39]
buffer_load_dwordx4 a[16:19], v183, s[24:27], s40 offen offset:2048
v_mfma_f32_16x16x32_bf16 v[68:71], a[196:199], a[88:91], v[68:71]
ds_read_b64_tr_b16 a[222:223], v207 offset:41984
v_mfma_f32_16x16x32_bf16 v[100:103], a[196:199], a[92:95], v[100:103]
s_waitcnt lgkmcnt(8)
s_waitcnt vmcnt(17)
s_barrier
v_mfma_f32_16x16x32_bf16 v[8:11], a[200:203], a[80:83], v[8:11]
ds_read_b64_tr_b16 a[192:193], v200 offset:49152
v_mfma_f32_16x16x32_bf16 v[40:43], a[200:203], a[84:87], v[40:43]
buffer_load_dwordx4 a[20:23], v183, s[24:27], s40 offen offset:2304
v_mfma_f32_16x16x32_bf16 v[72:75], a[200:203], a[88:91], v[72:75]
ds_read_b64_tr_b16 a[194:195], v200 offset:50176
v_mfma_f32_16x16x32_bf16 v[104:107], a[200:203], a[92:95], v[104:107]
s_add_u32 s40, s40, 4096
v_mfma_f32_16x16x32_bf16 v[12:15], a[204:207], a[80:83], v[12:15]
ds_read_b64_tr_b16 a[196:197], v201 offset:49152
v_mfma_f32_16x16x32_bf16 v[44:47], a[204:207], a[84:87], v[44:47]
buffer_load_dwordx4 a[24:27], v183, s[24:27], s41 offen offset:2048
v_mfma_f32_16x16x32_bf16 v[76:79], a[204:207], a[88:91], v[76:79]
ds_read_b64_tr_b16 a[198:199], v201 offset:50176
v_mfma_f32_16x16x32_bf16 v[108:111], a[204:207], a[92:95], v[108:111]
s_waitcnt lgkmcnt(8)
v_mfma_f32_16x16x32_bf16 v[16:19], a[208:211], a[80:83], v[16:19]
ds_read_b64_tr_b16 a[200:201], v202 offset:49152
v_mfma_f32_16x16x32_bf16 v[48:51], a[208:211], a[84:87], v[48:51]
buffer_load_dwordx4 a[28:31], v183, s[24:27], s41 offen offset:2304
v_mfma_f32_16x16x32_bf16 v[80:83], a[208:211], a[88:91], v[80:83]
ds_read_b64_tr_b16 a[202:203], v202 offset:50176
v_mfma_f32_16x16x32_bf16 v[112:115], a[208:211], a[92:95], v[112:115]
s_add_u32 s41, s41, 4096
s_add_u32 m0, s43, 114688
v_mfma_f32_16x16x32_bf16 v[20:23], a[212:215], a[80:83], v[20:23]
ds_read_b64_tr_b16 a[204:205], v203 offset:49152
v_mfma_f32_16x16x32_bf16 v[52:55], a[212:215], a[84:87], v[52:55]
buffer_load_dwordx4 v170, s[20:23], s42 offen offset:0 nt lds
v_mfma_f32_16x16x32_bf16 v[84:87], a[212:215], a[88:91], v[84:87]
ds_read_b64_tr_b16 a[206:207], v203 offset:50176
v_mfma_f32_16x16x32_bf16 v[116:119], a[212:215], a[92:95], v[116:119]
s_waitcnt lgkmcnt(8)
v_mfma_f32_16x16x32_bf16 v[24:27], a[216:219], a[80:83], v[24:27]
ds_read_b64_tr_b16 a[208:209], v204 offset:49152
v_mfma_f32_16x16x32_bf16 v[56:59], a[216:219], a[84:87], v[56:59]
buffer_load_dwordx4 v171, s[20:23], s42 offen offset:1024 nt lds
v_mfma_f32_16x16x32_bf16 v[88:91], a[216:219], a[88:91], v[88:91]
ds_read_b64_tr_b16 a[210:211], v204 offset:50176
v_mfma_f32_16x16x32_bf16 v[120:123], a[216:219], a[92:95], v[120:123]
v_mfma_f32_16x16x32_bf16 v[28:31], a[220:223], a[80:83], v[28:31]
ds_read_b64_tr_b16 a[212:213], v205 offset:49152
v_mfma_f32_16x16x32_bf16 v[60:63], a[220:223], a[84:87], v[60:63]
buffer_load_dwordx4 v172, s[20:23], s42 offen offset:2048 nt lds
v_mfma_f32_16x16x32_bf16 v[92:95], a[220:223], a[88:91], v[92:95]
ds_read_b64_tr_b16 a[214:215], v205 offset:50176
v_mfma_f32_16x16x32_bf16 v[124:127], a[220:223], a[92:95], v[124:127]
s_waitcnt vmcnt(19) lgkmcnt(8)
v_mfma_f32_16x16x32_bf16 v[0:3], a[192:195], a[96:99], v[0:3]
ds_read_b64_tr_b16 a[216:217], v206 offset:49152
v_mfma_f32_16x16x32_bf16 v[32:35], a[192:195], a[100:103], v[32:35]
buffer_load_dwordx4 v173, s[20:23], s42 offen offset:3072 nt lds
v_mfma_f32_16x16x32_bf16 v[64:67], a[192:195], a[104:107], v[64:67]
ds_read_b64_tr_b16 a[218:219], v206 offset:50176
v_mfma_f32_16x16x32_bf16 v[96:99], a[192:195], a[108:111], v[96:99]
s_add_u32 s42, s42, 524288
v_mfma_f32_16x16x32_bf16 v[4:7], a[196:199], a[96:99], v[4:7]
ds_read_b64_tr_b16 a[220:221], v207 offset:49152
v_mfma_f32_16x16x32_bf16 v[36:39], a[196:199], a[100:103], v[36:39]
buffer_load_dwordx4 a[32:35], v183, s[24:27], s40 offen offset:0
v_mfma_f32_16x16x32_bf16 v[68:71], a[196:199], a[104:107], v[68:71]
ds_read_b64_tr_b16 a[222:223], v207 offset:50176
v_mfma_f32_16x16x32_bf16 v[100:103], a[196:199], a[108:111], v[100:103]
s_waitcnt lgkmcnt(8)
v_mfma_f32_16x16x32_bf16 v[8:11], a[200:203], a[96:99], v[8:11]
ds_read_b64_tr_b16 a[192:193], v200 offset:57344
v_mfma_f32_16x16x32_bf16 v[40:43], a[200:203], a[100:103], v[40:43]
buffer_load_dwordx4 a[36:39], v183, s[24:27], s40 offen offset:256
v_mfma_f32_16x16x32_bf16 v[72:75], a[200:203], a[104:107], v[72:75]
ds_read_b64_tr_b16 a[194:195], v200 offset:58368
v_mfma_f32_16x16x32_bf16 v[104:107], a[200:203], a[108:111], v[104:107]
v_mfma_f32_16x16x32_bf16 v[12:15], a[204:207], a[96:99], v[12:15]
ds_read_b64_tr_b16 a[196:197], v201 offset:57344
v_mfma_f32_16x16x32_bf16 v[44:47], a[204:207], a[100:103], v[44:47]
buffer_load_dwordx4 a[40:43], v183, s[24:27], s41 offen offset:0
v_mfma_f32_16x16x32_bf16 v[76:79], a[204:207], a[104:107], v[76:79]
ds_read_b64_tr_b16 a[198:199], v201 offset:58368
v_mfma_f32_16x16x32_bf16 v[108:111], a[204:207], a[108:111], v[108:111]
s_waitcnt lgkmcnt(8)
v_mfma_f32_16x16x32_bf16 v[16:19], a[208:211], a[96:99], v[16:19]
ds_read_b64_tr_b16 a[200:201], v202 offset:57344
v_mfma_f32_16x16x32_bf16 v[48:51], a[208:211], a[100:103], v[48:51]
buffer_load_dwordx4 a[44:47], v183, s[24:27], s41 offen offset:256
v_mfma_f32_16x16x32_bf16 v[80:83], a[208:211], a[104:107], v[80:83]
ds_read_b64_tr_b16 a[202:203], v202 offset:58368
v_mfma_f32_16x16x32_bf16 v[112:115], a[208:211], a[108:111], v[112:115]
v_mfma_f32_16x16x32_bf16 v[20:23], a[212:215], a[96:99], v[20:23]
ds_read_b64_tr_b16 a[204:205], v203 offset:57344
v_mfma_f32_16x16x32_bf16 v[52:55], a[212:215], a[100:103], v[52:55]
v_mfma_f32_16x16x32_bf16 v[84:87], a[212:215], a[104:107], v[84:87]
ds_read_b64_tr_b16 a[206:207], v203 offset:58368
v_mfma_f32_16x16x32_bf16 v[116:119], a[212:215], a[108:111], v[116:119]
s_waitcnt lgkmcnt(8)
v_mfma_f32_16x16x32_bf16 v[24:27], a[216:219], a[96:99], v[24:27]
ds_read_b64_tr_b16 a[208:209], v204 offset:57344
v_mfma_f32_16x16x32_bf16 v[56:59], a[216:219], a[100:103], v[56:59]
v_mfma_f32_16x16x32_bf16 v[88:91], a[216:219], a[104:107], v[88:91]
ds_read_b64_tr_b16 a[210:211], v204 offset:58368
v_mfma_f32_16x16x32_bf16 v[120:123], a[216:219], a[108:111], v[120:123]
v_mfma_f32_16x16x32_bf16 v[28:31], a[220:223], a[96:99], v[28:31]
ds_read_b64_tr_b16 a[212:213], v205 offset:57344
v_mfma_f32_16x16x32_bf16 v[60:63], a[220:223], a[100:103], v[60:63]
v_mfma_f32_16x16x32_bf16 v[92:95], a[220:223], a[104:107], v[92:95]
ds_read_b64_tr_b16 a[214:215], v205 offset:58368
v_mfma_f32_16x16x32_bf16 v[124:127], a[220:223], a[108:111], v[124:127]
s_waitcnt vmcnt(20) lgkmcnt(8)
v_mfma_f32_16x16x32_bf16 v[0:3], a[192:195], a[112:115], v[0:3]
ds_read_b64_tr_b16 a[216:217], v206 offset:57344
v_mfma_f32_16x16x32_bf16 v[32:35], a[192:195], a[116:119], v[32:35]
v_mfma_f32_16x16x32_bf16 v[64:67], a[192:195], a[120:123], v[64:67]
ds_read_b64_tr_b16 a[218:219], v206 offset:58368
v_mfma_f32_16x16x32_bf16 v[96:99], a[192:195], a[124:127], v[96:99]
v_mfma_f32_16x16x32_bf16 v[4:7], a[196:199], a[112:115], v[4:7]
ds_read_b64_tr_b16 a[220:221], v207 offset:57344
v_mfma_f32_16x16x32_bf16 v[36:39], a[196:199], a[116:119], v[36:39]
buffer_load_dwordx4 a[48:51], v183, s[24:27], s40 offen offset:2048
v_mfma_f32_16x16x32_bf16 v[68:71], a[196:199], a[120:123], v[68:71]
ds_read_b64_tr_b16 a[222:223], v207 offset:58368
v_mfma_f32_16x16x32_bf16 v[100:103], a[196:199], a[124:127], v[100:103]
s_waitcnt lgkmcnt(8)
s_waitcnt vmcnt(17)
s_barrier
v_mfma_f32_16x16x32_bf16 v[8:11], a[200:203], a[112:115], v[8:11]
ds_read_b64_tr_b16 a[192:193], v200 offset:0
v_mfma_f32_16x16x32_bf16 v[40:43], a[200:203], a[116:119], v[40:43]
buffer_load_dwordx4 a[52:55], v183, s[24:27], s40 offen offset:2304
v_mfma_f32_16x16x32_bf16 v[72:75], a[200:203], a[120:123], v[72:75]
ds_read_b64_tr_b16 a[194:195], v200 offset:1024
v_mfma_f32_16x16x32_bf16 v[104:107], a[200:203], a[124:127], v[104:107]
s_add_u32 s40, s40, 4096
v_mfma_f32_16x16x32_bf16 v[12:15], a[204:207], a[112:115], v[12:15]
ds_read_b64_tr_b16 a[196:197], v201 offset:0
v_mfma_f32_16x16x32_bf16 v[44:47], a[204:207], a[116:119], v[44:47]
buffer_load_dwordx4 a[56:59], v183, s[24:27], s41 offen offset:2048
v_mfma_f32_16x16x32_bf16 v[76:79], a[204:207], a[120:123], v[76:79]
ds_read_b64_tr_b16 a[198:199], v201 offset:1024
v_mfma_f32_16x16x32_bf16 v[108:111], a[204:207], a[124:127], v[108:111]
s_waitcnt lgkmcnt(8)
v_mfma_f32_16x16x32_bf16 v[16:19], a[208:211], a[112:115], v[16:19]
ds_read_b64_tr_b16 a[200:201], v202 offset:0
v_mfma_f32_16x16x32_bf16 v[48:51], a[208:211], a[116:119], v[48:51]
buffer_load_dwordx4 a[60:63], v183, s[24:27], s41 offen offset:2304
v_mfma_f32_16x16x32_bf16 v[80:83], a[208:211], a[120:123], v[80:83]
ds_read_b64_tr_b16 a[202:203], v202 offset:1024
v_mfma_f32_16x16x32_bf16 v[112:115], a[208:211], a[124:127], v[112:115]
s_add_u32 s41, s41, 4096
s_add_u32 m0, s43, 131072
v_mfma_f32_16x16x32_bf16 v[20:23], a[212:215], a[112:115], v[20:23]
ds_read_b64_tr_b16 a[204:205], v203 offset:0
v_mfma_f32_16x16x32_bf16 v[52:55], a[212:215], a[116:119], v[52:55]
buffer_load_dwordx4 v170, s[20:23], s42 offen offset:0 nt lds
v_mfma_f32_16x16x32_bf16 v[84:87], a[212:215], a[120:123], v[84:87]
ds_read_b64_tr_b16 a[206:207], v203 offset:1024
v_mfma_f32_16x16x32_bf16 v[116:119], a[212:215], a[124:127], v[116:119]
s_waitcnt lgkmcnt(8)
v_mfma_f32_16x16x32_bf16 v[24:27], a[216:219], a[112:115], v[24:27]
ds_read_b64_tr_b16 a[208:209], v204 offset:0
v_mfma_f32_16x16x32_bf16 v[56:59], a[216:219], a[116:119], v[56:59]
buffer_load_dwordx4 v171, s[20:23], s42 offen offset:1024 nt lds
v_mfma_f32_16x16x32_bf16 v[88:91], a[216:219], a[120:123], v[88:91]
ds_read_b64_tr_b16 a[210:211], v204 offset:1024
v_mfma_f32_16x16x32_bf16 v[120:123], a[216:219], a[124:127], v[120:123]
v_mfma_f32_16x16x32_bf16 v[28:31], a[220:223], a[112:115], v[28:31]
ds_read_b64_tr_b16 a[212:213], v205 offset:0
v_mfma_f32_16x16x32_bf16 v[60:63], a[220:223], a[116:119], v[60:63]
buffer_load_dwordx4 v172, s[20:23], s42 offen offset:2048 nt lds
v_mfma_f32_16x16x32_bf16 v[92:95], a[220:223], a[120:123], v[92:95]
ds_read_b64_tr_b16 a[214:215], v205 offset:1024
v_mfma_f32_16x16x32_bf16 v[124:127], a[220:223], a[124:127], v[124:127]
s_waitcnt vmcnt(19) lgkmcnt(8)
v_mfma_f32_16x16x32_bf16 v[0:3], a[192:195], a[0:3], v[0:3]
ds_read_b64_tr_b16 a[216:217], v206 offset:0
v_mfma_f32_16x16x32_bf16 v[32:35], a[192:195], a[4:7], v[32:35]
buffer_load_dwordx4 v173, s[20:23], s42 offen offset:3072 nt lds
v_mfma_f32_16x16x32_bf16 v[64:67], a[192:195], a[8:11], v[64:67]
ds_read_b64_tr_b16 a[218:219], v206 offset:1024
v_mfma_f32_16x16x32_bf16 v[96:99], a[192:195], a[12:15], v[96:99]
s_add_u32 s42, s42, 524288
v_mfma_f32_16x16x32_bf16 v[4:7], a[196:199], a[0:3], v[4:7]
ds_read_b64_tr_b16 a[220:221], v207 offset:0
v_mfma_f32_16x16x32_bf16 v[36:39], a[196:199], a[4:7], v[36:39]
buffer_load_dwordx4 a[64:67], v183, s[24:27], s40 offen offset:0
v_mfma_f32_16x16x32_bf16 v[68:71], a[196:199], a[8:11], v[68:71]
ds_read_b64_tr_b16 a[222:223], v207 offset:1024
v_mfma_f32_16x16x32_bf16 v[100:103], a[196:199], a[12:15], v[100:103]
s_waitcnt lgkmcnt(8)
v_mfma_f32_16x16x32_bf16 v[8:11], a[200:203], a[0:3], v[8:11]
ds_read_b64_tr_b16 a[192:193], v200 offset:8192
v_mfma_f32_16x16x32_bf16 v[40:43], a[200:203], a[4:7], v[40:43]
buffer_load_dwordx4 a[68:71], v183, s[24:27], s40 offen offset:256
v_mfma_f32_16x16x32_bf16 v[72:75], a[200:203], a[8:11], v[72:75]
ds_read_b64_tr_b16 a[194:195], v200 offset:9216
v_mfma_f32_16x16x32_bf16 v[104:107], a[200:203], a[12:15], v[104:107]
v_mfma_f32_16x16x32_bf16 v[12:15], a[204:207], a[0:3], v[12:15]
ds_read_b64_tr_b16 a[196:197], v201 offset:8192
v_mfma_f32_16x16x32_bf16 v[44:47], a[204:207], a[4:7], v[44:47]
buffer_load_dwordx4 a[72:75], v183, s[24:27], s41 offen offset:0
v_mfma_f32_16x16x32_bf16 v[76:79], a[204:207], a[8:11], v[76:79]
ds_read_b64_tr_b16 a[198:199], v201 offset:9216
v_mfma_f32_16x16x32_bf16 v[108:111], a[204:207], a[12:15], v[108:111]
s_waitcnt lgkmcnt(8)
v_mfma_f32_16x16x32_bf16 v[16:19], a[208:211], a[0:3], v[16:19]
ds_read_b64_tr_b16 a[200:201], v202 offset:8192
v_mfma_f32_16x16x32_bf16 v[48:51], a[208:211], a[4:7], v[48:51]
buffer_load_dwordx4 a[76:79], v183, s[24:27], s41 offen offset:256
v_mfma_f32_16x16x32_bf16 v[80:83], a[208:211], a[8:11], v[80:83]
ds_read_b64_tr_b16 a[202:203], v202 offset:9216
v_mfma_f32_16x16x32_bf16 v[112:115], a[208:211], a[12:15], v[112:115]
v_mfma_f32_16x16x32_bf16 v[20:23], a[212:215], a[0:3], v[20:23]
ds_read_b64_tr_b16 a[204:205], v203 offset:8192
v_mfma_f32_16x16x32_bf16 v[52:55], a[212:215], a[4:7], v[52:55]
v_mfma_f32_16x16x32_bf16 v[84:87], a[212:215], a[8:11], v[84:87]
ds_read_b64_tr_b16 a[206:207], v203 offset:9216
v_mfma_f32_16x16x32_bf16 v[116:119], a[212:215], a[12:15], v[116:119]
s_waitcnt lgkmcnt(8)
v_mfma_f32_16x16x32_bf16 v[24:27], a[216:219], a[0:3], v[24:27]
ds_read_b64_tr_b16 a[208:209], v204 offset:8192
v_mfma_f32_16x16x32_bf16 v[56:59], a[216:219], a[4:7], v[56:59]
v_mfma_f32_16x16x32_bf16 v[88:91], a[216:219], a[8:11], v[88:91]
ds_read_b64_tr_b16 a[210:211], v204 offset:9216
v_mfma_f32_16x16x32_bf16 v[120:123], a[216:219], a[12:15], v[120:123]
v_mfma_f32_16x16x32_bf16 v[28:31], a[220:223], a[0:3], v[28:31]
ds_read_b64_tr_b16 a[212:213], v205 offset:8192
v_mfma_f32_16x16x32_bf16 v[60:63], a[220:223], a[4:7], v[60:63]
v_mfma_f32_16x16x32_bf16 v[92:95], a[220:223], a[8:11], v[92:95]
ds_read_b64_tr_b16 a[214:215], v205 offset:9216
v_mfma_f32_16x16x32_bf16 v[124:127], a[220:223], a[12:15], v[124:127]
s_waitcnt vmcnt(20) lgkmcnt(8)
v_mfma_f32_16x16x32_bf16 v[0:3], a[192:195], a[16:19], v[0:3]
ds_read_b64_tr_b16 a[216:217], v206 offset:8192
v_mfma_f32_16x16x32_bf16 v[32:35], a[192:195], a[20:23], v[32:35]
v_mfma_f32_16x16x32_bf16 v[64:67], a[192:195], a[24:27], v[64:67]
ds_read_b64_tr_b16 a[218:219], v206 offset:9216
v_mfma_f32_16x16x32_bf16 v[96:99], a[192:195], a[28:31], v[96:99]
v_mfma_f32_16x16x32_bf16 v[4:7], a[196:199], a[16:19], v[4:7]
ds_read_b64_tr_b16 a[220:221], v207 offset:8192
v_mfma_f32_16x16x32_bf16 v[36:39], a[196:199], a[20:23], v[36:39]
buffer_load_dwordx4 a[80:83], v183, s[24:27], s40 offen offset:2048
v_mfma_f32_16x16x32_bf16 v[68:71], a[196:199], a[24:27], v[68:71]
ds_read_b64_tr_b16 a[222:223], v207 offset:9216
v_mfma_f32_16x16x32_bf16 v[100:103], a[196:199], a[28:31], v[100:103]
s_waitcnt lgkmcnt(8)
s_waitcnt vmcnt(17)
s_barrier
v_mfma_f32_16x16x32_bf16 v[8:11], a[200:203], a[16:19], v[8:11]
ds_read_b64_tr_b16 a[192:193], v200 offset:16384
v_mfma_f32_16x16x32_bf16 v[40:43], a[200:203], a[20:23], v[40:43]
buffer_load_dwordx4 a[84:87], v183, s[24:27], s40 offen offset:2304
v_mfma_f32_16x16x32_bf16 v[72:75], a[200:203], a[24:27], v[72:75]
ds_read_b64_tr_b16 a[194:195], v200 offset:17408
v_mfma_f32_16x16x32_bf16 v[104:107], a[200:203], a[28:31], v[104:107]
s_add_u32 s40, s40, 4096
v_mfma_f32_16x16x32_bf16 v[12:15], a[204:207], a[16:19], v[12:15]
ds_read_b64_tr_b16 a[196:197], v201 offset:16384
v_mfma_f32_16x16x32_bf16 v[44:47], a[204:207], a[20:23], v[44:47]
buffer_load_dwordx4 a[88:91], v183, s[24:27], s41 offen offset:2048
v_mfma_f32_16x16x32_bf16 v[76:79], a[204:207], a[24:27], v[76:79]
ds_read_b64_tr_b16 a[198:199], v201 offset:17408
v_mfma_f32_16x16x32_bf16 v[108:111], a[204:207], a[28:31], v[108:111]
s_waitcnt lgkmcnt(8)
v_mfma_f32_16x16x32_bf16 v[16:19], a[208:211], a[16:19], v[16:19]
ds_read_b64_tr_b16 a[200:201], v202 offset:16384
v_mfma_f32_16x16x32_bf16 v[48:51], a[208:211], a[20:23], v[48:51]
buffer_load_dwordx4 a[92:95], v183, s[24:27], s41 offen offset:2304
v_mfma_f32_16x16x32_bf16 v[80:83], a[208:211], a[24:27], v[80:83]
ds_read_b64_tr_b16 a[202:203], v202 offset:17408
v_mfma_f32_16x16x32_bf16 v[112:115], a[208:211], a[28:31], v[112:115]
s_add_u32 s41, s41, 4096
s_add_u32 m0, s43, 147456
v_mfma_f32_16x16x32_bf16 v[20:23], a[212:215], a[16:19], v[20:23]
ds_read_b64_tr_b16 a[204:205], v203 offset:16384
v_mfma_f32_16x16x32_bf16 v[52:55], a[212:215], a[20:23], v[52:55]
buffer_load_dwordx4 v170, s[20:23], s42 offen offset:0 nt lds
v_mfma_f32_16x16x32_bf16 v[84:87], a[212:215], a[24:27], v[84:87]
ds_read_b64_tr_b16 a[206:207], v203 offset:17408
v_mfma_f32_16x16x32_bf16 v[116:119], a[212:215], a[28:31], v[116:119]
s_waitcnt lgkmcnt(8)
v_mfma_f32_16x16x32_bf16 v[24:27], a[216:219], a[16:19], v[24:27]
ds_read_b64_tr_b16 a[208:209], v204 offset:16384
v_mfma_f32_16x16x32_bf16 v[56:59], a[216:219], a[20:23], v[56:59]
buffer_load_dwordx4 v171, s[20:23], s42 offen offset:1024 nt lds
v_mfma_f32_16x16x32_bf16 v[88:91], a[216:219], a[24:27], v[88:91]
ds_read_b64_tr_b16 a[210:211], v204 offset:17408
v_mfma_f32_16x16x32_bf16 v[120:123], a[216:219], a[28:31], v[120:123]
v_mfma_f32_16x16x32_bf16 v[28:31], a[220:223], a[16:19], v[28:31]
ds_read_b64_tr_b16 a[212:213], v205 offset:16384
v_mfma_f32_16x16x32_bf16 v[60:63], a[220:223], a[20:23], v[60:63]
buffer_load_dwordx4 v172, s[20:23], s42 offen offset:2048 nt lds
v_mfma_f32_16x16x32_bf16 v[92:95], a[220:223], a[24:27], v[92:95]
ds_read_b64_tr_b16 a[214:215], v205 offset:17408
v_mfma_f32_16x16x32_bf16 v[124:127], a[220:223], a[28:31], v[124:127]
s_waitcnt vmcnt(19) lgkmcnt(8)
v_mfma_f32_16x16x32_bf16 v[0:3], a[192:195], a[32:35], v[0:3]
ds_read_b64_tr_b16 a[216:217], v206 offset:16384
v_mfma_f32_16x16x32_bf16 v[32:35], a[192:195], a[36:39], v[32:35]
buffer_load_dwordx4 v173, s[20:23], s42 offen offset:3072 nt lds
v_mfma_f32_16x16x32_bf16 v[64:67], a[192:195], a[40:43], v[64:67]
ds_read_b64_tr_b16 a[218:219], v206 offset:17408
v_mfma_f32_16x16x32_bf16 v[96:99], a[192:195], a[44:47], v[96:99]
s_add_u32 s42, s42, 524288
v_mfma_f32_16x16x32_bf16 v[4:7], a[196:199], a[32:35], v[4:7]
ds_read_b64_tr_b16 a[220:221], v207 offset:16384
v_mfma_f32_16x16x32_bf16 v[36:39], a[196:199], a[36:39], v[36:39]
buffer_load_dwordx4 a[96:99], v183, s[24:27], s40 offen offset:0
v_mfma_f32_16x16x32_bf16 v[68:71], a[196:199], a[40:43], v[68:71]
ds_read_b64_tr_b16 a[222:223], v207 offset:17408
v_mfma_f32_16x16x32_bf16 v[100:103], a[196:199], a[44:47], v[100:103]
s_waitcnt lgkmcnt(8)
v_mfma_f32_16x16x32_bf16 v[8:11], a[200:203], a[32:35], v[8:11]
ds_read_b64_tr_b16 a[192:193], v200 offset:24576
v_mfma_f32_16x16x32_bf16 v[40:43], a[200:203], a[36:39], v[40:43]
buffer_load_dwordx4 a[100:103], v183, s[24:27], s40 offen offset:256
v_mfma_f32_16x16x32_bf16 v[72:75], a[200:203], a[40:43], v[72:75]
ds_read_b64_tr_b16 a[194:195], v200 offset:25600
v_mfma_f32_16x16x32_bf16 v[104:107], a[200:203], a[44:47], v[104:107]
v_mfma_f32_16x16x32_bf16 v[12:15], a[204:207], a[32:35], v[12:15]
ds_read_b64_tr_b16 a[196:197], v201 offset:24576
v_mfma_f32_16x16x32_bf16 v[44:47], a[204:207], a[36:39], v[44:47]
buffer_load_dwordx4 a[104:107], v183, s[24:27], s41 offen offset:0
v_mfma_f32_16x16x32_bf16 v[76:79], a[204:207], a[40:43], v[76:79]
ds_read_b64_tr_b16 a[198:199], v201 offset:25600
v_mfma_f32_16x16x32_bf16 v[108:111], a[204:207], a[44:47], v[108:111]
s_waitcnt lgkmcnt(8)
v_mfma_f32_16x16x32_bf16 v[16:19], a[208:211], a[32:35], v[16:19]
ds_read_b64_tr_b16 a[200:201], v202 offset:24576
v_mfma_f32_16x16x32_bf16 v[48:51], a[208:211], a[36:39], v[48:51]
buffer_load_dwordx4 a[108:111], v183, s[24:27], s41 offen offset:256
v_mfma_f32_16x16x32_bf16 v[80:83], a[208:211], a[40:43], v[80:83]
ds_read_b64_tr_b16 a[202:203], v202 offset:25600
v_mfma_f32_16x16x32_bf16 v[112:115], a[208:211], a[44:47], v[112:115]
v_mfma_f32_16x16x32_bf16 v[20:23], a[212:215], a[32:35], v[20:23]
ds_read_b64_tr_b16 a[204:205], v203 offset:24576
v_mfma_f32_16x16x32_bf16 v[52:55], a[212:215], a[36:39], v[52:55]
v_mfma_f32_16x16x32_bf16 v[84:87], a[212:215], a[40:43], v[84:87]
ds_read_b64_tr_b16 a[206:207], v203 offset:25600
v_mfma_f32_16x16x32_bf16 v[116:119], a[212:215], a[44:47], v[116:119]
s_waitcnt lgkmcnt(8)
v_mfma_f32_16x16x32_bf16 v[24:27], a[216:219], a[32:35], v[24:27]
ds_read_b64_tr_b16 a[208:209], v204 offset:24576
v_mfma_f32_16x16x32_bf16 v[56:59], a[216:219], a[36:39], v[56:59]
v_mfma_f32_16x16x32_bf16 v[88:91], a[216:219], a[40:43], v[88:91]
ds_read_b64_tr_b16 a[210:211], v204 offset:25600
v_mfma_f32_16x16x32_bf16 v[120:123], a[216:219], a[44:47], v[120:123]
v_mfma_f32_16x16x32_bf16 v[28:31], a[220:223], a[32:35], v[28:31]
ds_read_b64_tr_b16 a[212:213], v205 offset:24576
v_mfma_f32_16x16x32_bf16 v[60:63], a[220:223], a[36:39], v[60:63]
v_mfma_f32_16x16x32_bf16 v[92:95], a[220:223], a[40:43], v[92:95]
ds_read_b64_tr_b16 a[214:215], v205 offset:25600
v_mfma_f32_16x16x32_bf16 v[124:127], a[220:223], a[44:47], v[124:127]
s_waitcnt vmcnt(20) lgkmcnt(8)
v_mfma_f32_16x16x32_bf16 v[0:3], a[192:195], a[48:51], v[0:3]
ds_read_b64_tr_b16 a[216:217], v206 offset:24576
v_mfma_f32_16x16x32_bf16 v[32:35], a[192:195], a[52:55], v[32:35]
v_mfma_f32_16x16x32_bf16 v[64:67], a[192:195], a[56:59], v[64:67]
ds_read_b64_tr_b16 a[218:219], v206 offset:25600
v_mfma_f32_16x16x32_bf16 v[96:99], a[192:195], a[60:63], v[96:99]
v_mfma_f32_16x16x32_bf16 v[4:7], a[196:199], a[48:51], v[4:7]
ds_read_b64_tr_b16 a[220:221], v207 offset:24576
v_mfma_f32_16x16x32_bf16 v[36:39], a[196:199], a[52:55], v[36:39]
buffer_load_dwordx4 a[112:115], v183, s[24:27], s40 offen offset:2048
v_mfma_f32_16x16x32_bf16 v[68:71], a[196:199], a[56:59], v[68:71]
ds_read_b64_tr_b16 a[222:223], v207 offset:25600
v_mfma_f32_16x16x32_bf16 v[100:103], a[196:199], a[60:63], v[100:103]
s_waitcnt lgkmcnt(8)
s_waitcnt vmcnt(17)
s_barrier
v_mfma_f32_16x16x32_bf16 v[8:11], a[200:203], a[48:51], v[8:11]
ds_read_b64_tr_b16 a[192:193], v200 offset:32768
v_mfma_f32_16x16x32_bf16 v[40:43], a[200:203], a[52:55], v[40:43]
buffer_load_dwordx4 a[116:119], v183, s[24:27], s40 offen offset:2304
v_mfma_f32_16x16x32_bf16 v[72:75], a[200:203], a[56:59], v[72:75]
ds_read_b64_tr_b16 a[194:195], v200 offset:33792
v_mfma_f32_16x16x32_bf16 v[104:107], a[200:203], a[60:63], v[104:107]
s_add_u32 s40, s40, 4096
v_mfma_f32_16x16x32_bf16 v[12:15], a[204:207], a[48:51], v[12:15]
ds_read_b64_tr_b16 a[196:197], v201 offset:32768
v_mfma_f32_16x16x32_bf16 v[44:47], a[204:207], a[52:55], v[44:47]
buffer_load_dwordx4 a[120:123], v183, s[24:27], s41 offen offset:2048
v_mfma_f32_16x16x32_bf16 v[76:79], a[204:207], a[56:59], v[76:79]
ds_read_b64_tr_b16 a[198:199], v201 offset:33792
v_mfma_f32_16x16x32_bf16 v[108:111], a[204:207], a[60:63], v[108:111]
s_waitcnt lgkmcnt(8)
v_mfma_f32_16x16x32_bf16 v[16:19], a[208:211], a[48:51], v[16:19]
ds_read_b64_tr_b16 a[200:201], v202 offset:32768
v_mfma_f32_16x16x32_bf16 v[48:51], a[208:211], a[52:55], v[48:51]
buffer_load_dwordx4 a[124:127], v183, s[24:27], s41 offen offset:2304
v_mfma_f32_16x16x32_bf16 v[80:83], a[208:211], a[56:59], v[80:83]
ds_read_b64_tr_b16 a[202:203], v202 offset:33792
v_mfma_f32_16x16x32_bf16 v[112:115], a[208:211], a[60:63], v[112:115]
s_add_u32 s41, s41, 4096
s_add_u32 m0, s43, 98304
v_mfma_f32_16x16x32_bf16 v[20:23], a[212:215], a[48:51], v[20:23]
ds_read_b64_tr_b16 a[204:205], v203 offset:32768
v_mfma_f32_16x16x32_bf16 v[52:55], a[212:215], a[52:55], v[52:55]
buffer_load_dwordx4 v170, s[20:23], s42 offen offset:0 nt lds
v_mfma_f32_16x16x32_bf16 v[84:87], a[212:215], a[56:59], v[84:87]
ds_read_b64_tr_b16 a[206:207], v203 offset:33792
v_mfma_f32_16x16x32_bf16 v[116:119], a[212:215], a[60:63], v[116:119]
s_waitcnt lgkmcnt(8)
v_mfma_f32_16x16x32_bf16 v[24:27], a[216:219], a[48:51], v[24:27]
ds_read_b64_tr_b16 a[208:209], v204 offset:32768
v_mfma_f32_16x16x32_bf16 v[56:59], a[216:219], a[52:55], v[56:59]
buffer_load_dwordx4 v171, s[20:23], s42 offen offset:1024 nt lds
v_mfma_f32_16x16x32_bf16 v[88:91], a[216:219], a[56:59], v[88:91]
ds_read_b64_tr_b16 a[210:211], v204 offset:33792
v_mfma_f32_16x16x32_bf16 v[120:123], a[216:219], a[60:63], v[120:123]
v_mfma_f32_16x16x32_bf16 v[28:31], a[220:223], a[48:51], v[28:31]
ds_read_b64_tr_b16 a[212:213], v205 offset:32768
v_mfma_f32_16x16x32_bf16 v[60:63], a[220:223], a[52:55], v[60:63]
buffer_load_dwordx4 v172, s[20:23], s42 offen offset:2048 nt lds
v_mfma_f32_16x16x32_bf16 v[92:95], a[220:223], a[56:59], v[92:95]
ds_read_b64_tr_b16 a[214:215], v205 offset:33792
v_mfma_f32_16x16x32_bf16 v[124:127], a[220:223], a[60:63], v[124:127]
s_waitcnt vmcnt(19) lgkmcnt(8)
v_mfma_f32_16x16x32_bf16 v[0:3], a[192:195], a[64:67], v[0:3]
ds_read_b64_tr_b16 a[216:217], v206 offset:32768
v_mfma_f32_16x16x32_bf16 v[32:35], a[192:195], a[68:71], v[32:35]
buffer_load_dwordx4 v173, s[20:23], s42 offen offset:3072 nt lds
v_mfma_f32_16x16x32_bf16 v[64:67], a[192:195], a[72:75], v[64:67]
ds_read_b64_tr_b16 a[218:219], v206 offset:33792
v_mfma_f32_16x16x32_bf16 v[96:99], a[192:195], a[76:79], v[96:99]
s_add_u32 s42, s42, 524288
v_mfma_f32_16x16x32_bf16 v[4:7], a[196:199], a[64:67], v[4:7]
ds_read_b64_tr_b16 a[220:221], v207 offset:32768
v_mfma_f32_16x16x32_bf16 v[36:39], a[196:199], a[68:71], v[36:39]
buffer_load_dwordx4 a[0:3], v183, s[24:27], s40 offen offset:0
v_mfma_f32_16x16x32_bf16 v[68:71], a[196:199], a[72:75], v[68:71]
ds_read_b64_tr_b16 a[222:223], v207 offset:33792
v_mfma_f32_16x16x32_bf16 v[100:103], a[196:199], a[76:79], v[100:103]
s_waitcnt lgkmcnt(8)
v_mfma_f32_16x16x32_bf16 v[8:11], a[200:203], a[64:67], v[8:11]
ds_read_b64_tr_b16 a[192:193], v200 offset:40960
v_mfma_f32_16x16x32_bf16 v[40:43], a[200:203], a[68:71], v[40:43]
buffer_load_dwordx4 a[4:7], v183, s[24:27], s40 offen offset:256
v_mfma_f32_16x16x32_bf16 v[72:75], a[200:203], a[72:75], v[72:75]
ds_read_b64_tr_b16 a[194:195], v200 offset:41984
v_mfma_f32_16x16x32_bf16 v[104:107], a[200:203], a[76:79], v[104:107]
v_mfma_f32_16x16x32_bf16 v[12:15], a[204:207], a[64:67], v[12:15]
ds_read_b64_tr_b16 a[196:197], v201 offset:40960
v_mfma_f32_16x16x32_bf16 v[44:47], a[204:207], a[68:71], v[44:47]
buffer_load_dwordx4 a[8:11], v183, s[24:27], s41 offen offset:0
v_mfma_f32_16x16x32_bf16 v[76:79], a[204:207], a[72:75], v[76:79]
ds_read_b64_tr_b16 a[198:199], v201 offset:41984
v_mfma_f32_16x16x32_bf16 v[108:111], a[204:207], a[76:79], v[108:111]
s_waitcnt lgkmcnt(8)
v_mfma_f32_16x16x32_bf16 v[16:19], a[208:211], a[64:67], v[16:19]
ds_read_b64_tr_b16 a[200:201], v202 offset:40960
v_mfma_f32_16x16x32_bf16 v[48:51], a[208:211], a[68:71], v[48:51]
buffer_load_dwordx4 a[12:15], v183, s[24:27], s41 offen offset:256
v_mfma_f32_16x16x32_bf16 v[80:83], a[208:211], a[72:75], v[80:83]
ds_read_b64_tr_b16 a[202:203], v202 offset:41984
v_mfma_f32_16x16x32_bf16 v[112:115], a[208:211], a[76:79], v[112:115]
v_mfma_f32_16x16x32_bf16 v[20:23], a[212:215], a[64:67], v[20:23]
ds_read_b64_tr_b16 a[204:205], v203 offset:40960
v_mfma_f32_16x16x32_bf16 v[52:55], a[212:215], a[68:71], v[52:55]
v_mfma_f32_16x16x32_bf16 v[84:87], a[212:215], a[72:75], v[84:87]
ds_read_b64_tr_b16 a[206:207], v203 offset:41984
v_mfma_f32_16x16x32_bf16 v[116:119], a[212:215], a[76:79], v[116:119]
s_waitcnt lgkmcnt(8)
v_mfma_f32_16x16x32_bf16 v[24:27], a[216:219], a[64:67], v[24:27]
ds_read_b64_tr_b16 a[208:209], v204 offset:40960
v_mfma_f32_16x16x32_bf16 v[56:59], a[216:219], a[68:71], v[56:59]
v_mfma_f32_16x16x32_bf16 v[88:91], a[216:219], a[72:75], v[88:91]
ds_read_b64_tr_b16 a[210:211], v204 offset:41984
v_mfma_f32_16x16x32_bf16 v[120:123], a[216:219], a[76:79], v[120:123]
v_mfma_f32_16x16x32_bf16 v[28:31], a[220:223], a[64:67], v[28:31]
ds_read_b64_tr_b16 a[212:213], v205 offset:40960
v_mfma_f32_16x16x32_bf16 v[60:63], a[220:223], a[68:71], v[60:63]
v_mfma_f32_16x16x32_bf16 v[92:95], a[220:223], a[72:75], v[92:95]
ds_read_b64_tr_b16 a[214:215], v205 offset:41984
v_mfma_f32_16x16x32_bf16 v[124:127], a[220:223], a[76:79], v[124:127]
s_waitcnt vmcnt(20) lgkmcnt(8)
v_mfma_f32_16x16x32_bf16 v[0:3], a[192:195], a[80:83], v[0:3]
ds_read_b64_tr_b16 a[216:217], v206 offset:40960
v_mfma_f32_16x16x32_bf16 v[32:35], a[192:195], a[84:87], v[32:35]
v_mfma_f32_16x16x32_bf16 v[64:67], a[192:195], a[88:91], v[64:67]
ds_read_b64_tr_b16 a[218:219], v206 offset:41984
v_mfma_f32_16x16x32_bf16 v[96:99], a[192:195], a[92:95], v[96:99]
v_mfma_f32_16x16x32_bf16 v[4:7], a[196:199], a[80:83], v[4:7]
ds_read_b64_tr_b16 a[220:221], v207 offset:40960
v_mfma_f32_16x16x32_bf16 v[36:39], a[196:199], a[84:87], v[36:39]
buffer_load_dwordx4 a[16:19], v183, s[24:27], s40 offen offset:2048
v_mfma_f32_16x16x32_bf16 v[68:71], a[196:199], a[88:91], v[68:71]
ds_read_b64_tr_b16 a[222:223], v207 offset:41984
v_mfma_f32_16x16x32_bf16 v[100:103], a[196:199], a[92:95], v[100:103]
s_waitcnt lgkmcnt(8)
s_waitcnt vmcnt(17)
s_barrier
v_mfma_f32_16x16x32_bf16 v[8:11], a[200:203], a[80:83], v[8:11]
ds_read_b64_tr_b16 a[192:193], v200 offset:49152
v_mfma_f32_16x16x32_bf16 v[40:43], a[200:203], a[84:87], v[40:43]
buffer_load_dwordx4 a[20:23], v183, s[24:27], s40 offen offset:2304
v_mfma_f32_16x16x32_bf16 v[72:75], a[200:203], a[88:91], v[72:75]
ds_read_b64_tr_b16 a[194:195], v200 offset:50176
v_mfma_f32_16x16x32_bf16 v[104:107], a[200:203], a[92:95], v[104:107]
s_add_u32 s40, s40, 4096
v_mfma_f32_16x16x32_bf16 v[12:15], a[204:207], a[80:83], v[12:15]
ds_read_b64_tr_b16 a[196:197], v201 offset:49152
v_mfma_f32_16x16x32_bf16 v[44:47], a[204:207], a[84:87], v[44:47]
buffer_load_dwordx4 a[24:27], v183, s[24:27], s41 offen offset:2048
v_mfma_f32_16x16x32_bf16 v[76:79], a[204:207], a[88:91], v[76:79]
ds_read_b64_tr_b16 a[198:199], v201 offset:50176
v_mfma_f32_16x16x32_bf16 v[108:111], a[204:207], a[92:95], v[108:111]
s_waitcnt lgkmcnt(8)
v_mfma_f32_16x16x32_bf16 v[16:19], a[208:211], a[80:83], v[16:19]
ds_read_b64_tr_b16 a[200:201], v202 offset:49152
v_mfma_f32_16x16x32_bf16 v[48:51], a[208:211], a[84:87], v[48:51]
buffer_load_dwordx4 a[28:31], v183, s[24:27], s41 offen offset:2304
v_mfma_f32_16x16x32_bf16 v[80:83], a[208:211], a[88:91], v[80:83]
ds_read_b64_tr_b16 a[202:203], v202 offset:50176
v_mfma_f32_16x16x32_bf16 v[112:115], a[208:211], a[92:95], v[112:115]
s_add_u32 s41, s41, 4096
s_add_u32 m0, s43, 114688
v_mfma_f32_16x16x32_bf16 v[20:23], a[212:215], a[80:83], v[20:23]
ds_read_b64_tr_b16 a[204:205], v203 offset:49152
v_mfma_f32_16x16x32_bf16 v[52:55], a[212:215], a[84:87], v[52:55]
buffer_load_dwordx4 v170, s[20:23], s42 offen offset:0 nt lds
v_mfma_f32_16x16x32_bf16 v[84:87], a[212:215], a[88:91], v[84:87]
ds_read_b64_tr_b16 a[206:207], v203 offset:50176
v_mfma_f32_16x16x32_bf16 v[116:119], a[212:215], a[92:95], v[116:119]
s_waitcnt lgkmcnt(8)
v_mfma_f32_16x16x32_bf16 v[24:27], a[216:219], a[80:83], v[24:27]
ds_read_b64_tr_b16 a[208:209], v204 offset:49152
v_mfma_f32_16x16x32_bf16 v[56:59], a[216:219], a[84:87], v[56:59]
buffer_load_dwordx4 v171, s[20:23], s42 offen offset:1024 nt lds
v_mfma_f32_16x16x32_bf16 v[88:91], a[216:219], a[88:91], v[88:91]
ds_read_b64_tr_b16 a[210:211], v204 offset:50176
v_mfma_f32_16x16x32_bf16 v[120:123], a[216:219], a[92:95], v[120:123]
v_mfma_f32_16x16x32_bf16 v[28:31], a[220:223], a[80:83], v[28:31]
ds_read_b64_tr_b16 a[212:213], v205 offset:49152
v_mfma_f32_16x16x32_bf16 v[60:63], a[220:223], a[84:87], v[60:63]
buffer_load_dwordx4 v172, s[20:23], s42 offen offset:2048 nt lds
v_mfma_f32_16x16x32_bf16 v[92:95], a[220:223], a[88:91], v[92:95]
ds_read_b64_tr_b16 a[214:215], v205 offset:50176
v_mfma_f32_16x16x32_bf16 v[124:127], a[220:223], a[92:95], v[124:127]
s_waitcnt vmcnt(19) lgkmcnt(8)
v_mfma_f32_16x16x32_bf16 v[0:3], a[192:195], a[96:99], v[0:3]
ds_read_b64_tr_b16 a[216:217], v206 offset:49152
v_mfma_f32_16x16x32_bf16 v[32:35], a[192:195], a[100:103], v[32:35]
buffer_load_dwordx4 v173, s[20:23], s42 offen offset:3072 nt lds
v_mfma_f32_16x16x32_bf16 v[64:67], a[192:195], a[104:107], v[64:67]
ds_read_b64_tr_b16 a[218:219], v206 offset:50176
v_mfma_f32_16x16x32_bf16 v[96:99], a[192:195], a[108:111], v[96:99]
s_add_u32 s42, s42, 524288
v_mfma_f32_16x16x32_bf16 v[4:7], a[196:199], a[96:99], v[4:7]
ds_read_b64_tr_b16 a[220:221], v207 offset:49152
v_mfma_f32_16x16x32_bf16 v[36:39], a[196:199], a[100:103], v[36:39]
buffer_load_dwordx4 a[32:35], v183, s[24:27], s40 offen offset:0
v_mfma_f32_16x16x32_bf16 v[68:71], a[196:199], a[104:107], v[68:71]
ds_read_b64_tr_b16 a[222:223], v207 offset:50176
v_mfma_f32_16x16x32_bf16 v[100:103], a[196:199], a[108:111], v[100:103]
s_waitcnt lgkmcnt(8)
v_mfma_f32_16x16x32_bf16 v[8:11], a[200:203], a[96:99], v[8:11]
ds_read_b64_tr_b16 a[192:193], v200 offset:57344
v_mfma_f32_16x16x32_bf16 v[40:43], a[200:203], a[100:103], v[40:43]
buffer_load_dwordx4 a[36:39], v183, s[24:27], s40 offen offset:256
v_mfma_f32_16x16x32_bf16 v[72:75], a[200:203], a[104:107], v[72:75]
ds_read_b64_tr_b16 a[194:195], v200 offset:58368
v_mfma_f32_16x16x32_bf16 v[104:107], a[200:203], a[108:111], v[104:107]
v_mfma_f32_16x16x32_bf16 v[12:15], a[204:207], a[96:99], v[12:15]
ds_read_b64_tr_b16 a[196:197], v201 offset:57344
v_mfma_f32_16x16x32_bf16 v[44:47], a[204:207], a[100:103], v[44:47]
buffer_load_dwordx4 a[40:43], v183, s[24:27], s41 offen offset:0
v_mfma_f32_16x16x32_bf16 v[76:79], a[204:207], a[104:107], v[76:79]
ds_read_b64_tr_b16 a[198:199], v201 offset:58368
v_mfma_f32_16x16x32_bf16 v[108:111], a[204:207], a[108:111], v[108:111]
s_waitcnt lgkmcnt(8)
v_mfma_f32_16x16x32_bf16 v[16:19], a[208:211], a[96:99], v[16:19]
ds_read_b64_tr_b16 a[200:201], v202 offset:57344
v_mfma_f32_16x16x32_bf16 v[48:51], a[208:211], a[100:103], v[48:51]
buffer_load_dwordx4 a[44:47], v183, s[24:27], s41 offen offset:256
v_mfma_f32_16x16x32_bf16 v[80:83], a[208:211], a[104:107], v[80:83]
ds_read_b64_tr_b16 a[202:203], v202 offset:58368
v_mfma_f32_16x16x32_bf16 v[112:115], a[208:211], a[108:111], v[112:115]
v_mfma_f32_16x16x32_bf16 v[20:23], a[212:215], a[96:99], v[20:23]
ds_read_b64_tr_b16 a[204:205], v203 offset:57344
v_mfma_f32_16x16x32_bf16 v[52:55], a[212:215], a[100:103], v[52:55]
v_mfma_f32_16x16x32_bf16 v[84:87], a[212:215], a[104:107], v[84:87]
ds_read_b64_tr_b16 a[206:207], v203 offset:58368
v_mfma_f32_16x16x32_bf16 v[116:119], a[212:215], a[108:111], v[116:119]
s_waitcnt lgkmcnt(8)
v_mfma_f32_16x16x32_bf16 v[24:27], a[216:219], a[96:99], v[24:27]
ds_read_b64_tr_b16 a[208:209], v204 offset:57344
v_mfma_f32_16x16x32_bf16 v[56:59], a[216:219], a[100:103], v[56:59]
v_mfma_f32_16x16x32_bf16 v[88:91], a[216:219], a[104:107], v[88:91]
ds_read_b64_tr_b16 a[210:211], v204 offset:58368
v_mfma_f32_16x16x32_bf16 v[120:123], a[216:219], a[108:111], v[120:123]
v_mfma_f32_16x16x32_bf16 v[28:31], a[220:223], a[96:99], v[28:31]
ds_read_b64_tr_b16 a[212:213], v205 offset:57344
v_mfma_f32_16x16x32_bf16 v[60:63], a[220:223], a[100:103], v[60:63]
v_mfma_f32_16x16x32_bf16 v[92:95], a[220:223], a[104:107], v[92:95]
ds_read_b64_tr_b16 a[214:215], v205 offset:58368
v_mfma_f32_16x16x32_bf16 v[124:127], a[220:223], a[108:111], v[124:127]
s_waitcnt vmcnt(20) lgkmcnt(8)
v_mfma_f32_16x16x32_bf16 v[0:3], a[192:195], a[112:115], v[0:3]
ds_read_b64_tr_b16 a[216:217], v206 offset:57344
v_mfma_f32_16x16x32_bf16 v[32:35], a[192:195], a[116:119], v[32:35]
v_mfma_f32_16x16x32_bf16 v[64:67], a[192:195], a[120:123], v[64:67]
ds_read_b64_tr_b16 a[218:219], v206 offset:58368
v_mfma_f32_16x16x32_bf16 v[96:99], a[192:195], a[124:127], v[96:99]
v_mfma_f32_16x16x32_bf16 v[4:7], a[196:199], a[112:115], v[4:7]
ds_read_b64_tr_b16 a[220:221], v207 offset:57344
v_mfma_f32_16x16x32_bf16 v[36:39], a[196:199], a[116:119], v[36:39]
buffer_load_dwordx4 a[48:51], v183, s[24:27], s40 offen offset:2048
v_mfma_f32_16x16x32_bf16 v[68:71], a[196:199], a[120:123], v[68:71]
ds_read_b64_tr_b16 a[222:223], v207 offset:58368
v_mfma_f32_16x16x32_bf16 v[100:103], a[196:199], a[124:127], v[100:103]
s_waitcnt lgkmcnt(8)
s_waitcnt vmcnt(17)
s_barrier
v_mfma_f32_16x16x32_bf16 v[8:11], a[200:203], a[112:115], v[8:11]
ds_read_b64_tr_b16 a[192:193], v200 offset:0
v_mfma_f32_16x16x32_bf16 v[40:43], a[200:203], a[116:119], v[40:43]
buffer_load_dwordx4 a[52:55], v183, s[24:27], s40 offen offset:2304
v_mfma_f32_16x16x32_bf16 v[72:75], a[200:203], a[120:123], v[72:75]
ds_read_b64_tr_b16 a[194:195], v200 offset:1024
v_mfma_f32_16x16x32_bf16 v[104:107], a[200:203], a[124:127], v[104:107]
s_add_u32 s40, s40, 4096
v_mfma_f32_16x16x32_bf16 v[12:15], a[204:207], a[112:115], v[12:15]
ds_read_b64_tr_b16 a[196:197], v201 offset:0
v_mfma_f32_16x16x32_bf16 v[44:47], a[204:207], a[116:119], v[44:47]
buffer_load_dwordx4 a[56:59], v183, s[24:27], s41 offen offset:2048
v_mfma_f32_16x16x32_bf16 v[76:79], a[204:207], a[120:123], v[76:79]
ds_read_b64_tr_b16 a[198:199], v201 offset:1024
v_mfma_f32_16x16x32_bf16 v[108:111], a[204:207], a[124:127], v[108:111]
s_waitcnt lgkmcnt(8)
v_mfma_f32_16x16x32_bf16 v[16:19], a[208:211], a[112:115], v[16:19]
ds_read_b64_tr_b16 a[200:201], v202 offset:0
v_mfma_f32_16x16x32_bf16 v[48:51], a[208:211], a[116:119], v[48:51]
buffer_load_dwordx4 a[60:63], v183, s[24:27], s41 offen offset:2304
v_mfma_f32_16x16x32_bf16 v[80:83], a[208:211], a[120:123], v[80:83]
ds_read_b64_tr_b16 a[202:203], v202 offset:1024
v_mfma_f32_16x16x32_bf16 v[112:115], a[208:211], a[124:127], v[112:115]
s_add_u32 s41, s41, 4096
s_add_u32 m0, s43, 131072
v_mfma_f32_16x16x32_bf16 v[20:23], a[212:215], a[112:115], v[20:23]
ds_read_b64_tr_b16 a[204:205], v203 offset:0
v_mfma_f32_16x16x32_bf16 v[52:55], a[212:215], a[116:119], v[52:55]
buffer_load_dwordx4 v170, s[20:23], s42 offen offset:0 nt lds
v_mfma_f32_16x16x32_bf16 v[84:87], a[212:215], a[120:123], v[84:87]
ds_read_b64_tr_b16 a[206:207], v203 offset:1024
v_mfma_f32_16x16x32_bf16 v[116:119], a[212:215], a[124:127], v[116:119]
s_waitcnt lgkmcnt(8)
v_mfma_f32_16x16x32_bf16 v[24:27], a[216:219], a[112:115], v[24:27]
ds_read_b64_tr_b16 a[208:209], v204 offset:0
v_mfma_f32_16x16x32_bf16 v[56:59], a[216:219], a[116:119], v[56:59]
buffer_load_dwordx4 v171, s[20:23], s42 offen offset:1024 nt lds
v_mfma_f32_16x16x32_bf16 v[88:91], a[216:219], a[120:123], v[88:91]
ds_read_b64_tr_b16 a[210:211], v204 offset:1024
v_mfma_f32_16x16x32_bf16 v[120:123], a[216:219], a[124:127], v[120:123]
v_mfma_f32_16x16x32_bf16 v[28:31], a[220:223], a[112:115], v[28:31]
ds_read_b64_tr_b16 a[212:213], v205 offset:0
v_mfma_f32_16x16x32_bf16 v[60:63], a[220:223], a[116:119], v[60:63]
buffer_load_dwordx4 v172, s[20:23], s42 offen offset:2048 nt lds
v_mfma_f32_16x16x32_bf16 v[92:95], a[220:223], a[120:123], v[92:95]
ds_read_b64_tr_b16 a[214:215], v205 offset:1024
v_mfma_f32_16x16x32_bf16 v[124:127], a[220:223], a[124:127], v[124:127]
s_waitcnt vmcnt(19) lgkmcnt(8)
s_barrier
v_mfma_f32_16x16x32_bf16 v[0:3], a[192:195], a[0:3], v[0:3]
ds_read_b64_tr_b16 a[216:217], v206 offset:0
v_mfma_f32_16x16x32_bf16 v[32:35], a[192:195], a[4:7], v[32:35]
buffer_load_dwordx4 v173, s[20:23], s42 offen offset:3072 nt lds
v_mfma_f32_16x16x32_bf16 v[64:67], a[192:195], a[8:11], v[64:67]
ds_read_b64_tr_b16 a[218:219], v206 offset:1024
v_mfma_f32_16x16x32_bf16 v[96:99], a[192:195], a[12:15], v[96:99]
s_add_u32 s42, s42, 524288
s_add_u32 m0, s43, 147456
v_mfma_f32_16x16x32_bf16 v[4:7], a[196:199], a[0:3], v[4:7]
ds_read_b64_tr_b16 a[220:221], v207 offset:0
v_mfma_f32_16x16x32_bf16 v[36:39], a[196:199], a[4:7], v[36:39]
buffer_load_dwordx4 v170, s[20:23], s42 offen offset:0 nt lds
v_mfma_f32_16x16x32_bf16 v[68:71], a[196:199], a[8:11], v[68:71]
ds_read_b64_tr_b16 a[222:223], v207 offset:1024
v_mfma_f32_16x16x32_bf16 v[100:103], a[196:199], a[12:15], v[100:103]
s_waitcnt lgkmcnt(8)
v_mfma_f32_16x16x32_bf16 v[8:11], a[200:203], a[0:3], v[8:11]
ds_read_b64_tr_b16 a[192:193], v200 offset:8192
v_mfma_f32_16x16x32_bf16 v[40:43], a[200:203], a[4:7], v[40:43]
buffer_load_dwordx4 v171, s[20:23], s42 offen offset:1024 nt lds
v_mfma_f32_16x16x32_bf16 v[72:75], a[200:203], a[8:11], v[72:75]
ds_read_b64_tr_b16 a[194:195], v200 offset:9216
v_mfma_f32_16x16x32_bf16 v[104:107], a[200:203], a[12:15], v[104:107]
v_mfma_f32_16x16x32_bf16 v[12:15], a[204:207], a[0:3], v[12:15]
ds_read_b64_tr_b16 a[196:197], v201 offset:8192
v_mfma_f32_16x16x32_bf16 v[44:47], a[204:207], a[4:7], v[44:47]
buffer_load_dwordx4 v172, s[20:23], s42 offen offset:2048 nt lds
v_mfma_f32_16x16x32_bf16 v[76:79], a[204:207], a[8:11], v[76:79]
ds_read_b64_tr_b16 a[198:199], v201 offset:9216
v_mfma_f32_16x16x32_bf16 v[108:111], a[204:207], a[12:15], v[108:111]
s_waitcnt lgkmcnt(8)
v_mfma_f32_16x16x32_bf16 v[16:19], a[208:211], a[0:3], v[16:19]
ds_read_b64_tr_b16 a[200:201], v202 offset:8192
v_mfma_f32_16x16x32_bf16 v[48:51], a[208:211], a[4:7], v[48:51]
buffer_load_dwordx4 v173, s[20:23], s42 offen offset:3072 nt lds
v_mfma_f32_16x16x32_bf16 v[80:83], a[208:211], a[8:11], v[80:83]
ds_read_b64_tr_b16 a[202:203], v202 offset:9216
v_mfma_f32_16x16x32_bf16 v[112:115], a[208:211], a[12:15], v[112:115]
s_add_u32 s42, s42, 524288
v_mfma_f32_16x16x32_bf16 v[20:23], a[212:215], a[0:3], v[20:23]
ds_read_b64_tr_b16 a[204:205], v203 offset:8192
v_mfma_f32_16x16x32_bf16 v[52:55], a[212:215], a[4:7], v[52:55]
buffer_load_dwordx4 a[64:67], v183, s[24:27], s40 offen offset:0
v_mfma_f32_16x16x32_bf16 v[84:87], a[212:215], a[8:11], v[84:87]
ds_read_b64_tr_b16 a[206:207], v203 offset:9216
v_mfma_f32_16x16x32_bf16 v[116:119], a[212:215], a[12:15], v[116:119]
s_waitcnt lgkmcnt(8)
v_mfma_f32_16x16x32_bf16 v[24:27], a[216:219], a[0:3], v[24:27]
ds_read_b64_tr_b16 a[208:209], v204 offset:8192
v_mfma_f32_16x16x32_bf16 v[56:59], a[216:219], a[4:7], v[56:59]
buffer_load_dwordx4 a[68:71], v183, s[24:27], s40 offen offset:256
v_mfma_f32_16x16x32_bf16 v[88:91], a[216:219], a[8:11], v[88:91]
ds_read_b64_tr_b16 a[210:211], v204 offset:9216
v_mfma_f32_16x16x32_bf16 v[120:123], a[216:219], a[12:15], v[120:123]
v_mfma_f32_16x16x32_bf16 v[28:31], a[220:223], a[0:3], v[28:31]
ds_read_b64_tr_b16 a[212:213], v205 offset:8192
v_mfma_f32_16x16x32_bf16 v[60:63], a[220:223], a[4:7], v[60:63]
buffer_load_dwordx4 a[72:75], v183, s[24:27], s41 offen offset:0
v_mfma_f32_16x16x32_bf16 v[92:95], a[220:223], a[8:11], v[92:95]
ds_read_b64_tr_b16 a[214:215], v205 offset:9216
v_mfma_f32_16x16x32_bf16 v[124:127], a[220:223], a[12:15], v[124:127]
s_waitcnt vmcnt(23) lgkmcnt(8)
v_mfma_f32_16x16x32_bf16 v[0:3], a[192:195], a[16:19], v[0:3]
ds_read_b64_tr_b16 a[216:217], v206 offset:8192
v_mfma_f32_16x16x32_bf16 v[32:35], a[192:195], a[20:23], v[32:35]
buffer_load_dwordx4 a[76:79], v183, s[24:27], s41 offen offset:256
v_mfma_f32_16x16x32_bf16 v[64:67], a[192:195], a[24:27], v[64:67]
ds_read_b64_tr_b16 a[218:219], v206 offset:9216
v_mfma_f32_16x16x32_bf16 v[96:99], a[192:195], a[28:31], v[96:99]
v_mfma_f32_16x16x32_bf16 v[4:7], a[196:199], a[16:19], v[4:7]
ds_read_b64_tr_b16 a[220:221], v207 offset:8192
v_mfma_f32_16x16x32_bf16 v[36:39], a[196:199], a[20:23], v[36:39]
buffer_load_dwordx4 a[80:83], v183, s[24:27], s40 offen offset:2048
v_mfma_f32_16x16x32_bf16 v[68:71], a[196:199], a[24:27], v[68:71]
ds_read_b64_tr_b16 a[222:223], v207 offset:9216
v_mfma_f32_16x16x32_bf16 v[100:103], a[196:199], a[28:31], v[100:103]
s_waitcnt lgkmcnt(8)
s_waitcnt vmcnt(21)
s_barrier
v_mfma_f32_16x16x32_bf16 v[8:11], a[200:203], a[16:19], v[8:11]
ds_read_b64_tr_b16 a[192:193], v200 offset:16384
v_mfma_f32_16x16x32_bf16 v[40:43], a[200:203], a[20:23], v[40:43]
buffer_load_dwordx4 a[84:87], v183, s[24:27], s40 offen offset:2304
v_mfma_f32_16x16x32_bf16 v[72:75], a[200:203], a[24:27], v[72:75]
ds_read_b64_tr_b16 a[194:195], v200 offset:17408
v_mfma_f32_16x16x32_bf16 v[104:107], a[200:203], a[28:31], v[104:107]
s_add_u32 s40, s40, 4096
v_mfma_f32_16x16x32_bf16 v[12:15], a[204:207], a[16:19], v[12:15]
ds_read_b64_tr_b16 a[196:197], v201 offset:16384
v_mfma_f32_16x16x32_bf16 v[44:47], a[204:207], a[20:23], v[44:47]
buffer_load_dwordx4 a[88:91], v183, s[24:27], s41 offen offset:2048
v_mfma_f32_16x16x32_bf16 v[76:79], a[204:207], a[24:27], v[76:79]
ds_read_b64_tr_b16 a[198:199], v201 offset:17408
v_mfma_f32_16x16x32_bf16 v[108:111], a[204:207], a[28:31], v[108:111]
s_waitcnt lgkmcnt(8)
v_mfma_f32_16x16x32_bf16 v[16:19], a[208:211], a[16:19], v[16:19]
ds_read_b64_tr_b16 a[200:201], v202 offset:16384
v_mfma_f32_16x16x32_bf16 v[48:51], a[208:211], a[20:23], v[48:51]
buffer_load_dwordx4 a[92:95], v183, s[24:27], s41 offen offset:2304
v_mfma_f32_16x16x32_bf16 v[80:83], a[208:211], a[24:27], v[80:83]
ds_read_b64_tr_b16 a[202:203], v202 offset:17408
v_mfma_f32_16x16x32_bf16 v[112:115], a[208:211], a[28:31], v[112:115]
s_add_u32 s41, s41, 4096
v_mfma_f32_16x16x32_bf16 v[20:23], a[212:215], a[16:19], v[20:23]
ds_read_b64_tr_b16 a[204:205], v203 offset:16384
v_mfma_f32_16x16x32_bf16 v[52:55], a[212:215], a[20:23], v[52:55]
buffer_load_dwordx4 a[96:99], v183, s[24:27], s40 offen offset:0
v_mfma_f32_16x16x32_bf16 v[84:87], a[212:215], a[24:27], v[84:87]
ds_read_b64_tr_b16 a[206:207], v203 offset:17408
v_mfma_f32_16x16x32_bf16 v[116:119], a[212:215], a[28:31], v[116:119]
s_waitcnt lgkmcnt(8)
v_mfma_f32_16x16x32_bf16 v[24:27], a[216:219], a[16:19], v[24:27]
ds_read_b64_tr_b16 a[208:209], v204 offset:16384
v_mfma_f32_16x16x32_bf16 v[56:59], a[216:219], a[20:23], v[56:59]
buffer_load_dwordx4 a[100:103], v183, s[24:27], s40 offen offset:256
v_mfma_f32_16x16x32_bf16 v[88:91], a[216:219], a[24:27], v[88:91]
ds_read_b64_tr_b16 a[210:211], v204 offset:17408
v_mfma_f32_16x16x32_bf16 v[120:123], a[216:219], a[28:31], v[120:123]
v_mfma_f32_16x16x32_bf16 v[28:31], a[220:223], a[16:19], v[28:31]
ds_read_b64_tr_b16 a[212:213], v205 offset:16384
v_mfma_f32_16x16x32_bf16 v[60:63], a[220:223], a[20:23], v[60:63]
buffer_load_dwordx4 a[104:107], v183, s[24:27], s41 offen offset:0
v_mfma_f32_16x16x32_bf16 v[92:95], a[220:223], a[24:27], v[92:95]
ds_read_b64_tr_b16 a[214:215], v205 offset:17408
v_mfma_f32_16x16x32_bf16 v[124:127], a[220:223], a[28:31], v[124:127]
s_waitcnt vmcnt(23) lgkmcnt(8)
v_mfma_f32_16x16x32_bf16 v[0:3], a[192:195], a[32:35], v[0:3]
ds_read_b64_tr_b16 a[216:217], v206 offset:16384
v_mfma_f32_16x16x32_bf16 v[32:35], a[192:195], a[36:39], v[32:35]
buffer_load_dwordx4 a[108:111], v183, s[24:27], s41 offen offset:256
v_mfma_f32_16x16x32_bf16 v[64:67], a[192:195], a[40:43], v[64:67]
ds_read_b64_tr_b16 a[218:219], v206 offset:17408
v_mfma_f32_16x16x32_bf16 v[96:99], a[192:195], a[44:47], v[96:99]
v_mfma_f32_16x16x32_bf16 v[4:7], a[196:199], a[32:35], v[4:7]
ds_read_b64_tr_b16 a[220:221], v207 offset:16384
v_mfma_f32_16x16x32_bf16 v[36:39], a[196:199], a[36:39], v[36:39]
buffer_load_dwordx4 a[112:115], v183, s[24:27], s40 offen offset:2048
v_mfma_f32_16x16x32_bf16 v[68:71], a[196:199], a[40:43], v[68:71]
ds_read_b64_tr_b16 a[222:223], v207 offset:17408
v_mfma_f32_16x16x32_bf16 v[100:103], a[196:199], a[44:47], v[100:103]
s_waitcnt lgkmcnt(8)
v_mfma_f32_16x16x32_bf16 v[8:11], a[200:203], a[32:35], v[8:11]
ds_read_b64_tr_b16 a[192:193], v200 offset:24576
v_mfma_f32_16x16x32_bf16 v[40:43], a[200:203], a[36:39], v[40:43]
buffer_load_dwordx4 a[116:119], v183, s[24:27], s40 offen offset:2304
v_mfma_f32_16x16x32_bf16 v[72:75], a[200:203], a[40:43], v[72:75]
ds_read_b64_tr_b16 a[194:195], v200 offset:25600
v_mfma_f32_16x16x32_bf16 v[104:107], a[200:203], a[44:47], v[104:107]
s_add_u32 s40, s40, 4096
v_mfma_f32_16x16x32_bf16 v[12:15], a[204:207], a[32:35], v[12:15]
ds_read_b64_tr_b16 a[196:197], v201 offset:24576
v_mfma_f32_16x16x32_bf16 v[44:47], a[204:207], a[36:39], v[44:47]
buffer_load_dwordx4 a[120:123], v183, s[24:27], s41 offen offset:2048
v_mfma_f32_16x16x32_bf16 v[76:79], a[204:207], a[40:43], v[76:79]
ds_read_b64_tr_b16 a[198:199], v201 offset:25600
v_mfma_f32_16x16x32_bf16 v[108:111], a[204:207], a[44:47], v[108:111]
s_waitcnt lgkmcnt(8)
v_mfma_f32_16x16x32_bf16 v[16:19], a[208:211], a[32:35], v[16:19]
ds_read_b64_tr_b16 a[200:201], v202 offset:24576
v_mfma_f32_16x16x32_bf16 v[48:51], a[208:211], a[36:39], v[48:51]
buffer_load_dwordx4 a[124:127], v183, s[24:27], s41 offen offset:2304
v_mfma_f32_16x16x32_bf16 v[80:83], a[208:211], a[40:43], v[80:83]
ds_read_b64_tr_b16 a[202:203], v202 offset:25600
v_mfma_f32_16x16x32_bf16 v[112:115], a[208:211], a[44:47], v[112:115]
s_add_u32 s41, s41, 4096
s_add_u32 m0, s43, 0
v_mfma_f32_16x16x32_bf16 v[20:23], a[212:215], a[32:35], v[20:23]
ds_read_b64_tr_b16 a[204:205], v203 offset:24576
v_mfma_f32_16x16x32_bf16 v[52:55], a[212:215], a[36:39], v[52:55]
buffer_load_dwordx4 v164, s[12:15], s44 offen offset:0 nt lds
v_mfma_f32_16x16x32_bf16 v[84:87], a[212:215], a[40:43], v[84:87]
ds_read_b64_tr_b16 a[206:207], v203 offset:25600
v_mfma_f32_16x16x32_bf16 v[116:119], a[212:215], a[44:47], v[116:119]
s_waitcnt lgkmcnt(8)
v_mfma_f32_16x16x32_bf16 v[24:27], a[216:219], a[32:35], v[24:27]
ds_read_b64_tr_b16 a[208:209], v204 offset:24576
v_mfma_f32_16x16x32_bf16 v[56:59], a[216:219], a[36:39], v[56:59]
buffer_load_dwordx4 v165, s[12:15], s44 offen offset:1024 nt lds
v_mfma_f32_16x16x32_bf16 v[88:91], a[216:219], a[40:43], v[88:91]
ds_read_b64_tr_b16 a[210:211], v204 offset:25600
v_mfma_f32_16x16x32_bf16 v[120:123], a[216:219], a[44:47], v[120:123]
v_mfma_f32_16x16x32_bf16 v[28:31], a[220:223], a[32:35], v[28:31]
ds_read_b64_tr_b16 a[212:213], v205 offset:24576
v_mfma_f32_16x16x32_bf16 v[60:63], a[220:223], a[36:39], v[60:63]
buffer_load_dwordx4 v166, s[12:15], s44 offen offset:2048 nt lds
v_mfma_f32_16x16x32_bf16 v[92:95], a[220:223], a[40:43], v[92:95]
ds_read_b64_tr_b16 a[214:215], v205 offset:25600
v_mfma_f32_16x16x32_bf16 v[124:127], a[220:223], a[44:47], v[124:127]
s_waitcnt vmcnt(27) lgkmcnt(8)
v_mfma_f32_16x16x32_bf16 v[0:3], a[192:195], a[48:51], v[0:3]
ds_read_b64_tr_b16 a[216:217], v206 offset:24576
v_mfma_f32_16x16x32_bf16 v[32:35], a[192:195], a[52:55], v[32:35]
buffer_load_dwordx4 v167, s[12:15], s44 offen offset:3072 nt lds
v_mfma_f32_16x16x32_bf16 v[64:67], a[192:195], a[56:59], v[64:67]
ds_read_b64_tr_b16 a[218:219], v206 offset:25600
v_mfma_f32_16x16x32_bf16 v[96:99], a[192:195], a[60:63], v[96:99]
s_add_u32 s44, s44, 16384
s_add_u32 m0, s43, 16384
v_mfma_f32_16x16x32_bf16 v[4:7], a[196:199], a[48:51], v[4:7]
ds_read_b64_tr_b16 a[220:221], v207 offset:24576
v_mfma_f32_16x16x32_bf16 v[36:39], a[196:199], a[52:55], v[36:39]
buffer_load_dwordx4 v164, s[12:15], s44 offen offset:0 nt lds
v_mfma_f32_16x16x32_bf16 v[68:71], a[196:199], a[56:59], v[68:71]
ds_read_b64_tr_b16 a[222:223], v207 offset:25600
v_mfma_f32_16x16x32_bf16 v[100:103], a[196:199], a[60:63], v[100:103]
s_waitcnt lgkmcnt(8)
s_waitcnt vmcnt(25)
s_barrier
v_mfma_f32_16x16x32_bf16 v[8:11], a[200:203], a[48:51], v[8:11]
ds_read_b64_tr_b16 a[192:193], v200 offset:32768
v_mfma_f32_16x16x32_bf16 v[40:43], a[200:203], a[52:55], v[40:43]
buffer_load_dwordx4 v165, s[12:15], s44 offen offset:1024 nt lds
v_mfma_f32_16x16x32_bf16 v[72:75], a[200:203], a[56:59], v[72:75]
ds_read_b64_tr_b16 a[194:195], v200 offset:33792
v_mfma_f32_16x16x32_bf16 v[104:107], a[200:203], a[60:63], v[104:107]
v_mfma_f32_16x16x32_bf16 v[12:15], a[204:207], a[48:51], v[12:15]
ds_read_b64_tr_b16 a[196:197], v201 offset:32768
v_mfma_f32_16x16x32_bf16 v[44:47], a[204:207], a[52:55], v[44:47]
buffer_load_dwordx4 v166, s[12:15], s44 offen offset:2048 nt lds
v_mfma_f32_16x16x32_bf16 v[76:79], a[204:207], a[56:59], v[76:79]
ds_read_b64_tr_b16 a[198:199], v201 offset:33792
v_mfma_f32_16x16x32_bf16 v[108:111], a[204:207], a[60:63], v[108:111]
s_waitcnt lgkmcnt(8)
v_mfma_f32_16x16x32_bf16 v[16:19], a[208:211], a[48:51], v[16:19]
ds_read_b64_tr_b16 a[200:201], v200 offset:40960
v_mfma_f32_16x16x32_bf16 v[48:51], a[208:211], a[52:55], v[48:51]
buffer_load_dwordx4 v167, s[12:15], s44 offen offset:3072 nt lds
v_mfma_f32_16x16x32_bf16 v[80:83], a[208:211], a[56:59], v[80:83]
ds_read_b64_tr_b16 a[202:203], v200 offset:41984
v_mfma_f32_16x16x32_bf16 v[112:115], a[208:211], a[60:63], v[112:115]
s_add_u32 s44, s44, 16384
s_add_u32 m0, s43, 65536
v_mfma_f32_16x16x32_bf16 v[20:23], a[212:215], a[48:51], v[20:23]
ds_read_b64_tr_b16 a[204:205], v201 offset:40960
v_mfma_f32_16x16x32_bf16 v[52:55], a[212:215], a[52:55], v[52:55]
buffer_load_dwordx4 v168, s[16:19], s45 offen offset:0 nt lds
v_mfma_f32_16x16x32_bf16 v[84:87], a[212:215], a[56:59], v[84:87]
ds_read_b64_tr_b16 a[206:207], v201 offset:41984
v_mfma_f32_16x16x32_bf16 v[116:119], a[212:215], a[60:63], v[116:119]
s_waitcnt lgkmcnt(8)
s_waitcnt vmcnt(25)
s_barrier
v_mfma_f32_16x16x32_bf16 v[24:27], a[216:219], a[48:51], v[24:27]
ds_read_b64_tr_b16 a[208:209], v200 offset:49152
v_mfma_f32_16x16x32_bf16 v[56:59], a[216:219], a[52:55], v[56:59]
buffer_load_dwordx4 v169, s[16:19], s45 offen offset:1024 nt lds
v_mfma_f32_16x16x32_bf16 v[88:91], a[216:219], a[56:59], v[88:91]
ds_read_b64_tr_b16 a[210:211], v200 offset:50176
v_mfma_f32_16x16x32_bf16 v[120:123], a[216:219], a[60:63], v[120:123]
v_mfma_f32_16x16x32_bf16 v[28:31], a[220:223], a[48:51], v[28:31]
ds_read_b64_tr_b16 a[212:213], v201 offset:49152
v_mfma_f32_16x16x32_bf16 v[60:63], a[220:223], a[52:55], v[60:63]
buffer_load_dwordx4 v168, s[16:19], s45 offen offset:2048 nt lds
v_mfma_f32_16x16x32_bf16 v[92:95], a[220:223], a[56:59], v[92:95]
ds_read_b64_tr_b16 a[214:215], v201 offset:50176
v_mfma_f32_16x16x32_bf16 v[124:127], a[220:223], a[60:63], v[124:127]
s_waitcnt vmcnt(23) lgkmcnt(8)
v_mfma_f32_16x16x32_bf16 v[0:3], a[192:195], a[64:67], v[0:3]
ds_read_b64_tr_b16 a[216:217], v200 offset:57344
v_mfma_f32_16x16x32_bf16 v[32:35], a[192:195], a[68:71], v[32:35]
buffer_load_dwordx4 v169, s[16:19], s45 offen offset:3072 nt lds
v_mfma_f32_16x16x32_bf16 v[64:67], a[192:195], a[72:75], v[64:67]
ds_read_b64_tr_b16 a[218:219], v200 offset:58368
v_mfma_f32_16x16x32_bf16 v[96:99], a[192:195], a[76:79], v[96:99]
s_add_u32 s45, s45, 16384
v_mfma_f32_16x16x32_bf16 v[4:7], a[196:199], a[64:67], v[4:7]
ds_read_b64_tr_b16 a[220:221], v201 offset:57344
v_mfma_f32_16x16x32_bf16 v[36:39], a[196:199], a[68:71], v[36:39]
v_mfma_f32_16x16x32_bf16 v[68:71], a[196:199], a[72:75], v[68:71]
ds_read_b64_tr_b16 a[222:223], v201 offset:58368
v_mfma_f32_16x16x32_bf16 v[100:103], a[196:199], a[76:79], v[100:103]
s_waitcnt vmcnt(20) lgkmcnt(8)
v_mfma_f32_16x16x32_bf16 v[0:3], a[200:203], a[80:83], v[0:3]
ds_read_b64_tr_b16 a[192:193], v202 offset:32768
v_mfma_f32_16x16x32_bf16 v[32:35], a[200:203], a[84:87], v[32:35]
v_mfma_f32_16x16x32_bf16 v[64:67], a[200:203], a[88:91], v[64:67]
ds_read_b64_tr_b16 a[194:195], v202 offset:33792
v_mfma_f32_16x16x32_bf16 v[96:99], a[200:203], a[92:95], v[96:99]
v_mfma_f32_16x16x32_bf16 v[4:7], a[204:207], a[80:83], v[4:7]
ds_read_b64_tr_b16 a[196:197], v203 offset:32768
v_mfma_f32_16x16x32_bf16 v[36:39], a[204:207], a[84:87], v[36:39]
v_mfma_f32_16x16x32_bf16 v[68:71], a[204:207], a[88:91], v[68:71]
ds_read_b64_tr_b16 a[198:199], v203 offset:33792
v_mfma_f32_16x16x32_bf16 v[100:103], a[204:207], a[92:95], v[100:103]
s_waitcnt vmcnt(16) lgkmcnt(8)
v_mfma_f32_16x16x32_bf16 v[0:3], a[208:211], a[96:99], v[0:3]
ds_read_b64_tr_b16 a[200:201], v202 offset:40960
v_mfma_f32_16x16x32_bf16 v[32:35], a[208:211], a[100:103], v[32:35]
v_mfma_f32_16x16x32_bf16 v[64:67], a[208:211], a[104:107], v[64:67]
ds_read_b64_tr_b16 a[202:203], v202 offset:41984
v_mfma_f32_16x16x32_bf16 v[96:99], a[208:211], a[108:111], v[96:99]
v_mfma_f32_16x16x32_bf16 v[4:7], a[212:215], a[96:99], v[4:7]
ds_read_b64_tr_b16 a[204:205], v203 offset:40960
v_mfma_f32_16x16x32_bf16 v[36:39], a[212:215], a[100:103], v[36:39]
v_mfma_f32_16x16x32_bf16 v[68:71], a[212:215], a[104:107], v[68:71]
ds_read_b64_tr_b16 a[206:207], v203 offset:41984
v_mfma_f32_16x16x32_bf16 v[100:103], a[212:215], a[108:111], v[100:103]
s_waitcnt vmcnt(12) lgkmcnt(8)
v_mfma_f32_16x16x32_bf16 v[0:3], a[216:219], a[112:115], v[0:3]
ds_read_b64_tr_b16 a[208:209], v202 offset:49152
v_mfma_f32_16x16x32_bf16 v[32:35], a[216:219], a[116:119], v[32:35]
v_mfma_f32_16x16x32_bf16 v[64:67], a[216:219], a[120:123], v[64:67]
ds_read_b64_tr_b16 a[210:211], v202 offset:50176
v_mfma_f32_16x16x32_bf16 v[96:99], a[216:219], a[124:127], v[96:99]
v_mfma_f32_16x16x32_bf16 v[4:7], a[220:223], a[112:115], v[4:7]
ds_read_b64_tr_b16 a[212:213], v203 offset:49152
v_mfma_f32_16x16x32_bf16 v[36:39], a[220:223], a[116:119], v[36:39]
v_mfma_f32_16x16x32_bf16 v[68:71], a[220:223], a[120:123], v[68:71]
ds_read_b64_tr_b16 a[214:215], v203 offset:50176
v_mfma_f32_16x16x32_bf16 v[100:103], a[220:223], a[124:127], v[100:103]
s_waitcnt lgkmcnt(8)
v_mfma_f32_16x16x32_bf16 v[8:11], a[192:195], a[64:67], v[8:11]
ds_read_b64_tr_b16 a[216:217], v202 offset:57344
v_mfma_f32_16x16x32_bf16 v[40:43], a[192:195], a[68:71], v[40:43]
v_mfma_f32_16x16x32_bf16 v[72:75], a[192:195], a[72:75], v[72:75]
ds_read_b64_tr_b16 a[218:219], v202 offset:58368
v_mfma_f32_16x16x32_bf16 v[104:107], a[192:195], a[76:79], v[104:107]
v_mfma_f32_16x16x32_bf16 v[12:15], a[196:199], a[64:67], v[12:15]
ds_read_b64_tr_b16 a[220:221], v203 offset:57344
v_mfma_f32_16x16x32_bf16 v[44:47], a[196:199], a[68:71], v[44:47]
v_cvt_pk_bf16_f32 v0, 0, v0
v_cvt_pk_bf16_f32 v1, 0, v1
v_cvt_pk_bf16_f32 v2, 0, v2
v_mfma_f32_16x16x32_bf16 v[76:79], a[196:199], a[72:75], v[76:79]
ds_read_b64_tr_b16 a[222:223], v203 offset:58368
v_cvt_pk_bf16_f32 v3, 0, v3
v_cvt_pk_bf16_f32 v4, 0, v4
v_mfma_f32_16x16x32_bf16 v[108:111], a[196:199], a[76:79], v[108:111]
s_waitcnt lgkmcnt(8)
v_cvt_pk_bf16_f32 v5, 0, v5
v_cvt_pk_bf16_f32 v6, 0, v6
v_cvt_pk_bf16_f32 v7, 0, v7
v_mfma_f32_16x16x32_bf16 v[8:11], a[200:203], a[80:83], v[8:11]
ds_read_b64_tr_b16 a[192:193], v204 offset:32768
v_mul_f32 v0, s64, v0
v_mul_f32 v1, s64, v1
v_mfma_f32_16x16x32_bf16 v[40:43], a[200:203], a[84:87], v[40:43]
v_mul_f32 v2, s64, v2
v_mul_f32 v3, s64, v3
v_mul_f32 v4, s64, v4
v_mfma_f32_16x16x32_bf16 v[72:75], a[200:203], a[88:91], v[72:75]
ds_read_b64_tr_b16 a[194:195], v204 offset:33792
v_mul_f32 v5, s64, v5
v_mul_f32 v6, s64, v6
v_mfma_f32_16x16x32_bf16 v[104:107], a[200:203], a[92:95], v[104:107]
v_mul_f32 v7, s64, v7
v_cvt_pk_bf16_f32 v0, v0, v1
v_cvt_pk_bf16_f32 v1, v2, v3
v_mfma_f32_16x16x32_bf16 v[12:15], a[204:207], a[80:83], v[12:15]
ds_read_b64_tr_b16 a[196:197], v205 offset:32768
v_cvt_pk_bf16_f32 v2, v4, v5
v_cvt_pk_bf16_f32 v3, v6, v7
v_mfma_f32_16x16x32_bf16 v[44:47], a[204:207], a[84:87], v[44:47]
s_nop 1
v_permlane16_swap_b32 v0, v2
v_mfma_f32_16x16x32_bf16 v[76:79], a[204:207], a[88:91], v[76:79]
ds_read_b64_tr_b16 a[198:199], v205 offset:33792
v_permlane16_swap_b32 v1, v3
v_accvgpr_write_b32 a128, v0
v_mfma_f32_16x16x32_bf16 v[108:111], a[204:207], a[92:95], v[108:111]
s_waitcnt lgkmcnt(8)
v_accvgpr_write_b32 a129, v1
v_accvgpr_write_b32 a130, v2
v_accvgpr_write_b32 a131, v3
v_mfma_f32_16x16x32_bf16 v[8:11], a[208:211], a[96:99], v[8:11]
ds_read_b64_tr_b16 a[200:201], v204 offset:40960
v_cvt_pk_bf16_f32 v32, 0, v32
v_cvt_pk_bf16_f32 v33, 0, v33
v_mfma_f32_16x16x32_bf16 v[40:43], a[208:211], a[100:103], v[40:43]
v_cvt_pk_bf16_f32 v34, 0, v34
v_cvt_pk_bf16_f32 v35, 0, v35
v_cvt_pk_bf16_f32 v36, 0, v36
v_mfma_f32_16x16x32_bf16 v[72:75], a[208:211], a[104:107], v[72:75]
ds_read_b64_tr_b16 a[202:203], v204 offset:41984
v_cvt_pk_bf16_f32 v37, 0, v37
v_cvt_pk_bf16_f32 v38, 0, v38
v_mfma_f32_16x16x32_bf16 v[104:107], a[208:211], a[108:111], v[104:107]
v_cvt_pk_bf16_f32 v39, 0, v39
v_mul_f32 v32, s64, v32
v_mul_f32 v33, s64, v33
v_mfma_f32_16x16x32_bf16 v[12:15], a[212:215], a[96:99], v[12:15]
ds_read_b64_tr_b16 a[204:205], v205 offset:40960
v_mul_f32 v34, s64, v34
v_mul_f32 v35, s64, v35
v_mfma_f32_16x16x32_bf16 v[44:47], a[212:215], a[100:103], v[44:47]
v_mul_f32 v36, s64, v36
v_mul_f32 v37, s64, v37
v_mul_f32 v38, s64, v38
v_mfma_f32_16x16x32_bf16 v[76:79], a[212:215], a[104:107], v[76:79]
ds_read_b64_tr_b16 a[206:207], v205 offset:41984
v_mul_f32 v39, s64, v39
v_cvt_pk_bf16_f32 v32, v32, v33
v_mfma_f32_16x16x32_bf16 v[108:111], a[212:215], a[108:111], v[108:111]
s_waitcnt lgkmcnt(8)
v_cvt_pk_bf16_f32 v33, v34, v35
v_cvt_pk_bf16_f32 v34, v36, v37
v_cvt_pk_bf16_f32 v35, v38, v39
v_mfma_f32_16x16x32_bf16 v[8:11], a[216:219], a[112:115], v[8:11]
ds_read_b64_tr_b16 a[208:209], v204 offset:49152
s_nop 1
v_mfma_f32_16x16x32_bf16 v[40:43], a[216:219], a[116:119], v[40:43]
v_permlane16_swap_b32 v32, v34
v_permlane16_swap_b32 v33, v35
v_accvgpr_write_b32 a144, v32
v_mfma_f32_16x16x32_bf16 v[72:75], a[216:219], a[120:123], v[72:75]
ds_read_b64_tr_b16 a[210:211], v204 offset:50176
v_accvgpr_write_b32 a145, v33
v_accvgpr_write_b32 a146, v34
v_mfma_f32_16x16x32_bf16 v[104:107], a[216:219], a[124:127], v[104:107]
v_accvgpr_write_b32 a147, v35
v_cvt_pk_bf16_f32 v64, 0, v64
v_cvt_pk_bf16_f32 v65, 0, v65
v_mfma_f32_16x16x32_bf16 v[12:15], a[220:223], a[112:115], v[12:15]
ds_read_b64_tr_b16 a[212:213], v205 offset:49152
v_cvt_pk_bf16_f32 v66, 0, v66
v_cvt_pk_bf16_f32 v67, 0, v67
v_mfma_f32_16x16x32_bf16 v[44:47], a[220:223], a[116:119], v[44:47]
v_cvt_pk_bf16_f32 v68, 0, v68
v_cvt_pk_bf16_f32 v69, 0, v69
v_cvt_pk_bf16_f32 v70, 0, v70
v_mfma_f32_16x16x32_bf16 v[76:79], a[220:223], a[120:123], v[76:79]
ds_read_b64_tr_b16 a[214:215], v205 offset:50176
v_cvt_pk_bf16_f32 v71, 0, v71
v_mul_f32 v64, s64, v64
v_mfma_f32_16x16x32_bf16 v[108:111], a[220:223], a[124:127], v[108:111]
s_waitcnt lgkmcnt(8)
v_mul_f32 v65, s64, v65
v_mul_f32 v66, s64, v66
v_mul_f32 v67, s64, v67
v_mfma_f32_16x16x32_bf16 v[16:19], a[192:195], a[64:67], v[16:19]
ds_read_b64_tr_b16 a[216:217], v204 offset:57344
v_mul_f32 v68, s64, v68
v_mul_f32 v69, s64, v69
v_mfma_f32_16x16x32_bf16 v[48:51], a[192:195], a[68:71], v[48:51]
v_mul_f32 v70, s64, v70
v_mul_f32 v71, s64, v71
v_cvt_pk_bf16_f32 v64, v64, v65
v_mfma_f32_16x16x32_bf16 v[80:83], a[192:195], a[72:75], v[80:83]
ds_read_b64_tr_b16 a[218:219], v204 offset:58368
v_cvt_pk_bf16_f32 v65, v66, v67
v_cvt_pk_bf16_f32 v66, v68, v69
v_mfma_f32_16x16x32_bf16 v[112:115], a[192:195], a[76:79], v[112:115]
v_cvt_pk_bf16_f32 v67, v70, v71
s_nop 1
v_mfma_f32_16x16x32_bf16 v[20:23], a[196:199], a[64:67], v[20:23]
ds_read_b64_tr_b16 a[220:221], v205 offset:57344
v_permlane16_swap_b32 v64, v66
v_permlane16_swap_b32 v65, v67
v_mfma_f32_16x16x32_bf16 v[52:55], a[196:199], a[68:71], v[52:55]
v_accvgpr_write_b32 a160, v64
v_accvgpr_write_b32 a161, v65
v_accvgpr_write_b32 a162, v66
v_mfma_f32_16x16x32_bf16 v[84:87], a[196:199], a[72:75], v[84:87]
ds_read_b64_tr_b16 a[222:223], v205 offset:58368
v_accvgpr_write_b32 a163, v67
v_cvt_pk_bf16_f32 v96, 0, v96
v_mfma_f32_16x16x32_bf16 v[116:119], a[196:199], a[76:79], v[116:119]
s_waitcnt lgkmcnt(8)
v_cvt_pk_bf16_f32 v97, 0, v97
v_cvt_pk_bf16_f32 v98, 0, v98
v_cvt_pk_bf16_f32 v99, 0, v99
v_mfma_f32_16x16x32_bf16 v[16:19], a[200:203], a[80:83], v[16:19]
ds_read_b64_tr_b16 a[192:193], v206 offset:32768
v_cvt_pk_bf16_f32 v100, 0, v100
v_cvt_pk_bf16_f32 v101, 0, v101
v_mfma_f32_16x16x32_bf16 v[48:51], a[200:203], a[84:87], v[48:51]
v_cvt_pk_bf16_f32 v102, 0, v102
v_cvt_pk_bf16_f32 v103, 0, v103
v_mul_f32 v96, s64, v96
v_mfma_f32_16x16x32_bf16 v[80:83], a[200:203], a[88:91], v[80:83]
ds_read_b64_tr_b16 a[194:195], v206 offset:33792
v_mul_f32 v97, s64, v97
v_mul_f32 v98, s64, v98
v_mfma_f32_16x16x32_bf16 v[112:115], a[200:203], a[92:95], v[112:115]
v_mul_f32 v99, s64, v99
v_mul_f32 v100, s64, v100
v_mul_f32 v101, s64, v101
v_mfma_f32_16x16x32_bf16 v[20:23], a[204:207], a[80:83], v[20:23]
ds_read_b64_tr_b16 a[196:197], v207 offset:32768
v_mul_f32 v102, s64, v102
v_mul_f32 v103, s64, v103
v_mfma_f32_16x16x32_bf16 v[52:55], a[204:207], a[84:87], v[52:55]
v_cvt_pk_bf16_f32 v96, v96, v97
v_cvt_pk_bf16_f32 v97, v98, v99
v_cvt_pk_bf16_f32 v98, v100, v101
v_mfma_f32_16x16x32_bf16 v[84:87], a[204:207], a[88:91], v[84:87]
ds_read_b64_tr_b16 a[198:199], v207 offset:33792
v_cvt_pk_bf16_f32 v99, v102, v103
s_nop 1
v_mfma_f32_16x16x32_bf16 v[116:119], a[204:207], a[92:95], v[116:119]
s_waitcnt lgkmcnt(8)
v_permlane16_swap_b32 v96, v98
v_permlane16_swap_b32 v97, v99
v_accvgpr_write_b32 a176, v96
v_mfma_f32_16x16x32_bf16 v[16:19], a[208:211], a[96:99], v[16:19]
ds_read_b64_tr_b16 a[200:201], v206 offset:40960
v_accvgpr_write_b32 a177, v97
v_accvgpr_write_b32 a178, v98
v_mfma_f32_16x16x32_bf16 v[48:51], a[208:211], a[100:103], v[48:51]
v_accvgpr_write_b32 a179, v99
v_cvt_pk_bf16_f32 v8, 0, v8
v_cvt_pk_bf16_f32 v9, 0, v9
v_mfma_f32_16x16x32_bf16 v[80:83], a[208:211], a[104:107], v[80:83]
ds_read_b64_tr_b16 a[202:203], v206 offset:41984
v_cvt_pk_bf16_f32 v10, 0, v10
v_cvt_pk_bf16_f32 v11, 0, v11
v_mfma_f32_16x16x32_bf16 v[112:115], a[208:211], a[108:111], v[112:115]
v_cvt_pk_bf16_f32 v12, 0, v12
v_cvt_pk_bf16_f32 v13, 0, v13
v_cvt_pk_bf16_f32 v14, 0, v14
v_mfma_f32_16x16x32_bf16 v[20:23], a[212:215], a[96:99], v[20:23]
ds_read_b64_tr_b16 a[204:205], v207 offset:40960
v_cvt_pk_bf16_f32 v15, 0, v15
v_mul_f32 v8, s64, v8
v_mfma_f32_16x16x32_bf16 v[52:55], a[212:215], a[100:103], v[52:55]
v_mul_f32 v9, s64, v9
v_mul_f32 v10, s64, v10
v_mul_f32 v11, s64, v11
v_mfma_f32_16x16x32_bf16 v[84:87], a[212:215], a[104:107], v[84:87]
ds_read_b64_tr_b16 a[206:207], v207 offset:41984
v_mul_f32 v12, s64, v12
v_mul_f32 v13, s64, v13
v_mfma_f32_16x16x32_bf16 v[116:119], a[212:215], a[108:111], v[116:119]
s_waitcnt lgkmcnt(8)
v_mul_f32 v14, s64, v14
v_mul_f32 v15, s64, v15
v_cvt_pk_bf16_f32 v8, v8, v9
v_mfma_f32_16x16x32_bf16 v[16:19], a[216:219], a[112:115], v[16:19]
ds_read_b64_tr_b16 a[208:209], v206 offset:49152
v_cvt_pk_bf16_f32 v9, v10, v11
v_cvt_pk_bf16_f32 v10, v12, v13
v_mfma_f32_16x16x32_bf16 v[48:51], a[216:219], a[116:119], v[48:51]
v_cvt_pk_bf16_f32 v11, v14, v15
s_nop 1
v_mfma_f32_16x16x32_bf16 v[80:83], a[216:219], a[120:123], v[80:83]
ds_read_b64_tr_b16 a[210:211], v206 offset:50176
v_permlane16_swap_b32 v8, v10
v_permlane16_swap_b32 v9, v11
v_mfma_f32_16x16x32_bf16 v[112:115], a[216:219], a[124:127], v[112:115]
v_accvgpr_write_b32 a132, v8
v_accvgpr_write_b32 a133, v9
v_accvgpr_write_b32 a134, v10
v_mfma_f32_16x16x32_bf16 v[20:23], a[220:223], a[112:115], v[20:23]
ds_read_b64_tr_b16 a[212:213], v207 offset:49152
v_accvgpr_write_b32 a135, v11
v_cvt_pk_bf16_f32 v40, 0, v40
v_mfma_f32_16x16x32_bf16 v[52:55], a[220:223], a[116:119], v[52:55]
v_cvt_pk_bf16_f32 v41, 0, v41
v_cvt_pk_bf16_f32 v42, 0, v42
v_cvt_pk_bf16_f32 v43, 0, v43
v_mfma_f32_16x16x32_bf16 v[84:87], a[220:223], a[120:123], v[84:87]
ds_read_b64_tr_b16 a[214:215], v207 offset:50176
v_cvt_pk_bf16_f32 v44, 0, v44
v_cvt_pk_bf16_f32 v45, 0, v45
v_mfma_f32_16x16x32_bf16 v[116:119], a[220:223], a[124:127], v[116:119]
s_waitcnt lgkmcnt(8)
v_cvt_pk_bf16_f32 v46, 0, v46
v_cvt_pk_bf16_f32 v47, 0, v47
v_mul_f32 v40, s64, v40
v_mfma_f32_16x16x32_bf16 v[24:27], a[192:195], a[64:67], v[24:27]
ds_read_b64_tr_b16 a[216:217], v206 offset:57344
v_mul_f32 v41, s64, v41
v_mul_f32 v42, s64, v42
v_mfma_f32_16x16x32_bf16 v[56:59], a[192:195], a[68:71], v[56:59]
v_mul_f32 v43, s64, v43
v_mul_f32 v44, s64, v44
v_mul_f32 v45, s64, v45
v_mfma_f32_16x16x32_bf16 v[88:91], a[192:195], a[72:75], v[88:91]
ds_read_b64_tr_b16 a[218:219], v206 offset:58368
v_mul_f32 v46, s64, v46
v_mul_f32 v47, s64, v47
v_mfma_f32_16x16x32_bf16 v[120:123], a[192:195], a[76:79], v[120:123]
v_cvt_pk_bf16_f32 v40, v40, v41
v_cvt_pk_bf16_f32 v41, v42, v43
v_cvt_pk_bf16_f32 v42, v44, v45
v_mfma_f32_16x16x32_bf16 v[28:31], a[196:199], a[64:67], v[28:31]
ds_read_b64_tr_b16 a[220:221], v207 offset:57344
v_cvt_pk_bf16_f32 v43, v46, v47
s_nop 1
v_mfma_f32_16x16x32_bf16 v[60:63], a[196:199], a[68:71], v[60:63]
v_permlane16_swap_b32 v40, v42
v_permlane16_swap_b32 v41, v43
v_accvgpr_write_b32 a148, v40
v_mfma_f32_16x16x32_bf16 v[92:95], a[196:199], a[72:75], v[92:95]
ds_read_b64_tr_b16 a[222:223], v207 offset:58368
v_accvgpr_write_b32 a149, v41
v_accvgpr_write_b32 a150, v42
v_mfma_f32_16x16x32_bf16 v[124:127], a[196:199], a[76:79], v[124:127]
s_waitcnt lgkmcnt(8)
v_accvgpr_write_b32 a151, v43
v_cvt_pk_bf16_f32 v72, 0, v72
v_cvt_pk_bf16_f32 v73, 0, v73
v_mfma_f32_16x16x32_bf16 v[24:27], a[200:203], a[80:83], v[24:27]
v_cvt_pk_bf16_f32 v74, 0, v74
v_cvt_pk_bf16_f32 v75, 0, v75
v_cvt_pk_bf16_f32 v76, 0, v76
v_mfma_f32_16x16x32_bf16 v[56:59], a[200:203], a[84:87], v[56:59]
v_cvt_pk_bf16_f32 v77, 0, v77
v_cvt_pk_bf16_f32 v78, 0, v78
v_cvt_pk_bf16_f32 v79, 0, v79
v_mfma_f32_16x16x32_bf16 v[88:91], a[200:203], a[88:91], v[88:91]
v_mul_f32 v72, s64, v72
v_mul_f32 v73, s64, v73
v_mul_f32 v74, s64, v74
v_mfma_f32_16x16x32_bf16 v[120:123], a[200:203], a[92:95], v[120:123]
v_mul_f32 v75, s64, v75
v_mul_f32 v76, s64, v76
v_mul_f32 v77, s64, v77
v_mfma_f32_16x16x32_bf16 v[28:31], a[204:207], a[80:83], v[28:31]
v_mul_f32 v78, s64, v78
v_mul_f32 v79, s64, v79
v_cvt_pk_bf16_f32 v72, v72, v73
v_mfma_f32_16x16x32_bf16 v[60:63], a[204:207], a[84:87], v[60:63]
v_cvt_pk_bf16_f32 v73, v74, v75
v_cvt_pk_bf16_f32 v74, v76, v77
v_cvt_pk_bf16_f32 v75, v78, v79
v_mfma_f32_16x16x32_bf16 v[92:95], a[204:207], a[88:91], v[92:95]
s_nop 1
v_permlane16_swap_b32 v72, v74
v_mfma_f32_16x16x32_bf16 v[124:127], a[204:207], a[92:95], v[124:127]
s_waitcnt lgkmcnt(4)
v_permlane16_swap_b32 v73, v75
v_accvgpr_write_b32 a164, v72
v_accvgpr_write_b32 a165, v73
v_mfma_f32_16x16x32_bf16 v[24:27], a[208:211], a[96:99], v[24:27]
v_accvgpr_write_b32 a166, v74
v_accvgpr_write_b32 a167, v75
v_cvt_pk_bf16_f32 v104, 0, v104
v_mfma_f32_16x16x32_bf16 v[56:59], a[208:211], a[100:103], v[56:59]
v_cvt_pk_bf16_f32 v105, 0, v105
v_cvt_pk_bf16_f32 v106, 0, v106
v_cvt_pk_bf16_f32 v107, 0, v107
v_mfma_f32_16x16x32_bf16 v[88:91], a[208:211], a[104:107], v[88:91]
v_cvt_pk_bf16_f32 v108, 0, v108
v_cvt_pk_bf16_f32 v109, 0, v109
v_cvt_pk_bf16_f32 v110, 0, v110
v_mfma_f32_16x16x32_bf16 v[120:123], a[208:211], a[108:111], v[120:123]
v_cvt_pk_bf16_f32 v111, 0, v111
v_mul_f32 v104, s64, v104
v_mul_f32 v105, s64, v105
v_mfma_f32_16x16x32_bf16 v[28:31], a[212:215], a[96:99], v[28:31]
v_mul_f32 v106, s64, v106
v_mul_f32 v107, s64, v107
v_mul_f32 v108, s64, v108
v_mfma_f32_16x16x32_bf16 v[60:63], a[212:215], a[100:103], v[60:63]
v_mul_f32 v109, s64, v109
v_mul_f32 v110, s64, v110
v_mul_f32 v111, s64, v111
v_mfma_f32_16x16x32_bf16 v[92:95], a[212:215], a[104:107], v[92:95]
v_cvt_pk_bf16_f32 v104, v104, v105
v_cvt_pk_bf16_f32 v105, v106, v107
v_cvt_pk_bf16_f32 v106, v108, v109
v_mfma_f32_16x16x32_bf16 v[124:127], a[212:215], a[108:111], v[124:127]
s_waitcnt lgkmcnt(0)
v_cvt_pk_bf16_f32 v107, v110, v111
s_nop 1
v_mfma_f32_16x16x32_bf16 v[24:27], a[216:219], a[112:115], v[24:27]
v_permlane16_swap_b32 v104, v106
v_permlane16_swap_b32 v105, v107
v_accvgpr_write_b32 a180, v104
v_mfma_f32_16x16x32_bf16 v[56:59], a[216:219], a[116:119], v[56:59]
v_accvgpr_write_b32 a181, v105
v_accvgpr_write_b32 a182, v106
v_accvgpr_write_b32 a183, v107
v_mfma_f32_16x16x32_bf16 v[88:91], a[216:219], a[120:123], v[88:91]
v_cvt_pk_bf16_f32 v16, 0, v16
v_cvt_pk_bf16_f32 v17, 0, v17
v_cvt_pk_bf16_f32 v18, 0, v18
v_mfma_f32_16x16x32_bf16 v[120:123], a[216:219], a[124:127], v[120:123]
v_cvt_pk_bf16_f32 v19, 0, v19
v_cvt_pk_bf16_f32 v20, 0, v20
v_cvt_pk_bf16_f32 v21, 0, v21
v_mfma_f32_16x16x32_bf16 v[28:31], a[220:223], a[112:115], v[28:31]
v_cvt_pk_bf16_f32 v22, 0, v22
v_cvt_pk_bf16_f32 v23, 0, v23
v_mul_f32 v16, s64, v16
v_mfma_f32_16x16x32_bf16 v[60:63], a[220:223], a[116:119], v[60:63]
v_mul_f32 v17, s64, v17
v_mul_f32 v18, s64, v18
v_mul_f32 v19, s64, v19
v_mfma_f32_16x16x32_bf16 v[92:95], a[220:223], a[120:123], v[92:95]
v_mul_f32 v20, s64, v20
v_mul_f32 v21, s64, v21
v_mul_f32 v22, s64, v22
v_mfma_f32_16x16x32_bf16 v[124:127], a[220:223], a[124:127], v[124:127]
v_mul_f32 v23, s64, v23
v_cvt_pk_bf16_f32 v16, v16, v17
v_cvt_pk_bf16_f32 v17, v18, v19
s_nop 15
v_cvt_pk_bf16_f32 v18, v20, v21
v_cvt_pk_bf16_f32 v19, v22, v23
s_nop 1
v_permlane16_swap_b32 v16, v18
v_permlane16_swap_b32 v17, v19
v_accvgpr_write_b32 a136, v16
v_accvgpr_write_b32 a137, v17
v_accvgpr_write_b32 a138, v18
v_accvgpr_write_b32 a139, v19
v_cvt_pk_bf16_f32 v48, 0, v48
v_cvt_pk_bf16_f32 v49, 0, v49
v_cvt_pk_bf16_f32 v50, 0, v50
v_cvt_pk_bf16_f32 v51, 0, v51
v_cvt_pk_bf16_f32 v52, 0, v52
v_cvt_pk_bf16_f32 v53, 0, v53
v_cvt_pk_bf16_f32 v54, 0, v54
v_cvt_pk_bf16_f32 v55, 0, v55
v_mul_f32 v48, s64, v48
v_mul_f32 v49, s64, v49
v_mul_f32 v50, s64, v50
v_mul_f32 v51, s64, v51
v_mul_f32 v52, s64, v52
v_mul_f32 v53, s64, v53
v_mul_f32 v54, s64, v54
v_mul_f32 v55, s64, v55
v_cvt_pk_bf16_f32 v48, v48, v49
v_cvt_pk_bf16_f32 v49, v50, v51
v_cvt_pk_bf16_f32 v50, v52, v53
v_cvt_pk_bf16_f32 v51, v54, v55
s_nop 1
v_permlane16_swap_b32 v48, v50
v_permlane16_swap_b32 v49, v51
v_accvgpr_write_b32 a152, v48
v_accvgpr_write_b32 a153, v49
v_accvgpr_write_b32 a154, v50
v_accvgpr_write_b32 a155, v51
v_cvt_pk_bf16_f32 v80, 0, v80
v_cvt_pk_bf16_f32 v81, 0, v81
v_cvt_pk_bf16_f32 v82, 0, v82
v_cvt_pk_bf16_f32 v83, 0, v83
v_cvt_pk_bf16_f32 v84, 0, v84
v_cvt_pk_bf16_f32 v85, 0, v85
v_cvt_pk_bf16_f32 v86, 0, v86
v_cvt_pk_bf16_f32 v87, 0, v87
v_mul_f32 v80, s64, v80
v_mul_f32 v81, s64, v81
v_mul_f32 v82, s64, v82
v_mul_f32 v83, s64, v83
v_mul_f32 v84, s64, v84
v_mul_f32 v85, s64, v85
v_mul_f32 v86, s64, v86
v_mul_f32 v87, s64, v87
v_cvt_pk_bf16_f32 v80, v80, v81
v_cvt_pk_bf16_f32 v81, v82, v83
v_cvt_pk_bf16_f32 v82, v84, v85
v_cvt_pk_bf16_f32 v83, v86, v87
s_nop 1
v_permlane16_swap_b32 v80, v82
v_permlane16_swap_b32 v81, v83
v_accvgpr_write_b32 a168, v80
v_accvgpr_write_b32 a169, v81
v_accvgpr_write_b32 a170, v82
v_accvgpr_write_b32 a171, v83
v_cvt_pk_bf16_f32 v112, 0, v112
v_cvt_pk_bf16_f32 v113, 0, v113
v_cvt_pk_bf16_f32 v114, 0, v114
v_cvt_pk_bf16_f32 v115, 0, v115
v_cvt_pk_bf16_f32 v116, 0, v116
v_cvt_pk_bf16_f32 v117, 0, v117
v_cvt_pk_bf16_f32 v118, 0, v118
v_cvt_pk_bf16_f32 v119, 0, v119
v_mul_f32 v112, s64, v112
v_mul_f32 v113, s64, v113
v_mul_f32 v114, s64, v114
v_mul_f32 v115, s64, v115
v_mul_f32 v116, s64, v116
v_mul_f32 v117, s64, v117
v_mul_f32 v118, s64, v118
v_mul_f32 v119, s64, v119
v_cvt_pk_bf16_f32 v112, v112, v113
v_cvt_pk_bf16_f32 v113, v114, v115
v_cvt_pk_bf16_f32 v114, v116, v117
v_cvt_pk_bf16_f32 v115, v118, v119
s_nop 1
v_permlane16_swap_b32 v112, v114
v_permlane16_swap_b32 v113, v115
v_accvgpr_write_b32 a184, v112
v_accvgpr_write_b32 a185, v113
v_accvgpr_write_b32 a186, v114
v_accvgpr_write_b32 a187, v115
v_cvt_pk_bf16_f32 v24, 0, v24
v_cvt_pk_bf16_f32 v25, 0, v25
v_cvt_pk_bf16_f32 v26, 0, v26
v_cvt_pk_bf16_f32 v27, 0, v27
v_cvt_pk_bf16_f32 v28, 0, v28
v_cvt_pk_bf16_f32 v29, 0, v29
v_cvt_pk_bf16_f32 v30, 0, v30
v_cvt_pk_bf16_f32 v31, 0, v31
v_mul_f32 v24, s64, v24
v_mul_f32 v25, s64, v25
v_mul_f32 v26, s64, v26
v_mul_f32 v27, s64, v27
v_mul_f32 v28, s64, v28
v_mul_f32 v29, s64, v29
v_mul_f32 v30, s64, v30
v_mul_f32 v31, s64, v31
v_cvt_pk_bf16_f32 v24, v24, v25
v_cvt_pk_bf16_f32 v25, v26, v27
v_cvt_pk_bf16_f32 v26, v28, v29
v_cvt_pk_bf16_f32 v27, v30, v31
s_nop 1
v_permlane16_swap_b32 v24, v26
v_permlane16_swap_b32 v25, v27
v_accvgpr_write_b32 a140, v24
v_accvgpr_write_b32 a141, v25
v_accvgpr_write_b32 a142, v26
v_accvgpr_write_b32 a143, v27
v_cvt_pk_bf16_f32 v56, 0, v56
v_cvt_pk_bf16_f32 v57, 0, v57
v_cvt_pk_bf16_f32 v58, 0, v58
v_cvt_pk_bf16_f32 v59, 0, v59
v_cvt_pk_bf16_f32 v60, 0, v60
v_cvt_pk_bf16_f32 v61, 0, v61
v_cvt_pk_bf16_f32 v62, 0, v62
v_cvt_pk_bf16_f32 v63, 0, v63
v_mul_f32 v56, s64, v56
v_mul_f32 v57, s64, v57
v_mul_f32 v58, s64, v58
v_mul_f32 v59, s64, v59
v_mul_f32 v60, s64, v60
v_mul_f32 v61, s64, v61
v_mul_f32 v62, s64, v62
v_mul_f32 v63, s64, v63
v_cvt_pk_bf16_f32 v56, v56, v57
v_cvt_pk_bf16_f32 v57, v58, v59
v_cvt_pk_bf16_f32 v58, v60, v61
v_cvt_pk_bf16_f32 v59, v62, v63
s_nop 1
v_permlane16_swap_b32 v56, v58
v_permlane16_swap_b32 v57, v59
v_accvgpr_write_b32 a156, v56
v_accvgpr_write_b32 a157, v57
v_accvgpr_write_b32 a158, v58
v_accvgpr_write_b32 a159, v59
v_cvt_pk_bf16_f32 v88, 0, v88
v_cvt_pk_bf16_f32 v89, 0, v89
v_cvt_pk_bf16_f32 v90, 0, v90
v_cvt_pk_bf16_f32 v91, 0, v91
v_cvt_pk_bf16_f32 v92, 0, v92
v_cvt_pk_bf16_f32 v93, 0, v93
v_cvt_pk_bf16_f32 v94, 0, v94
v_cvt_pk_bf16_f32 v95, 0, v95
v_mul_f32 v88, s64, v88
v_mul_f32 v89, s64, v89
v_mul_f32 v90, s64, v90
v_mul_f32 v91, s64, v91
v_mul_f32 v92, s64, v92
v_mul_f32 v93, s64, v93
v_mul_f32 v94, s64, v94
v_mul_f32 v95, s64, v95
v_cvt_pk_bf16_f32 v88, v88, v89
v_cvt_pk_bf16_f32 v89, v90, v91
v_cvt_pk_bf16_f32 v90, v92, v93
v_cvt_pk_bf16_f32 v91, v94, v95
s_nop 1
v_permlane16_swap_b32 v88, v90
v_permlane16_swap_b32 v89, v91
v_accvgpr_write_b32 a172, v88
v_accvgpr_write_b32 a173, v89
v_accvgpr_write_b32 a174, v90
v_accvgpr_write_b32 a175, v91
v_cvt_pk_bf16_f32 v120, 0, v120
v_cvt_pk_bf16_f32 v121, 0, v121
v_cvt_pk_bf16_f32 v122, 0, v122
v_cvt_pk_bf16_f32 v123, 0, v123
v_cvt_pk_bf16_f32 v124, 0, v124
v_cvt_pk_bf16_f32 v125, 0, v125
v_cvt_pk_bf16_f32 v126, 0, v126
v_cvt_pk_bf16_f32 v127, 0, v127
v_mul_f32 v120, s64, v120
v_mul_f32 v121, s64, v121
v_mul_f32 v122, s64, v122
v_mul_f32 v123, s64, v123
v_mul_f32 v124, s64, v124
v_mul_f32 v125, s64, v125
v_mul_f32 v126, s64, v126
v_mul_f32 v127, s64, v127
v_cvt_pk_bf16_f32 v120, v120, v121
v_cvt_pk_bf16_f32 v121, v122, v123
v_cvt_pk_bf16_f32 v122, v124, v125
v_cvt_pk_bf16_f32 v123, v126, v127
s_nop 1
v_permlane16_swap_b32 v120, v122
v_permlane16_swap_b32 v121, v123
v_accvgpr_write_b32 a188, v120
v_accvgpr_write_b32 a189, v121
v_accvgpr_write_b32 a190, v122
v_accvgpr_write_b32 a191, v123
L_attn_start:
s_mov_b32 s39, s43
s_add_u32 s65, s43, 0x8000
v_lshrrev_b32 v188, 3, v179
v_lshlrev_b32 v188, 3, v188
s_and_b32 s66, s2, 3
s_lshl_b32 s66, s66, 8
s_lshl_b32 s67, s33, 6
s_add_u32 s66, s66, s67
v_add_u32 v188, s66, v188
v_lshlrev_b32 v171, 1, v188
v_mul_u32_u24 v170, 12288, v188
v_and_b32 v189, 7, v179
v_lshl_add_u32 v170, v189, 4, v170
s_lshr_b32 s67, s2, 2
s_lshl_b32 s67, s67, 7
s_add_u32 s67, s67, 4096
s_lshl_b32 s68, s33, 10
s_add_u32 s68, s68, 131072
s_movk_i32 s28, 12288
s_mul_i32 s47, s37, 263168
s_lshl_b32 s36, s34, 13
s_add_u32 s47, s47, s36
s_waitcnt vmcnt(8)
s_barrier
ds_read_b128 a[192:195], v152 offset:0
ds_read_b128 a[196:199], v153 offset:0
ds_read_b128 a[200:203], v154 offset:0
ds_read_b128 a[204:207], v155 offset:0
ds_read_b128 a[208:211], v152 offset:4096
ds_read_b128 a[212:215], v153 offset:4096
s_waitcnt lgkmcnt(4)
v_mfma_f32_16x16x32_bf16 v[0:3], a[192:195], a[128:131], v[128:131]
ds_read_b128 a[216:219], v154 offset:4096
v_mfma_f32_16x16x32_bf16 v[16:19], a[192:195], a[144:147], v[132:135]
buffer_load_dwordx4 v[248:251], v171, s[56:59], 0 offen
v_mfma_f32_16x16x32_bf16 v[32:35], a[192:195], a[160:163], v[136:139]
v_mfma_f32_16x16x32_bf16 v[48:51], a[192:195], a[176:179], v[140:143]
s_add_u32 m0, s43, 32768
v_mfma_f32_16x16x32_bf16 v[0:3], a[196:199], a[132:135], v[0:3]
ds_read_b128 a[220:223], v155 offset:4096
buffer_load_dwordx4 v164, s[12:15], s44 offen offset:0 nt lds
v_mfma_f32_16x16x32_bf16 v[16:19], a[196:199], a[148:151], v[16:19]
v_mfma_f32_16x16x32_bf16 v[32:35], a[196:199], a[164:167], v[32:35]
v_mfma_f32_16x16x32_bf16 v[48:51], a[196:199], a[180:183], v[48:51]
s_waitcnt lgkmcnt(4)
buffer_load_dwordx4 v165, s[12:15], s44 offen offset:1024 nt lds
v_mfma_f32_16x16x32_bf16 v[0:3], a[200:203], a[136:139], v[0:3]
ds_read_b128 a[192:195], v152 offset:8192
v_mfma_f32_16x16x32_bf16 v[16:19], a[200:203], a[152:155], v[16:19]
v_mfma_f32_16x16x32_bf16 v[32:35], a[200:203], a[168:171], v[32:35]
buffer_load_dwordx4 v166, s[12:15], s44 offen offset:2048 nt lds
v_mfma_f32_16x16x32_bf16 v[48:51], a[200:203], a[184:187], v[48:51]
v_mfma_f32_16x16x32_bf16 v[0:3], a[204:207], a[140:143], v[0:3]
ds_read_b128 a[196:199], v153 offset:8192
v_mfma_f32_16x16x32_bf16 v[16:19], a[204:207], a[156:159], v[16:19]
buffer_load_dwordx4 v167, s[12:15], s44 offen offset:3072 nt lds
v_mfma_f32_16x16x32_bf16 v[32:35], a[204:207], a[172:175], v[32:35]
s_add_u32 s44, s44, 16384
v_mfma_f32_16x16x32_bf16 v[48:51], a[204:207], a[188:191], v[48:51]
s_waitcnt lgkmcnt(4)
s_add_u32 m0, s43, 81920
v_mfma_f32_16x16x32_bf16 v[4:7], a[208:211], a[128:131], v[128:131]
ds_read_b128 a[200:203], v154 offset:8192
buffer_load_dwordx4 v168, s[16:19], s45 offen offset:0 nt lds
v_mfma_f32_16x16x32_bf16 v[20:23], a[208:211], a[144:147], v[132:135]
v_mfma_f32_16x16x32_bf16 v[36:39], a[208:211], a[160:163], v[136:139]
v_mfma_f32_16x16x32_bf16 v[52:55], a[208:211], a[176:179], v[140:143]
buffer_load_dwordx4 v169, s[16:19], s45 offen offset:1024 nt lds
v_mfma_f32_16x16x32_bf16 v[4:7], a[212:215], a[132:135], v[4:7]
ds_read_b128 a[204:207], v155 offset:8192
v_mfma_f32_16x16x32_bf16 v[20:23], a[212:215], a[148:151], v[20:23]
v_mfma_f32_16x16x32_bf16 v[36:39], a[212:215], a[164:167], v[36:39]
buffer_load_dwordx4 v168, s[16:19], s45 offen offset:2048 nt lds
v_mfma_f32_16x16x32_bf16 v[52:55], a[212:215], a[180:183], v[52:55]
s_waitcnt lgkmcnt(4)
v_mfma_f32_16x16x32_bf16 v[4:7], a[216:219], a[136:139], v[4:7]
ds_read_b128 a[208:211], v152 offset:12288
v_mfma_f32_16x16x32_bf16 v[20:23], a[216:219], a[152:155], v[20:23]
buffer_load_dwordx4 v169, s[16:19], s45 offen offset:3072 nt lds
v_mfma_f32_16x16x32_bf16 v[36:39], a[216:219], a[168:171], v[36:39]
s_add_u32 s45, s45, 16384
v_mfma_f32_16x16x32_bf16 v[52:55], a[216:219], a[184:187], v[52:55]
s_add_u32 m0, s43, 49152
v_mfma_f32_16x16x32_bf16 v[4:7], a[220:223], a[140:143], v[4:7]
ds_read_b128 a[212:215], v153 offset:12288
buffer_load_dwordx4 v164, s[12:15], s44 offen offset:0 nt lds
v_mfma_f32_16x16x32_bf16 v[20:23], a[220:223], a[156:159], v[20:23]
v_mfma_f32_16x16x32_bf16 v[36:39], a[220:223], a[172:175], v[36:39]
v_mfma_f32_16x16x32_bf16 v[52:55], a[220:223], a[188:191], v[52:55]
s_waitcnt lgkmcnt(4)
buffer_load_dwordx4 v165, s[12:15], s44 offen offset:1024 nt lds
v_mfma_f32_16x16x32_bf16 v[8:11], a[192:195], a[128:131], v[128:131]
ds_read_b128 a[216:219], v154 offset:12288
v_mfma_f32_16x16x32_bf16 v[24:27], a[192:195], a[144:147], v[132:135]
v_mfma_f32_16x16x32_bf16 v[40:43], a[192:195], a[160:163], v[136:139]
buffer_load_dwordx4 v166, s[12:15], s44 offen offset:2048 nt lds
v_mfma_f32_16x16x32_bf16 v[56:59], a[192:195], a[176:179], v[140:143]
s_waitcnt vmcnt(12)
v_mfma_f32_16x16x32_bf16 v[8:11], a[196:199], a[132:135], v[8:11]
ds_read_b128 a[220:223], v155 offset:12288
v_mfma_f32_16x16x32_bf16 v[24:27], a[196:199], a[148:151], v[24:27]
s_waitcnt lgkmcnt(0)
s_barrier
buffer_load_dwordx4 v167, s[12:15], s44 offen offset:3072 nt lds
v_mfma_f32_16x16x32_bf16 v[40:43], a[196:199], a[164:167], v[40:43]
s_add_u32 s44, s44, 16384
v_mfma_f32_16x16x32_bf16 v[56:59], a[196:199], a[180:183], v[56:59]
v_mfma_f32_16x16x32_bf16 v[8:11], a[200:203], a[136:139], v[8:11]
ds_read_b128 a[192:195], v152 offset:16384
v_mfma_f32_16x16x32_bf16 v[24:27], a[200:203], a[152:155], v[24:27]
s_add_u32 m0, s39, 0
v_mfma_f32_16x16x32_bf16 v[40:43], a[200:203], a[168:171], v[40:43]
v_mfma_f32_16x16x32_bf16 v[56:59], a[200:203], a[184:187], v[56:59]
buffer_load_dwordx4 v164, s[12:15], s44 offen offset:0 nt lds
v_mfma_f32_16x16x32_bf16 v[8:11], a[204:207], a[140:143], v[8:11]
ds_read_b128 a[196:199], v153 offset:16384
v_mfma_f32_16x16x32_bf16 v[24:27], a[204:207], a[156:159], v[24:27]
v_mfma_f32_16x16x32_bf16 v[40:43], a[204:207], a[172:175], v[40:43]
v_mfma_f32_16x16x32_bf16 v[56:59], a[204:207], a[188:191], v[56:59]
v_mfma_f32_16x16x32_bf16 v[12:15], a[208:211], a[128:131], v[128:131]
ds_read_b128 a[200:203], v154 offset:16384
v_mfma_f32_16x16x32_bf16 v[28:31], a[208:211], a[144:147], v[132:135]
v_mfma_f32_16x16x32_bf16 v[44:47], a[208:211], a[160:163], v[136:139]
v_mfma_f32_16x16x32_bf16 v[60:63], a[208:211], a[176:179], v[140:143]
buffer_load_dwordx4 v165, s[12:15], s44 offen offset:1024 nt lds
v_mfma_f32_16x16x32_bf16 v[12:15], a[212:215], a[132:135], v[12:15]
ds_read_b128 a[204:207], v155 offset:16384
v_mfma_f32_16x16x32_bf16 v[28:31], a[212:215], a[148:151], v[28:31]
v_mfma_f32_16x16x32_bf16 v[44:47], a[212:215], a[164:167], v[44:47]
v_mfma_f32_16x16x32_bf16 v[60:63], a[212:215], a[180:183], v[60:63]
v_mfma_f32_16x16x32_bf16 v[12:15], a[216:219], a[136:139], v[12:15]
ds_read_b128 a[208:211], v152 offset:20480
v_mfma_f32_16x16x32_bf16 v[28:31], a[216:219], a[152:155], v[28:31]
v_mfma_f32_16x16x32_bf16 v[44:47], a[216:219], a[168:171], v[44:47]
v_mfma_f32_16x16x32_bf16 v[60:63], a[216:219], a[184:187], v[60:63]
buffer_load_dwordx4 v166, s[12:15], s44 offen offset:2048 nt lds
v_mfma_f32_16x16x32_bf16 v[12:15], a[220:223], a[140:143], v[12:15]
ds_read_b128 a[212:215], v153 offset:20480
v_mfma_f32_16x16x32_bf16 v[28:31], a[220:223], a[156:159], v[28:31]
v_mfma_f32_16x16x32_bf16 v[44:47], a[220:223], a[172:175], v[44:47]
v_mfma_f32_16x16x32_bf16 v[60:63], a[220:223], a[188:191], v[60:63]
s_waitcnt lgkmcnt(4)
s_cmp_lg_u32 s55, 0
s_cbranch_scc1 L_attn_ref_done
s_nop 7
v_max3_f32 v188, v0, v1, v2
v_max3_f32 v188, v188, v3, v4
v_max3_f32 v188, v188, v5, v6
v_max3_f32 v188, v188, v7, v8
v_max3_f32 v188, v188, v9, v10
v_max3_f32 v188, v188, v11, v12
v_max3_f32 v188, v188, v13, v14
v_max_f32 v188, v188, v15
v_max3_f32 v189, v16, v17, v18
v_max3_f32 v189, v189, v19, v20
v_max3_f32 v189, v189, v21, v22
v_max3_f32 v189, v189, v23, v24
v_max3_f32 v189, v189, v25, v26
v_max3_f32 v189, v189, v27, v28
v_max3_f32 v189, v189, v29, v30
v_max_f32 v189, v189, v31
v_max3_f32 v190, v32, v33, v34
v_max3_f32 v190, v190, v35, v36
v_max3_f32 v190, v190, v37, v38
v_max3_f32 v190, v190, v39, v40
v_max3_f32 v190, v190, v41, v42
v_max3_f32 v190, v190, v43, v44
v_max3_f32 v190, v190, v45, v46
v_max_f32 v190, v190, v47
v_max3_f32 v191, v48, v49, v50
v_max3_f32 v191, v191, v51, v52
v_max3_f32 v191, v191, v53, v54
v_max3_f32 v191, v191, v55, v56
v_max3_f32 v191, v191, v57, v58
v_max3_f32 v191, v191, v59, v60
v_max3_f32 v191, v191, v61, v62
v_max_f32 v191, v191, v63
v_mov_b32 v192, v188
v_mov_b32 v193, v189
v_mov_b32 v194, v190
v_mov_b32 v195, v191
s_nop 1
v_permlane16_swap_b32 v188, v192
v_permlane16_swap_b32 v189, v193
v_permlane16_swap_b32 v190, v194
v_permlane16_swap_b32 v191, v195
s_nop 1
v_max_f32 v188, v188, v192
v_max_f32 v189, v189, v193
v_max_f32 v190, v190, v194
v_max_f32 v191, v191, v195
v_mov_b32 v192, v188
v_mov_b32 v193, v189
v_mov_b32 v194, v190
v_mov_b32 v195, v191
s_nop 1
v_permlane32_swap_b32 v188, v192
v_permlane32_swap_b32 v189, v193
v_permlane32_swap_b32 v190, v194
v_permlane32_swap_b32 v191, v195
s_nop 1
v_max_f32 v188, v188, v192
v_max_f32 v189, v189, v193
v_max_f32 v190, v190, v194
v_max_f32 v191, v191, v195
v_add_f32 v188, 0x42dc0000, v188
v_add_f32 v189, 0x42dc0000, v189
v_add_f32 v190, 0x42dc0000, v190
v_add_f32 v191, 0x42dc0000, v191
v_sub_f32 v128, 0, v188
v_sub_f32 v129, 0, v188
v_sub_f32 v130, 0, v188
v_sub_f32 v131, 0, v188
v_sub_f32 v132, 0, v189
v_sub_f32 v133, 0, v189
v_sub_f32 v134, 0, v189
v_sub_f32 v135, 0, v189
v_sub_f32 v136, 0, v190
v_sub_f32 v137, 0, v190
v_sub_f32 v138, 0, v190
v_sub_f32 v139, 0, v190
v_sub_f32 v140, 0, v191
v_sub_f32 v141, 0, v191
v_sub_f32 v142, 0, v191
v_sub_f32 v143, 0, v191
v_sub_f32 v0, v0, v188
v_sub_f32 v1, v1, v188
v_sub_f32 v2, v2, v188
v_sub_f32 v3, v3, v188
v_sub_f32 v4, v4, v188
v_sub_f32 v5, v5, v188
v_sub_f32 v6, v6, v188
v_sub_f32 v7, v7, v188
v_sub_f32 v8, v8, v188
v_sub_f32 v9, v9, v188
v_sub_f32 v10, v10, v188
v_sub_f32 v11, v11, v188
v_sub_f32 v12, v12, v188
v_sub_f32 v13, v13, v188
v_sub_f32 v14, v14, v188
v_sub_f32 v15, v15, v188
v_sub_f32 v16, v16, v189
v_sub_f32 v17, v17, v189
v_sub_f32 v18, v18, v189
v_sub_f32 v19, v19, v189
v_sub_f32 v20, v20, v189
v_sub_f32 v21, v21, v189
v_sub_f32 v22, v22, v189
v_sub_f32 v23, v23, v189
v_sub_f32 v24, v24, v189
v_sub_f32 v25, v25, v189
v_sub_f32 v26, v26, v189
v_sub_f32 v27, v27, v189
v_sub_f32 v28, v28, v189
v_sub_f32 v29, v29, v189
v_sub_f32 v30, v30, v189
v_sub_f32 v31, v31, v189
v_sub_f32 v32, v32, v190
v_sub_f32 v33, v33, v190
v_sub_f32 v34, v34, v190
v_sub_f32 v35, v35, v190
v_sub_f32 v36, v36, v190
v_sub_f32 v37, v37, v190
v_sub_f32 v38, v38, v190
v_sub_f32 v39, v39, v190
v_sub_f32 v40, v40, v190
v_sub_f32 v41, v41, v190
v_sub_f32 v42, v42, v190
v_sub_f32 v43, v43, v190
v_sub_f32 v44, v44, v190
v_sub_f32 v45, v45, v190
v_sub_f32 v46, v46, v190
v_sub_f32 v47, v47, v190
v_sub_f32 v48, v48, v191
v_sub_f32 v49, v49, v191
v_sub_f32 v50, v50, v191
v_sub_f32 v51, v51, v191
v_sub_f32 v52, v52, v191
v_sub_f32 v53, v53, v191
v_sub_f32 v54, v54, v191
v_sub_f32 v55, v55, v191
v_sub_f32 v56, v56, v191
v_sub_f32 v57, v57, v191
v_sub_f32 v58, v58, v191
v_sub_f32 v59, v59, v191
v_sub_f32 v60, v60, v191
v_sub_f32 v61, v61, v191
v_sub_f32 v62, v62, v191
v_sub_f32 v63, v63, v191
L_attn_ref_done:
s_nop 7
v_mfma_f32_16x16x32_bf16 v[64:67], a[192:195], a[128:131], v[128:131]
ds_read_b128 a[216:219], v154 offset:20480
v_mfma_f32_16x16x32_bf16 v[80:83], a[192:195], a[144:147], v[132:135]
v_exp_f32 v0, v0
v_mfma_f32_16x16x32_bf16 v[96:99], a[192:195], a[160:163], v[136:139]
v_exp_f32 v1, v1
v_mfma_f32_16x16x32_bf16 v[112:115], a[192:195], a[176:179], v[140:143]
buffer_load_dwordx4 v167, s[12:15], s44 offen offset:3072 nt lds
v_mfma_f32_16x16x32_bf16 v[64:67], a[196:199], a[132:135], v[64:67]
ds_read_b128 a[220:223], v155 offset:20480
v_cvt_pk_bf16_f32 v0, v0, v1
v_mfma_f32_16x16x32_bf16 v[80:83], a[196:199], a[148:151], v[80:83]
s_add_u32 s44, s44, 16384
v_exp_f32 v2, v2
v_mfma_f32_16x16x32_bf16 v[96:99], a[196:199], a[164:167], v[96:99]
v_exp_f32 v3, v3
v_mfma_f32_16x16x32_bf16 v[112:115], a[196:199], a[180:183], v[112:115]
s_waitcnt lgkmcnt(4)
v_exp_f32 v4, v4
v_mfma_f32_16x16x32_bf16 v[64:67], a[200:203], a[136:139], v[64:67]
ds_read_b128 a[192:195], v152 offset:24576
v_cvt_pk_bf16_f32 v1, v2, v3
v_mfma_f32_16x16x32_bf16 v[80:83], a[200:203], a[152:155], v[80:83]
s_add_u32 m0, s65, 65536
v_exp_f32 v5, v5
v_mfma_f32_16x16x32_bf16 v[96:99], a[200:203], a[168:171], v[96:99]
v_exp_f32 v6, v6
v_mfma_f32_16x16x32_bf16 v[112:115], a[200:203], a[184:187], v[112:115]
buffer_load_dwordx4 v168, s[16:19], s45 offen offset:0 nt lds
v_mfma_f32_16x16x32_bf16 v[64:67], a[204:207], a[140:143], v[64:67]
ds_read_b128 a[196:199], v153 offset:24576
v_cvt_pk_bf16_f32 v2, v4, v5
v_mfma_f32_16x16x32_bf16 v[80:83], a[204:207], a[156:159], v[80:83]
v_exp_f32 v7, v7
v_mfma_f32_16x16x32_bf16 v[96:99], a[204:207], a[172:175], v[96:99]
v_exp_f32 v16, v16
v_mfma_f32_16x16x32_bf16 v[112:115], a[204:207], a[188:191], v[112:115]
s_waitcnt lgkmcnt(4)
v_exp_f32 v17, v17
v_mfma_f32_16x16x32_bf16 v[68:71], a[208:211], a[128:131], v[128:131]
ds_read_b128 a[200:203], v154 offset:24576
v_cvt_pk_bf16_f32 v3, v6, v7
v_mfma_f32_16x16x32_bf16 v[84:87], a[208:211], a[144:147], v[132:135]
v_exp_f32 v18, v18
v_mfma_f32_16x16x32_bf16 v[100:103], a[208:211], a[160:163], v[136:139]
v_exp_f32 v19, v19
v_mfma_f32_16x16x32_bf16 v[116:119], a[208:211], a[176:179], v[140:143]
buffer_load_dwordx4 v169, s[16:19], s45 offen offset:1024 nt lds
v_mfma_f32_16x16x32_bf16 v[68:71], a[212:215], a[132:135], v[68:71]
ds_read_b128 a[204:207], v155 offset:24576
v_cvt_pk_bf16_f32 v16, v16, v17
v_mfma_f32_16x16x32_bf16 v[84:87], a[212:215], a[148:151], v[84:87]
v_exp_f32 v20, v20
v_mfma_f32_16x16x32_bf16 v[100:103], a[212:215], a[164:167], v[100:103]
v_exp_f32 v21, v21
v_mfma_f32_16x16x32_bf16 v[116:119], a[212:215], a[180:183], v[116:119]
s_waitcnt lgkmcnt(4)
v_exp_f32 v22, v22
v_mfma_f32_16x16x32_bf16 v[68:71], a[216:219], a[136:139], v[68:71]
ds_read_b128 a[208:211], v152 offset:28672
v_cvt_pk_bf16_f32 v17, v18, v19
v_mfma_f32_16x16x32_bf16 v[84:87], a[216:219], a[152:155], v[84:87]
v_exp_f32 v23, v23
v_mfma_f32_16x16x32_bf16 v[100:103], a[216:219], a[168:171], v[100:103]
v_exp_f32 v32, v32
v_mfma_f32_16x16x32_bf16 v[116:119], a[216:219], a[184:187], v[116:119]
buffer_load_dwordx4 v168, s[16:19], s45 offen offset:2048 nt lds
v_mfma_f32_16x16x32_bf16 v[68:71], a[220:223], a[140:143], v[68:71]
ds_read_b128 a[212:215], v153 offset:28672
v_cvt_pk_bf16_f32 v18, v20, v21
v_mfma_f32_16x16x32_bf16 v[84:87], a[220:223], a[156:159], v[84:87]
v_exp_f32 v33, v33
v_mfma_f32_16x16x32_bf16 v[100:103], a[220:223], a[172:175], v[100:103]
v_exp_f32 v34, v34
v_mfma_f32_16x16x32_bf16 v[116:119], a[220:223], a[188:191], v[116:119]
s_waitcnt lgkmcnt(4)
v_exp_f32 v35, v35
v_mfma_f32_16x16x32_bf16 v[72:75], a[192:195], a[128:131], v[128:131]
ds_read_b128 a[216:219], v154 offset:28672
v_cvt_pk_bf16_f32 v19, v22, v23
v_mfma_f32_16x16x32_bf16 v[88:91], a[192:195], a[144:147], v[132:135]
v_exp_f32 v36, v36
v_mfma_f32_16x16x32_bf16 v[104:107], a[192:195], a[160:163], v[136:139]
v_exp_f32 v37, v37
v_mfma_f32_16x16x32_bf16 v[120:123], a[192:195], a[176:179], v[140:143]
buffer_load_dwordx4 v169, s[16:19], s45 offen offset:3072 nt lds
v_mfma_f32_16x16x32_bf16 v[72:75], a[196:199], a[132:135], v[72:75]
ds_read_b128 a[220:223], v155 offset:28672
v_cvt_pk_bf16_f32 v32, v32, v33
v_mfma_f32_16x16x32_bf16 v[88:91], a[196:199], a[148:151], v[88:91]
s_add_u32 s45, s45, 16384
v_exp_f32 v38, v38
v_mfma_f32_16x16x32_bf16 v[104:107], a[196:199], a[164:167], v[104:107]
v_exp_f32 v39, v39
v_mfma_f32_16x16x32_bf16 v[120:123], a[196:199], a[180:183], v[120:123]
s_waitcnt lgkmcnt(4)
v_exp_f32 v48, v48
v_mfma_f32_16x16x32_bf16 v[72:75], a[200:203], a[136:139], v[72:75]
ds_read_b64_tr_b16 a[192:193], v156 offset:0
v_xor_b32 v152, 0x8000, v152
v_mfma_f32_16x16x32_bf16 v[88:91], a[200:203], a[152:155], v[88:91]
s_mov_b32 m0, s68
v_exp_f32 v49, v49
v_mfma_f32_16x16x32_bf16 v[104:107], a[200:203], a[168:171], v[104:107]
ds_read_b64_tr_b16 a[194:195], v156 offset:4096
v_xor_b32 v153, 0x8000, v153
v_mfma_f32_16x16x32_bf16 v[120:123], a[200:203], a[184:187], v[120:123]
buffer_load_dwordx4 v170, s[60:63], s67 offen nt lds
v_mfma_f32_16x16x32_bf16 v[72:75], a[204:207], a[140:143], v[72:75]
ds_read_b64_tr_b16 a[196:197], v157 offset:0
v_xor_b32 v154, 0x8000, v154
v_mfma_f32_16x16x32_bf16 v[88:91], a[204:207], a[156:159], v[88:91]
s_add_u32 s68, s68, 4096
v_exp_f32 v50, v50
v_mfma_f32_16x16x32_bf16 v[104:107], a[204:207], a[172:175], v[104:107]
ds_read_b64_tr_b16 a[198:199], v157 offset:4096
v_xor_b32 v155, 0x8000, v155
v_mfma_f32_16x16x32_bf16 v[120:123], a[204:207], a[188:191], v[120:123]
s_waitcnt lgkmcnt(6)
v_exp_f32 v51, v51
v_mfma_f32_16x16x32_bf16 v[76:79], a[208:211], a[128:131], v[128:131]
ds_read_b64_tr_b16 a[200:201], v158 offset:0
v_cvt_pk_bf16_f32 v33, v34, v35
v_mfma_f32_16x16x32_bf16 v[92:95], a[208:211], a[144:147], v[132:135]
s_cmp_lt_u32 s68, 163840
v_exp_f32 v52, v52
v_mfma_f32_16x16x32_bf16 v[108:111], a[208:211], a[160:163], v[136:139]
ds_read_b64_tr_b16 a[202:203], v158 offset:4096
v_cvt_pk_bf16_f32 v34, v36, v37
v_mfma_f32_16x16x32_bf16 v[124:127], a[208:211], a[176:179], v[140:143]
s_cselect_b32 s66, s28, 0x1000000
v_exp_f32 v53, v53
v_mfma_f32_16x16x32_bf16 v[76:79], a[212:215], a[132:135], v[76:79]
ds_read_b64_tr_b16 a[204:205], v159 offset:0
v_cvt_pk_bf16_f32 v35, v38, v39
v_mfma_f32_16x16x32_bf16 v[92:95], a[212:215], a[148:151], v[92:95]
s_add_u32 s67, s67, s66
v_exp_f32 v54, v54
v_mfma_f32_16x16x32_bf16 v[108:111], a[212:215], a[164:167], v[108:111]
ds_read_b64_tr_b16 a[206:207], v159 offset:4096
v_cvt_pk_bf16_f32 v48, v48, v49
v_mfma_f32_16x16x32_bf16 v[124:127], a[212:215], a[180:183], v[124:127]
s_waitcnt lgkmcnt(8)
v_exp_f32 v55, v55
v_mfma_f32_16x16x32_bf16 v[76:79], a[216:219], a[136:139], v[76:79]
ds_read_b64_tr_b16 a[208:209], v160 offset:0
v_cvt_pk_bf16_f32 v49, v50, v51
v_mfma_f32_16x16x32_bf16 v[92:95], a[216:219], a[152:155], v[92:95]
v_exp_f32 v8, v8
v_mfma_f32_16x16x32_bf16 v[108:111], a[216:219], a[168:171], v[108:111]
ds_read_b64_tr_b16 a[210:211], v160 offset:4096
v_cvt_pk_bf16_f32 v50, v52, v53
v_mfma_f32_16x16x32_bf16 v[124:127], a[216:219], a[184:187], v[124:127]
buffer_load_dword v181, v182, s[84:87], s69 offen
v_mfma_f32_16x16x32_bf16 v[76:79], a[220:223], a[140:143], v[76:79]
ds_read_b64_tr_b16 a[212:213], v161 offset:0
v_cvt_pk_bf16_f32 v51, v54, v55
v_mfma_f32_16x16x32_bf16 v[92:95], a[220:223], a[156:159], v[92:95]
s_add_u32 s69, s69, 524288
v_exp_f32 v9, v9
v_mfma_f32_16x16x32_bf16 v[108:111], a[220:223], a[172:175], v[108:111]
ds_read_b64_tr_b16 a[214:215], v161 offset:4096
v_cvt_pk_bf16_f32 v8, v8, v9
v_mfma_f32_16x16x32_bf16 v[124:127], a[220:223], a[188:191], v[124:127]
s_waitcnt lgkmcnt(8)
v_exp_f32 v10, v10
v_mfma_f32_16x16x32_bf16 a[0:3], a[192:195], v[0:3], 0
ds_read_b64_tr_b16 a[216:217], v162 offset:0
v_mfma_f32_16x16x32_bf16 a[32:35], a[192:195], v[16:19], 0
v_exp_f32 v11, v11
v_mfma_f32_16x16x32_bf16 a[64:67], a[192:195], v[32:35], 0
ds_read_b64_tr_b16 a[218:219], v162 offset:4096
v_cvt_pk_bf16_f32 v9, v10, v11
v_mfma_f32_16x16x32_bf16 a[96:99], a[192:195], v[48:51], 0
v_exp_f32 v12, v12
v_mfma_f32_16x16x32_bf16 a[4:7], a[196:199], v[0:3], 0
ds_read_b64_tr_b16 a[220:221], v163 offset:0
v_mfma_f32_16x16x32_bf16 a[36:39], a[196:199], v[16:19], 0
v_exp_f32 v13, v13
v_mfma_f32_16x16x32_bf16 a[224:227], a[240:243], v[0:3], 0
v_exp_f32 v14, v14
v_mfma_f32_16x16x32_bf16 a[68:71], a[196:199], v[32:35], 0
ds_read_b64_tr_b16 a[222:223], v163 offset:4096
v_cvt_pk_bf16_f32 v10, v12, v13
v_mfma_f32_16x16x32_bf16 a[100:103], a[196:199], v[48:51], 0
s_waitcnt lgkmcnt(8)
v_exp_f32 v15, v15
v_mfma_f32_16x16x32_bf16 a[8:11], a[200:203], v[0:3], 0
ds_read_b64_tr_b16 a[192:193], v156 offset:8192
v_cvt_pk_bf16_f32 v11, v14, v15
v_mfma_f32_16x16x32_bf16 a[40:43], a[200:203], v[16:19], 0
v_exp_f32 v24, v24
v_mfma_f32_16x16x32_bf16 a[72:75], a[200:203], v[32:35], 0
ds_read_b64_tr_b16 a[194:195], v156 offset:12288
v_mfma_f32_16x16x32_bf16 a[104:107], a[200:203], v[48:51], 0
v_exp_f32 v25, v25
v_mfma_f32_16x16x32_bf16 a[12:15], a[204:207], v[0:3], 0
ds_read_b64_tr_b16 a[196:197], v157 offset:8192
v_cvt_pk_bf16_f32 v24, v24, v25
v_mfma_f32_16x16x32_bf16 a[44:47], a[204:207], v[16:19], 0
v_exp_f32 v26, v26
v_mfma_f32_16x16x32_bf16 a[228:231], a[240:243], v[16:19], 0
v_exp_f32 v27, v27
v_mfma_f32_16x16x32_bf16 a[76:79], a[204:207], v[32:35], 0
ds_read_b64_tr_b16 a[198:199], v157 offset:12288
v_cvt_pk_bf16_f32 v25, v26, v27
v_mfma_f32_16x16x32_bf16 a[108:111], a[204:207], v[48:51], 0
s_waitcnt lgkmcnt(8)
v_exp_f32 v28, v28
v_mfma_f32_16x16x32_bf16 a[16:19], a[208:211], v[0:3], 0
ds_read_b64_tr_b16 a[200:201], v158 offset:8192
v_mfma_f32_16x16x32_bf16 a[48:51], a[208:211], v[16:19], 0
v_exp_f32 v29, v29
v_mfma_f32_16x16x32_bf16 a[80:83], a[208:211], v[32:35], 0
ds_read_b64_tr_b16 a[202:203], v158 offset:12288
v_cvt_pk_bf16_f32 v26, v28, v29
v_mfma_f32_16x16x32_bf16 a[112:115], a[208:211], v[48:51], 0
v_exp_f32 v30, v30
v_mfma_f32_16x16x32_bf16 a[20:23], a[212:215], v[0:3], 0
ds_read_b64_tr_b16 a[204:205], v159 offset:8192
v_mfma_f32_16x16x32_bf16 a[52:55], a[212:215], v[16:19], 0
v_exp_f32 v31, v31
v_mfma_f32_16x16x32_bf16 a[232:235], a[240:243], v[32:35], 0
v_exp_f32 v40, v40
v_mfma_f32_16x16x32_bf16 a[84:87], a[212:215], v[32:35], 0
ds_read_b64_tr_b16 a[206:207], v159 offset:12288
v_cvt_pk_bf16_f32 v27, v30, v31
v_mfma_f32_16x16x32_bf16 a[116:119], a[212:215], v[48:51], 0
s_waitcnt lgkmcnt(8)
v_exp_f32 v41, v41
v_mfma_f32_16x16x32_bf16 a[24:27], a[216:219], v[0:3], 0
ds_read_b64_tr_b16 a[208:209], v160 offset:8192
v_cvt_pk_bf16_f32 v40, v40, v41
v_mfma_f32_16x16x32_bf16 a[56:59], a[216:219], v[16:19], 0
v_exp_f32 v42, v42
v_mfma_f32_16x16x32_bf16 a[88:91], a[216:219], v[32:35], 0
ds_read_b64_tr_b16 a[210:211], v160 offset:12288
v_mfma_f32_16x16x32_bf16 a[120:123], a[216:219], v[48:51], 0
v_exp_f32 v43, v43
v_mfma_f32_16x16x32_bf16 a[28:31], a[220:223], v[0:3], 0
ds_read_b64_tr_b16 a[212:213], v161 offset:8192
v_cvt_pk_bf16_f32 v41, v42, v43
v_mfma_f32_16x16x32_bf16 a[60:63], a[220:223], v[16:19], 0
v_exp_f32 v44, v44
v_mfma_f32_16x16x32_bf16 a[236:239], a[240:243], v[48:51], 0
v_exp_f32 v45, v45
v_mfma_f32_16x16x32_bf16 a[92:95], a[220:223], v[32:35], 0
ds_read_b64_tr_b16 a[214:215], v161 offset:12288
v_exp_f32 v46, v46
v_cvt_pk_bf16_f32 v42, v44, v45
v_exp_f32 v47, v47
s_nop 0
v_cvt_pk_bf16_f32 v43, v46, v47
v_exp_f32 v56, v56
v_exp_f32 v57, v57
v_exp_f32 v58, v58
v_cvt_pk_bf16_f32 v56, v56, v57
v_exp_f32 v59, v59
v_exp_f32 v60, v60
v_cvt_pk_bf16_f32 v57, v58, v59
v_exp_f32 v61, v61
v_exp_f32 v62, v62
v_cvt_pk_bf16_f32 v58, v60, v61
v_exp_f32 v63, v63
s_nop 0
v_cvt_pk_bf16_f32 v59, v62, v63
v_mfma_f32_16x16x32_bf16 a[124:127], a[220:223], v[48:51], 0
s_waitcnt lgkmcnt(8)
v_mfma_f32_16x16x32_bf16 a[0:3], a[192:195], v[8:11], a[0:3]
ds_read_b64_tr_b16 a[216:217], v162 offset:8192
v_mfma_f32_16x16x32_bf16 a[32:35], a[192:195], v[24:27], a[32:35]
v_mfma_f32_16x16x32_bf16 a[64:67], a[192:195], v[40:43], a[64:67]
ds_read_b64_tr_b16 a[218:219], v162 offset:12288
v_mfma_f32_16x16x32_bf16 a[96:99], a[192:195], v[56:59], a[96:99]
s_waitcnt vmcnt(14)
v_mfma_f32_16x16x32_bf16 a[4:7], a[196:199], v[8:11], a[4:7]
ds_read_b64_tr_b16 a[220:221], v163 offset:8192
v_mfma_f32_16x16x32_bf16 a[36:39], a[196:199], v[24:27], a[36:39]
s_barrier
v_exp_f32 v64, v64
v_mfma_f32_16x16x32_bf16 a[224:227], a[240:243], v[8:11], a[224:227]
v_exp_f32 v65, v65
v_mfma_f32_16x16x32_bf16 a[68:71], a[196:199], v[40:43], a[68:71]
ds_read_b64_tr_b16 a[222:223], v163 offset:12288
v_cvt_pk_bf16_f32 v64, v64, v65
v_mfma_f32_16x16x32_bf16 a[100:103], a[196:199], v[56:59], a[100:103]
s_waitcnt lgkmcnt(8)
v_exp_f32 v66, v66
v_mfma_f32_16x16x32_bf16 a[8:11], a[200:203], v[8:11], a[8:11]
ds_read_b128 a[192:195], v152 offset:0
v_mfma_f32_16x16x32_bf16 a[40:43], a[200:203], v[24:27], a[40:43]
s_add_u32 m0, s39, 16384
v_exp_f32 v67, v67
v_mfma_f32_16x16x32_bf16 a[72:75], a[200:203], v[40:43], a[72:75]
v_exp_f32 v68, v68
v_mfma_f32_16x16x32_bf16 a[104:107], a[200:203], v[56:59], a[104:107]
buffer_load_dwordx4 v164, s[12:15], s44 offen offset:0 nt lds
v_mfma_f32_16x16x32_bf16 a[12:15], a[204:207], v[8:11], a[12:15]
ds_read_b128 a[196:199], v153 offset:0
v_cvt_pk_bf16_f32 v65, v66, v67
v_mfma_f32_16x16x32_bf16 a[44:47], a[204:207], v[24:27], a[44:47]
v_exp_f32 v69, v69
v_mfma_f32_16x16x32_bf16 a[228:231], a[240:243], v[24:27], a[228:231]
v_exp_f32 v70, v70
v_mfma_f32_16x16x32_bf16 a[76:79], a[204:207], v[40:43], a[76:79]
v_exp_f32 v71, v71
v_mfma_f32_16x16x32_bf16 a[108:111], a[204:207], v[56:59], a[108:111]
s_waitcnt lgkmcnt(6)
v_exp_f32 v80, v80
v_mfma_f32_16x16x32_bf16 a[16:19], a[208:211], v[8:11], a[16:19]
ds_read_b128 a[200:203], v154 offset:0
v_cvt_pk_bf16_f32 v66, v68, v69
v_mfma_f32_16x16x32_bf16 a[48:51], a[208:211], v[24:27], a[48:51]
v_exp_f32 v81, v81
v_mfma_f32_16x16x32_bf16 a[80:83], a[208:211], v[40:43], a[80:83]
v_exp_f32 v82, v82
v_mfma_f32_16x16x32_bf16 a[112:115], a[208:211], v[56:59], a[112:115]
buffer_load_dwordx4 v165, s[12:15], s44 offen offset:1024 nt lds
v_mfma_f32_16x16x32_bf16 a[20:23], a[212:215], v[8:11], a[20:23]
ds_read_b128 a[204:207], v155 offset:0
v_cvt_pk_bf16_f32 v67, v70, v71
v_mfma_f32_16x16x32_bf16 a[52:55], a[212:215], v[24:27], a[52:55]
s_xor_b32 s39, s39, 0x8000
v_exp_f32 v83, v83
v_mfma_f32_16x16x32_bf16 a[232:235], a[240:243], v[40:43], a[232:235]
v_exp_f32 v84, v84
v_mfma_f32_16x16x32_bf16 a[84:87], a[212:215], v[40:43], a[84:87]
v_exp_f32 v85, v85
v_mfma_f32_16x16x32_bf16 a[116:119], a[212:215], v[56:59], a[116:119]
s_waitcnt lgkmcnt(4)
v_exp_f32 v86, v86
v_mfma_f32_16x16x32_bf16 a[24:27], a[216:219], v[8:11], a[24:27]
ds_read_b128 a[208:211], v152 offset:4096
v_cvt_pk_bf16_f32 v80, v80, v81
v_mfma_f32_16x16x32_bf16 a[56:59], a[216:219], v[24:27], a[56:59]
v_exp_f32 v87, v87
v_mfma_f32_16x16x32_bf16 a[88:91], a[216:219], v[40:43], a[88:91]
v_exp_f32 v96, v96
v_mfma_f32_16x16x32_bf16 a[120:123], a[216:219], v[56:59], a[120:123]
buffer_load_dwordx4 v166, s[12:15], s44 offen offset:2048 nt lds
v_mfma_f32_16x16x32_bf16 a[28:31], a[220:223], v[8:11], a[28:31]
ds_read_b128 a[212:215], v153 offset:4096
v_cvt_pk_bf16_f32 v81, v82, v83
v_mfma_f32_16x16x32_bf16 a[60:63], a[220:223], v[24:27], a[60:63]
v_exp_f32 v97, v97
v_mfma_f32_16x16x32_bf16 a[236:239], a[240:243], v[56:59], a[236:239]
v_exp_f32 v98, v98
v_mfma_f32_16x16x32_bf16 a[92:95], a[220:223], v[40:43], a[92:95]
v_exp_f32 v99, v99
v_mfma_f32_16x16x32_bf16 a[124:127], a[220:223], v[56:59], a[124:127]
s_waitcnt lgkmcnt(4)
v_exp_f32 v100, v100
v_mfma_f32_16x16x32_bf16 v[0:3], a[192:195], a[128:131], v[128:131]
ds_read_b128 a[216:219], v154 offset:4096
v_cvt_pk_bf16_f32 v82, v84, v85
v_mfma_f32_16x16x32_bf16 v[16:19], a[192:195], a[144:147], v[132:135]
v_exp_f32 v101, v101
v_mfma_f32_16x16x32_bf16 v[32:35], a[192:195], a[160:163], v[136:139]
v_exp_f32 v102, v102
v_mfma_f32_16x16x32_bf16 v[48:51], a[192:195], a[176:179], v[140:143]
buffer_load_dwordx4 v167, s[12:15], s44 offen offset:3072 nt lds
v_mfma_f32_16x16x32_bf16 v[0:3], a[196:199], a[132:135], v[0:3]
ds_read_b128 a[220:223], v155 offset:4096
v_cvt_pk_bf16_f32 v83, v86, v87
v_mfma_f32_16x16x32_bf16 v[16:19], a[196:199], a[148:151], v[16:19]
s_add_u32 s44, s44, 16384
v_exp_f32 v103, v103
v_mfma_f32_16x16x32_bf16 v[32:35], a[196:199], a[164:167], v[32:35]
v_exp_f32 v112, v112
v_mfma_f32_16x16x32_bf16 v[48:51], a[196:199], a[180:183], v[48:51]
s_waitcnt lgkmcnt(4)
v_exp_f32 v113, v113
v_mfma_f32_16x16x32_bf16 v[0:3], a[200:203], a[136:139], v[0:3]
ds_read_b128 a[192:195], v152 offset:8192
v_cvt_pk_bf16_f32 v96, v96, v97
v_mfma_f32_16x16x32_bf16 v[16:19], a[200:203], a[152:155], v[16:19]
s_add_u32 m0, s65, 81920
v_exp_f32 v114, v114
v_mfma_f32_16x16x32_bf16 v[32:35], a[200:203], a[168:171], v[32:35]
v_exp_f32 v115, v115
v_mfma_f32_16x16x32_bf16 v[48:51], a[200:203], a[184:187], v[48:51]
buffer_load_dwordx4 v168, s[16:19], s45 offen offset:0 nt lds
v_mfma_f32_16x16x32_bf16 v[0:3], a[204:207], a[140:143], v[0:3]
ds_read_b128 a[196:199], v153 offset:8192
v_cvt_pk_bf16_f32 v97, v98, v99
v_mfma_f32_16x16x32_bf16 v[16:19], a[204:207], a[156:159], v[16:19]
v_exp_f32 v116, v116
v_mfma_f32_16x16x32_bf16 v[32:35], a[204:207], a[172:175], v[32:35]
v_exp_f32 v117, v117
v_mfma_f32_16x16x32_bf16 v[48:51], a[204:207], a[188:191], v[48:51]
s_waitcnt lgkmcnt(4)
v_exp_f32 v118, v118
v_mfma_f32_16x16x32_bf16 v[4:7], a[208:211], a[128:131], v[128:131]
ds_read_b128 a[200:203], v154 offset:8192
v_cvt_pk_bf16_f32 v98, v100, v101
v_mfma_f32_16x16x32_bf16 v[20:23], a[208:211], a[144:147], v[132:135]
v_exp_f32 v119, v119
v_mfma_f32_16x16x32_bf16 v[36:39], a[208:211], a[160:163], v[136:139]
v_exp_f32 v72, v72
v_mfma_f32_16x16x32_bf16 v[52:55], a[208:211], a[176:179], v[140:143]
buffer_load_dwordx4 v169, s[16:19], s45 offen offset:1024 nt lds
v_mfma_f32_16x16x32_bf16 v[4:7], a[212:215], a[132:135], v[4:7]
ds_read_b128 a[204:207], v155 offset:8192
v_cvt_pk_bf16_f32 v99, v102, v103
v_mfma_f32_16x16x32_bf16 v[20:23], a[212:215], a[148:151], v[20:23]
s_xor_b32 s65, s65, 0x8000
v_exp_f32 v73, v73
v_mfma_f32_16x16x32_bf16 v[36:39], a[212:215], a[164:167], v[36:39]
v_exp_f32 v74, v74
v_mfma_f32_16x16x32_bf16 v[52:55], a[212:215], a[180:183], v[52:55]
s_waitcnt lgkmcnt(4)
v_cvt_pk_bf16_f32 v112, v112, v113
v_cvt_pk_bf16_f32 v113, v114, v115
v_mfma_f32_16x16x32_bf16 v[4:7], a[216:219], a[136:139], v[4:7]
ds_read_b128 a[208:211], v152 offset:12288
v_cvt_pk_bf16_f32 v114, v116, v117
v_mfma_f32_16x16x32_bf16 v[20:23], a[216:219], a[152:155], v[20:23]
v_exp_f32 v75, v75
v_mfma_f32_16x16x32_bf16 v[36:39], a[216:219], a[168:171], v[36:39]
v_exp_f32 v76, v76
v_mfma_f32_16x16x32_bf16 v[52:55], a[216:219], a[184:187], v[52:55]
buffer_load_dwordx4 v168, s[16:19], s45 offen offset:2048 nt lds
v_mfma_f32_16x16x32_bf16 v[4:7], a[220:223], a[140:143], v[4:7]
ds_read_b128 a[212:215], v153 offset:12288
v_cvt_pk_bf16_f32 v115, v118, v119
v_mfma_f32_16x16x32_bf16 v[20:23], a[220:223], a[156:159], v[20:23]
v_exp_f32 v77, v77
v_mfma_f32_16x16x32_bf16 v[36:39], a[220:223], a[172:175], v[36:39]
v_exp_f32 v78, v78
v_mfma_f32_16x16x32_bf16 v[52:55], a[220:223], a[188:191], v[52:55]
s_waitcnt lgkmcnt(4)
v_exp_f32 v79, v79
v_mfma_f32_16x16x32_bf16 v[8:11], a[192:195], a[128:131], v[128:131]
ds_read_b128 a[216:219], v154 offset:12288
v_cvt_pk_bf16_f32 v72, v72, v73
v_mfma_f32_16x16x32_bf16 v[24:27], a[192:195], a[144:147], v[132:135]
v_exp_f32 v88, v88
v_mfma_f32_16x16x32_bf16 v[40:43], a[192:195], a[160:163], v[136:139]
v_exp_f32 v89, v89
v_mfma_f32_16x16x32_bf16 v[56:59], a[192:195], a[176:179], v[140:143]
buffer_load_dwordx4 v169, s[16:19], s45 offen offset:3072 nt lds
v_mfma_f32_16x16x32_bf16 v[8:11], a[196:199], a[132:135], v[8:11]
ds_read_b128 a[220:223], v155 offset:12288
v_cvt_pk_bf16_f32 v73, v74, v75
v_mfma_f32_16x16x32_bf16 v[24:27], a[196:199], a[148:151], v[24:27]
s_add_u32 s45, s45, 16384
v_exp_f32 v90, v90
v_mfma_f32_16x16x32_bf16 v[40:43], a[196:199], a[164:167], v[40:43]
v_exp_f32 v91, v91
v_mfma_f32_16x16x32_bf16 v[56:59], a[196:199], a[180:183], v[56:59]
s_waitcnt lgkmcnt(4)
v_exp_f32 v92, v92
v_mfma_f32_16x16x32_bf16 v[8:11], a[200:203], a[136:139], v[8:11]
ds_read_b64_tr_b16 a[192:193], v156 offset:16384
v_cvt_pk_bf16_f32 v74, v76, v77
v_mfma_f32_16x16x32_bf16 v[24:27], a[200:203], a[152:155], v[24:27]
v_exp_f32 v93, v93
v_mfma_f32_16x16x32_bf16 v[40:43], a[200:203], a[168:171], v[40:43]
ds_read_b64_tr_b16 a[194:195], v156 offset:20480
v_cvt_pk_bf16_f32 v75, v78, v79
v_mfma_f32_16x16x32_bf16 v[56:59], a[200:203], a[184:187], v[56:59]
buffer_load_dword v181, v182, s[84:87], s69 offen
v_mfma_f32_16x16x32_bf16 v[8:11], a[204:207], a[140:143], v[8:11]
ds_read_b64_tr_b16 a[196:197], v157 offset:16384
v_cvt_pk_bf16_f32 v88, v88, v89
v_mfma_f32_16x16x32_bf16 v[24:27], a[204:207], a[156:159], v[24:27]
s_add_u32 s69, s69, 524288
v_exp_f32 v94, v94
v_mfma_f32_16x16x32_bf16 v[40:43], a[204:207], a[172:175], v[40:43]
ds_read_b64_tr_b16 a[198:199], v157 offset:20480
v_cvt_pk_bf16_f32 v89, v90, v91
v_mfma_f32_16x16x32_bf16 v[56:59], a[204:207], a[188:191], v[56:59]
s_waitcnt lgkmcnt(6)
v_exp_f32 v95, v95
v_mfma_f32_16x16x32_bf16 v[12:15], a[208:211], a[128:131], v[128:131]
ds_read_b64_tr_b16 a[200:201], v158 offset:16384
v_cvt_pk_bf16_f32 v90, v92, v93
v_mfma_f32_16x16x32_bf16 v[28:31], a[208:211], a[144:147], v[132:135]
v_exp_f32 v104, v104
v_mfma_f32_16x16x32_bf16 v[44:47], a[208:211], a[160:163], v[136:139]
ds_read_b64_tr_b16 a[202:203], v158 offset:20480
v_cvt_pk_bf16_f32 v91, v94, v95
v_mfma_f32_16x16x32_bf16 v[60:63], a[208:211], a[176:179], v[140:143]
v_exp_f32 v105, v105
v_mfma_f32_16x16x32_bf16 v[12:15], a[212:215], a[132:135], v[12:15]
ds_read_b64_tr_b16 a[204:205], v159 offset:16384
v_cvt_pk_bf16_f32 v104, v104, v105
v_mfma_f32_16x16x32_bf16 v[28:31], a[212:215], a[148:151], v[28:31]
v_exp_f32 v106, v106
v_mfma_f32_16x16x32_bf16 v[44:47], a[212:215], a[164:167], v[44:47]
ds_read_b64_tr_b16 a[206:207], v159 offset:20480
v_mfma_f32_16x16x32_bf16 v[60:63], a[212:215], a[180:183], v[60:63]
s_waitcnt lgkmcnt(8)
v_exp_f32 v107, v107
v_mfma_f32_16x16x32_bf16 v[12:15], a[216:219], a[136:139], v[12:15]
ds_read_b64_tr_b16 a[208:209], v160 offset:16384
v_cvt_pk_bf16_f32 v105, v106, v107
v_mfma_f32_16x16x32_bf16 v[28:31], a[216:219], a[152:155], v[28:31]
v_exp_f32 v108, v108
v_mfma_f32_16x16x32_bf16 v[44:47], a[216:219], a[168:171], v[44:47]
ds_read_b64_tr_b16 a[210:211], v160 offset:20480
v_mfma_f32_16x16x32_bf16 v[60:63], a[216:219], a[184:187], v[60:63]
v_exp_f32 v109, v109
v_mfma_f32_16x16x32_bf16 v[12:15], a[220:223], a[140:143], v[12:15]
ds_read_b64_tr_b16 a[212:213], v161 offset:16384
v_cvt_pk_bf16_f32 v106, v108, v109
v_mfma_f32_16x16x32_bf16 v[28:31], a[220:223], a[156:159], v[28:31]
v_exp_f32 v110, v110
v_mfma_f32_16x16x32_bf16 v[44:47], a[220:223], a[172:175], v[44:47]
ds_read_b64_tr_b16 a[214:215], v161 offset:20480
v_mfma_f32_16x16x32_bf16 v[60:63], a[220:223], a[188:191], v[60:63]
s_waitcnt lgkmcnt(8)
v_exp_f32 v111, v111
v_mfma_f32_16x16x32_bf16 a[0:3], a[192:195], v[64:67], a[0:3]
ds_read_b64_tr_b16 a[216:217], v162 offset:16384
v_cvt_pk_bf16_f32 v107, v110, v111
v_mfma_f32_16x16x32_bf16 a[32:35], a[192:195], v[80:83], a[32:35]
v_exp_f32 v120, v120
v_mfma_f32_16x16x32_bf16 a[64:67], a[192:195], v[96:99], a[64:67]
ds_read_b64_tr_b16 a[218:219], v162 offset:20480
v_mfma_f32_16x16x32_bf16 a[96:99], a[192:195], v[112:115], a[96:99]
v_exp_f32 v121, v121
v_mfma_f32_16x16x32_bf16 a[4:7], a[196:199], v[64:67], a[4:7]
ds_read_b64_tr_b16 a[220:221], v163 offset:16384
v_cvt_pk_bf16_f32 v120, v120, v121
v_mfma_f32_16x16x32_bf16 a[36:39], a[196:199], v[80:83], a[36:39]
v_exp_f32 v122, v122
v_mfma_f32_16x16x32_bf16 a[224:227], a[240:243], v[64:67], a[224:227]
v_exp_f32 v123, v123
v_mfma_f32_16x16x32_bf16 a[68:71], a[196:199], v[96:99], a[68:71]
ds_read_b64_tr_b16 a[222:223], v163 offset:20480
v_cvt_pk_bf16_f32 v121, v122, v123
v_mfma_f32_16x16x32_bf16 a[100:103], a[196:199], v[112:115], a[100:103]
s_waitcnt lgkmcnt(8)
v_exp_f32 v124, v124
v_mfma_f32_16x16x32_bf16 a[8:11], a[200:203], v[64:67], a[8:11]
ds_read_b64_tr_b16 a[192:193], v156 offset:24576
v_mfma_f32_16x16x32_bf16 a[40:43], a[200:203], v[80:83], a[40:43]
v_exp_f32 v125, v125
v_mfma_f32_16x16x32_bf16 a[72:75], a[200:203], v[96:99], a[72:75]
ds_read_b64_tr_b16 a[194:195], v156 offset:28672
v_cvt_pk_bf16_f32 v122, v124, v125
v_mfma_f32_16x16x32_bf16 a[104:107], a[200:203], v[112:115], a[104:107]
v_exp_f32 v126, v126
v_mfma_f32_16x16x32_bf16 a[12:15], a[204:207], v[64:67], a[12:15]
ds_read_b64_tr_b16 a[196:197], v157 offset:24576
v_mfma_f32_16x16x32_bf16 a[44:47], a[204:207], v[80:83], a[44:47]
v_exp_f32 v127, v127
v_mfma_f32_16x16x32_bf16 a[228:231], a[240:243], v[80:83], a[228:231]
v_cvt_pk_bf16_f32 v123, v126, v127
v_mfma_f32_16x16x32_bf16 a[76:79], a[204:207], v[96:99], a[76:79]
ds_read_b64_tr_b16 a[198:199], v157 offset:28672
v_mfma_f32_16x16x32_bf16 a[108:111], a[204:207], v[112:115], a[108:111]
s_waitcnt lgkmcnt(8)
v_mfma_f32_16x16x32_bf16 a[16:19], a[208:211], v[64:67], a[16:19]
ds_read_b64_tr_b16 a[200:201], v158 offset:24576
v_mfma_f32_16x16x32_bf16 a[48:51], a[208:211], v[80:83], a[48:51]
v_mfma_f32_16x16x32_bf16 a[80:83], a[208:211], v[96:99], a[80:83]
ds_read_b64_tr_b16 a[202:203], v158 offset:28672
v_mfma_f32_16x16x32_bf16 a[112:115], a[208:211], v[112:115], a[112:115]
v_mfma_f32_16x16x32_bf16 a[20:23], a[212:215], v[64:67], a[20:23]
ds_read_b64_tr_b16 a[204:205], v159 offset:24576
v_mfma_f32_16x16x32_bf16 a[52:55], a[212:215], v[80:83], a[52:55]
v_mfma_f32_16x16x32_bf16 a[232:235], a[240:243], v[96:99], a[232:235]
v_mfma_f32_16x16x32_bf16 a[84:87], a[212:215], v[96:99], a[84:87]
ds_read_b64_tr_b16 a[206:207], v159 offset:28672
v_mfma_f32_16x16x32_bf16 a[116:119], a[212:215], v[112:115], a[116:119]
s_waitcnt lgkmcnt(8)
v_mfma_f32_16x16x32_bf16 a[24:27], a[216:219], v[64:67], a[24:27]
ds_read_b64_tr_b16 a[208:209], v160 offset:24576
v_mfma_f32_16x16x32_bf16 a[56:59], a[216:219], v[80:83], a[56:59]
v_mfma_f32_16x16x32_bf16 a[88:91], a[216:219], v[96:99], a[88:91]
ds_read_b64_tr_b16 a[210:211], v160 offset:28672
v_mfma_f32_16x16x32_bf16 a[120:123], a[216:219], v[112:115], a[120:123]
v_mfma_f32_16x16x32_bf16 a[28:31], a[220:223], v[64:67], a[28:31]
ds_read_b64_tr_b16 a[212:213], v161 offset:24576
v_mfma_f32_16x16x32_bf16 a[60:63], a[220:223], v[80:83], a[60:63]
v_mfma_f32_16x16x32_bf16 a[236:239], a[240:243], v[112:115], a[236:239]
v_mfma_f32_16x16x32_bf16 a[92:95], a[220:223], v[96:99], a[92:95]
ds_read_b64_tr_b16 a[214:215], v161 offset:28672
v_mfma_f32_16x16x32_bf16 a[124:127], a[220:223], v[112:115], a[124:127]
s_waitcnt lgkmcnt(8)
v_mfma_f32_16x16x32_bf16 a[0:3], a[192:195], v[72:75], a[0:3]
ds_read_b64_tr_b16 a[216:217], v162 offset:24576
v_mfma_f32_16x16x32_bf16 a[32:35], a[192:195], v[88:91], a[32:35]
v_mfma_f32_16x16x32_bf16 a[64:67], a[192:195], v[104:107], a[64:67]
ds_read_b64_tr_b16 a[218:219], v162 offset:28672
v_mfma_f32_16x16x32_bf16 a[96:99], a[192:195], v[120:123], a[96:99]
s_waitcnt vmcnt(11)
v_mfma_f32_16x16x32_bf16 a[4:7], a[196:199], v[72:75], a[4:7]
ds_read_b64_tr_b16 a[220:221], v163 offset:24576
v_mfma_f32_16x16x32_bf16 a[36:39], a[196:199], v[88:91], a[36:39]
s_barrier
v_exp_f32 v0, v0
v_mfma_f32_16x16x32_bf16 a[224:227], a[240:243], v[72:75], a[224:227]
v_exp_f32 v1, v1
v_mfma_f32_16x16x32_bf16 a[68:71], a[196:199], v[104:107], a[68:71]
ds_read_b64_tr_b16 a[222:223], v163 offset:28672
v_cvt_pk_bf16_f32 v0, v0, v1
v_mfma_f32_16x16x32_bf16 a[100:103], a[196:199], v[120:123], a[100:103]
s_waitcnt lgkmcnt(8)
v_exp_f32 v2, v2
v_mfma_f32_16x16x32_bf16 a[8:11], a[200:203], v[72:75], a[8:11]
ds_read_b128 a[192:195], v152 offset:16384
v_xor_b32 v156, 0x8000, v156
v_mfma_f32_16x16x32_bf16 a[40:43], a[200:203], v[88:91], a[40:43]
s_add_u32 m0, s39, 0
v_exp_f32 v3, v3
v_mfma_f32_16x16x32_bf16 a[72:75], a[200:203], v[104:107], a[72:75]
v_exp_f32 v4, v4
v_mfma_f32_16x16x32_bf16 a[104:107], a[200:203], v[120:123], a[104:107]
buffer_load_dwordx4 v164, s[12:15], s44 offen offset:0 nt lds
v_mfma_f32_16x16x32_bf16 a[12:15], a[204:207], v[72:75], a[12:15]
ds_read_b128 a[196:199], v153 offset:16384
v_xor_b32 v157, 0x8000, v157
v_mfma_f32_16x16x32_bf16 a[44:47], a[204:207], v[88:91], a[44:47]
v_exp_f32 v5, v5
v_mfma_f32_16x16x32_bf16 a[228:231], a[240:243], v[88:91], a[228:231]
v_exp_f32 v6, v6
v_mfma_f32_16x16x32_bf16 a[76:79], a[204:207], v[104:107], a[76:79]
v_exp_f32 v7, v7
v_mfma_f32_16x16x32_bf16 a[108:111], a[204:207], v[120:123], a[108:111]
s_waitcnt lgkmcnt(6)
v_exp_f32 v16, v16
v_mfma_f32_16x16x32_bf16 a[16:19], a[208:211], v[72:75], a[16:19]
ds_read_b128 a[200:203], v154 offset:16384
v_xor_b32 v158, 0x8000, v158
v_mfma_f32_16x16x32_bf16 a[48:51], a[208:211], v[88:91], a[48:51]
v_exp_f32 v17, v17
v_mfma_f32_16x16x32_bf16 a[80:83], a[208:211], v[104:107], a[80:83]
v_exp_f32 v18, v18
v_mfma_f32_16x16x32_bf16 a[112:115], a[208:211], v[120:123], a[112:115]
buffer_load_dwordx4 v165, s[12:15], s44 offen offset:1024 nt lds
v_mfma_f32_16x16x32_bf16 a[20:23], a[212:215], v[72:75], a[20:23]
ds_read_b128 a[204:207], v155 offset:16384
v_xor_b32 v159, 0x8000, v159
v_mfma_f32_16x16x32_bf16 a[52:55], a[212:215], v[88:91], a[52:55]
v_exp_f32 v19, v19
v_mfma_f32_16x16x32_bf16 a[232:235], a[240:243], v[104:107], a[232:235]
v_exp_f32 v20, v20
v_mfma_f32_16x16x32_bf16 a[84:87], a[212:215], v[104:107], a[84:87]
v_exp_f32 v21, v21
v_mfma_f32_16x16x32_bf16 a[116:119], a[212:215], v[120:123], a[116:119]
s_waitcnt lgkmcnt(4)
v_exp_f32 v22, v22
v_mfma_f32_16x16x32_bf16 a[24:27], a[216:219], v[72:75], a[24:27]
ds_read_b128 a[208:211], v152 offset:20480
v_xor_b32 v160, 0x8000, v160
v_mfma_f32_16x16x32_bf16 a[56:59], a[216:219], v[88:91], a[56:59]
v_exp_f32 v23, v23
v_mfma_f32_16x16x32_bf16 a[88:91], a[216:219], v[104:107], a[88:91]
v_exp_f32 v32, v32
v_mfma_f32_16x16x32_bf16 a[120:123], a[216:219], v[120:123], a[120:123]
buffer_load_dwordx4 v166, s[12:15], s44 offen offset:2048 nt lds
v_mfma_f32_16x16x32_bf16 a[28:31], a[220:223], v[72:75], a[28:31]
ds_read_b128 a[212:215], v153 offset:20480
v_xor_b32 v161, 0x8000, v161
v_mfma_f32_16x16x32_bf16 a[60:63], a[220:223], v[88:91], a[60:63]
v_exp_f32 v33, v33
v_mfma_f32_16x16x32_bf16 a[236:239], a[240:243], v[120:123], a[236:239]
v_exp_f32 v34, v34
v_mfma_f32_16x16x32_bf16 a[92:95], a[220:223], v[104:107], a[92:95]
v_cvt_pk_bf16_f32 v1, v2, v3
v_cvt_pk_bf16_f32 v2, v4, v5
v_mfma_f32_16x16x32_bf16 a[124:127], a[220:223], v[120:123], a[124:127]
s_waitcnt lgkmcnt(4)
v_cvt_pk_bf16_f32 v3, v6, v7
v_cvt_pk_bf16_f32 v16, v16, v17
s_mov_b32 s46, 14
.p2align 6
L_attn_loop:
v_mfma_f32_16x16x32_bf16 v[64:67], a[192:195], a[128:131], v[128:131]
ds_read_b128 a[216:219], v154 offset:20480
v_xor_b32 v162, 0x8000, v162
v_mfma_f32_16x16x32_bf16 v[80:83], a[192:195], a[144:147], v[132:135]
v_exp_f32 v35, v35
v_mfma_f32_16x16x32_bf16 v[96:99], a[192:195], a[160:163], v[136:139]
v_exp_f32 v36, v36
v_mfma_f32_16x16x32_bf16 v[112:115], a[192:195], a[176:179], v[140:143]
buffer_load_dwordx4 v167, s[12:15], s44 offen offset:3072 nt lds
v_mfma_f32_16x16x32_bf16 v[64:67], a[196:199], a[132:135], v[64:67]
ds_read_b128 a[220:223], v155 offset:20480
v_xor_b32 v163, 0x8000, v163
v_mfma_f32_16x16x32_bf16 v[80:83], a[196:199], a[148:151], v[80:83]
s_add_u32 s44, s44, 16384
v_exp_f32 v37, v37
v_mfma_f32_16x16x32_bf16 v[96:99], a[196:199], a[164:167], v[96:99]
v_exp_f32 v38, v38
v_mfma_f32_16x16x32_bf16 v[112:115], a[196:199], a[180:183], v[112:115]
s_waitcnt lgkmcnt(4)
v_exp_f32 v39, v39
v_mfma_f32_16x16x32_bf16 v[64:67], a[200:203], a[136:139], v[64:67]
ds_read_b128 a[192:195], v152 offset:24576
v_cvt_pk_bf16_f32 v17, v18, v19
v_mfma_f32_16x16x32_bf16 v[80:83], a[200:203], a[152:155], v[80:83]
s_add_u32 m0, s65, 65536
v_exp_f32 v48, v48
v_mfma_f32_16x16x32_bf16 v[96:99], a[200:203], a[168:171], v[96:99]
v_exp_f32 v49, v49
v_mfma_f32_16x16x32_bf16 v[112:115], a[200:203], a[184:187], v[112:115]
buffer_load_dwordx4 v168, s[16:19], s45 offen offset:0 nt lds
v_mfma_f32_16x16x32_bf16 v[64:67], a[204:207], a[140:143], v[64:67]
ds_read_b128 a[196:199], v153 offset:24576
v_cvt_pk_bf16_f32 v18, v20, v21
v_mfma_f32_16x16x32_bf16 v[80:83], a[204:207], a[156:159], v[80:83]
v_exp_f32 v50, v50
v_mfma_f32_16x16x32_bf16 v[96:99], a[204:207], a[172:175], v[96:99]
v_cvt_pk_bf16_f32 v19, v22, v23
v_cvt_pk_bf16_f32 v32, v32, v33
v_mfma_f32_16x16x32_bf16 v[112:115], a[204:207], a[188:191], v[112:115]
s_waitcnt lgkmcnt(4)
v_exp_f32 v51, v51
v_mfma_f32_16x16x32_bf16 v[68:71], a[208:211], a[128:131], v[128:131]
ds_read_b128 a[200:203], v154 offset:24576
v_cvt_pk_bf16_f32 v33, v34, v35
v_mfma_f32_16x16x32_bf16 v[84:87], a[208:211], a[144:147], v[132:135]
v_exp_f32 v52, v52
v_mfma_f32_16x16x32_bf16 v[100:103], a[208:211], a[160:163], v[136:139]
v_exp_f32 v53, v53
v_mfma_f32_16x16x32_bf16 v[116:119], a[208:211], a[176:179], v[140:143]
buffer_load_dwordx4 v169, s[16:19], s45 offen offset:1024 nt lds
v_mfma_f32_16x16x32_bf16 v[68:71], a[212:215], a[132:135], v[68:71]
ds_read_b128 a[204:207], v155 offset:24576
v_cvt_pk_bf16_f32 v34, v36, v37
v_mfma_f32_16x16x32_bf16 v[84:87], a[212:215], a[148:151], v[84:87]
v_exp_f32 v54, v54
v_mfma_f32_16x16x32_bf16 v[100:103], a[212:215], a[164:167], v[100:103]
v_exp_f32 v55, v55
v_mfma_f32_16x16x32_bf16 v[116:119], a[212:215], a[180:183], v[116:119]
s_waitcnt lgkmcnt(4)
v_exp_f32 v8, v8
v_mfma_f32_16x16x32_bf16 v[68:71], a[216:219], a[136:139], v[68:71]
ds_read_b128 a[208:211], v152 offset:28672
v_cvt_pk_bf16_f32 v35, v38, v39
v_mfma_f32_16x16x32_bf16 v[84:87], a[216:219], a[152:155], v[84:87]
v_exp_f32 v9, v9
v_mfma_f32_16x16x32_bf16 v[100:103], a[216:219], a[168:171], v[100:103]
v_exp_f32 v10, v10
v_mfma_f32_16x16x32_bf16 v[116:119], a[216:219], a[184:187], v[116:119]
buffer_load_dwordx4 v168, s[16:19], s45 offen offset:2048 nt lds
v_mfma_f32_16x16x32_bf16 v[68:71], a[220:223], a[140:143], v[68:71]
ds_read_b128 a[212:215], v153 offset:28672
v_cvt_pk_bf16_f32 v48, v48, v49
v_mfma_f32_16x16x32_bf16 v[84:87], a[220:223], a[156:159], v[84:87]
v_exp_f32 v11, v11
v_mfma_f32_16x16x32_bf16 v[100:103], a[220:223], a[172:175], v[100:103]
v_exp_f32 v12, v12
v_mfma_f32_16x16x32_bf16 v[116:119], a[220:223], a[188:191], v[116:119]
s_waitcnt lgkmcnt(4)
v_exp_f32 v13, v13
v_mfma_f32_16x16x32_bf16 v[72:75], a[192:195], a[128:131], v[128:131]
ds_read_b128 a[216:219], v154 offset:28672
v_cvt_pk_bf16_f32 v49, v50, v51
v_mfma_f32_16x16x32_bf16 v[88:91], a[192:195], a[144:147], v[132:135]
v_exp_f32 v14, v14
v_mfma_f32_16x16x32_bf16 v[104:107], a[192:195], a[160:163], v[136:139]
v_exp_f32 v15, v15
v_mfma_f32_16x16x32_bf16 v[120:123], a[192:195], a[176:179], v[140:143]
buffer_load_dwordx4 v169, s[16:19], s45 offen offset:3072 nt lds
v_mfma_f32_16x16x32_bf16 v[72:75], a[196:199], a[132:135], v[72:75]
ds_read_b128 a[220:223], v155 offset:28672
v_cvt_pk_bf16_f32 v50, v52, v53
v_mfma_f32_16x16x32_bf16 v[88:91], a[196:199], a[148:151], v[88:91]
s_add_u32 s45, s45, 16384
v_exp_f32 v24, v24
v_mfma_f32_16x16x32_bf16 v[104:107], a[196:199], a[164:167], v[104:107]
v_exp_f32 v25, v25
v_mfma_f32_16x16x32_bf16 v[120:123], a[196:199], a[180:183], v[120:123]
s_waitcnt lgkmcnt(4)
v_exp_f32 v26, v26
v_mfma_f32_16x16x32_bf16 v[72:75], a[200:203], a[136:139], v[72:75]
ds_read_b64_tr_b16 a[192:193], v156 offset:0
v_xor_b32 v152, 0x8000, v152
v_mfma_f32_16x16x32_bf16 v[88:91], a[200:203], a[152:155], v[88:91]
s_mov_b32 m0, s68
v_cvt_pk_bf16_f32 v51, v54, v55
v_cvt_pk_bf16_f32 v8, v8, v9
v_mfma_f32_16x16x32_bf16 v[104:107], a[200:203], a[168:171], v[104:107]
ds_read_b64_tr_b16 a[194:195], v156 offset:4096
v_xor_b32 v153, 0x8000, v153
v_mfma_f32_16x16x32_bf16 v[120:123], a[200:203], a[184:187], v[120:123]
buffer_load_dwordx4 v170, s[60:63], s67 offen nt lds
v_mfma_f32_16x16x32_bf16 v[72:75], a[204:207], a[140:143], v[72:75]
ds_read_b64_tr_b16 a[196:197], v157 offset:0
v_xor_b32 v154, 0x8000, v154
v_mfma_f32_16x16x32_bf16 v[88:91], a[204:207], a[156:159], v[88:91]
s_add_u32 s68, s68, 4096
v_exp_f32 v27, v27
v_mfma_f32_16x16x32_bf16 v[104:107], a[204:207], a[172:175], v[104:107]
ds_read_b64_tr_b16 a[198:199], v157 offset:4096
v_xor_b32 v155, 0x8000, v155
v_mfma_f32_16x16x32_bf16 v[120:123], a[204:207], a[188:191], v[120:123]
s_waitcnt lgkmcnt(6)
v_exp_f32 v28, v28
v_mfma_f32_16x16x32_bf16 v[76:79], a[208:211], a[128:131], v[128:131]
ds_read_b64_tr_b16 a[200:201], v158 offset:0
v_cvt_pk_bf16_f32 v9, v10, v11
v_mfma_f32_16x16x32_bf16 v[92:95], a[208:211], a[144:147], v[132:135]
s_cmp_lt_u32 s68, 163840
v_exp_f32 v29, v29
v_mfma_f32_16x16x32_bf16 v[108:111], a[208:211], a[160:163], v[136:139]
ds_read_b64_tr_b16 a[202:203], v158 offset:4096
v_cvt_pk_bf16_f32 v10, v12, v13
v_mfma_f32_16x16x32_bf16 v[124:127], a[208:211], a[176:179], v[140:143]
s_cselect_b32 s66, s28, 0x1000000
v_exp_f32 v30, v30
v_mfma_f32_16x16x32_bf16 v[76:79], a[212:215], a[132:135], v[76:79]
ds_read_b64_tr_b16 a[204:205], v159 offset:0
v_cvt_pk_bf16_f32 v11, v14, v15
v_mfma_f32_16x16x32_bf16 v[92:95], a[212:215], a[148:151], v[92:95]
s_add_u32 s67, s67, s66
v_exp_f32 v31, v31
v_mfma_f32_16x16x32_bf16 v[108:111], a[212:215], a[164:167], v[108:111]
ds_read_b64_tr_b16 a[206:207], v159 offset:4096
v_cvt_pk_bf16_f32 v24, v24, v25
v_mfma_f32_16x16x32_bf16 v[124:127], a[212:215], a[180:183], v[124:127]
s_waitcnt lgkmcnt(8)
v_exp_f32 v40, v40
v_mfma_f32_16x16x32_bf16 v[76:79], a[216:219], a[136:139], v[76:79]
ds_read_b64_tr_b16 a[208:209], v160 offset:0
v_cvt_pk_bf16_f32 v25, v26, v27
v_mfma_f32_16x16x32_bf16 v[92:95], a[216:219], a[152:155], v[92:95]
v_exp_f32 v41, v41
v_mfma_f32_16x16x32_bf16 v[108:111], a[216:219], a[168:171], v[108:111]
ds_read_b64_tr_b16 a[210:211], v160 offset:4096
v_cvt_pk_bf16_f32 v26, v28, v29
v_mfma_f32_16x16x32_bf16 v[124:127], a[216:219], a[184:187], v[124:127]
buffer_load_dword v181, v182, s[84:87], s69 offen
v_mfma_f32_16x16x32_bf16 v[76:79], a[220:223], a[140:143], v[76:79]
ds_read_b64_tr_b16 a[212:213], v161 offset:0
v_cvt_pk_bf16_f32 v27, v30, v31
v_mfma_f32_16x16x32_bf16 v[92:95], a[220:223], a[156:159], v[92:95]
s_add_u32 s69, s69, 524288
v_exp_f32 v42, v42
v_mfma_f32_16x16x32_bf16 v[108:111], a[220:223], a[172:175], v[108:111]
ds_read_b64_tr_b16 a[214:215], v161 offset:4096
v_cvt_pk_bf16_f32 v40, v40, v41
v_mfma_f32_16x16x32_bf16 v[124:127], a[220:223], a[188:191], v[124:127]
s_waitcnt lgkmcnt(8)
v_exp_f32 v43, v43
v_mfma_f32_16x16x32_bf16 a[0:3], a[192:195], v[0:3], a[0:3]
ds_read_b64_tr_b16 a[216:217], v162 offset:0
v_cvt_pk_bf16_f32 v41, v42, v43
v_mfma_f32_16x16x32_bf16 a[32:35], a[192:195], v[16:19], a[32:35]
v_exp_f32 v44, v44
v_mfma_f32_16x16x32_bf16 a[64:67], a[192:195], v[32:35], a[64:67]
ds_read_b64_tr_b16 a[218:219], v162 offset:4096
v_mfma_f32_16x16x32_bf16 a[96:99], a[192:195], v[48:51], a[96:99]
v_exp_f32 v45, v45
v_mfma_f32_16x16x32_bf16 a[4:7], a[196:199], v[0:3], a[4:7]
ds_read_b64_tr_b16 a[220:221], v163 offset:0
v_cvt_pk_bf16_f32 v42, v44, v45
v_mfma_f32_16x16x32_bf16 a[36:39], a[196:199], v[16:19], a[36:39]
v_exp_f32 v46, v46
v_mfma_f32_16x16x32_bf16 a[224:227], a[240:243], v[0:3], a[224:227]
v_exp_f32 v47, v47
v_mfma_f32_16x16x32_bf16 a[68:71], a[196:199], v[32:35], a[68:71]
ds_read_b64_tr_b16 a[222:223], v163 offset:4096
v_cvt_pk_bf16_f32 v43, v46, v47
v_mfma_f32_16x16x32_bf16 a[100:103], a[196:199], v[48:51], a[100:103]
s_waitcnt lgkmcnt(8)
v_exp_f32 v56, v56
v_mfma_f32_16x16x32_bf16 a[8:11], a[200:203], v[0:3], a[8:11]
ds_read_b64_tr_b16 a[192:193], v156 offset:8192
v_mfma_f32_16x16x32_bf16 a[40:43], a[200:203], v[16:19], a[40:43]
v_exp_f32 v57, v57
v_mfma_f32_16x16x32_bf16 a[72:75], a[200:203], v[32:35], a[72:75]
ds_read_b64_tr_b16 a[194:195], v156 offset:12288
v_cvt_pk_bf16_f32 v56, v56, v57
v_mfma_f32_16x16x32_bf16 a[104:107], a[200:203], v[48:51], a[104:107]
v_exp_f32 v58, v58
v_mfma_f32_16x16x32_bf16 a[12:15], a[204:207], v[0:3], a[12:15]
ds_read_b64_tr_b16 a[196:197], v157 offset:8192
v_mfma_f32_16x16x32_bf16 a[44:47], a[204:207], v[16:19], a[44:47]
v_exp_f32 v59, v59
v_mfma_f32_16x16x32_bf16 a[228:231], a[240:243], v[16:19], a[228:231]
v_exp_f32 v60, v60
v_mfma_f32_16x16x32_bf16 a[76:79], a[204:207], v[32:35], a[76:79]
ds_read_b64_tr_b16 a[198:199], v157 offset:12288
v_cvt_pk_bf16_f32 v57, v58, v59
v_mfma_f32_16x16x32_bf16 a[108:111], a[204:207], v[48:51], a[108:111]
s_waitcnt lgkmcnt(8)
v_exp_f32 v61, v61
v_mfma_f32_16x16x32_bf16 a[16:19], a[208:211], v[0:3], a[16:19]
ds_read_b64_tr_b16 a[200:201], v158 offset:8192
v_cvt_pk_bf16_f32 v58, v60, v61
v_mfma_f32_16x16x32_bf16 a[48:51], a[208:211], v[16:19], a[48:51]
v_exp_f32 v62, v62
v_mfma_f32_16x16x32_bf16 a[80:83], a[208:211], v[32:35], a[80:83]
ds_read_b64_tr_b16 a[202:203], v158 offset:12288
v_mfma_f32_16x16x32_bf16 a[112:115], a[208:211], v[48:51], a[112:115]
v_exp_f32 v63, v63
v_mfma_f32_16x16x32_bf16 a[20:23], a[212:215], v[0:3], a[20:23]
ds_read_b64_tr_b16 a[204:205], v159 offset:8192
v_cvt_pk_bf16_f32 v59, v62, v63
v_mfma_f32_16x16x32_bf16 a[52:55], a[212:215], v[16:19], a[52:55]
v_mfma_f32_16x16x32_bf16 a[232:235], a[240:243], v[32:35], a[232:235]
v_mfma_f32_16x16x32_bf16 a[84:87], a[212:215], v[32:35], a[84:87]
ds_read_b64_tr_b16 a[206:207], v159 offset:12288
v_mfma_f32_16x16x32_bf16 a[116:119], a[212:215], v[48:51], a[116:119]
s_waitcnt lgkmcnt(8)
v_mfma_f32_16x16x32_bf16 a[24:27], a[216:219], v[0:3], a[24:27]
ds_read_b64_tr_b16 a[208:209], v160 offset:8192
v_mfma_f32_16x16x32_bf16 a[56:59], a[216:219], v[16:19], a[56:59]
v_mfma_f32_16x16x32_bf16 a[88:91], a[216:219], v[32:35], a[88:91]
ds_read_b64_tr_b16 a[210:211], v160 offset:12288
v_mfma_f32_16x16x32_bf16 a[120:123], a[216:219], v[48:51], a[120:123]
v_mfma_f32_16x16x32_bf16 a[28:31], a[220:223], v[0:3], a[28:31]
ds_read_b64_tr_b16 a[212:213], v161 offset:8192
v_mfma_f32_16x16x32_bf16 a[60:63], a[220:223], v[16:19], a[60:63]
v_mfma_f32_16x16x32_bf16 a[236:239], a[240:243], v[48:51], a[236:239]
v_mfma_f32_16x16x32_bf16 a[92:95], a[220:223], v[32:35], a[92:95]
ds_read_b64_tr_b16 a[214:215], v161 offset:12288
v_mfma_f32_16x16x32_bf16 a[124:127], a[220:223], v[48:51], a[124:127]
s_waitcnt lgkmcnt(8)
v_mfma_f32_16x16x32_bf16 a[0:3], a[192:195], v[8:11], a[0:3]
ds_read_b64_tr_b16 a[216:217], v162 offset:8192
v_mfma_f32_16x16x32_bf16 a[32:35], a[192:195], v[24:27], a[32:35]
v_mfma_f32_16x16x32_bf16 a[64:67], a[192:195], v[40:43], a[64:67]
ds_read_b64_tr_b16 a[218:219], v162 offset:12288
v_mfma_f32_16x16x32_bf16 a[96:99], a[192:195], v[56:59], a[96:99]
s_waitcnt vmcnt(11)
v_mfma_f32_16x16x32_bf16 a[4:7], a[196:199], v[8:11], a[4:7]
ds_read_b64_tr_b16 a[220:221], v163 offset:8192
v_mfma_f32_16x16x32_bf16 a[36:39], a[196:199], v[24:27], a[36:39]
s_barrier
v_exp_f32 v64, v64
v_mfma_f32_16x16x32_bf16 a[224:227], a[240:243], v[8:11], a[224:227]
v_exp_f32 v65, v65
v_mfma_f32_16x16x32_bf16 a[68:71], a[196:199], v[40:43], a[68:71]
ds_read_b64_tr_b16 a[222:223], v163 offset:12288
v_cvt_pk_bf16_f32 v64, v64, v65
v_mfma_f32_16x16x32_bf16 a[100:103], a[196:199], v[56:59], a[100:103]
s_waitcnt lgkmcnt(8)
v_exp_f32 v66, v66
v_mfma_f32_16x16x32_bf16 a[8:11], a[200:203], v[8:11], a[8:11]
ds_read_b128 a[192:195], v152 offset:0
v_mfma_f32_16x16x32_bf16 a[40:43], a[200:203], v[24:27], a[40:43]
s_add_u32 m0, s39, 16384
v_exp_f32 v67, v67
v_mfma_f32_16x16x32_bf16 a[72:75], a[200:203], v[40:43], a[72:75]
v_exp_f32 v68, v68
v_mfma_f32_16x16x32_bf16 a[104:107], a[200:203], v[56:59], a[104:107]
buffer_load_dwordx4 v164, s[12:15], s44 offen offset:0 nt lds
v_mfma_f32_16x16x32_bf16 a[12:15], a[204:207], v[8:11], a[12:15]
ds_read_b128 a[196:199], v153 offset:0
v_cvt_pk_bf16_f32 v65, v66, v67
v_mfma_f32_16x16x32_bf16 a[44:47], a[204:207], v[24:27], a[44:47]
v_exp_f32 v69, v69
v_mfma_f32_16x16x32_bf16 a[228:231], a[240:243], v[24:27], a[228:231]
v_exp_f32 v70, v70
v_mfma_f32_16x16x32_bf16 a[76:79], a[204:207], v[40:43], a[76:79]
v_exp_f32 v71, v71
v_mfma_f32_16x16x32_bf16 a[108:111], a[204:207], v[56:59], a[108:111]
s_waitcnt lgkmcnt(6)
v_exp_f32 v80, v80
v_mfma_f32_16x16x32_bf16 a[16:19], a[208:211], v[8:11], a[16:19]
ds_read_b128 a[200:203], v154 offset:0
v_cvt_pk_bf16_f32 v66, v68, v69
v_mfma_f32_16x16x32_bf16 a[48:51], a[208:211], v[24:27], a[48:51]
v_exp_f32 v81, v81
v_mfma_f32_16x16x32_bf16 a[80:83], a[208:211], v[40:43], a[80:83]
v_exp_f32 v82, v82
v_mfma_f32_16x16x32_bf16 a[112:115], a[208:211], v[56:59], a[112:115]
buffer_load_dwordx4 v165, s[12:15], s44 offen offset:1024 nt lds
v_mfma_f32_16x16x32_bf16 a[20:23], a[212:215], v[8:11], a[20:23]
ds_read_b128 a[204:207], v155 offset:0
v_cvt_pk_bf16_f32 v67, v70, v71
v_mfma_f32_16x16x32_bf16 a[52:55], a[212:215], v[24:27], a[52:55]
s_xor_b32 s39, s39, 0x8000
v_exp_f32 v83, v83
v_mfma_f32_16x16x32_bf16 a[232:235], a[240:243], v[40:43], a[232:235]
v_exp_f32 v84, v84
v_mfma_f32_16x16x32_bf16 a[84:87], a[212:215], v[40:43], a[84:87]
v_exp_f32 v85, v85
v_mfma_f32_16x16x32_bf16 a[116:119], a[212:215], v[56:59], a[116:119]
s_waitcnt lgkmcnt(4)
v_exp_f32 v86, v86
v_mfma_f32_16x16x32_bf16 a[24:27], a[216:219], v[8:11], a[24:27]
ds_read_b128 a[208:211], v152 offset:4096
v_cvt_pk_bf16_f32 v80, v80, v81
v_mfma_f32_16x16x32_bf16 a[56:59], a[216:219], v[24:27], a[56:59]
v_exp_f32 v87, v87
v_mfma_f32_16x16x32_bf16 a[88:91], a[216:219], v[40:43], a[88:91]
v_exp_f32 v96, v96
v_mfma_f32_16x16x32_bf16 a[120:123], a[216:219], v[56:59], a[120:123]
buffer_load_dwordx4 v166, s[12:15], s44 offen offset:2048 nt lds
v_mfma_f32_16x16x32_bf16 a[28:31], a[220:223], v[8:11], a[28:31]
ds_read_b128 a[212:215], v153 offset:4096
v_cvt_pk_bf16_f32 v81, v82, v83
v_mfma_f32_16x16x32_bf16 a[60:63], a[220:223], v[24:27], a[60:63]
v_exp_f32 v97, v97
v_mfma_f32_16x16x32_bf16 a[236:239], a[240:243], v[56:59], a[236:239]
v_exp_f32 v98, v98
v_mfma_f32_16x16x32_bf16 a[92:95], a[220:223], v[40:43], a[92:95]
v_exp_f32 v99, v99
v_mfma_f32_16x16x32_bf16 a[124:127], a[220:223], v[56:59], a[124:127]
s_waitcnt lgkmcnt(4)
v_exp_f32 v100, v100
v_mfma_f32_16x16x32_bf16 v[0:3], a[192:195], a[128:131], v[128:131]
ds_read_b128 a[216:219], v154 offset:4096
v_cvt_pk_bf16_f32 v82, v84, v85
v_mfma_f32_16x16x32_bf16 v[16:19], a[192:195], a[144:147], v[132:135]
v_exp_f32 v101, v101
v_mfma_f32_16x16x32_bf16 v[32:35], a[192:195], a[160:163], v[136:139]
v_exp_f32 v102, v102
v_mfma_f32_16x16x32_bf16 v[48:51], a[192:195], a[176:179], v[140:143]
buffer_load_dwordx4 v167, s[12:15], s44 offen offset:3072 nt lds
v_mfma_f32_16x16x32_bf16 v[0:3], a[196:199], a[132:135], v[0:3]
ds_read_b128 a[220:223], v155 offset:4096
v_cvt_pk_bf16_f32 v83, v86, v87
v_mfma_f32_16x16x32_bf16 v[16:19], a[196:199], a[148:151], v[16:19]
s_add_u32 s44, s44, 16384
v_exp_f32 v103, v103
v_mfma_f32_16x16x32_bf16 v[32:35], a[196:199], a[164:167], v[32:35]
v_exp_f32 v112, v112
v_mfma_f32_16x16x32_bf16 v[48:51], a[196:199], a[180:183], v[48:51]
s_waitcnt lgkmcnt(4)
v_exp_f32 v113, v113
v_mfma_f32_16x16x32_bf16 v[0:3], a[200:203], a[136:139], v[0:3]
ds_read_b128 a[192:195], v152 offset:8192
v_cvt_pk_bf16_f32 v96, v96, v97
v_mfma_f32_16x16x32_bf16 v[16:19], a[200:203], a[152:155], v[16:19]
s_add_u32 m0, s65, 81920
v_exp_f32 v114, v114
v_mfma_f32_16x16x32_bf16 v[32:35], a[200:203], a[168:171], v[32:35]
v_exp_f32 v115, v115
v_mfma_f32_16x16x32_bf16 v[48:51], a[200:203], a[184:187], v[48:51]
buffer_load_dwordx4 v168, s[16:19], s45 offen offset:0 nt lds
v_mfma_f32_16x16x32_bf16 v[0:3], a[204:207], a[140:143], v[0:3]
ds_read_b128 a[196:199], v153 offset:8192
v_cvt_pk_bf16_f32 v97, v98, v99
v_mfma_f32_16x16x32_bf16 v[16:19], a[204:207], a[156:159], v[16:19]
v_exp_f32 v116, v116
v_mfma_f32_16x16x32_bf16 v[32:35], a[204:207], a[172:175], v[32:35]
v_exp_f32 v117, v117
v_mfma_f32_16x16x32_bf16 v[48:51], a[204:207], a[188:191], v[48:51]
s_waitcnt lgkmcnt(4)
v_exp_f32 v118, v118
v_mfma_f32_16x16x32_bf16 v[4:7], a[208:211], a[128:131], v[128:131]
ds_read_b128 a[200:203], v154 offset:8192
v_cvt_pk_bf16_f32 v98, v100, v101
v_mfma_f32_16x16x32_bf16 v[20:23], a[208:211], a[144:147], v[132:135]
v_exp_f32 v119, v119
v_mfma_f32_16x16x32_bf16 v[36:39], a[208:211], a[160:163], v[136:139]
v_exp_f32 v72, v72
v_mfma_f32_16x16x32_bf16 v[52:55], a[208:211], a[176:179], v[140:143]
buffer_load_dwordx4 v169, s[16:19], s45 offen offset:1024 nt lds
v_mfma_f32_16x16x32_bf16 v[4:7], a[212:215], a[132:135], v[4:7]
ds_read_b128 a[204:207], v155 offset:8192
v_cvt_pk_bf16_f32 v99, v102, v103
v_mfma_f32_16x16x32_bf16 v[20:23], a[212:215], a[148:151], v[20:23]
s_xor_b32 s65, s65, 0x8000
v_exp_f32 v73, v73
v_mfma_f32_16x16x32_bf16 v[36:39], a[212:215], a[164:167], v[36:39]
v_exp_f32 v74, v74
v_mfma_f32_16x16x32_bf16 v[52:55], a[212:215], a[180:183], v[52:55]
s_waitcnt lgkmcnt(4)
v_cvt_pk_bf16_f32 v112, v112, v113
v_cvt_pk_bf16_f32 v113, v114, v115
v_mfma_f32_16x16x32_bf16 v[4:7], a[216:219], a[136:139], v[4:7]
ds_read_b128 a[208:211], v152 offset:12288
v_cvt_pk_bf16_f32 v114, v116, v117
v_mfma_f32_16x16x32_bf16 v[20:23], a[216:219], a[152:155], v[20:23]
v_exp_f32 v75, v75
v_mfma_f32_16x16x32_bf16 v[36:39], a[216:219], a[168:171], v[36:39]
v_exp_f32 v76, v76
v_mfma_f32_16x16x32_bf16 v[52:55], a[216:219], a[184:187], v[52:55]
buffer_load_dwordx4 v168, s[16:19], s45 offen offset:2048 nt lds
v_mfma_f32_16x16x32_bf16 v[4:7], a[220:223], a[140:143], v[4:7]
ds_read_b128 a[212:215], v153 offset:12288
v_cvt_pk_bf16_f32 v115, v118, v119
v_mfma_f32_16x16x32_bf16 v[20:23], a[220:223], a[156:159], v[20:23]
v_exp_f32 v77, v77
v_mfma_f32_16x16x32_bf16 v[36:39], a[220:223], a[172:175], v[36:39]
v_exp_f32 v78, v78
v_mfma_f32_16x16x32_bf16 v[52:55], a[220:223], a[188:191], v[52:55]
s_waitcnt lgkmcnt(4)
v_exp_f32 v79, v79
v_mfma_f32_16x16x32_bf16 v[8:11], a[192:195], a[128:131], v[128:131]
ds_read_b128 a[216:219], v154 offset:12288
v_cvt_pk_bf16_f32 v72, v72, v73
v_mfma_f32_16x16x32_bf16 v[24:27], a[192:195], a[144:147], v[132:135]
v_exp_f32 v88, v88
v_mfma_f32_16x16x32_bf16 v[40:43], a[192:195], a[160:163], v[136:139]
v_exp_f32 v89, v89
v_mfma_f32_16x16x32_bf16 v[56:59], a[192:195], a[176:179], v[140:143]
buffer_load_dwordx4 v169, s[16:19], s45 offen offset:3072 nt lds
v_mfma_f32_16x16x32_bf16 v[8:11], a[196:199], a[132:135], v[8:11]
ds_read_b128 a[220:223], v155 offset:12288
v_cvt_pk_bf16_f32 v73, v74, v75
v_mfma_f32_16x16x32_bf16 v[24:27], a[196:199], a[148:151], v[24:27]
s_add_u32 s45, s45, 16384
v_exp_f32 v90, v90
v_mfma_f32_16x16x32_bf16 v[40:43], a[196:199], a[164:167], v[40:43]
v_exp_f32 v91, v91
v_mfma_f32_16x16x32_bf16 v[56:59], a[196:199], a[180:183], v[56:59]
s_waitcnt lgkmcnt(4)
v_exp_f32 v92, v92
v_mfma_f32_16x16x32_bf16 v[8:11], a[200:203], a[136:139], v[8:11]
ds_read_b64_tr_b16 a[192:193], v156 offset:16384
v_cvt_pk_bf16_f32 v74, v76, v77
v_mfma_f32_16x16x32_bf16 v[24:27], a[200:203], a[152:155], v[24:27]
v_exp_f32 v93, v93
v_mfma_f32_16x16x32_bf16 v[40:43], a[200:203], a[168:171], v[40:43]
ds_read_b64_tr_b16 a[194:195], v156 offset:20480
v_cvt_pk_bf16_f32 v75, v78, v79
v_mfma_f32_16x16x32_bf16 v[56:59], a[200:203], a[184:187], v[56:59]
buffer_load_dword v181, v182, s[84:87], s69 offen
v_mfma_f32_16x16x32_bf16 v[8:11], a[204:207], a[140:143], v[8:11]
ds_read_b64_tr_b16 a[196:197], v157 offset:16384
v_cvt_pk_bf16_f32 v88, v88, v89
v_mfma_f32_16x16x32_bf16 v[24:27], a[204:207], a[156:159], v[24:27]
s_add_u32 s69, s69, 524288
v_exp_f32 v94, v94
v_mfma_f32_16x16x32_bf16 v[40:43], a[204:207], a[172:175], v[40:43]
ds_read_b64_tr_b16 a[198:199], v157 offset:20480
v_cvt_pk_bf16_f32 v89, v90, v91
v_mfma_f32_16x16x32_bf16 v[56:59], a[204:207], a[188:191], v[56:59]
s_waitcnt lgkmcnt(6)
v_exp_f32 v95, v95
v_mfma_f32_16x16x32_bf16 v[12:15], a[208:211], a[128:131], v[128:131]
ds_read_b64_tr_b16 a[200:201], v158 offset:16384
v_cvt_pk_bf16_f32 v90, v92, v93
v_mfma_f32_16x16x32_bf16 v[28:31], a[208:211], a[144:147], v[132:135]
v_exp_f32 v104, v104
v_mfma_f32_16x16x32_bf16 v[44:47], a[208:211], a[160:163], v[136:139]
ds_read_b64_tr_b16 a[202:203], v158 offset:20480
v_cvt_pk_bf16_f32 v91, v94, v95
v_mfma_f32_16x16x32_bf16 v[60:63], a[208:211], a[176:179], v[140:143]
v_exp_f32 v105, v105
v_mfma_f32_16x16x32_bf16 v[12:15], a[212:215], a[132:135], v[12:15]
ds_read_b64_tr_b16 a[204:205], v159 offset:16384
v_cvt_pk_bf16_f32 v104, v104, v105
v_mfma_f32_16x16x32_bf16 v[28:31], a[212:215], a[148:151], v[28:31]
v_exp_f32 v106, v106
v_mfma_f32_16x16x32_bf16 v[44:47], a[212:215], a[164:167], v[44:47]
ds_read_b64_tr_b16 a[206:207], v159 offset:20480
v_mfma_f32_16x16x32_bf16 v[60:63], a[212:215], a[180:183], v[60:63]
s_waitcnt lgkmcnt(8)
v_exp_f32 v107, v107
v_mfma_f32_16x16x32_bf16 v[12:15], a[216:219], a[136:139], v[12:15]
ds_read_b64_tr_b16 a[208:209], v160 offset:16384
v_cvt_pk_bf16_f32 v105, v106, v107
v_mfma_f32_16x16x32_bf16 v[28:31], a[216:219], a[152:155], v[28:31]
v_exp_f32 v108, v108
v_mfma_f32_16x16x32_bf16 v[44:47], a[216:219], a[168:171], v[44:47]
ds_read_b64_tr_b16 a[210:211], v160 offset:20480
v_mfma_f32_16x16x32_bf16 v[60:63], a[216:219], a[184:187], v[60:63]
v_exp_f32 v109, v109
v_mfma_f32_16x16x32_bf16 v[12:15], a[220:223], a[140:143], v[12:15]
ds_read_b64_tr_b16 a[212:213], v161 offset:16384
v_cvt_pk_bf16_f32 v106, v108, v109
v_mfma_f32_16x16x32_bf16 v[28:31], a[220:223], a[156:159], v[28:31]
v_exp_f32 v110, v110
v_mfma_f32_16x16x32_bf16 v[44:47], a[220:223], a[172:175], v[44:47]
ds_read_b64_tr_b16 a[214:215], v161 offset:20480
v_mfma_f32_16x16x32_bf16 v[60:63], a[220:223], a[188:191], v[60:63]
s_waitcnt lgkmcnt(8)
v_exp_f32 v111, v111
v_mfma_f32_16x16x32_bf16 a[0:3], a[192:195], v[64:67], a[0:3]
ds_read_b64_tr_b16 a[216:217], v162 offset:16384
v_cvt_pk_bf16_f32 v107, v110, v111
v_mfma_f32_16x16x32_bf16 a[32:35], a[192:195], v[80:83], a[32:35]
v_exp_f32 v120, v120
v_mfma_f32_16x16x32_bf16 a[64:67], a[192:195], v[96:99], a[64:67]
ds_read_b64_tr_b16 a[218:219], v162 offset:20480
v_mfma_f32_16x16x32_bf16 a[96:99], a[192:195], v[112:115], a[96:99]
v_exp_f32 v121, v121
v_mfma_f32_16x16x32_bf16 a[4:7], a[196:199], v[64:67], a[4:7]
ds_read_b64_tr_b16 a[220:221], v163 offset:16384
v_cvt_pk_bf16_f32 v120, v120, v121
v_mfma_f32_16x16x32_bf16 a[36:39], a[196:199], v[80:83], a[36:39]
v_exp_f32 v122, v122
v_mfma_f32_16x16x32_bf16 a[224:227], a[240:243], v[64:67], a[224:227]
v_exp_f32 v123, v123
v_mfma_f32_16x16x32_bf16 a[68:71], a[196:199], v[96:99], a[68:71]
ds_read_b64_tr_b16 a[222:223], v163 offset:20480
v_cvt_pk_bf16_f32 v121, v122, v123
v_mfma_f32_16x16x32_bf16 a[100:103], a[196:199], v[112:115], a[100:103]
s_waitcnt lgkmcnt(8)
v_exp_f32 v124, v124
v_mfma_f32_16x16x32_bf16 a[8:11], a[200:203], v[64:67], a[8:11]
ds_read_b64_tr_b16 a[192:193], v156 offset:24576
v_mfma_f32_16x16x32_bf16 a[40:43], a[200:203], v[80:83], a[40:43]
v_exp_f32 v125, v125
v_mfma_f32_16x16x32_bf16 a[72:75], a[200:203], v[96:99], a[72:75]
ds_read_b64_tr_b16 a[194:195], v156 offset:28672
v_cvt_pk_bf16_f32 v122, v124, v125
v_mfma_f32_16x16x32_bf16 a[104:107], a[200:203], v[112:115], a[104:107]
v_exp_f32 v126, v126
v_mfma_f32_16x16x32_bf16 a[12:15], a[204:207], v[64:67], a[12:15]
ds_read_b64_tr_b16 a[196:197], v157 offset:24576
v_mfma_f32_16x16x32_bf16 a[44:47], a[204:207], v[80:83], a[44:47]
v_exp_f32 v127, v127
v_mfma_f32_16x16x32_bf16 a[228:231], a[240:243], v[80:83], a[228:231]
v_cvt_pk_bf16_f32 v123, v126, v127
v_mfma_f32_16x16x32_bf16 a[76:79], a[204:207], v[96:99], a[76:79]
ds_read_b64_tr_b16 a[198:199], v157 offset:28672
v_mfma_f32_16x16x32_bf16 a[108:111], a[204:207], v[112:115], a[108:111]
s_waitcnt lgkmcnt(8)
v_mfma_f32_16x16x32_bf16 a[16:19], a[208:211], v[64:67], a[16:19]
ds_read_b64_tr_b16 a[200:201], v158 offset:24576
v_mfma_f32_16x16x32_bf16 a[48:51], a[208:211], v[80:83], a[48:51]
v_mfma_f32_16x16x32_bf16 a[80:83], a[208:211], v[96:99], a[80:83]
ds_read_b64_tr_b16 a[202:203], v158 offset:28672
v_mfma_f32_16x16x32_bf16 a[112:115], a[208:211], v[112:115], a[112:115]
v_mfma_f32_16x16x32_bf16 a[20:23], a[212:215], v[64:67], a[20:23]
ds_read_b64_tr_b16 a[204:205], v159 offset:24576
v_mfma_f32_16x16x32_bf16 a[52:55], a[212:215], v[80:83], a[52:55]
v_mfma_f32_16x16x32_bf16 a[232:235], a[240:243], v[96:99], a[232:235]
v_mfma_f32_16x16x32_bf16 a[84:87], a[212:215], v[96:99], a[84:87]
ds_read_b64_tr_b16 a[206:207], v159 offset:28672
v_mfma_f32_16x16x32_bf16 a[116:119], a[212:215], v[112:115], a[116:119]
s_waitcnt lgkmcnt(8)
v_mfma_f32_16x16x32_bf16 a[24:27], a[216:219], v[64:67], a[24:27]
ds_read_b64_tr_b16 a[208:209], v160 offset:24576
v_mfma_f32_16x16x32_bf16 a[56:59], a[216:219], v[80:83], a[56:59]
v_mfma_f32_16x16x32_bf16 a[88:91], a[216:219], v[96:99], a[88:91]
ds_read_b64_tr_b16 a[210:211], v160 offset:28672
v_mfma_f32_16x16x32_bf16 a[120:123], a[216:219], v[112:115], a[120:123]
v_mfma_f32_16x16x32_bf16 a[28:31], a[220:223], v[64:67], a[28:31]
ds_read_b64_tr_b16 a[212:213], v161 offset:24576
v_mfma_f32_16x16x32_bf16 a[60:63], a[220:223], v[80:83], a[60:63]
v_mfma_f32_16x16x32_bf16 a[236:239], a[240:243], v[112:115], a[236:239]
v_mfma_f32_16x16x32_bf16 a[92:95], a[220:223], v[96:99], a[92:95]
ds_read_b64_tr_b16 a[214:215], v161 offset:28672
v_mfma_f32_16x16x32_bf16 a[124:127], a[220:223], v[112:115], a[124:127]
s_waitcnt lgkmcnt(8)
v_mfma_f32_16x16x32_bf16 a[0:3], a[192:195], v[72:75], a[0:3]
ds_read_b64_tr_b16 a[216:217], v162 offset:24576
v_mfma_f32_16x16x32_bf16 a[32:35], a[192:195], v[88:91], a[32:35]
v_mfma_f32_16x16x32_bf16 a[64:67], a[192:195], v[104:107], a[64:67]
ds_read_b64_tr_b16 a[218:219], v162 offset:28672
v_mfma_f32_16x16x32_bf16 a[96:99], a[192:195], v[120:123], a[96:99]
s_waitcnt vmcnt(11)
v_mfma_f32_16x16x32_bf16 a[4:7], a[196:199], v[72:75], a[4:7]
ds_read_b64_tr_b16 a[220:221], v163 offset:24576
v_mfma_f32_16x16x32_bf16 a[36:39], a[196:199], v[88:91], a[36:39]
s_barrier
v_exp_f32 v0, v0
v_mfma_f32_16x16x32_bf16 a[224:227], a[240:243], v[72:75], a[224:227]
v_exp_f32 v1, v1
v_mfma_f32_16x16x32_bf16 a[68:71], a[196:199], v[104:107], a[68:71]
ds_read_b64_tr_b16 a[222:223], v163 offset:28672
v_cvt_pk_bf16_f32 v0, v0, v1
v_mfma_f32_16x16x32_bf16 a[100:103], a[196:199], v[120:123], a[100:103]
s_waitcnt lgkmcnt(8)
v_exp_f32 v2, v2
v_mfma_f32_16x16x32_bf16 a[8:11], a[200:203], v[72:75], a[8:11]
ds_read_b128 a[192:195], v152 offset:16384
v_xor_b32 v156, 0x8000, v156
v_mfma_f32_16x16x32_bf16 a[40:43], a[200:203], v[88:91], a[40:43]
s_add_u32 m0, s39, 0
v_exp_f32 v3, v3
v_mfma_f32_16x16x32_bf16 a[72:75], a[200:203], v[104:107], a[72:75]
v_exp_f32 v4, v4
v_mfma_f32_16x16x32_bf16 a[104:107], a[200:203], v[120:123], a[104:107]
buffer_load_dwordx4 v164, s[12:15], s44 offen offset:0 nt lds
v_mfma_f32_16x16x32_bf16 a[12:15], a[204:207], v[72:75], a[12:15]
ds_read_b128 a[196:199], v153 offset:16384
v_xor_b32 v157, 0x8000, v157
v_mfma_f32_16x16x32_bf16 a[44:47], a[204:207], v[88:91], a[44:47]
v_exp_f32 v5, v5
v_mfma_f32_16x16x32_bf16 a[228:231], a[240:243], v[88:91], a[228:231]
v_exp_f32 v6, v6
v_mfma_f32_16x16x32_bf16 a[76:79], a[204:207], v[104:107], a[76:79]
v_exp_f32 v7, v7
v_mfma_f32_16x16x32_bf16 a[108:111], a[204:207], v[120:123], a[108:111]
s_waitcnt lgkmcnt(6)
v_exp_f32 v16, v16
v_mfma_f32_16x16x32_bf16 a[16:19], a[208:211], v[72:75], a[16:19]
ds_read_b128 a[200:203], v154 offset:16384
v_xor_b32 v158, 0x8000, v158
v_mfma_f32_16x16x32_bf16 a[48:51], a[208:211], v[88:91], a[48:51]
v_exp_f32 v17, v17
v_mfma_f32_16x16x32_bf16 a[80:83], a[208:211], v[104:107], a[80:83]
v_exp_f32 v18, v18
v_mfma_f32_16x16x32_bf16 a[112:115], a[208:211], v[120:123], a[112:115]
buffer_load_dwordx4 v165, s[12:15], s44 offen offset:1024 nt lds
v_mfma_f32_16x16x32_bf16 a[20:23], a[212:215], v[72:75], a[20:23]
ds_read_b128 a[204:207], v155 offset:16384
v_xor_b32 v159, 0x8000, v159
v_mfma_f32_16x16x32_bf16 a[52:55], a[212:215], v[88:91], a[52:55]
v_exp_f32 v19, v19
v_mfma_f32_16x16x32_bf16 a[232:235], a[240:243], v[104:107], a[232:235]
v_exp_f32 v20, v20
v_mfma_f32_16x16x32_bf16 a[84:87], a[212:215], v[104:107], a[84:87]
v_exp_f32 v21, v21
v_mfma_f32_16x16x32_bf16 a[116:119], a[212:215], v[120:123], a[116:119]
s_waitcnt lgkmcnt(4)
v_exp_f32 v22, v22
v_mfma_f32_16x16x32_bf16 a[24:27], a[216:219], v[72:75], a[24:27]
ds_read_b128 a[208:211], v152 offset:20480
v_xor_b32 v160, 0x8000, v160
v_mfma_f32_16x16x32_bf16 a[56:59], a[216:219], v[88:91], a[56:59]
v_exp_f32 v23, v23
v_mfma_f32_16x16x32_bf16 a[88:91], a[216:219], v[104:107], a[88:91]
v_exp_f32 v32, v32
v_mfma_f32_16x16x32_bf16 a[120:123], a[216:219], v[120:123], a[120:123]
buffer_load_dwordx4 v166, s[12:15], s44 offen offset:2048 nt lds
v_mfma_f32_16x16x32_bf16 a[28:31], a[220:223], v[72:75], a[28:31]
ds_read_b128 a[212:215], v153 offset:20480
v_xor_b32 v161, 0x8000, v161
v_mfma_f32_16x16x32_bf16 a[60:63], a[220:223], v[88:91], a[60:63]
v_exp_f32 v33, v33
v_mfma_f32_16x16x32_bf16 a[236:239], a[240:243], v[120:123], a[236:239]
v_exp_f32 v34, v34
v_mfma_f32_16x16x32_bf16 a[92:95], a[220:223], v[104:107], a[92:95]
v_cvt_pk_bf16_f32 v1, v2, v3
v_cvt_pk_bf16_f32 v2, v4, v5
v_mfma_f32_16x16x32_bf16 a[124:127], a[220:223], v[120:123], a[124:127]
s_waitcnt lgkmcnt(4)
v_cvt_pk_bf16_f32 v3, v6, v7
v_cvt_pk_bf16_f32 v16, v16, v17
s_sub_u32 s46, s46, 1
s_cmp_lg_u32 s46, 0
s_cbranch_scc1 L_attn_loop
v_mfma_f32_16x16x32_bf16 v[64:67], a[192:195], a[128:131], v[128:131]
ds_read_b128 a[216:219], v154 offset:20480
v_xor_b32 v162, 0x8000, v162
v_mfma_f32_16x16x32_bf16 v[80:83], a[192:195], a[144:147], v[132:135]
v_exp_f32 v35, v35
v_mfma_f32_16x16x32_bf16 v[96:99], a[192:195], a[160:163], v[136:139]
v_exp_f32 v36, v36
v_mfma_f32_16x16x32_bf16 v[112:115], a[192:195], a[176:179], v[140:143]
buffer_load_dwordx4 v167, s[12:15], s44 offen offset:3072 nt lds
v_mfma_f32_16x16x32_bf16 v[64:67], a[196:199], a[132:135], v[64:67]
ds_read_b128 a[220:223], v155 offset:20480
v_xor_b32 v163, 0x8000, v163
v_mfma_f32_16x16x32_bf16 v[80:83], a[196:199], a[148:151], v[80:83]
s_add_u32 s44, s44, 16384
v_exp_f32 v37, v37
v_mfma_f32_16x16x32_bf16 v[96:99], a[196:199], a[164:167], v[96:99]
v_exp_f32 v38, v38
v_mfma_f32_16x16x32_bf16 v[112:115], a[196:199], a[180:183], v[112:115]
s_waitcnt lgkmcnt(4)
v_exp_f32 v39, v39
v_mfma_f32_16x16x32_bf16 v[64:67], a[200:203], a[136:139], v[64:67]
ds_read_b128 a[192:195], v152 offset:24576
v_cvt_pk_bf16_f32 v17, v18, v19
v_mfma_f32_16x16x32_bf16 v[80:83], a[200:203], a[152:155], v[80:83]
s_add_u32 m0, s65, 65536
v_exp_f32 v48, v48
v_mfma_f32_16x16x32_bf16 v[96:99], a[200:203], a[168:171], v[96:99]
v_exp_f32 v49, v49
v_mfma_f32_16x16x32_bf16 v[112:115], a[200:203], a[184:187], v[112:115]
buffer_load_dwordx4 v168, s[16:19], s45 offen offset:0 nt lds
v_mfma_f32_16x16x32_bf16 v[64:67], a[204:207], a[140:143], v[64:67]
ds_read_b128 a[196:199], v153 offset:24576
v_cvt_pk_bf16_f32 v18, v20, v21
v_mfma_f32_16x16x32_bf16 v[80:83], a[204:207], a[156:159], v[80:83]
v_exp_f32 v50, v50
v_mfma_f32_16x16x32_bf16 v[96:99], a[204:207], a[172:175], v[96:99]
v_cvt_pk_bf16_f32 v19, v22, v23
v_cvt_pk_bf16_f32 v32, v32, v33
v_mfma_f32_16x16x32_bf16 v[112:115], a[204:207], a[188:191], v[112:115]
s_waitcnt lgkmcnt(4)
v_exp_f32 v51, v51
v_mfma_f32_16x16x32_bf16 v[68:71], a[208:211], a[128:131], v[128:131]
ds_read_b128 a[200:203], v154 offset:24576
v_cvt_pk_bf16_f32 v33, v34, v35
v_mfma_f32_16x16x32_bf16 v[84:87], a[208:211], a[144:147], v[132:135]
v_exp_f32 v52, v52
v_mfma_f32_16x16x32_bf16 v[100:103], a[208:211], a[160:163], v[136:139]
v_exp_f32 v53, v53
v_mfma_f32_16x16x32_bf16 v[116:119], a[208:211], a[176:179], v[140:143]
buffer_load_dwordx4 v169, s[16:19], s45 offen offset:1024 nt lds
v_mfma_f32_16x16x32_bf16 v[68:71], a[212:215], a[132:135], v[68:71]
ds_read_b128 a[204:207], v155 offset:24576
v_cvt_pk_bf16_f32 v34, v36, v37
v_mfma_f32_16x16x32_bf16 v[84:87], a[212:215], a[148:151], v[84:87]
v_exp_f32 v54, v54
v_mfma_f32_16x16x32_bf16 v[100:103], a[212:215], a[164:167], v[100:103]
v_exp_f32 v55, v55
v_mfma_f32_16x16x32_bf16 v[116:119], a[212:215], a[180:183], v[116:119]
s_waitcnt lgkmcnt(4)
v_exp_f32 v8, v8
v_mfma_f32_16x16x32_bf16 v[68:71], a[216:219], a[136:139], v[68:71]
ds_read_b128 a[208:211], v152 offset:28672
v_cvt_pk_bf16_f32 v35, v38, v39
v_mfma_f32_16x16x32_bf16 v[84:87], a[216:219], a[152:155], v[84:87]
v_exp_f32 v9, v9
v_mfma_f32_16x16x32_bf16 v[100:103], a[216:219], a[168:171], v[100:103]
v_exp_f32 v10, v10
v_mfma_f32_16x16x32_bf16 v[116:119], a[216:219], a[184:187], v[116:119]
buffer_load_dwordx4 v168, s[16:19], s45 offen offset:2048 nt lds
v_mfma_f32_16x16x32_bf16 v[68:71], a[220:223], a[140:143], v[68:71]
ds_read_b128 a[212:215], v153 offset:28672
v_cvt_pk_bf16_f32 v48, v48, v49
v_mfma_f32_16x16x32_bf16 v[84:87], a[220:223], a[156:159], v[84:87]
v_exp_f32 v11, v11
v_mfma_f32_16x16x32_bf16 v[100:103], a[220:223], a[172:175], v[100:103]
v_exp_f32 v12, v12
v_mfma_f32_16x16x32_bf16 v[116:119], a[220:223], a[188:191], v[116:119]
s_waitcnt lgkmcnt(4)
v_exp_f32 v13, v13
v_mfma_f32_16x16x32_bf16 v[72:75], a[192:195], a[128:131], v[128:131]
ds_read_b128 a[216:219], v154 offset:28672
v_cvt_pk_bf16_f32 v49, v50, v51
v_mfma_f32_16x16x32_bf16 v[88:91], a[192:195], a[144:147], v[132:135]
v_exp_f32 v14, v14
v_mfma_f32_16x16x32_bf16 v[104:107], a[192:195], a[160:163], v[136:139]
v_exp_f32 v15, v15
v_mfma_f32_16x16x32_bf16 v[120:123], a[192:195], a[176:179], v[140:143]
buffer_load_dwordx4 v169, s[16:19], s45 offen offset:3072 nt lds
v_mfma_f32_16x16x32_bf16 v[72:75], a[196:199], a[132:135], v[72:75]
ds_read_b128 a[220:223], v155 offset:28672
v_cvt_pk_bf16_f32 v50, v52, v53
v_mfma_f32_16x16x32_bf16 v[88:91], a[196:199], a[148:151], v[88:91]
s_add_u32 s45, s45, 16384
v_exp_f32 v24, v24
v_mfma_f32_16x16x32_bf16 v[104:107], a[196:199], a[164:167], v[104:107]
v_exp_f32 v25, v25
v_mfma_f32_16x16x32_bf16 v[120:123], a[196:199], a[180:183], v[120:123]
s_waitcnt lgkmcnt(4)
v_exp_f32 v26, v26
v_mfma_f32_16x16x32_bf16 v[72:75], a[200:203], a[136:139], v[72:75]
ds_read_b64_tr_b16 a[192:193], v156 offset:0
v_xor_b32 v152, 0x8000, v152
v_mfma_f32_16x16x32_bf16 v[88:91], a[200:203], a[152:155], v[88:91]
s_mov_b32 m0, s68
v_cvt_pk_bf16_f32 v51, v54, v55
v_cvt_pk_bf16_f32 v8, v8, v9
v_mfma_f32_16x16x32_bf16 v[104:107], a[200:203], a[168:171], v[104:107]
ds_read_b64_tr_b16 a[194:195], v156 offset:4096
v_xor_b32 v153, 0x8000, v153
v_mfma_f32_16x16x32_bf16 v[120:123], a[200:203], a[184:187], v[120:123]
buffer_load_dwordx4 v170, s[60:63], s67 offen nt lds
v_mfma_f32_16x16x32_bf16 v[72:75], a[204:207], a[140:143], v[72:75]
ds_read_b64_tr_b16 a[196:197], v157 offset:0
v_xor_b32 v154, 0x8000, v154
v_mfma_f32_16x16x32_bf16 v[88:91], a[204:207], a[156:159], v[88:91]
s_add_u32 s68, s68, 4096
v_exp_f32 v27, v27
v_mfma_f32_16x16x32_bf16 v[104:107], a[204:207], a[172:175], v[104:107]
ds_read_b64_tr_b16 a[198:199], v157 offset:4096
v_xor_b32 v155, 0x8000, v155
v_mfma_f32_16x16x32_bf16 v[120:123], a[204:207], a[188:191], v[120:123]
s_waitcnt lgkmcnt(6)
v_exp_f32 v28, v28
v_mfma_f32_16x16x32_bf16 v[76:79], a[208:211], a[128:131], v[128:131]
ds_read_b64_tr_b16 a[200:201], v158 offset:0
v_cvt_pk_bf16_f32 v9, v10, v11
v_mfma_f32_16x16x32_bf16 v[92:95], a[208:211], a[144:147], v[132:135]
s_cmp_lt_u32 s68, 163840
v_exp_f32 v29, v29
v_mfma_f32_16x16x32_bf16 v[108:111], a[208:211], a[160:163], v[136:139]
ds_read_b64_tr_b16 a[202:203], v158 offset:4096
v_cvt_pk_bf16_f32 v10, v12, v13
v_mfma_f32_16x16x32_bf16 v[124:127], a[208:211], a[176:179], v[140:143]
s_cselect_b32 s66, s28, 0x1000000
v_exp_f32 v30, v30
v_mfma_f32_16x16x32_bf16 v[76:79], a[212:215], a[132:135], v[76:79]
ds_read_b64_tr_b16 a[204:205], v159 offset:0
v_cvt_pk_bf16_f32 v11, v14, v15
v_mfma_f32_16x16x32_bf16 v[92:95], a[212:215], a[148:151], v[92:95]
s_add_u32 s67, s67, s66
v_exp_f32 v31, v31
v_mfma_f32_16x16x32_bf16 v[108:111], a[212:215], a[164:167], v[108:111]
ds_read_b64_tr_b16 a[206:207], v159 offset:4096
v_cvt_pk_bf16_f32 v24, v24, v25
v_mfma_f32_16x16x32_bf16 v[124:127], a[212:215], a[180:183], v[124:127]
s_waitcnt lgkmcnt(8)
v_exp_f32 v40, v40
v_mfma_f32_16x16x32_bf16 v[76:79], a[216:219], a[136:139], v[76:79]
ds_read_b64_tr_b16 a[208:209], v160 offset:0
v_cvt_pk_bf16_f32 v25, v26, v27
v_mfma_f32_16x16x32_bf16 v[92:95], a[216:219], a[152:155], v[92:95]
v_exp_f32 v41, v41
v_mfma_f32_16x16x32_bf16 v[108:111], a[216:219], a[168:171], v[108:111]
ds_read_b64_tr_b16 a[210:211], v160 offset:4096
v_cvt_pk_bf16_f32 v26, v28, v29
v_mfma_f32_16x16x32_bf16 v[124:127], a[216:219], a[184:187], v[124:127]
buffer_load_dword v181, v182, s[84:87], s69 offen
v_mfma_f32_16x16x32_bf16 v[76:79], a[220:223], a[140:143], v[76:79]
ds_read_b64_tr_b16 a[212:213], v161 offset:0
v_cvt_pk_bf16_f32 v27, v30, v31
v_mfma_f32_16x16x32_bf16 v[92:95], a[220:223], a[156:159], v[92:95]
s_add_u32 s69, s69, 524288
v_exp_f32 v42, v42
v_mfma_f32_16x16x32_bf16 v[108:111], a[220:223], a[172:175], v[108:111]
ds_read_b64_tr_b16 a[214:215], v161 offset:4096
v_cvt_pk_bf16_f32 v40, v40, v41
v_mfma_f32_16x16x32_bf16 v[124:127], a[220:223], a[188:191], v[124:127]
s_waitcnt lgkmcnt(8)
v_exp_f32 v43, v43
v_mfma_f32_16x16x32_bf16 a[0:3], a[192:195], v[0:3], a[0:3]
ds_read_b64_tr_b16 a[216:217], v162 offset:0
v_cvt_pk_bf16_f32 v41, v42, v43
v_mfma_f32_16x16x32_bf16 a[32:35], a[192:195], v[16:19], a[32:35]
v_exp_f32 v44, v44
v_mfma_f32_16x16x32_bf16 a[64:67], a[192:195], v[32:35], a[64:67]
ds_read_b64_tr_b16 a[218:219], v162 offset:4096
v_mfma_f32_16x16x32_bf16 a[96:99], a[192:195], v[48:51], a[96:99]
v_exp_f32 v45, v45
v_mfma_f32_16x16x32_bf16 a[4:7], a[196:199], v[0:3], a[4:7]
ds_read_b64_tr_b16 a[220:221], v163 offset:0
v_cvt_pk_bf16_f32 v42, v44, v45
v_mfma_f32_16x16x32_bf16 a[36:39], a[196:199], v[16:19], a[36:39]
v_exp_f32 v46, v46
v_mfma_f32_16x16x32_bf16 a[224:227], a[240:243], v[0:3], a[224:227]
v_exp_f32 v47, v47
v_mfma_f32_16x16x32_bf16 a[68:71], a[196:199], v[32:35], a[68:71]
ds_read_b64_tr_b16 a[222:223], v163 offset:4096
v_cvt_pk_bf16_f32 v43, v46, v47
v_mfma_f32_16x16x32_bf16 a[100:103], a[196:199], v[48:51], a[100:103]
s_waitcnt lgkmcnt(8)
v_exp_f32 v56, v56
v_mfma_f32_16x16x32_bf16 a[8:11], a[200:203], v[0:3], a[8:11]
ds_read_b64_tr_b16 a[192:193], v156 offset:8192
v_mfma_f32_16x16x32_bf16 a[40:43], a[200:203], v[16:19], a[40:43]
v_exp_f32 v57, v57
v_mfma_f32_16x16x32_bf16 a[72:75], a[200:203], v[32:35], a[72:75]
ds_read_b64_tr_b16 a[194:195], v156 offset:12288
v_cvt_pk_bf16_f32 v56, v56, v57
v_mfma_f32_16x16x32_bf16 a[104:107], a[200:203], v[48:51], a[104:107]
v_exp_f32 v58, v58
v_mfma_f32_16x16x32_bf16 a[12:15], a[204:207], v[0:3], a[12:15]
ds_read_b64_tr_b16 a[196:197], v157 offset:8192
v_mfma_f32_16x16x32_bf16 a[44:47], a[204:207], v[16:19], a[44:47]
v_exp_f32 v59, v59
v_mfma_f32_16x16x32_bf16 a[228:231], a[240:243], v[16:19], a[228:231]
v_exp_f32 v60, v60
v_mfma_f32_16x16x32_bf16 a[76:79], a[204:207], v[32:35], a[76:79]
ds_read_b64_tr_b16 a[198:199], v157 offset:12288
v_cvt_pk_bf16_f32 v57, v58, v59
v_mfma_f32_16x16x32_bf16 a[108:111], a[204:207], v[48:51], a[108:111]
s_waitcnt lgkmcnt(8)
v_exp_f32 v61, v61
v_mfma_f32_16x16x32_bf16 a[16:19], a[208:211], v[0:3], a[16:19]
ds_read_b64_tr_b16 a[200:201], v158 offset:8192
v_cvt_pk_bf16_f32 v58, v60, v61
v_mfma_f32_16x16x32_bf16 a[48:51], a[208:211], v[16:19], a[48:51]
v_exp_f32 v62, v62
v_mfma_f32_16x16x32_bf16 a[80:83], a[208:211], v[32:35], a[80:83]
ds_read_b64_tr_b16 a[202:203], v158 offset:12288
v_mfma_f32_16x16x32_bf16 a[112:115], a[208:211], v[48:51], a[112:115]
v_exp_f32 v63, v63
v_mfma_f32_16x16x32_bf16 a[20:23], a[212:215], v[0:3], a[20:23]
ds_read_b64_tr_b16 a[204:205], v159 offset:8192
v_cvt_pk_bf16_f32 v59, v62, v63
v_mfma_f32_16x16x32_bf16 a[52:55], a[212:215], v[16:19], a[52:55]
v_mfma_f32_16x16x32_bf16 a[232:235], a[240:243], v[32:35], a[232:235]
v_mfma_f32_16x16x32_bf16 a[84:87], a[212:215], v[32:35], a[84:87]
ds_read_b64_tr_b16 a[206:207], v159 offset:12288
v_mfma_f32_16x16x32_bf16 a[116:119], a[212:215], v[48:51], a[116:119]
s_waitcnt lgkmcnt(8)
v_mfma_f32_16x16x32_bf16 a[24:27], a[216:219], v[0:3], a[24:27]
ds_read_b64_tr_b16 a[208:209], v160 offset:8192
v_mfma_f32_16x16x32_bf16 a[56:59], a[216:219], v[16:19], a[56:59]
v_mfma_f32_16x16x32_bf16 a[88:91], a[216:219], v[32:35], a[88:91]
ds_read_b64_tr_b16 a[210:211], v160 offset:12288
v_mfma_f32_16x16x32_bf16 a[120:123], a[216:219], v[48:51], a[120:123]
v_mfma_f32_16x16x32_bf16 a[28:31], a[220:223], v[0:3], a[28:31]
ds_read_b64_tr_b16 a[212:213], v161 offset:8192
v_mfma_f32_16x16x32_bf16 a[60:63], a[220:223], v[16:19], a[60:63]
v_mfma_f32_16x16x32_bf16 a[236:239], a[240:243], v[48:51], a[236:239]
v_mfma_f32_16x16x32_bf16 a[92:95], a[220:223], v[32:35], a[92:95]
ds_read_b64_tr_b16 a[214:215], v161 offset:12288
v_mfma_f32_16x16x32_bf16 a[124:127], a[220:223], v[48:51], a[124:127]
s_waitcnt lgkmcnt(8)
v_mfma_f32_16x16x32_bf16 a[0:3], a[192:195], v[8:11], a[0:3]
ds_read_b64_tr_b16 a[216:217], v162 offset:8192
v_mfma_f32_16x16x32_bf16 a[32:35], a[192:195], v[24:27], a[32:35]
v_mfma_f32_16x16x32_bf16 a[64:67], a[192:195], v[40:43], a[64:67]
ds_read_b64_tr_b16 a[218:219], v162 offset:12288
v_mfma_f32_16x16x32_bf16 a[96:99], a[192:195], v[56:59], a[96:99]
s_waitcnt vmcnt(11)
v_mfma_f32_16x16x32_bf16 a[4:7], a[196:199], v[8:11], a[4:7]
ds_read_b64_tr_b16 a[220:221], v163 offset:8192
v_mfma_f32_16x16x32_bf16 a[36:39], a[196:199], v[24:27], a[36:39]
s_barrier
v_exp_f32 v64, v64
v_mfma_f32_16x16x32_bf16 a[224:227], a[240:243], v[8:11], a[224:227]
v_exp_f32 v65, v65
v_mfma_f32_16x16x32_bf16 a[68:71], a[196:199], v[40:43], a[68:71]
ds_read_b64_tr_b16 a[222:223], v163 offset:12288
v_cvt_pk_bf16_f32 v64, v64, v65
v_mfma_f32_16x16x32_bf16 a[100:103], a[196:199], v[56:59], a[100:103]
s_waitcnt lgkmcnt(8)
v_exp_f32 v66, v66
v_mfma_f32_16x16x32_bf16 a[8:11], a[200:203], v[8:11], a[8:11]
ds_read_b64_tr_b16 a[192:193], v156 offset:16384
v_mfma_f32_16x16x32_bf16 a[40:43], a[200:203], v[24:27], a[40:43]
v_exp_f32 v67, v67
v_mfma_f32_16x16x32_bf16 a[72:75], a[200:203], v[40:43], a[72:75]
ds_read_b64_tr_b16 a[194:195], v156 offset:20480
v_cvt_pk_bf16_f32 v65, v66, v67
v_mfma_f32_16x16x32_bf16 a[104:107], a[200:203], v[56:59], a[104:107]
v_exp_f32 v68, v68
v_mfma_f32_16x16x32_bf16 a[12:15], a[204:207], v[8:11], a[12:15]
ds_read_b64_tr_b16 a[196:197], v157 offset:16384
v_mfma_f32_16x16x32_bf16 a[44:47], a[204:207], v[24:27], a[44:47]
v_exp_f32 v69, v69
v_mfma_f32_16x16x32_bf16 a[228:231], a[240:243], v[24:27], a[228:231]
v_exp_f32 v70, v70
v_mfma_f32_16x16x32_bf16 a[76:79], a[204:207], v[40:43], a[76:79]
ds_read_b64_tr_b16 a[198:199], v157 offset:20480
v_cvt_pk_bf16_f32 v66, v68, v69
v_mfma_f32_16x16x32_bf16 a[108:111], a[204:207], v[56:59], a[108:111]
s_waitcnt lgkmcnt(8)
v_exp_f32 v71, v71
v_mfma_f32_16x16x32_bf16 a[16:19], a[208:211], v[8:11], a[16:19]
ds_read_b64_tr_b16 a[200:201], v158 offset:16384
v_cvt_pk_bf16_f32 v67, v70, v71
v_mfma_f32_16x16x32_bf16 a[48:51], a[208:211], v[24:27], a[48:51]
v_exp_f32 v80, v80
v_mfma_f32_16x16x32_bf16 a[80:83], a[208:211], v[40:43], a[80:83]
ds_read_b64_tr_b16 a[202:203], v158 offset:20480
v_mfma_f32_16x16x32_bf16 a[112:115], a[208:211], v[56:59], a[112:115]
v_exp_f32 v81, v81
v_mfma_f32_16x16x32_bf16 a[20:23], a[212:215], v[8:11], a[20:23]
ds_read_b64_tr_b16 a[204:205], v159 offset:16384
v_cvt_pk_bf16_f32 v80, v80, v81
v_mfma_f32_16x16x32_bf16 a[52:55], a[212:215], v[24:27], a[52:55]
v_exp_f32 v82, v82
v_mfma_f32_16x16x32_bf16 a[232:235], a[240:243], v[40:43], a[232:235]
v_exp_f32 v83, v83
v_mfma_f32_16x16x32_bf16 a[84:87], a[212:215], v[40:43], a[84:87]
ds_read_b64_tr_b16 a[206:207], v159 offset:20480
v_cvt_pk_bf16_f32 v81, v82, v83
v_mfma_f32_16x16x32_bf16 a[116:119], a[212:215], v[56:59], a[116:119]
s_waitcnt lgkmcnt(8)
v_exp_f32 v84, v84
v_mfma_f32_16x16x32_bf16 a[24:27], a[216:219], v[8:11], a[24:27]
ds_read_b64_tr_b16 a[208:209], v160 offset:16384
v_mfma_f32_16x16x32_bf16 a[56:59], a[216:219], v[24:27], a[56:59]
v_exp_f32 v85, v85
v_mfma_f32_16x16x32_bf16 a[88:91], a[216:219], v[40:43], a[88:91]
ds_read_b64_tr_b16 a[210:211], v160 offset:20480
v_cvt_pk_bf16_f32 v82, v84, v85
v_mfma_f32_16x16x32_bf16 a[120:123], a[216:219], v[56:59], a[120:123]
v_exp_f32 v86, v86
v_mfma_f32_16x16x32_bf16 a[28:31], a[220:223], v[8:11], a[28:31]
ds_read_b64_tr_b16 a[212:213], v161 offset:16384
v_mfma_f32_16x16x32_bf16 a[60:63], a[220:223], v[24:27], a[60:63]
v_exp_f32 v87, v87
v_mfma_f32_16x16x32_bf16 a[236:239], a[240:243], v[56:59], a[236:239]
v_exp_f32 v96, v96
v_mfma_f32_16x16x32_bf16 a[92:95], a[220:223], v[40:43], a[92:95]
ds_read_b64_tr_b16 a[214:215], v161 offset:20480
v_cvt_pk_bf16_f32 v83, v86, v87
v_exp_f32 v97, v97
v_exp_f32 v98, v98
v_cvt_pk_bf16_f32 v96, v96, v97
v_exp_f32 v99, v99
v_exp_f32 v100, v100
v_cvt_pk_bf16_f32 v97, v98, v99
v_exp_f32 v101, v101
v_exp_f32 v102, v102
v_cvt_pk_bf16_f32 v98, v100, v101
v_exp_f32 v103, v103
s_nop 0
v_cvt_pk_bf16_f32 v99, v102, v103
v_exp_f32 v112, v112
v_exp_f32 v113, v113
v_exp_f32 v114, v114
v_cvt_pk_bf16_f32 v112, v112, v113
v_exp_f32 v115, v115
v_exp_f32 v116, v116
v_cvt_pk_bf16_f32 v113, v114, v115
v_exp_f32 v117, v117
v_exp_f32 v118, v118
v_cvt_pk_bf16_f32 v114, v116, v117
v_exp_f32 v119, v119
s_nop 0
v_cvt_pk_bf16_f32 v115, v118, v119
v_mfma_f32_16x16x32_bf16 a[124:127], a[220:223], v[56:59], a[124:127]
s_waitcnt lgkmcnt(8)
v_exp_f32 v72, v72
v_mfma_f32_16x16x32_bf16 a[0:3], a[192:195], v[64:67], a[0:3]
ds_read_b64_tr_b16 a[216:217], v162 offset:16384
v_mfma_f32_16x16x32_bf16 a[32:35], a[192:195], v[80:83], a[32:35]
v_exp_f32 v73, v73
v_mfma_f32_16x16x32_bf16 a[64:67], a[192:195], v[96:99], a[64:67]
ds_read_b64_tr_b16 a[218:219], v162 offset:20480
v_cvt_pk_bf16_f32 v72, v72, v73
v_mfma_f32_16x16x32_bf16 a[96:99], a[192:195], v[112:115], a[96:99]
v_exp_f32 v74, v74
v_mfma_f32_16x16x32_bf16 a[4:7], a[196:199], v[64:67], a[4:7]
ds_read_b64_tr_b16 a[220:221], v163 offset:16384
v_mfma_f32_16x16x32_bf16 a[36:39], a[196:199], v[80:83], a[36:39]
v_exp_f32 v75, v75
v_mfma_f32_16x16x32_bf16 a[224:227], a[240:243], v[64:67], a[224:227]
v_exp_f32 v76, v76
v_mfma_f32_16x16x32_bf16 a[68:71], a[196:199], v[96:99], a[68:71]
ds_read_b64_tr_b16 a[222:223], v163 offset:20480
v_cvt_pk_bf16_f32 v73, v74, v75
v_mfma_f32_16x16x32_bf16 a[100:103], a[196:199], v[112:115], a[100:103]
s_waitcnt lgkmcnt(8)
v_exp_f32 v77, v77
v_mfma_f32_16x16x32_bf16 a[8:11], a[200:203], v[64:67], a[8:11]
ds_read_b64_tr_b16 a[192:193], v156 offset:24576
v_cvt_pk_bf16_f32 v74, v76, v77
v_mfma_f32_16x16x32_bf16 a[40:43], a[200:203], v[80:83], a[40:43]
v_exp_f32 v78, v78
v_mfma_f32_16x16x32_bf16 a[72:75], a[200:203], v[96:99], a[72:75]
ds_read_b64_tr_b16 a[194:195], v156 offset:28672
v_mfma_f32_16x16x32_bf16 a[104:107], a[200:203], v[112:115], a[104:107]
v_exp_f32 v79, v79
v_mfma_f32_16x16x32_bf16 a[12:15], a[204:207], v[64:67], a[12:15]
ds_read_b64_tr_b16 a[196:197], v157 offset:24576
v_cvt_pk_bf16_f32 v75, v78, v79
v_mfma_f32_16x16x32_bf16 a[44:47], a[204:207], v[80:83], a[44:47]
v_exp_f32 v88, v88
v_mfma_f32_16x16x32_bf16 a[228:231], a[240:243], v[80:83], a[228:231]
v_exp_f32 v89, v89
v_mfma_f32_16x16x32_bf16 a[76:79], a[204:207], v[96:99], a[76:79]
ds_read_b64_tr_b16 a[198:199], v157 offset:28672
v_cvt_pk_bf16_f32 v88, v88, v89
v_mfma_f32_16x16x32_bf16 a[108:111], a[204:207], v[112:115], a[108:111]
s_waitcnt lgkmcnt(8)
v_exp_f32 v90, v90
v_mfma_f32_16x16x32_bf16 a[16:19], a[208:211], v[64:67], a[16:19]
ds_read_b64_tr_b16 a[200:201], v158 offset:24576
v_mfma_f32_16x16x32_bf16 a[48:51], a[208:211], v[80:83], a[48:51]
v_exp_f32 v91, v91
v_mfma_f32_16x16x32_bf16 a[80:83], a[208:211], v[96:99], a[80:83]
ds_read_b64_tr_b16 a[202:203], v158 offset:28672
v_cvt_pk_bf16_f32 v89, v90, v91
v_mfma_f32_16x16x32_bf16 a[112:115], a[208:211], v[112:115], a[112:115]
v_exp_f32 v92, v92
v_mfma_f32_16x16x32_bf16 a[20:23], a[212:215], v[64:67], a[20:23]
ds_read_b64_tr_b16 a[204:205], v159 offset:24576
v_mfma_f32_16x16x32_bf16 a[52:55], a[212:215], v[80:83], a[52:55]
v_exp_f32 v93, v93
v_mfma_f32_16x16x32_bf16 a[232:235], a[240:243], v[96:99], a[232:235]
v_exp_f32 v94, v94
v_mfma_f32_16x16x32_bf16 a[84:87], a[212:215], v[96:99], a[84:87]
ds_read_b64_tr_b16 a[206:207], v159 offset:28672
v_cvt_pk_bf16_f32 v90, v92, v93
v_mfma_f32_16x16x32_bf16 a[116:119], a[212:215], v[112:115], a[116:119]
s_waitcnt lgkmcnt(8)
v_exp_f32 v95, v95
v_mfma_f32_16x16x32_bf16 a[24:27], a[216:219], v[64:67], a[24:27]
ds_read_b64_tr_b16 a[208:209], v160 offset:24576
v_cvt_pk_bf16_f32 v91, v94, v95
v_mfma_f32_16x16x32_bf16 a[56:59], a[216:219], v[80:83], a[56:59]
v_exp_f32 v104, v104
v_mfma_f32_16x16x32_bf16 a[88:91], a[216:219], v[96:99], a[88:91]
ds_read_b64_tr_b16 a[210:211], v160 offset:28672
v_mfma_f32_16x16x32_bf16 a[120:123], a[216:219], v[112:115], a[120:123]
v_exp_f32 v105, v105
v_mfma_f32_16x16x32_bf16 a[28:31], a[220:223], v[64:67], a[28:31]
ds_read_b64_tr_b16 a[212:213], v161 offset:24576
v_cvt_pk_bf16_f32 v104, v104, v105
v_mfma_f32_16x16x32_bf16 a[60:63], a[220:223], v[80:83], a[60:63]
v_exp_f32 v106, v106
v_mfma_f32_16x16x32_bf16 a[236:239], a[240:243], v[112:115], a[236:239]
v_exp_f32 v107, v107
v_mfma_f32_16x16x32_bf16 a[92:95], a[220:223], v[96:99], a[92:95]
ds_read_b64_tr_b16 a[214:215], v161 offset:28672
v_exp_f32 v108, v108
v_cvt_pk_bf16_f32 v105, v106, v107
v_exp_f32 v109, v109
v_exp_f32 v110, v110
v_cvt_pk_bf16_f32 v106, v108, v109
v_exp_f32 v111, v111
s_nop 0
v_cvt_pk_bf16_f32 v107, v110, v111
v_exp_f32 v120, v120
v_exp_f32 v121, v121
v_exp_f32 v122, v122
v_cvt_pk_bf16_f32 v120, v120, v121
v_exp_f32 v123, v123
v_exp_f32 v124, v124
v_cvt_pk_bf16_f32 v121, v122, v123
v_exp_f32 v125, v125
v_exp_f32 v126, v126
v_cvt_pk_bf16_f32 v122, v124, v125
v_exp_f32 v127, v127
s_nop 0
v_cvt_pk_bf16_f32 v123, v126, v127
v_mfma_f32_16x16x32_bf16 a[124:127], a[220:223], v[112:115], a[124:127]
s_waitcnt lgkmcnt(8)
v_mfma_f32_16x16x32_bf16 a[0:3], a[192:195], v[72:75], a[0:3]
ds_read_b64_tr_b16 a[216:217], v162 offset:24576
v_mfma_f32_16x16x32_bf16 a[32:35], a[192:195], v[88:91], a[32:35]
v_mfma_f32_16x16x32_bf16 a[64:67], a[192:195], v[104:107], a[64:67]
ds_read_b64_tr_b16 a[218:219], v162 offset:28672
v_mfma_f32_16x16x32_bf16 a[96:99], a[192:195], v[120:123], a[96:99]
v_mfma_f32_16x16x32_bf16 a[4:7], a[196:199], v[72:75], a[4:7]
ds_read_b64_tr_b16 a[220:221], v163 offset:24576
v_mfma_f32_16x16x32_bf16 a[36:39], a[196:199], v[88:91], a[36:39]
v_mfma_f32_16x16x32_bf16 a[224:227], a[240:243], v[72:75], a[224:227]
v_mfma_f32_16x16x32_bf16 a[68:71], a[196:199], v[104:107], a[68:71]
ds_read_b64_tr_b16 a[222:223], v163 offset:28672
v_mfma_f32_16x16x32_bf16 a[100:103], a[196:199], v[120:123], a[100:103]
s_waitcnt lgkmcnt(8)
v_mfma_f32_16x16x32_bf16 a[8:11], a[200:203], v[72:75], a[8:11]
v_mfma_f32_16x16x32_bf16 a[40:43], a[200:203], v[88:91], a[40:43]
v_mfma_f32_16x16x32_bf16 a[72:75], a[200:203], v[104:107], a[72:75]
v_mfma_f32_16x16x32_bf16 a[104:107], a[200:203], v[120:123], a[104:107]
v_mfma_f32_16x16x32_bf16 a[12:15], a[204:207], v[72:75], a[12:15]
v_mfma_f32_16x16x32_bf16 a[44:47], a[204:207], v[88:91], a[44:47]
v_mfma_f32_16x16x32_bf16 a[228:231], a[240:243], v[88:91], a[228:231]
v_mfma_f32_16x16x32_bf16 a[76:79], a[204:207], v[104:107], a[76:79]
v_mfma_f32_16x16x32_bf16 a[108:111], a[204:207], v[120:123], a[108:111]
s_waitcnt lgkmcnt(4)
v_mfma_f32_16x16x32_bf16 a[16:19], a[208:211], v[72:75], a[16:19]
v_mfma_f32_16x16x32_bf16 a[48:51], a[208:211], v[88:91], a[48:51]
v_mfma_f32_16x16x32_bf16 a[80:83], a[208:211], v[104:107], a[80:83]
v_mfma_f32_16x16x32_bf16 a[112:115], a[208:211], v[120:123], a[112:115]
v_mfma_f32_16x16x32_bf16 a[20:23], a[212:215], v[72:75], a[20:23]
v_mfma_f32_16x16x32_bf16 a[52:55], a[212:215], v[88:91], a[52:55]
v_mfma_f32_16x16x32_bf16 a[232:235], a[240:243], v[104:107], a[232:235]
v_mfma_f32_16x16x32_bf16 a[84:87], a[212:215], v[104:107], a[84:87]
v_mfma_f32_16x16x32_bf16 a[116:119], a[212:215], v[120:123], a[116:119]
s_waitcnt lgkmcnt(0)
v_mfma_f32_16x16x32_bf16 a[24:27], a[216:219], v[72:75], a[24:27]
v_mfma_f32_16x16x32_bf16 a[56:59], a[216:219], v[88:91], a[56:59]
v_mfma_f32_16x16x32_bf16 a[88:91], a[216:219], v[104:107], a[88:91]
v_mfma_f32_16x16x32_bf16 a[120:123], a[216:219], v[120:123], a[120:123]
v_mfma_f32_16x16x32_bf16 a[28:31], a[220:223], v[72:75], a[28:31]
v_mfma_f32_16x16x32_bf16 a[60:63], a[220:223], v[88:91], a[60:63]
v_mfma_f32_16x16x32_bf16 a[236:239], a[240:243], v[120:123], a[236:239]
v_mfma_f32_16x16x32_bf16 a[92:95], a[220:223], v[104:107], a[92:95]
v_mfma_f32_16x16x32_bf16 a[124:127], a[220:223], v[120:123], a[124:127]
s_nop 7
v_accvgpr_read_b32 v188, a224
v_accvgpr_read_b32 v189, a228
v_accvgpr_read_b32 v190, a232
v_accvgpr_read_b32 v191, a236
v_rcp_f32 v184, v188
v_rcp_f32 v185, v189
v_rcp_f32 v186, v190
v_rcp_f32 v187, v191
v_maximum3_f32 v192, v188, v189, v190
v_maximum3_f32 v192, v192, v191, v191
v_cmp_ngt_f32 vcc, 0x53800000, v192
s_cmp_lg_u64 vcc, 0
s_cselect_b32 s54, 1, 0
s_waitcnt vmcnt(1)
s_lshl_b32 s66, s33, 10
s_add_u32 s66, s66, 131072
v_add_u32 v170, s66, v178
ds_read_b128 v[200:203], v170 offset:0
ds_read_b128 v[204:207], v170 offset:4096
ds_read_b128 v[208:211], v170 offset:8192
ds_read_b128 v[212:215], v170 offset:12288
ds_read_b128 v[216:219], v170 offset:16384
ds_read_b128 v[220:223], v170 offset:20480
ds_read_b128 v[224:227], v170 offset:24576
ds_read_b128 v[228:231], v170 offset:28672
v_accvgpr_read_b32 v0, a0
v_accvgpr_read_b32 v1, a1
v_accvgpr_read_b32 v2, a2
v_accvgpr_read_b32 v3, a3
v_accvgpr_read_b32 v4, a32
v_accvgpr_read_b32 v5, a33
v_accvgpr_read_b32 v6, a34
v_accvgpr_read_b32 v7, a35
v_mul_f32 v0, v0, v184
v_mul_f32 v1, v1, v184
v_mul_f32 v2, v2, v184
v_mul_f32 v3, v3, v184
v_mul_f32 v4, v4, v185
v_mul_f32 v5, v5, v185
v_mul_f32 v6, v6, v185
v_mul_f32 v7, v7, v185
v_cvt_pk_bf16_f32 v0, v0, v1
v_cvt_pk_bf16_f32 v1, v2, v3
v_cvt_pk_bf16_f32 v2, v4, v5
v_cvt_pk_bf16_f32 v3, v6, v7
v_lshlrev_b32 v232, 16, v248
v_and_b32 v233, 0xffff0000, v248
v_lshlrev_b32 v234, 16, v249
v_and_b32 v235, 0xffff0000, v249
v_permlane16_swap_b32 v0, v2
v_permlane16_swap_b32 v1, v3
buffer_store_dwordx4 v[0:3], v178, s[48:51], s47 offen offset:0 sc1
v_lshlrev_b32 v236, 16, v250
v_and_b32 v237, 0xffff0000, v250
v_lshlrev_b32 v238, 16, v251
v_and_b32 v239, 0xffff0000, v251
v_mul_f32 v252, 0xbfb8aa3b, v232
v_mul_f32 v253, 0xbfb8aa3b, v233
v_mul_f32 v254, 0xbfb8aa3b, v234
v_mul_f32 v255, 0xbfb8aa3b, v235
v_exp_f32 v252, v252
v_exp_f32 v253, v253
v_exp_f32 v254, v254
v_exp_f32 v255, v255
v_accvgpr_read_b32 v8, a4
v_accvgpr_read_b32 v9, a5
v_accvgpr_read_b32 v10, a6
v_accvgpr_read_b32 v11, a7
v_accvgpr_read_b32 v12, a36
v_accvgpr_read_b32 v13, a37
v_accvgpr_read_b32 v14, a38
v_accvgpr_read_b32 v15, a39
v_mul_f32 v8, v8, v184
v_mul_f32 v9, v9, v184
v_mul_f32 v10, v10, v184
v_mul_f32 v11, v11, v184
v_mul_f32 v12, v12, v185
v_mul_f32 v13, v13, v185
v_mul_f32 v14, v14, v185
v_mul_f32 v15, v15, v185
v_cvt_pk_bf16_f32 v8, v8, v9
v_cvt_pk_bf16_f32 v9, v10, v11
v_cvt_pk_bf16_f32 v10, v12, v13
v_cvt_pk_bf16_f32 v11, v14, v15
v_add_f32 v252, 1.0, v252
v_add_f32 v253, 1.0, v253
v_add_f32 v254, 1.0, v254
v_add_f32 v255, 1.0, v255
v_permlane16_swap_b32 v8, v10
v_permlane16_swap_b32 v9, v11
buffer_store_dwordx4 v[8:11], v178, s[48:51], s47 offen offset:1024 sc1
v_rcp_f32 v252, v252
v_rcp_f32 v253, v253
v_rcp_f32 v254, v254
v_rcp_f32 v255, v255
v_mul_f32 v232, v232, v252
v_mul_f32 v233, v233, v253
v_mul_f32 v234, v234, v254
v_mul_f32 v235, v235, v255
v_cvt_pk_bf16_f32 v232, 0, v232
v_cvt_pk_bf16_f32 v233, 0, v233
v_cvt_pk_bf16_f32 v234, 0, v234
v_cvt_pk_bf16_f32 v235, 0, v235
v_accvgpr_read_b32 v16, a8
v_accvgpr_read_b32 v17, a9
v_accvgpr_read_b32 v18, a10
v_accvgpr_read_b32 v19, a11
v_accvgpr_read_b32 v20, a40
v_accvgpr_read_b32 v21, a41
v_accvgpr_read_b32 v22, a42
v_accvgpr_read_b32 v23, a43
v_mul_f32 v16, v16, v184
v_mul_f32 v17, v17, v184
v_mul_f32 v18, v18, v184
v_mul_f32 v19, v19, v184
v_mul_f32 v20, v20, v185
v_mul_f32 v21, v21, v185
v_mul_f32 v22, v22, v185
v_mul_f32 v23, v23, v185
v_cvt_pk_bf16_f32 v16, v16, v17
v_cvt_pk_bf16_f32 v17, v18, v19
v_cvt_pk_bf16_f32 v18, v20, v21
v_cvt_pk_bf16_f32 v19, v22, v23
v_mul_f32 v252, 0xbfb8aa3b, v236
v_mul_f32 v253, 0xbfb8aa3b, v237
v_mul_f32 v254, 0xbfb8aa3b, v238
v_mul_f32 v255, 0xbfb8aa3b, v239
v_permlane16_swap_b32 v16, v18
v_permlane16_swap_b32 v17, v19
buffer_store_dwordx4 v[16:19], v178, s[48:51], s47 offen offset:2048 sc1
v_exp_f32 v252, v252
v_exp_f32 v253, v253
v_exp_f32 v254, v254
v_exp_f32 v255, v255
v_add_f32 v252, 1.0, v252
v_add_f32 v253, 1.0, v253
v_add_f32 v254, 1.0, v254
v_add_f32 v255, 1.0, v255
v_rcp_f32 v252, v252
v_rcp_f32 v253, v253
v_rcp_f32 v254, v254
v_rcp_f32 v255, v255
v_accvgpr_read_b32 v24, a12
v_accvgpr_read_b32 v25, a13
v_accvgpr_read_b32 v26, a14
v_accvgpr_read_b32 v27, a15
v_accvgpr_read_b32 v28, a44
v_accvgpr_read_b32 v29, a45
v_accvgpr_read_b32 v30, a46
v_accvgpr_read_b32 v31, a47
v_mul_f32 v24, v24, v184
v_mul_f32 v25, v25, v184
v_mul_f32 v26, v26, v184
v_mul_f32 v27, v27, v184
v_mul_f32 v28, v28, v185
v_mul_f32 v29, v29, v185
v_mul_f32 v30, v30, v185
v_mul_f32 v31, v31, v185
v_cvt_pk_bf16_f32 v24, v24, v25
v_cvt_pk_bf16_f32 v25, v26, v27
v_cvt_pk_bf16_f32 v26, v28, v29
v_cvt_pk_bf16_f32 v27, v30, v31
v_mul_f32 v236, v236, v252
v_mul_f32 v237, v237, v253
v_mul_f32 v238, v238, v254
v_mul_f32 v239, v239, v255
v_permlane16_swap_b32 v24, v26
v_permlane16_swap_b32 v25, v27
buffer_store_dwordx4 v[24:27], v178, s[48:51], s47 offen offset:3072 sc1
s_add_u32 s47, s47, 4096
v_cvt_pk_bf16_f32 v236, 0, v236
v_cvt_pk_bf16_f32 v237, 0, v237
v_cvt_pk_bf16_f32 v238, 0, v238
v_cvt_pk_bf16_f32 v239, 0, v239
s_waitcnt lgkmcnt(0)
v_lshlrev_b32 v252, 16, v200
v_and_b32 v253, 0xffff0000, v200
v_mul_f32 v240, v232, v252
v_mul_f32 v241, v232, v253
v_lshlrev_b32 v254, 16, v201
v_and_b32 v255, 0xffff0000, v201
v_mul_f32 v242, v232, v254
v_accvgpr_read_b32 v32, a16
v_accvgpr_read_b32 v33, a17
v_accvgpr_read_b32 v34, a18
v_accvgpr_read_b32 v35, a19
v_accvgpr_read_b32 v36, a48
v_accvgpr_read_b32 v37, a49
v_accvgpr_read_b32 v38, a50
v_accvgpr_read_b32 v39, a51
v_mul_f32 v32, v32, v184
v_mul_f32 v33, v33, v184
v_mul_f32 v34, v34, v184
v_mul_f32 v35, v35, v184
v_mul_f32 v36, v36, v185
v_mul_f32 v37, v37, v185
v_mul_f32 v38, v38, v185
v_mul_f32 v39, v39, v185
v_cvt_pk_bf16_f32 v32, v32, v33
v_cvt_pk_bf16_f32 v33, v34, v35
v_cvt_pk_bf16_f32 v34, v36, v37
v_cvt_pk_bf16_f32 v35, v38, v39
v_mul_f32 v243, v232, v255
v_lshlrev_b32 v252, 16, v202
v_and_b32 v253, 0xffff0000, v202
v_mul_f32 v244, v232, v252
v_permlane16_swap_b32 v32, v34
v_permlane16_swap_b32 v33, v35
buffer_store_dwordx4 v[32:35], v178, s[48:51], s47 offen offset:0 sc1
v_mul_f32 v245, v232, v253
v_lshlrev_b32 v254, 16, v203
v_and_b32 v255, 0xffff0000, v203
v_mul_f32 v246, v232, v254
v_mul_f32 v247, v232, v255
v_lshlrev_b32 v252, 16, v204
v_and_b32 v253, 0xffff0000, v204
v_fmac_f32 v240, v233, v252
v_fmac_f32 v241, v233, v253
v_lshlrev_b32 v254, 16, v205
v_and_b32 v255, 0xffff0000, v205
v_fmac_f32 v242, v233, v254
v_accvgpr_read_b32 v40, a20
v_accvgpr_read_b32 v41, a21
v_accvgpr_read_b32 v42, a22
v_accvgpr_read_b32 v43, a23
v_accvgpr_read_b32 v44, a52
v_accvgpr_read_b32 v45, a53
v_accvgpr_read_b32 v46, a54
v_accvgpr_read_b32 v47, a55
v_mul_f32 v40, v40, v184
v_mul_f32 v41, v41, v184
v_mul_f32 v42, v42, v184
v_mul_f32 v43, v43, v184
v_mul_f32 v44, v44, v185
v_mul_f32 v45, v45, v185
v_mul_f32 v46, v46, v185
v_mul_f32 v47, v47, v185
v_cvt_pk_bf16_f32 v40, v40, v41
v_cvt_pk_bf16_f32 v41, v42, v43
v_cvt_pk_bf16_f32 v42, v44, v45
v_cvt_pk_bf16_f32 v43, v46, v47
v_fmac_f32 v243, v233, v255
v_lshlrev_b32 v252, 16, v206
v_and_b32 v253, 0xffff0000, v206
v_fmac_f32 v244, v233, v252
v_permlane16_swap_b32 v40, v42
v_permlane16_swap_b32 v41, v43
buffer_store_dwordx4 v[40:43], v178, s[48:51], s47 offen offset:1024 sc1
v_fmac_f32 v245, v233, v253
v_lshlrev_b32 v254, 16, v207
v_and_b32 v255, 0xffff0000, v207
v_fmac_f32 v246, v233, v254
v_fmac_f32 v247, v233, v255
v_lshlrev_b32 v252, 16, v208
v_and_b32 v253, 0xffff0000, v208
v_fmac_f32 v240, v234, v252
v_fmac_f32 v241, v234, v253
v_lshlrev_b32 v254, 16, v209
v_and_b32 v255, 0xffff0000, v209
v_fmac_f32 v242, v234, v254
v_accvgpr_read_b32 v48, a24
v_accvgpr_read_b32 v49, a25
v_accvgpr_read_b32 v50, a26
v_accvgpr_read_b32 v51, a27
v_accvgpr_read_b32 v52, a56
v_accvgpr_read_b32 v53, a57
v_accvgpr_read_b32 v54, a58
v_accvgpr_read_b32 v55, a59
v_mul_f32 v48, v48, v184
v_mul_f32 v49, v49, v184
v_mul_f32 v50, v50, v184
v_mul_f32 v51, v51, v184
v_mul_f32 v52, v52, v185
v_mul_f32 v53, v53, v185
v_mul_f32 v54, v54, v185
v_mul_f32 v55, v55, v185
v_cvt_pk_bf16_f32 v48, v48, v49
v_cvt_pk_bf16_f32 v49, v50, v51
v_cvt_pk_bf16_f32 v50, v52, v53
v_cvt_pk_bf16_f32 v51, v54, v55
v_fmac_f32 v243, v234, v255
v_lshlrev_b32 v252, 16, v210
v_and_b32 v253, 0xffff0000, v210
v_fmac_f32 v244, v234, v252
v_permlane16_swap_b32 v48, v50
v_permlane16_swap_b32 v49, v51
buffer_store_dwordx4 v[48:51], v178, s[48:51], s47 offen offset:2048 sc1
v_fmac_f32 v245, v234, v253
v_lshlrev_b32 v254, 16, v211
v_and_b32 v255, 0xffff0000, v211
v_fmac_f32 v246, v234, v254
v_fmac_f32 v247, v234, v255
v_lshlrev_b32 v252, 16, v212
v_and_b32 v253, 0xffff0000, v212
v_fmac_f32 v240, v235, v252
v_fmac_f32 v241, v235, v253
v_lshlrev_b32 v254, 16, v213
v_and_b32 v255, 0xffff0000, v213
v_fmac_f32 v242, v235, v254
v_accvgpr_read_b32 v56, a28
v_accvgpr_read_b32 v57, a29
v_accvgpr_read_b32 v58, a30
v_accvgpr_read_b32 v59, a31
v_accvgpr_read_b32 v60, a60
v_accvgpr_read_b32 v61, a61
v_accvgpr_read_b32 v62, a62
v_accvgpr_read_b32 v63, a63
v_mul_f32 v56, v56, v184
v_mul_f32 v57, v57, v184
v_mul_f32 v58, v58, v184
v_mul_f32 v59, v59, v184
v_mul_f32 v60, v60, v185
v_mul_f32 v61, v61, v185
v_mul_f32 v62, v62, v185
v_mul_f32 v63, v63, v185
v_cvt_pk_bf16_f32 v56, v56, v57
v_cvt_pk_bf16_f32 v57, v58, v59
v_cvt_pk_bf16_f32 v58, v60, v61
v_cvt_pk_bf16_f32 v59, v62, v63
v_fmac_f32 v243, v235, v255
v_lshlrev_b32 v252, 16, v214
v_and_b32 v253, 0xffff0000, v214
v_fmac_f32 v244, v235, v252
v_permlane16_swap_b32 v56, v58
v_permlane16_swap_b32 v57, v59
buffer_store_dwordx4 v[56:59], v178, s[48:51], s47 offen offset:3072 sc1
v_fmac_f32 v245, v235, v253
v_lshlrev_b32 v254, 16, v215
v_and_b32 v255, 0xffff0000, v215
v_fmac_f32 v246, v235, v254
v_fmac_f32 v247, v235, v255
v_lshlrev_b32 v252, 16, v216
v_and_b32 v253, 0xffff0000, v216
v_fmac_f32 v240, v236, v252
v_fmac_f32 v241, v236, v253
v_lshlrev_b32 v254, 16, v217
v_and_b32 v255, 0xffff0000, v217
v_fmac_f32 v242, v236, v254
s_add_u32 s47, s47, 259072
v_accvgpr_read_b32 v64, a64
v_accvgpr_read_b32 v65, a65
v_accvgpr_read_b32 v66, a66
v_accvgpr_read_b32 v67, a67
v_accvgpr_read_b32 v68, a96
v_accvgpr_read_b32 v69, a97
v_accvgpr_read_b32 v70, a98
v_accvgpr_read_b32 v71, a99
v_mul_f32 v64, v64, v186
v_mul_f32 v65, v65, v186
v_mul_f32 v66, v66, v186
v_mul_f32 v67, v67, v186
v_mul_f32 v68, v68, v187
v_mul_f32 v69, v69, v187
v_mul_f32 v70, v70, v187
v_mul_f32 v71, v71, v187
v_cvt_pk_bf16_f32 v64, v64, v65
v_cvt_pk_bf16_f32 v65, v66, v67
v_cvt_pk_bf16_f32 v66, v68, v69
v_cvt_pk_bf16_f32 v67, v70, v71
v_fmac_f32 v243, v236, v255
v_lshlrev_b32 v252, 16, v218
v_and_b32 v253, 0xffff0000, v218
v_fmac_f32 v244, v236, v252
v_permlane16_swap_b32 v64, v66
v_permlane16_swap_b32 v65, v67
buffer_store_dwordx4 v[64:67], v178, s[48:51], s47 offen offset:0 sc1
v_fmac_f32 v245, v236, v253
v_lshlrev_b32 v254, 16, v219
v_and_b32 v255, 0xffff0000, v219
v_fmac_f32 v246, v236, v254
v_fmac_f32 v247, v236, v255
v_lshlrev_b32 v252, 16, v220
v_and_b32 v253, 0xffff0000, v220
v_fmac_f32 v240, v237, v252
v_fmac_f32 v241, v237, v253
v_lshlrev_b32 v254, 16, v221
v_and_b32 v255, 0xffff0000, v221
v_fmac_f32 v242, v237, v254
v_accvgpr_read_b32 v72, a68
v_accvgpr_read_b32 v73, a69
v_accvgpr_read_b32 v74, a70
v_accvgpr_read_b32 v75, a71
v_accvgpr_read_b32 v76, a100
v_accvgpr_read_b32 v77, a101
v_accvgpr_read_b32 v78, a102
v_accvgpr_read_b32 v79, a103
v_mul_f32 v72, v72, v186
v_mul_f32 v73, v73, v186
v_mul_f32 v74, v74, v186
v_mul_f32 v75, v75, v186
v_mul_f32 v76, v76, v187
v_mul_f32 v77, v77, v187
v_mul_f32 v78, v78, v187
v_mul_f32 v79, v79, v187
v_cvt_pk_bf16_f32 v72, v72, v73
v_cvt_pk_bf16_f32 v73, v74, v75
v_cvt_pk_bf16_f32 v74, v76, v77
v_cvt_pk_bf16_f32 v75, v78, v79
v_fmac_f32 v243, v237, v255
v_lshlrev_b32 v252, 16, v222
v_and_b32 v253, 0xffff0000, v222
v_fmac_f32 v244, v237, v252
v_permlane16_swap_b32 v72, v74
v_permlane16_swap_b32 v73, v75
buffer_store_dwordx4 v[72:75], v178, s[48:51], s47 offen offset:1024 sc1
v_fmac_f32 v245, v237, v253
v_lshlrev_b32 v254, 16, v223
v_and_b32 v255, 0xffff0000, v223
v_fmac_f32 v246, v237, v254
v_fmac_f32 v247, v237, v255
v_lshlrev_b32 v252, 16, v224
v_and_b32 v253, 0xffff0000, v224
v_fmac_f32 v240, v238, v252
v_fmac_f32 v241, v238, v253
v_lshlrev_b32 v254, 16, v225
v_and_b32 v255, 0xffff0000, v225
v_fmac_f32 v242, v238, v254
v_accvgpr_read_b32 v80, a72
v_accvgpr_read_b32 v81, a73
v_accvgpr_read_b32 v82, a74
v_accvgpr_read_b32 v83, a75
v_accvgpr_read_b32 v84, a104
v_accvgpr_read_b32 v85, a105
v_accvgpr_read_b32 v86, a106
v_accvgpr_read_b32 v87, a107
v_mul_f32 v80, v80, v186
v_mul_f32 v81, v81, v186
v_mul_f32 v82, v82, v186
v_mul_f32 v83, v83, v186
v_mul_f32 v84, v84, v187
v_mul_f32 v85, v85, v187
v_mul_f32 v86, v86, v187
v_mul_f32 v87, v87, v187
v_cvt_pk_bf16_f32 v80, v80, v81
v_cvt_pk_bf16_f32 v81, v82, v83
v_cvt_pk_bf16_f32 v82, v84, v85
v_cvt_pk_bf16_f32 v83, v86, v87
v_fmac_f32 v243, v238, v255
v_lshlrev_b32 v252, 16, v226
v_and_b32 v253, 0xffff0000, v226
v_fmac_f32 v244, v238, v252
v_permlane16_swap_b32 v80, v82
v_permlane16_swap_b32 v81, v83
buffer_store_dwordx4 v[80:83], v178, s[48:51], s47 offen offset:2048 sc1
v_fmac_f32 v245, v238, v253
v_lshlrev_b32 v254, 16, v227
v_and_b32 v255, 0xffff0000, v227
v_fmac_f32 v246, v238, v254
v_fmac_f32 v247, v238, v255
v_lshlrev_b32 v252, 16, v228
v_and_b32 v253, 0xffff0000, v228
v_fmac_f32 v240, v239, v252
v_fmac_f32 v241, v239, v253
v_lshlrev_b32 v254, 16, v229
v_and_b32 v255, 0xffff0000, v229
v_fmac_f32 v242, v239, v254
v_accvgpr_read_b32 v88, a76
v_accvgpr_read_b32 v89, a77
v_accvgpr_read_b32 v90, a78
v_accvgpr_read_b32 v91, a79
v_accvgpr_read_b32 v92, a108
v_accvgpr_read_b32 v93, a109
v_accvgpr_read_b32 v94, a110
v_accvgpr_read_b32 v95, a111
v_mul_f32 v88, v88, v186
v_mul_f32 v89, v89, v186
v_mul_f32 v90, v90, v186
v_mul_f32 v91, v91, v186
v_mul_f32 v92, v92, v187
v_mul_f32 v93, v93, v187
v_mul_f32 v94, v94, v187
v_mul_f32 v95, v95, v187
v_cvt_pk_bf16_f32 v88, v88, v89
v_cvt_pk_bf16_f32 v89, v90, v91
v_cvt_pk_bf16_f32 v90, v92, v93
v_cvt_pk_bf16_f32 v91, v94, v95
v_fmac_f32 v243, v239, v255
v_lshlrev_b32 v252, 16, v230
v_and_b32 v253, 0xffff0000, v230
v_fmac_f32 v244, v239, v252
v_permlane16_swap_b32 v88, v90
v_permlane16_swap_b32 v89, v91
buffer_store_dwordx4 v[88:91], v178, s[48:51], s47 offen offset:3072 sc1
s_add_u32 s47, s47, 4096
v_fmac_f32 v245, v239, v253
v_lshlrev_b32 v254, 16, v231
v_and_b32 v255, 0xffff0000, v231
v_fmac_f32 v246, v239, v254
v_fmac_f32 v247, v239, v255
v_and_b32 v170, 31, v179
v_lshlrev_b32 v170, 5, v170
v_lshrrev_b32 v252, 5, v179
v_lshl_add_u32 v170, v252, 12, v170
v_add_u32 v170, s66, v170
ds_write_b128 v170, v[240:243]
ds_write_b128 v170, v[244:247] offset:16
v_accvgpr_read_b32 v96, a80
v_accvgpr_read_b32 v97, a81
v_accvgpr_read_b32 v98, a82
v_accvgpr_read_b32 v99, a83
v_accvgpr_read_b32 v100, a112
v_accvgpr_read_b32 v101, a113
v_accvgpr_read_b32 v102, a114
v_accvgpr_read_b32 v103, a115
v_mul_f32 v96, v96, v186
v_mul_f32 v97, v97, v186
v_mul_f32 v98, v98, v186
v_mul_f32 v99, v99, v186
v_mul_f32 v100, v100, v187
v_mul_f32 v101, v101, v187
v_mul_f32 v102, v102, v187
v_mul_f32 v103, v103, v187
v_cvt_pk_bf16_f32 v96, v96, v97
v_cvt_pk_bf16_f32 v97, v98, v99
v_cvt_pk_bf16_f32 v98, v100, v101
v_cvt_pk_bf16_f32 v99, v102, v103
v_mov_b32 v252, s66
v_mov_b32 v253, s54
ds_write_b32 v252, v253 offset:8192
v_lshlrev_b32 v171, 2, v179
v_permlane16_swap_b32 v96, v98
v_permlane16_swap_b32 v97, v99
buffer_store_dwordx4 v[96:99], v178, s[48:51], s47 offen offset:0 sc1
v_add_u32 v170, 131072, v171
v_mov_b32 v252, 139264
v_accvgpr_read_b32 v104, a84
v_accvgpr_read_b32 v105, a85
v_accvgpr_read_b32 v106, a86
v_accvgpr_read_b32 v107, a87
v_accvgpr_read_b32 v108, a116
v_accvgpr_read_b32 v109, a117
v_accvgpr_read_b32 v110, a118
v_accvgpr_read_b32 v111, a119
v_mul_f32 v104, v104, v186
v_mul_f32 v105, v105, v186
v_mul_f32 v106, v106, v186
v_mul_f32 v107, v107, v186
v_mul_f32 v108, v108, v187
v_mul_f32 v109, v109, v187
v_mul_f32 v110, v110, v187
v_mul_f32 v111, v111, v187
v_cvt_pk_bf16_f32 v104, v104, v105
v_cvt_pk_bf16_f32 v105, v106, v107
v_cvt_pk_bf16_f32 v106, v108, v109
v_cvt_pk_bf16_f32 v107, v110, v111
s_nop 1
v_permlane16_swap_b32 v104, v106
v_permlane16_swap_b32 v105, v107
buffer_store_dwordx4 v[104:107], v178, s[48:51], s47 offen offset:1024 sc1
v_accvgpr_read_b32 v112, a88
v_accvgpr_read_b32 v113, a89
v_accvgpr_read_b32 v114, a90
v_accvgpr_read_b32 v115, a91
v_accvgpr_read_b32 v116, a120
v_accvgpr_read_b32 v117, a121
v_accvgpr_read_b32 v118, a122
v_accvgpr_read_b32 v119, a123
v_mul_f32 v112, v112, v186
v_mul_f32 v113, v113, v186
v_mul_f32 v114, v114, v186
v_mul_f32 v115, v115, v186
v_mul_f32 v116, v116, v187
v_mul_f32 v117, v117, v187
v_mul_f32 v118, v118, v187
v_mul_f32 v119, v119, v187
v_cvt_pk_bf16_f32 v112, v112, v113
v_cvt_pk_bf16_f32 v113, v114, v115
v_cvt_pk_bf16_f32 v114, v116, v117
v_cvt_pk_bf16_f32 v115, v118, v119
s_nop 1
v_permlane16_swap_b32 v112, v114
v_permlane16_swap_b32 v113, v115
buffer_store_dwordx4 v[112:115], v178, s[48:51], s47 offen offset:2048 sc1
v_accvgpr_read_b32 v120, a92
v_accvgpr_read_b32 v121, a93
v_accvgpr_read_b32 v122, a94
v_accvgpr_read_b32 v123, a95
v_accvgpr_read_b32 v124, a124
v_accvgpr_read_b32 v125, a125
v_accvgpr_read_b32 v126, a126
v_accvgpr_read_b32 v127, a127
v_mul_f32 v120, v120, v186
v_mul_f32 v121, v121, v186
v_mul_f32 v122, v122, v186
v_mul_f32 v123, v123, v186
v_mul_f32 v124, v124, v187
v_mul_f32 v125, v125, v187
v_mul_f32 v126, v126, v187
v_mul_f32 v127, v127, v187
v_cvt_pk_bf16_f32 v120, v120, v121
v_cvt_pk_bf16_f32 v121, v122, v123
v_cvt_pk_bf16_f32 v122, v124, v125
v_cvt_pk_bf16_f32 v123, v126, v127
s_nop 1
v_permlane16_swap_b32 v120, v122
v_permlane16_swap_b32 v121, v123
buffer_store_dwordx4 v[120:123], v178, s[48:51], s47 offen offset:3072 sc1
s_waitcnt lgkmcnt(0)
s_barrier
ds_read_b32 v200, v170 offset:0
ds_read_b32 v201, v170 offset:256
ds_read_b32 v202, v170 offset:512
ds_read_b32 v203, v170 offset:768
ds_read_b32 v204, v170 offset:1024
ds_read_b32 v205, v170 offset:1280
ds_read_b32 v206, v170 offset:1536
ds_read_b32 v207, v170 offset:1792
ds_read_b32 v208, v170 offset:2048
ds_read_b32 v209, v170 offset:2304
ds_read_b32 v210, v170 offset:2560
ds_read_b32 v211, v170 offset:2816
ds_read_b32 v212, v170 offset:3072
ds_read_b32 v213, v170 offset:3328
ds_read_b32 v214, v170 offset:3584
ds_read_b32 v215, v170 offset:3840
ds_read_b32 v216, v170 offset:4096
ds_read_b32 v217, v170 offset:4352
ds_read_b32 v218, v170 offset:4608
ds_read_b32 v219, v170 offset:4864
ds_read_b32 v220, v170 offset:5120
ds_read_b32 v221, v170 offset:5376
ds_read_b32 v222, v170 offset:5632
ds_read_b32 v223, v170 offset:5888
ds_read_b32 v224, v170 offset:6144
ds_read_b32 v225, v170 offset:6400
ds_read_b32 v226, v170 offset:6656
ds_read_b32 v227, v170 offset:6912
ds_read_b32 v228, v170 offset:7168
ds_read_b32 v229, v170 offset:7424
ds_read_b32 v230, v170 offset:7680
ds_read_b32 v231, v170 offset:7936
ds_read_b32 v248, v252 offset:0
ds_read_b32 v249, v252 offset:1024
ds_read_b32 v250, v252 offset:2048
ds_read_b32 v251, v252 offset:3072
s_add_u32 s88, s10, 65536
s_addc_u32 s89, s11, 0
s_and_b32 s89, s89, 0xffff
s_mov_b32 s90, 98304
s_mov_b32 s91, 0x20000
s_and_b32 s66, s2, 3
s_mul_i32 s66, s66, 24576
s_lshr_b32 s67, s2, 2
s_lshl_b32 s67, s67, 8
s_add_u32 s66, s66, s67
s_add_u32 s66, s66, 8192
s_waitcnt lgkmcnt(0)
v_add_f32 v200, v200, v204
v_add_f32 v201, v201, v205
v_add_f32 v202, v202, v206
v_add_f32 v203, v203, v207
v_add_f32 v200, v200, v208
v_add_f32 v201, v201, v209
v_add_f32 v202, v202, v210
v_add_f32 v203, v203, v211
v_add_f32 v200, v200, v212
v_add_f32 v201, v201, v213
v_add_f32 v202, v202, v214
v_add_f32 v203, v203, v215
v_add_f32 v200, v200, v216
v_add_f32 v201, v201, v217
v_add_f32 v202, v202, v218
v_add_f32 v203, v203, v219
v_add_f32 v200, v200, v220
v_add_f32 v201, v201, v221
v_add_f32 v202, v202, v222
v_add_f32 v203, v203, v223
v_add_f32 v200, v200, v224
v_add_f32 v201, v201, v225
v_add_f32 v202, v202, v226
v_add_f32 v203, v203, v227
v_add_f32 v200, v200, v228
v_add_f32 v201, v201, v229
v_add_f32 v202, v202, v230
v_add_f32 v203, v203, v231
v_add_f32 v200, v200, v201
v_add_f32 v202, v202, v203
v_add_f32 v200, v200, v202
buffer_store_dword v200, v171, s[88:91], s66 offen sc1
v_or3_b32 v248, v248, v249, v250
v_or_b32 v248, v248, v251
s_nop 0
v_readfirstlane_b32 s54, v248
s_andn2_b32 s54, s54, s55
s_cmp_lg_u32 s54, 0
s_cbranch_scc1 L_attn_redo
L_attn_end:
s_endpgm
L_attn_redo:
s_waitcnt vmcnt(0) lgkmcnt(0)
s_barrier
s_mov_b32 s44, s38
v_and_b32 v152, 0xffff7fff, v152
v_and_b32 v153, 0xffff7fff, v153
v_and_b32 v154, 0xffff7fff, v154
v_and_b32 v155, 0xffff7fff, v155
v_and_b32 v156, 0xffff7fff, v156
v_and_b32 v157, 0xffff7fff, v157
v_and_b32 v158, 0xffff7fff, v158
v_and_b32 v159, 0xffff7fff, v159
v_and_b32 v160, 0xffff7fff, v160
v_and_b32 v161, 0xffff7fff, v161
v_and_b32 v162, 0xffff7fff, v162
v_and_b32 v163, 0xffff7fff, v163
v_mov_b32 v188, 0xff800000
v_mov_b32 v189, 0xff800000
v_mov_b32 v190, 0xff800000
v_mov_b32 v191, 0xff800000
s_mov_b32 s46, 32
L_attn_mx:
s_mov_b32 m0, s43
s_nop 0
buffer_load_dwordx4 v164, s[12:15], s44 offen offset:0 lds
buffer_load_dwordx4 v165, s[12:15], s44 offen offset:1024 lds
buffer_load_dwordx4 v166, s[12:15], s44 offen offset:2048 lds
buffer_load_dwordx4 v167, s[12:15], s44 offen offset:3072 lds
s_add_u32 s44, s44, 16384
s_waitcnt vmcnt(0)
s_barrier
ds_read_b128 a[192:195], v152 offset:0
ds_read_b128 a[196:199], v153 offset:0
ds_read_b128 a[200:203], v154 offset:0
ds_read_b128 a[204:207], v155 offset:0
s_waitcnt lgkmcnt(0)
v_mfma_f32_16x16x32_bf16 v[0:3], a[192:195], a[128:131], 0
v_mfma_f32_16x16x32_bf16 v[16:19], a[192:195], a[144:147], 0
v_mfma_f32_16x16x32_bf16 v[32:35], a[192:195], a[160:163], 0
v_mfma_f32_16x16x32_bf16 v[48:51], a[192:195], a[176:179], 0
v_mfma_f32_16x16x32_bf16 v[0:3], a[196:199], a[132:135], v[0:3]
v_mfma_f32_16x16x32_bf16 v[16:19], a[196:199], a[148:151], v[16:19]
v_mfma_f32_16x16x32_bf16 v[32:35], a[196:199], a[164:167], v[32:35]
v_mfma_f32_16x16x32_bf16 v[48:51], a[196:199], a[180:183], v[48:51]
v_mfma_f32_16x16x32_bf16 v[0:3], a[200:203], a[136:139], v[0:3]
v_mfma_f32_16x16x32_bf16 v[16:19], a[200:203], a[152:155], v[16:19]
v_mfma_f32_16x16x32_bf16 v[32:35], a[200:203], a[168:171], v[32:35]
v_mfma_f32_16x16x32_bf16 v[48:51], a[200:203], a[184:187], v[48:51]
v_mfma_f32_16x16x32_bf16 v[0:3], a[204:207], a[140:143], v[0:3]
v_mfma_f32_16x16x32_bf16 v[16:19], a[204:207], a[156:159], v[16:19]
v_mfma_f32_16x16x32_bf16 v[32:35], a[204:207], a[172:175], v[32:35]
v_mfma_f32_16x16x32_bf16 v[48:51], a[204:207], a[188:191], v[48:51]
ds_read_b128 a[192:195], v152 offset:4096
ds_read_b128 a[196:199], v153 offset:4096
ds_read_b128 a[200:203], v154 offset:4096
ds_read_b128 a[204:207], v155 offset:4096
s_waitcnt lgkmcnt(0)
v_mfma_f32_16x16x32_bf16 v[4:7], a[192:195], a[128:131], 0
v_mfma_f32_16x16x32_bf16 v[20:23], a[192:195], a[144:147], 0
v_mfma_f32_16x16x32_bf16 v[36:39], a[192:195], a[160:163], 0
v_mfma_f32_16x16x32_bf16 v[52:55], a[192:195], a[176:179], 0
v_mfma_f32_16x16x32_bf16 v[4:7], a[196:199], a[132:135], v[4:7]
v_mfma_f32_16x16x32_bf16 v[20:23], a[196:199], a[148:151], v[20:23]
v_mfma_f32_16x16x32_bf16 v[36:39], a[196:199], a[164:167], v[36:39]
v_mfma_f32_16x16x32_bf16 v[52:55], a[196:199], a[180:183], v[52:55]
v_mfma_f32_16x16x32_bf16 v[4:7], a[200:203], a[136:139], v[4:7]
v_mfma_f32_16x16x32_bf16 v[20:23], a[200:203], a[152:155], v[20:23]
v_mfma_f32_16x16x32_bf16 v[36:39], a[200:203], a[168:171], v[36:39]
v_mfma_f32_16x16x32_bf16 v[52:55], a[200:203], a[184:187], v[52:55]
v_mfma_f32_16x16x32_bf16 v[4:7], a[204:207], a[140:143], v[4:7]
v_mfma_f32_16x16x32_bf16 v[20:23], a[204:207], a[156:159], v[20:23]
v_mfma_f32_16x16x32_bf16 v[36:39], a[204:207], a[172:175], v[36:39]
v_mfma_f32_16x16x32_bf16 v[52:55], a[204:207], a[188:191], v[52:55]
ds_read_b128 a[192:195], v152 offset:8192
ds_read_b128 a[196:199], v153 offset:8192
ds_read_b128 a[200:203], v154 offset:8192
ds_read_b128 a[204:207], v155 offset:8192
s_waitcnt lgkmcnt(0)
v_mfma_f32_16x16x32_bf16 v[8:11], a[192:195], a[128:131], 0
v_mfma_f32_16x16x32_bf16 v[24:27], a[192:195], a[144:147], 0
v_mfma_f32_16x16x32_bf16 v[40:43], a[192:195], a[160:163], 0
v_mfma_f32_16x16x32_bf16 v[56:59], a[192:195], a[176:179], 0
v_mfma_f32_16x16x32_bf16 v[8:11], a[196:199], a[132:135], v[8:11]
v_mfma_f32_16x16x32_bf16 v[24:27], a[196:199], a[148:151], v[24:27]
v_mfma_f32_16x16x32_bf16 v[40:43], a[196:199], a[164:167], v[40:43]
v_mfma_f32_16x16x32_bf16 v[56:59], a[196:199], a[180:183], v[56:59]
v_mfma_f32_16x16x32_bf16 v[8:11], a[200:203], a[136:139], v[8:11]
v_mfma_f32_16x16x32_bf16 v[24:27], a[200:203], a[152:155], v[24:27]
v_mfma_f32_16x16x32_bf16 v[40:43], a[200:203], a[168:171], v[40:43]
v_mfma_f32_16x16x32_bf16 v[56:59], a[200:203], a[184:187], v[56:59]
v_mfma_f32_16x16x32_bf16 v[8:11], a[204:207], a[140:143], v[8:11]
v_mfma_f32_16x16x32_bf16 v[24:27], a[204:207], a[156:159], v[24:27]
v_mfma_f32_16x16x32_bf16 v[40:43], a[204:207], a[172:175], v[40:43]
v_mfma_f32_16x16x32_bf16 v[56:59], a[204:207], a[188:191], v[56:59]
ds_read_b128 a[192:195], v152 offset:12288
ds_read_b128 a[196:199], v153 offset:12288
ds_read_b128 a[200:203], v154 offset:12288
ds_read_b128 a[204:207], v155 offset:12288
s_waitcnt lgkmcnt(0)
v_mfma_f32_16x16x32_bf16 v[12:15], a[192:195], a[128:131], 0
v_mfma_f32_16x16x32_bf16 v[28:31], a[192:195], a[144:147], 0
v_mfma_f32_16x16x32_bf16 v[44:47], a[192:195], a[160:163], 0
v_mfma_f32_16x16x32_bf16 v[60:63], a[192:195], a[176:179], 0
v_mfma_f32_16x16x32_bf16 v[12:15], a[196:199], a[132:135], v[12:15]
v_mfma_f32_16x16x32_bf16 v[28:31], a[196:199], a[148:151], v[28:31]
v_mfma_f32_16x16x32_bf16 v[44:47], a[196:199], a[164:167], v[44:47]
v_mfma_f32_16x16x32_bf16 v[60:63], a[196:199], a[180:183], v[60:63]
v_mfma_f32_16x16x32_bf16 v[12:15], a[200:203], a[136:139], v[12:15]
v_mfma_f32_16x16x32_bf16 v[28:31], a[200:203], a[152:155], v[28:31]
v_mfma_f32_16x16x32_bf16 v[44:47], a[200:203], a[168:171], v[44:47]
v_mfma_f32_16x16x32_bf16 v[60:63], a[200:203], a[184:187], v[60:63]
v_mfma_f32_16x16x32_bf16 v[12:15], a[204:207], a[140:143], v[12:15]
v_mfma_f32_16x16x32_bf16 v[28:31], a[204:207], a[156:159], v[28:31]
v_mfma_f32_16x16x32_bf16 v[44:47], a[204:207], a[172:175], v[44:47]
v_mfma_f32_16x16x32_bf16 v[60:63], a[204:207], a[188:191], v[60:63]
s_nop 15
v_max3_f32 v188, v188, v0, v1
v_max3_f32 v188, v188, v2, v3
v_max3_f32 v188, v188, v4, v5
v_max3_f32 v188, v188, v6, v7
v_max3_f32 v188, v188, v8, v9
v_max3_f32 v188, v188, v10, v11
v_max3_f32 v188, v188, v12, v13
v_max3_f32 v188, v188, v14, v15
v_max3_f32 v189, v189, v16, v17
v_max3_f32 v189, v189, v18, v19
v_max3_f32 v189, v189, v20, v21
v_max3_f32 v189, v189, v22, v23
v_max3_f32 v189, v189, v24, v25
v_max3_f32 v189, v189, v26, v27
v_max3_f32 v189, v189, v28, v29
v_max3_f32 v189, v189, v30, v31
v_max3_f32 v190, v190, v32, v33
v_max3_f32 v190, v190, v34, v35
v_max3_f32 v190, v190, v36, v37
v_max3_f32 v190, v190, v38, v39
v_max3_f32 v190, v190, v40, v41
v_max3_f32 v190, v190, v42, v43
v_max3_f32 v190, v190, v44, v45
v_max3_f32 v190, v190, v46, v47
v_max3_f32 v191, v191, v48, v49
v_max3_f32 v191, v191, v50, v51
v_max3_f32 v191, v191, v52, v53
v_max3_f32 v191, v191, v54, v55
v_max3_f32 v191, v191, v56, v57
v_max3_f32 v191, v191, v58, v59
v_max3_f32 v191, v191, v60, v61
v_max3_f32 v191, v191, v62, v63
s_barrier
s_sub_u32 s46, s46, 1
s_cmp_lg_u32 s46, 0
s_cbranch_scc1 L_attn_mx
v_mov_b32 v192, v188
s_nop 1
v_permlane16_swap_b32 v188, v192
s_nop 1
v_max_f32 v188, v188, v192
v_mov_b32 v192, v188
s_nop 1
v_permlane32_swap_b32 v188, v192
s_nop 1
v_max_f32 v188, v188, v192
v_add_f32 v188, 0x42dc0000, v188
v_sub_f32 v128, 0, v188
v_sub_f32 v129, 0, v188
v_sub_f32 v130, 0, v188
v_sub_f32 v131, 0, v188
v_mov_b32 v192, v189
s_nop 1
v_permlane16_swap_b32 v189, v192
s_nop 1
v_max_f32 v189, v189, v192
v_mov_b32 v192, v189
s_nop 1
v_permlane32_swap_b32 v189, v192
s_nop 1
v_max_f32 v189, v189, v192
v_add_f32 v189, 0x42dc0000, v189
v_sub_f32 v132, 0, v189
v_sub_f32 v133, 0, v189
v_sub_f32 v134, 0, v189
v_sub_f32 v135, 0, v189
v_mov_b32 v192, v190
s_nop 1
v_permlane16_swap_b32 v190, v192
s_nop 1
v_max_f32 v190, v190, v192
v_mov_b32 v192, v190
s_nop 1
v_permlane32_swap_b32 v190, v192
s_nop 1
v_max_f32 v190, v190, v192
v_add_f32 v190, 0x42dc0000, v190
v_sub_f32 v136, 0, v190
v_sub_f32 v137, 0, v190
v_sub_f32 v138, 0, v190
v_sub_f32 v139, 0, v190
v_mov_b32 v192, v191
s_nop 1
v_permlane16_swap_b32 v191, v192
s_nop 1
v_max_f32 v191, v191, v192
v_mov_b32 v192, v191
s_nop 1
v_permlane32_swap_b32 v191, v192
s_nop 1
v_max_f32 v191, v191, v192
v_add_f32 v191, 0x42dc0000, v191
v_sub_f32 v140, 0, v191
v_sub_f32 v141, 0, v191
v_sub_f32 v142, 0, v191
v_sub_f32 v143, 0, v191
s_mov_b32 s44, s38
s_mov_b32 s45, s38
s_mov_b32 s55, 1
s_add_u32 m0, s43, 0
s_nop 0
buffer_load_dwordx4 v164, s[12:15], s44 offen offset:0 nt lds
buffer_load_dwordx4 v165, s[12:15], s44 offen offset:1024 nt lds
buffer_load_dwordx4 v166, s[12:15], s44 offen offset:2048 nt lds
buffer_load_dwordx4 v167, s[12:15], s44 offen offset:3072 nt lds
s_add_u32 s44, s44, 16384
s_add_u32 m0, s43, 16384
s_nop 0
buffer_load_dwordx4 v164, s[12:15], s44 offen offset:0 nt lds
buffer_load_dwordx4 v165, s[12:15], s44 offen offset:1024 nt lds
buffer_load_dwordx4 v166, s[12:15], s44 offen offset:2048 nt lds
buffer_load_dwordx4 v167, s[12:15], s44 offen offset:3072 nt lds
s_add_u32 s44, s44, 16384
s_add_u32 m0, s43, 65536
s_nop 0
buffer_load_dwordx4 v168, s[16:19], s45 offen offset:0 nt lds
buffer_load_dwordx4 v169, s[16:19], s45 offen offset:1024 nt lds
buffer_load_dwordx4 v168, s[16:19], s45 offen offset:2048 nt lds
buffer_load_dwordx4 v169, s[16:19], s45 offen offset:3072 nt lds
s_add_u32 s45, s45, 16384
s_waitcnt vmcnt(0)
s_branch L_attn_start
.text
.globl oproj_kernel
.p2align 8
.type oproj_kernel,@function
oproj_kernel:
s_cmp_ge_u32 s2, 256
s_cbranch_scc1 L_oproj_end
s_load_dwordx2 s[4:5], s[0:1], 32
s_load_dwordx2 s[8:9], s[0:1], 104
v_and_b32 v128, 63, v0
v_lshrrev_b32 v152, 6, v0
v_lshlrev_b32 v129, 4, v128
v_readfirstlane_b32 s33, v152
s_and_b32 s30, s2, 7
s_lshr_b32 s31, s2, 3
s_and_b32 s38, s30, 3
s_lshr_b32 s34, s30, 2
s_lshl_b32 s34, s34, 2
s_and_b32 s36, s31, 3
s_add_u32 s34, s34, s36
s_lshr_b32 s35, s31, 2
s_lshl_b32 s37, s34, 3
s_lshl_b32 s36, s33, 1
s_add_u32 s37, s37, s36
s_mul_i32 s40, s37, 263168
s_mul_i32 s36, s38, 65536
s_add_u32 s40, s40, s36
s_add_u32 s41, s40, 263168
v_lshrrev_b32 v152, 4, v128
v_and_b32 v153, 15, v128
v_lshlrev_b32 v154, 1, v152
v_xor_b32 v154, v154, v153
v_lshlrev_b32 v154, 4, v154
v_lshl_add_u32 v130, v152, 11, v154
v_add_u32 v131, 7168, v130
v_xor_b32 v132, 128, v130
v_add_u32 v133, 21504, v132
v_add_u32 v132, 14336, v132
v_lshrrev_b32 v152, 4, v128
v_and_b32 v134, 15, v128
v_lshlrev_b32 v134, 4, v134
v_lshl_add_u32 v134, v152, 9, v134
s_lshl_b32 s42, s35, 8
s_lshl_b32 s36, s33, 15
s_add_u32 s42, s42, s36
s_mul_i32 s36, s38, 2097152
s_add_u32 s42, s42, s36
s_lshl_b32 s43, s33, 12
s_waitcnt lgkmcnt(0)
s_mov_b32 s12, s4
s_and_b32 s13, s5, 0xffff
s_mov_b32 s14, 8388608
s_mov_b32 s15, 0x20000
s_add_u32 s16, s8, 8388608
s_addc_u32 s17, s9, 0
s_and_b32 s17, s17, 0xffff
s_mov_b32 s18, 16842752
s_mov_b32 s19, 0x20000
s_add_u32 s60, s40, 57344
s_add_u32 s61, s41, 57344
s_add_u32 m0, s43, 0
s_nop 0
buffer_load_dwordx4 v130, s[12:15], s42 offen offset:0 lds
buffer_load_dwordx4 v131, s[12:15], s42 offen offset:1024 lds
buffer_load_dwordx4 v132, s[12:15], s42 offen offset:2048 lds
buffer_load_dwordx4 v133, s[12:15], s42 offen offset:3072 lds
s_add_u32 s42, s42, 131072
s_add_u32 m0, s43, 16384
s_nop 0
buffer_load_dwordx4 v130, s[12:15], s42 offen offset:0 lds
buffer_load_dwordx4 v131, s[12:15], s42 offen offset:1024 lds
s_xor_b32 s43, s43, 0x8000
buffer_load_dwordx4 v132, s[12:15], s42 offen offset:2048 lds
buffer_load_dwordx4 v133, s[12:15], s42 offen offset:3072 lds
s_add_u32 s42, s42, 131072
buffer_load_dwordx4 a[0:3], v134, s[16:19], s40 offen offset:0
buffer_load_dwordx4 a[4:7], v134, s[16:19], s40 offen offset:256
buffer_load_dwordx4 a[8:11], v134, s[16:19], s41 offen offset:0
buffer_load_dwordx4 a[12:15], v134, s[16:19], s41 offen offset:256
buffer_load_dwordx4 a[16:19], v134, s[16:19], s40 offen offset:2048
buffer_load_dwordx4 a[20:23], v134, s[16:19], s40 offen offset:2304
s_add_u32 s40, s40, 4096
buffer_load_dwordx4 a[24:27], v134, s[16:19], s41 offen offset:2048
buffer_load_dwordx4 a[28:31], v134, s[16:19], s41 offen offset:2304
s_add_u32 s41, s41, 4096
buffer_load_dwordx4 a[32:35], v134, s[16:19], s40 offen offset:0
buffer_load_dwordx4 a[36:39], v134, s[16:19], s40 offen offset:256
buffer_load_dwordx4 a[40:43], v134, s[16:19], s41 offen offset:0
buffer_load_dwordx4 a[44:47], v134, s[16:19], s41 offen offset:256
v_lshrrev_b32 v152, 4, v128
v_bfe_u32 v153, v128, 2, 2
v_lshl_add_u32 v154, v152, 3, v153
v_and_b32 v155, 3, v128
v_lshlrev_b32 v155, 3, v155
v_lshl_add_u32 v154, v154, 8, v155
v_bfe_u32 v155, v128, 2, 3
v_xor_b32 v156, 0, v155
v_lshl_add_u32 v136, v156, 5, v154
v_xor_b32 v156, 1, v155
v_lshl_add_u32 v137, v156, 5, v154
v_xor_b32 v156, 2, v155
v_lshl_add_u32 v138, v156, 5, v154
v_xor_b32 v156, 3, v155
v_lshl_add_u32 v139, v156, 5, v154
v_xor_b32 v156, 4, v155
v_lshl_add_u32 v140, v156, 5, v154
v_xor_b32 v156, 5, v155
v_lshl_add_u32 v141, v156, 5, v154
v_xor_b32 v156, 6, v155
v_lshl_add_u32 v142, v156, 5, v154
v_xor_b32 v156, 7, v155
v_lshl_add_u32 v143, v156, 5, v154
s_add_u32 s20, s8, 30408704
s_addc_u32 s21, s9, 0
s_and_b32 s21, s21, 0xffff
s_mov_b32 s22, 17039360
s_mov_b32 s23, 0x20000
s_mul_i32 s45, s37, 66560
s_lshl_b32 s36, s35, 13
s_add_u32 s45, s45, s36
s_mul_i32 s44, s38, 4259840
s_add_u32 s44, s44, s45
s_add_u32 s45, s44, 4096
s_add_u32 s47, s44, 66560
s_add_u32 s48, s45, 66560
s_add_u32 s24, s8, 65536
s_addc_u32 s25, s9, 0
s_and_b32 s25, s25, 0xffff
s_mov_b32 s26, 98304
s_mov_b32 s27, 0x20000
s_mov_b32 s52, s8
s_and_b32 s53, s9, 0xffff
s_mov_b32 s54, 24576
s_mov_b32 s55, 0x20000
s_lshl_b32 s36, s2, 6
s_add_u32 s36, s36, 8192
v_and_b32 v135, 3, v128
v_lshlrev_b32 v135, 4, v135
v_add_u32 v135, s36, v135
s_mov_b32 s56, 24576
s_mov_b32 s57, 49152
s_mov_b32 s58, 73728
s_waitcnt vmcnt(16)
s_barrier
ds_read_b64_tr_b16 a[192:193], v136 offset:0
ds_read_b64_tr_b16 a[194:195], v136 offset:1024
ds_read_b64_tr_b16 a[196:197], v137 offset:0
ds_read_b64_tr_b16 a[198:199], v137 offset:1024
ds_read_b64_tr_b16 a[200:201], v138 offset:0
ds_read_b64_tr_b16 a[202:203], v138 offset:1024
ds_read_b64_tr_b16 a[204:205], v139 offset:0
ds_read_b64_tr_b16 a[206:207], v139 offset:1024
ds_read_b64_tr_b16 a[208:209], v140 offset:0
ds_read_b64_tr_b16 a[210:211], v140 offset:1024
ds_read_b64_tr_b16 a[212:213], v141 offset:0
ds_read_b64_tr_b16 a[214:215], v141 offset:1024
s_waitcnt vmcnt(8) lgkmcnt(8)
v_mfma_f32_16x16x32_bf16 v[0:3], a[192:195], a[0:3], 0
ds_read_b64_tr_b16 a[216:217], v142 offset:0
v_mfma_f32_16x16x32_bf16 v[4:7], a[192:195], a[4:7], 0
buffer_load_dwordx4 a[48:51], v134, s[16:19], s40 offen offset:2048
v_mfma_f32_16x16x32_bf16 v[64:67], a[192:195], a[8:11], 0
ds_read_b64_tr_b16 a[218:219], v142 offset:1024
v_mfma_f32_16x16x32_bf16 v[68:71], a[192:195], a[12:15], 0
v_mfma_f32_16x16x32_bf16 v[8:11], a[196:199], a[0:3], 0
ds_read_b64_tr_b16 a[220:221], v143 offset:0
v_mfma_f32_16x16x32_bf16 v[12:15], a[196:199], a[4:7], 0
buffer_load_dwordx4 a[52:55], v134, s[16:19], s40 offen offset:2304
v_mfma_f32_16x16x32_bf16 v[72:75], a[196:199], a[8:11], 0
ds_read_b64_tr_b16 a[222:223], v143 offset:1024
v_mfma_f32_16x16x32_bf16 v[76:79], a[196:199], a[12:15], 0
s_waitcnt lgkmcnt(8)
s_add_u32 s40, s40, 4096
v_mfma_f32_16x16x32_bf16 v[16:19], a[200:203], a[0:3], 0
ds_read_b64_tr_b16 a[192:193], v136 offset:8192
v_mfma_f32_16x16x32_bf16 v[20:23], a[200:203], a[4:7], 0
buffer_load_dwordx4 a[56:59], v134, s[16:19], s41 offen offset:2048
v_mfma_f32_16x16x32_bf16 v[80:83], a[200:203], a[8:11], 0
ds_read_b64_tr_b16 a[194:195], v136 offset:9216
v_mfma_f32_16x16x32_bf16 v[84:87], a[200:203], a[12:15], 0
v_mfma_f32_16x16x32_bf16 v[24:27], a[204:207], a[0:3], 0
ds_read_b64_tr_b16 a[196:197], v137 offset:8192
v_mfma_f32_16x16x32_bf16 v[28:31], a[204:207], a[4:7], 0
buffer_load_dwordx4 a[60:63], v134, s[16:19], s41 offen offset:2304
v_mfma_f32_16x16x32_bf16 v[88:91], a[204:207], a[8:11], 0
ds_read_b64_tr_b16 a[198:199], v137 offset:9216
v_mfma_f32_16x16x32_bf16 v[92:95], a[204:207], a[12:15], 0
s_waitcnt lgkmcnt(8)
s_add_u32 s41, s41, 4096
s_add_u32 m0, s43, 0
v_mfma_f32_16x16x32_bf16 v[32:35], a[208:211], a[0:3], 0
ds_read_b64_tr_b16 a[200:201], v138 offset:8192
v_mfma_f32_16x16x32_bf16 v[36:39], a[208:211], a[4:7], 0
buffer_load_dwordx4 v130, s[12:15], s42 offen offset:0 lds
v_mfma_f32_16x16x32_bf16 v[96:99], a[208:211], a[8:11], 0
ds_read_b64_tr_b16 a[202:203], v138 offset:9216
v_mfma_f32_16x16x32_bf16 v[100:103], a[208:211], a[12:15], 0
v_mfma_f32_16x16x32_bf16 v[40:43], a[212:215], a[0:3], 0
ds_read_b64_tr_b16 a[204:205], v139 offset:8192
v_mfma_f32_16x16x32_bf16 v[44:47], a[212:215], a[4:7], 0
buffer_load_dwordx4 v131, s[12:15], s42 offen offset:1024 lds
v_mfma_f32_16x16x32_bf16 v[104:107], a[212:215], a[8:11], 0
ds_read_b64_tr_b16 a[206:207], v139 offset:9216
v_mfma_f32_16x16x32_bf16 v[108:111], a[212:215], a[12:15], 0
s_waitcnt lgkmcnt(8)
v_mfma_f32_16x16x32_bf16 v[48:51], a[216:219], a[0:3], 0
ds_read_b64_tr_b16 a[208:209], v140 offset:8192
v_mfma_f32_16x16x32_bf16 v[52:55], a[216:219], a[4:7], 0
buffer_load_dwordx4 v132, s[12:15], s42 offen offset:2048 lds
v_mfma_f32_16x16x32_bf16 v[112:115], a[216:219], a[8:11], 0
ds_read_b64_tr_b16 a[210:211], v140 offset:9216
v_mfma_f32_16x16x32_bf16 v[116:119], a[216:219], a[12:15], 0
v_mfma_f32_16x16x32_bf16 v[56:59], a[220:223], a[0:3], 0
ds_read_b64_tr_b16 a[212:213], v141 offset:8192
v_mfma_f32_16x16x32_bf16 v[60:63], a[220:223], a[4:7], 0
buffer_load_dwordx4 v133, s[12:15], s42 offen offset:3072 lds
v_mfma_f32_16x16x32_bf16 v[120:123], a[220:223], a[8:11], 0
ds_read_b64_tr_b16 a[214:215], v141 offset:9216
v_mfma_f32_16x16x32_bf16 v[124:127], a[220:223], a[12:15], 0
s_waitcnt vmcnt(12) lgkmcnt(8)
s_add_u32 s42, s42, 131072
v_mfma_f32_16x16x32_bf16 v[0:3], a[192:195], a[16:19], v[0:3]
ds_read_b64_tr_b16 a[216:217], v142 offset:8192
v_mfma_f32_16x16x32_bf16 v[4:7], a[192:195], a[20:23], v[4:7]
buffer_load_dwordx4 a[0:3], v134, s[16:19], s40 offen offset:0
v_mfma_f32_16x16x32_bf16 v[64:67], a[192:195], a[24:27], v[64:67]
ds_read_b64_tr_b16 a[218:219], v142 offset:9216
v_mfma_f32_16x16x32_bf16 v[68:71], a[192:195], a[28:31], v[68:71]
v_mfma_f32_16x16x32_bf16 v[8:11], a[196:199], a[16:19], v[8:11]
ds_read_b64_tr_b16 a[220:221], v143 offset:8192
v_mfma_f32_16x16x32_bf16 v[12:15], a[196:199], a[20:23], v[12:15]
buffer_load_dwordx4 a[4:7], v134, s[16:19], s40 offen offset:256
v_mfma_f32_16x16x32_bf16 v[72:75], a[196:199], a[24:27], v[72:75]
ds_read_b64_tr_b16 a[222:223], v143 offset:9216
v_mfma_f32_16x16x32_bf16 v[76:79], a[196:199], a[28:31], v[76:79]
s_waitcnt lgkmcnt(8)
s_barrier
v_mfma_f32_16x16x32_bf16 v[16:19], a[200:203], a[16:19], v[16:19]
ds_read_b64_tr_b16 a[192:193], v136 offset:16384
v_mfma_f32_16x16x32_bf16 v[20:23], a[200:203], a[20:23], v[20:23]
buffer_load_dwordx4 a[8:11], v134, s[16:19], s41 offen offset:0
v_mfma_f32_16x16x32_bf16 v[80:83], a[200:203], a[24:27], v[80:83]
ds_read_b64_tr_b16 a[194:195], v136 offset:17408
v_mfma_f32_16x16x32_bf16 v[84:87], a[200:203], a[28:31], v[84:87]
v_mfma_f32_16x16x32_bf16 v[24:27], a[204:207], a[16:19], v[24:27]
ds_read_b64_tr_b16 a[196:197], v137 offset:16384
v_mfma_f32_16x16x32_bf16 v[28:31], a[204:207], a[20:23], v[28:31]
buffer_load_dwordx4 a[12:15], v134, s[16:19], s41 offen offset:256
v_mfma_f32_16x16x32_bf16 v[88:91], a[204:207], a[24:27], v[88:91]
ds_read_b64_tr_b16 a[198:199], v137 offset:17408
v_mfma_f32_16x16x32_bf16 v[92:95], a[204:207], a[28:31], v[92:95]
s_waitcnt lgkmcnt(8)
s_add_u32 m0, s43, 16384
v_mfma_f32_16x16x32_bf16 v[32:35], a[208:211], a[16:19], v[32:35]
ds_read_b64_tr_b16 a[200:201], v138 offset:16384
v_mfma_f32_16x16x32_bf16 v[36:39], a[208:211], a[20:23], v[36:39]
buffer_load_dwordx4 v130, s[12:15], s42 offen offset:0 lds
v_mfma_f32_16x16x32_bf16 v[96:99], a[208:211], a[24:27], v[96:99]
ds_read_b64_tr_b16 a[202:203], v138 offset:17408
v_mfma_f32_16x16x32_bf16 v[100:103], a[208:211], a[28:31], v[100:103]
v_mfma_f32_16x16x32_bf16 v[40:43], a[212:215], a[16:19], v[40:43]
ds_read_b64_tr_b16 a[204:205], v139 offset:16384
v_mfma_f32_16x16x32_bf16 v[44:47], a[212:215], a[20:23], v[44:47]
buffer_load_dwordx4 v131, s[12:15], s42 offen offset:1024 lds
v_mfma_f32_16x16x32_bf16 v[104:107], a[212:215], a[24:27], v[104:107]
ds_read_b64_tr_b16 a[206:207], v139 offset:17408
v_mfma_f32_16x16x32_bf16 v[108:111], a[212:215], a[28:31], v[108:111]
s_waitcnt lgkmcnt(8)
s_xor_b32 s43, s43, 0x8000
v_mfma_f32_16x16x32_bf16 v[48:51], a[216:219], a[16:19], v[48:51]
ds_read_b64_tr_b16 a[208:209], v140 offset:16384
v_mfma_f32_16x16x32_bf16 v[52:55], a[216:219], a[20:23], v[52:55]
buffer_load_dwordx4 v132, s[12:15], s42 offen offset:2048 lds
v_mfma_f32_16x16x32_bf16 v[112:115], a[216:219], a[24:27], v[112:115]
ds_read_b64_tr_b16 a[210:211], v140 offset:17408
v_mfma_f32_16x16x32_bf16 v[116:119], a[216:219], a[28:31], v[116:119]
v_mfma_f32_16x16x32_bf16 v[56:59], a[220:223], a[16:19], v[56:59]
ds_read_b64_tr_b16 a[212:213], v141 offset:16384
v_mfma_f32_16x16x32_bf16 v[60:63], a[220:223], a[20:23], v[60:63]
buffer_load_dwordx4 v133, s[12:15], s42 offen offset:3072 lds
v_mfma_f32_16x16x32_bf16 v[120:123], a[220:223], a[24:27], v[120:123]
ds_read_b64_tr_b16 a[214:215], v141 offset:17408
v_mfma_f32_16x16x32_bf16 v[124:127], a[220:223], a[28:31], v[124:127]
s_waitcnt vmcnt(16) lgkmcnt(8)
s_add_u32 s42, s42, 131072
v_mfma_f32_16x16x32_bf16 v[0:3], a[192:195], a[32:35], v[0:3]
ds_read_b64_tr_b16 a[216:217], v142 offset:16384
v_mfma_f32_16x16x32_bf16 v[4:7], a[192:195], a[36:39], v[4:7]
buffer_load_dwordx4 a[16:19], v134, s[16:19], s40 offen offset:2048
v_mfma_f32_16x16x32_bf16 v[64:67], a[192:195], a[40:43], v[64:67]
ds_read_b64_tr_b16 a[218:219], v142 offset:17408
v_mfma_f32_16x16x32_bf16 v[68:71], a[192:195], a[44:47], v[68:71]
v_mfma_f32_16x16x32_bf16 v[8:11], a[196:199], a[32:35], v[8:11]
ds_read_b64_tr_b16 a[220:221], v143 offset:16384
v_mfma_f32_16x16x32_bf16 v[12:15], a[196:199], a[36:39], v[12:15]
buffer_load_dwordx4 a[20:23], v134, s[16:19], s40 offen offset:2304
v_mfma_f32_16x16x32_bf16 v[72:75], a[196:199], a[40:43], v[72:75]
ds_read_b64_tr_b16 a[222:223], v143 offset:17408
v_mfma_f32_16x16x32_bf16 v[76:79], a[196:199], a[44:47], v[76:79]
s_waitcnt lgkmcnt(8)
s_add_u32 s40, s40, 4096
v_mfma_f32_16x16x32_bf16 v[16:19], a[200:203], a[32:35], v[16:19]
ds_read_b64_tr_b16 a[192:193], v136 offset:24576
v_mfma_f32_16x16x32_bf16 v[20:23], a[200:203], a[36:39], v[20:23]
buffer_load_dwordx4 a[24:27], v134, s[16:19], s41 offen offset:2048
v_mfma_f32_16x16x32_bf16 v[80:83], a[200:203], a[40:43], v[80:83]
ds_read_b64_tr_b16 a[194:195], v136 offset:25600
v_mfma_f32_16x16x32_bf16 v[84:87], a[200:203], a[44:47], v[84:87]
v_xor_b32 v136, 0x8000, v136
v_mfma_f32_16x16x32_bf16 v[24:27], a[204:207], a[32:35], v[24:27]
ds_read_b64_tr_b16 a[196:197], v137 offset:24576
v_mfma_f32_16x16x32_bf16 v[28:31], a[204:207], a[36:39], v[28:31]
buffer_load_dwordx4 a[28:31], v134, s[16:19], s41 offen offset:2304
v_mfma_f32_16x16x32_bf16 v[88:91], a[204:207], a[40:43], v[88:91]
ds_read_b64_tr_b16 a[198:199], v137 offset:25600
v_mfma_f32_16x16x32_bf16 v[92:95], a[204:207], a[44:47], v[92:95]
s_waitcnt lgkmcnt(8)
v_xor_b32 v137, 0x8000, v137
s_add_u32 s41, s41, 4096
v_mfma_f32_16x16x32_bf16 v[32:35], a[208:211], a[32:35], v[32:35]
ds_read_b64_tr_b16 a[200:201], v138 offset:24576
v_mfma_f32_16x16x32_bf16 v[36:39], a[208:211], a[36:39], v[36:39]
v_mfma_f32_16x16x32_bf16 v[96:99], a[208:211], a[40:43], v[96:99]
ds_read_b64_tr_b16 a[202:203], v138 offset:25600
v_mfma_f32_16x16x32_bf16 v[100:103], a[208:211], a[44:47], v[100:103]
v_xor_b32 v138, 0x8000, v138
v_mfma_f32_16x16x32_bf16 v[40:43], a[212:215], a[32:35], v[40:43]
ds_read_b64_tr_b16 a[204:205], v139 offset:24576
v_mfma_f32_16x16x32_bf16 v[44:47], a[212:215], a[36:39], v[44:47]
v_mfma_f32_16x16x32_bf16 v[104:107], a[212:215], a[40:43], v[104:107]
ds_read_b64_tr_b16 a[206:207], v139 offset:25600
v_mfma_f32_16x16x32_bf16 v[108:111], a[212:215], a[44:47], v[108:111]
s_waitcnt lgkmcnt(8)
v_xor_b32 v139, 0x8000, v139
v_mfma_f32_16x16x32_bf16 v[48:51], a[216:219], a[32:35], v[48:51]
ds_read_b64_tr_b16 a[208:209], v140 offset:24576
v_mfma_f32_16x16x32_bf16 v[52:55], a[216:219], a[36:39], v[52:55]
v_mfma_f32_16x16x32_bf16 v[112:115], a[216:219], a[40:43], v[112:115]
ds_read_b64_tr_b16 a[210:211], v140 offset:25600
v_mfma_f32_16x16x32_bf16 v[116:119], a[216:219], a[44:47], v[116:119]
v_xor_b32 v140, 0x8000, v140
v_mfma_f32_16x16x32_bf16 v[56:59], a[220:223], a[32:35], v[56:59]
ds_read_b64_tr_b16 a[212:213], v141 offset:24576
v_mfma_f32_16x16x32_bf16 v[60:63], a[220:223], a[36:39], v[60:63]
v_mfma_f32_16x16x32_bf16 v[120:123], a[220:223], a[40:43], v[120:123]
ds_read_b64_tr_b16 a[214:215], v141 offset:25600
v_mfma_f32_16x16x32_bf16 v[124:127], a[220:223], a[44:47], v[124:127]
s_waitcnt vmcnt(16) lgkmcnt(8)
v_xor_b32 v141, 0x8000, v141
v_mfma_f32_16x16x32_bf16 v[0:3], a[192:195], a[48:51], v[0:3]
ds_read_b64_tr_b16 a[216:217], v142 offset:24576
v_mfma_f32_16x16x32_bf16 v[4:7], a[192:195], a[52:55], v[4:7]
buffer_load_dwordx4 a[32:35], v134, s[16:19], s40 offen offset:0
v_mfma_f32_16x16x32_bf16 v[64:67], a[192:195], a[56:59], v[64:67]
ds_read_b64_tr_b16 a[218:219], v142 offset:25600
v_mfma_f32_16x16x32_bf16 v[68:71], a[192:195], a[60:63], v[68:71]
v_xor_b32 v142, 0x8000, v142
v_mfma_f32_16x16x32_bf16 v[8:11], a[196:199], a[48:51], v[8:11]
ds_read_b64_tr_b16 a[220:221], v143 offset:24576
v_mfma_f32_16x16x32_bf16 v[12:15], a[196:199], a[52:55], v[12:15]
buffer_load_dwordx4 a[36:39], v134, s[16:19], s40 offen offset:256
v_mfma_f32_16x16x32_bf16 v[72:75], a[196:199], a[56:59], v[72:75]
ds_read_b64_tr_b16 a[222:223], v143 offset:25600
v_mfma_f32_16x16x32_bf16 v[76:79], a[196:199], a[60:63], v[76:79]
s_waitcnt lgkmcnt(8)
s_waitcnt vmcnt(14)
s_barrier
v_xor_b32 v143, 0x8000, v143
v_mfma_f32_16x16x32_bf16 v[16:19], a[200:203], a[48:51], v[16:19]
ds_read_b64_tr_b16 a[192:193], v136 offset:0
v_mfma_f32_16x16x32_bf16 v[20:23], a[200:203], a[52:55], v[20:23]
buffer_load_dwordx4 a[40:43], v134, s[16:19], s41 offen offset:0
v_mfma_f32_16x16x32_bf16 v[80:83], a[200:203], a[56:59], v[80:83]
ds_read_b64_tr_b16 a[194:195], v136 offset:1024
v_mfma_f32_16x16x32_bf16 v[84:87], a[200:203], a[60:63], v[84:87]
v_mfma_f32_16x16x32_bf16 v[24:27], a[204:207], a[48:51], v[24:27]
ds_read_b64_tr_b16 a[196:197], v137 offset:0
v_mfma_f32_16x16x32_bf16 v[28:31], a[204:207], a[52:55], v[28:31]
buffer_load_dwordx4 a[44:47], v134, s[16:19], s41 offen offset:256
v_mfma_f32_16x16x32_bf16 v[88:91], a[204:207], a[56:59], v[88:91]
ds_read_b64_tr_b16 a[198:199], v137 offset:1024
v_mfma_f32_16x16x32_bf16 v[92:95], a[204:207], a[60:63], v[92:95]
s_waitcnt lgkmcnt(8)
s_add_u32 m0, s43, 0
v_mfma_f32_16x16x32_bf16 v[32:35], a[208:211], a[48:51], v[32:35]
ds_read_b64_tr_b16 a[200:201], v138 offset:0
v_mfma_f32_16x16x32_bf16 v[36:39], a[208:211], a[52:55], v[36:39]
buffer_load_dwordx4 v130, s[12:15], s42 offen offset:0 lds
v_mfma_f32_16x16x32_bf16 v[96:99], a[208:211], a[56:59], v[96:99]
ds_read_b64_tr_b16 a[202:203], v138 offset:1024
v_mfma_f32_16x16x32_bf16 v[100:103], a[208:211], a[60:63], v[100:103]
v_mfma_f32_16x16x32_bf16 v[40:43], a[212:215], a[48:51], v[40:43]
ds_read_b64_tr_b16 a[204:205], v139 offset:0
v_mfma_f32_16x16x32_bf16 v[44:47], a[212:215], a[52:55], v[44:47]
buffer_load_dwordx4 v131, s[12:15], s42 offen offset:1024 lds
v_mfma_f32_16x16x32_bf16 v[104:107], a[212:215], a[56:59], v[104:107]
ds_read_b64_tr_b16 a[206:207], v139 offset:1024
v_mfma_f32_16x16x32_bf16 v[108:111], a[212:215], a[60:63], v[108:111]
s_waitcnt lgkmcnt(8)
v_mfma_f32_16x16x32_bf16 v[48:51], a[216:219], a[48:51], v[48:51]
ds_read_b64_tr_b16 a[208:209], v140 offset:0
v_mfma_f32_16x16x32_bf16 v[52:55], a[216:219], a[52:55], v[52:55]
buffer_load_dwordx4 v132, s[12:15], s42 offen offset:2048 lds
v_mfma_f32_16x16x32_bf16 v[112:115], a[216:219], a[56:59], v[112:115]
ds_read_b64_tr_b16 a[210:211], v140 offset:1024
v_mfma_f32_16x16x32_bf16 v[116:119], a[216:219], a[60:63], v[116:119]
v_mfma_f32_16x16x32_bf16 v[56:59], a[220:223], a[48:51], v[56:59]
ds_read_b64_tr_b16 a[212:213], v141 offset:0
v_mfma_f32_16x16x32_bf16 v[60:63], a[220:223], a[52:55], v[60:63]
buffer_load_dwordx4 v133, s[12:15], s42 offen offset:3072 lds
v_mfma_f32_16x16x32_bf16 v[120:123], a[220:223], a[56:59], v[120:123]
ds_read_b64_tr_b16 a[214:215], v141 offset:1024
v_mfma_f32_16x16x32_bf16 v[124:127], a[220:223], a[60:63], v[124:127]
s_waitcnt vmcnt(16) lgkmcnt(8)
s_add_u32 s42, s42, 131072
s_mov_b32 s46, 5
.p2align 6
L_oproj_loop:
v_mfma_f32_16x16x32_bf16 v[0:3], a[192:195], a[0:3], v[0:3]
ds_read_b64_tr_b16 a[216:217], v142 offset:0
v_mfma_f32_16x16x32_bf16 v[4:7], a[192:195], a[4:7], v[4:7]
buffer_load_dwordx4 a[48:51], v134, s[16:19], s40 offen offset:2048
v_mfma_f32_16x16x32_bf16 v[64:67], a[192:195], a[8:11], v[64:67]
ds_read_b64_tr_b16 a[218:219], v142 offset:1024
v_mfma_f32_16x16x32_bf16 v[68:71], a[192:195], a[12:15], v[68:71]
v_mfma_f32_16x16x32_bf16 v[8:11], a[196:199], a[0:3], v[8:11]
ds_read_b64_tr_b16 a[220:221], v143 offset:0
v_mfma_f32_16x16x32_bf16 v[12:15], a[196:199], a[4:7], v[12:15]
buffer_load_dwordx4 a[52:55], v134, s[16:19], s40 offen offset:2304
v_mfma_f32_16x16x32_bf16 v[72:75], a[196:199], a[8:11], v[72:75]
ds_read_b64_tr_b16 a[222:223], v143 offset:1024
v_mfma_f32_16x16x32_bf16 v[76:79], a[196:199], a[12:15], v[76:79]
s_waitcnt lgkmcnt(8)
s_add_u32 s40, s40, 4096
v_mfma_f32_16x16x32_bf16 v[16:19], a[200:203], a[0:3], v[16:19]
ds_read_b64_tr_b16 a[192:193], v136 offset:8192
v_mfma_f32_16x16x32_bf16 v[20:23], a[200:203], a[4:7], v[20:23]
buffer_load_dwordx4 a[56:59], v134, s[16:19], s41 offen offset:2048
v_mfma_f32_16x16x32_bf16 v[80:83], a[200:203], a[8:11], v[80:83]
ds_read_b64_tr_b16 a[194:195], v136 offset:9216
v_mfma_f32_16x16x32_bf16 v[84:87], a[200:203], a[12:15], v[84:87]
v_mfma_f32_16x16x32_bf16 v[24:27], a[204:207], a[0:3], v[24:27]
ds_read_b64_tr_b16 a[196:197], v137 offset:8192
v_mfma_f32_16x16x32_bf16 v[28:31], a[204:207], a[4:7], v[28:31]
buffer_load_dwordx4 a[60:63], v134, s[16:19], s41 offen offset:2304
v_mfma_f32_16x16x32_bf16 v[88:91], a[204:207], a[8:11], v[88:91]
ds_read_b64_tr_b16 a[198:199], v137 offset:9216
v_mfma_f32_16x16x32_bf16 v[92:95], a[204:207], a[12:15], v[92:95]
s_waitcnt lgkmcnt(8)
s_add_u32 s41, s41, 4096
v_mfma_f32_16x16x32_bf16 v[32:35], a[208:211], a[0:3], v[32:35]
ds_read_b64_tr_b16 a[200:201], v138 offset:8192
v_mfma_f32_16x16x32_bf16 v[36:39], a[208:211], a[4:7], v[36:39]
v_mfma_f32_16x16x32_bf16 v[96:99], a[208:211], a[8:11], v[96:99]
ds_read_b64_tr_b16 a[202:203], v138 offset:9216
v_mfma_f32_16x16x32_bf16 v[100:103], a[208:211], a[12:15], v[100:103]
v_mfma_f32_16x16x32_bf16 v[40:43], a[212:215], a[0:3], v[40:43]
ds_read_b64_tr_b16 a[204:205], v139 offset:8192
v_mfma_f32_16x16x32_bf16 v[44:47], a[212:215], a[4:7], v[44:47]
v_mfma_f32_16x16x32_bf16 v[104:107], a[212:215], a[8:11], v[104:107]
ds_read_b64_tr_b16 a[206:207], v139 offset:9216
v_mfma_f32_16x16x32_bf16 v[108:111], a[212:215], a[12:15], v[108:111]
s_waitcnt lgkmcnt(8)
v_mfma_f32_16x16x32_bf16 v[48:51], a[216:219], a[0:3], v[48:51]
ds_read_b64_tr_b16 a[208:209], v140 offset:8192
v_mfma_f32_16x16x32_bf16 v[52:55], a[216:219], a[4:7], v[52:55]
v_mfma_f32_16x16x32_bf16 v[112:115], a[216:219], a[8:11], v[112:115]
ds_read_b64_tr_b16 a[210:211], v140 offset:9216
v_mfma_f32_16x16x32_bf16 v[116:119], a[216:219], a[12:15], v[116:119]
v_mfma_f32_16x16x32_bf16 v[56:59], a[220:223], a[0:3], v[56:59]
ds_read_b64_tr_b16 a[212:213], v141 offset:8192
v_mfma_f32_16x16x32_bf16 v[60:63], a[220:223], a[4:7], v[60:63]
v_mfma_f32_16x16x32_bf16 v[120:123], a[220:223], a[8:11], v[120:123]
ds_read_b64_tr_b16 a[214:215], v141 offset:9216
v_mfma_f32_16x16x32_bf16 v[124:127], a[220:223], a[12:15], v[124:127]
s_waitcnt vmcnt(12) lgkmcnt(8)
v_mfma_f32_16x16x32_bf16 v[0:3], a[192:195], a[16:19], v[0:3]
ds_read_b64_tr_b16 a[216:217], v142 offset:8192
v_mfma_f32_16x16x32_bf16 v[4:7], a[192:195], a[20:23], v[4:7]
buffer_load_dwordx4 a[0:3], v134, s[16:19], s40 offen offset:0
v_mfma_f32_16x16x32_bf16 v[64:67], a[192:195], a[24:27], v[64:67]
ds_read_b64_tr_b16 a[218:219], v142 offset:9216
v_mfma_f32_16x16x32_bf16 v[68:71], a[192:195], a[28:31], v[68:71]
v_mfma_f32_16x16x32_bf16 v[8:11], a[196:199], a[16:19], v[8:11]
ds_read_b64_tr_b16 a[220:221], v143 offset:8192
v_mfma_f32_16x16x32_bf16 v[12:15], a[196:199], a[20:23], v[12:15]
buffer_load_dwordx4 a[4:7], v134, s[16:19], s40 offen offset:256
v_mfma_f32_16x16x32_bf16 v[72:75], a[196:199], a[24:27], v[72:75]
ds_read_b64_tr_b16 a[222:223], v143 offset:9216
v_mfma_f32_16x16x32_bf16 v[76:79], a[196:199], a[28:31], v[76:79]
s_waitcnt lgkmcnt(8)
s_barrier
v_mfma_f32_16x16x32_bf16 v[16:19], a[200:203], a[16:19], v[16:19]
ds_read_b64_tr_b16 a[192:193], v136 offset:16384
v_mfma_f32_16x16x32_bf16 v[20:23], a[200:203], a[20:23], v[20:23]
buffer_load_dwordx4 a[8:11], v134, s[16:19], s41 offen offset:0
v_mfma_f32_16x16x32_bf16 v[80:83], a[200:203], a[24:27], v[80:83]
ds_read_b64_tr_b16 a[194:195], v136 offset:17408
v_mfma_f32_16x16x32_bf16 v[84:87], a[200:203], a[28:31], v[84:87]
v_mfma_f32_16x16x32_bf16 v[24:27], a[204:207], a[16:19], v[24:27]
ds_read_b64_tr_b16 a[196:197], v137 offset:16384
v_mfma_f32_16x16x32_bf16 v[28:31], a[204:207], a[20:23], v[28:31]
buffer_load_dwordx4 a[12:15], v134, s[16:19], s41 offen offset:256
v_mfma_f32_16x16x32_bf16 v[88:91], a[204:207], a[24:27], v[88:91]
ds_read_b64_tr_b16 a[198:199], v137 offset:17408
v_mfma_f32_16x16x32_bf16 v[92:95], a[204:207], a[28:31], v[92:95]
s_waitcnt lgkmcnt(8)
s_add_u32 m0, s43, 16384
v_mfma_f32_16x16x32_bf16 v[32:35], a[208:211], a[16:19], v[32:35]
ds_read_b64_tr_b16 a[200:201], v138 offset:16384
v_mfma_f32_16x16x32_bf16 v[36:39], a[208:211], a[20:23], v[36:39]
buffer_load_dwordx4 v130, s[12:15], s42 offen offset:0 lds
v_mfma_f32_16x16x32_bf16 v[96:99], a[208:211], a[24:27], v[96:99]
ds_read_b64_tr_b16 a[202:203], v138 offset:17408
v_mfma_f32_16x16x32_bf16 v[100:103], a[208:211], a[28:31], v[100:103]
v_mfma_f32_16x16x32_bf16 v[40:43], a[212:215], a[16:19], v[40:43]
ds_read_b64_tr_b16 a[204:205], v139 offset:16384
v_mfma_f32_16x16x32_bf16 v[44:47], a[212:215], a[20:23], v[44:47]
buffer_load_dwordx4 v131, s[12:15], s42 offen offset:1024 lds
v_mfma_f32_16x16x32_bf16 v[104:107], a[212:215], a[24:27], v[104:107]
ds_read_b64_tr_b16 a[206:207], v139 offset:17408
v_mfma_f32_16x16x32_bf16 v[108:111], a[212:215], a[28:31], v[108:111]
s_waitcnt lgkmcnt(8)
s_xor_b32 s43, s43, 0x8000
v_mfma_f32_16x16x32_bf16 v[48:51], a[216:219], a[16:19], v[48:51]
ds_read_b64_tr_b16 a[208:209], v140 offset:16384
v_mfma_f32_16x16x32_bf16 v[52:55], a[216:219], a[20:23], v[52:55]
buffer_load_dwordx4 v132, s[12:15], s42 offen offset:2048 lds
v_mfma_f32_16x16x32_bf16 v[112:115], a[216:219], a[24:27], v[112:115]
ds_read_b64_tr_b16 a[210:211], v140 offset:17408
v_mfma_f32_16x16x32_bf16 v[116:119], a[216:219], a[28:31], v[116:119]
v_mfma_f32_16x16x32_bf16 v[56:59], a[220:223], a[16:19], v[56:59]
ds_read_b64_tr_b16 a[212:213], v141 offset:16384
v_mfma_f32_16x16x32_bf16 v[60:63], a[220:223], a[20:23], v[60:63]
buffer_load_dwordx4 v133, s[12:15], s42 offen offset:3072 lds
v_mfma_f32_16x16x32_bf16 v[120:123], a[220:223], a[24:27], v[120:123]
ds_read_b64_tr_b16 a[214:215], v141 offset:17408
v_mfma_f32_16x16x32_bf16 v[124:127], a[220:223], a[28:31], v[124:127]
s_waitcnt vmcnt(16) lgkmcnt(8)
s_add_u32 s42, s42, 131072
v_mfma_f32_16x16x32_bf16 v[0:3], a[192:195], a[32:35], v[0:3]
ds_read_b64_tr_b16 a[216:217], v142 offset:16384
v_mfma_f32_16x16x32_bf16 v[4:7], a[192:195], a[36:39], v[4:7]
buffer_load_dwordx4 a[16:19], v134, s[16:19], s40 offen offset:2048
v_mfma_f32_16x16x32_bf16 v[64:67], a[192:195], a[40:43], v[64:67]
ds_read_b64_tr_b16 a[218:219], v142 offset:17408
v_mfma_f32_16x16x32_bf16 v[68:71], a[192:195], a[44:47], v[68:71]
v_mfma_f32_16x16x32_bf16 v[8:11], a[196:199], a[32:35], v[8:11]
ds_read_b64_tr_b16 a[220:221], v143 offset:16384
v_mfma_f32_16x16x32_bf16 v[12:15], a[196:199], a[36:39], v[12:15]
buffer_load_dwordx4 a[20:23], v134, s[16:19], s40 offen offset:2304
v_mfma_f32_16x16x32_bf16 v[72:75], a[196:199], a[40:43], v[72:75]
ds_read_b64_tr_b16 a[222:223], v143 offset:17408
v_mfma_f32_16x16x32_bf16 v[76:79], a[196:199], a[44:47], v[76:79]
s_waitcnt lgkmcnt(8)
s_add_u32 s40, s40, 4096
v_mfma_f32_16x16x32_bf16 v[16:19], a[200:203], a[32:35], v[16:19]
ds_read_b64_tr_b16 a[192:193], v136 offset:24576
v_mfma_f32_16x16x32_bf16 v[20:23], a[200:203], a[36:39], v[20:23]
buffer_load_dwordx4 a[24:27], v134, s[16:19], s41 offen offset:2048
v_mfma_f32_16x16x32_bf16 v[80:83], a[200:203], a[40:43], v[80:83]
ds_read_b64_tr_b16 a[194:195], v136 offset:25600
v_mfma_f32_16x16x32_bf16 v[84:87], a[200:203], a[44:47], v[84:87]
v_xor_b32 v136, 0x8000, v136
v_mfma_f32_16x16x32_bf16 v[24:27], a[204:207], a[32:35], v[24:27]
ds_read_b64_tr_b16 a[196:197], v137 offset:24576
v_mfma_f32_16x16x32_bf16 v[28:31], a[204:207], a[36:39], v[28:31]
buffer_load_dwordx4 a[28:31], v134, s[16:19], s41 offen offset:2304
v_mfma_f32_16x16x32_bf16 v[88:91], a[204:207], a[40:43], v[88:91]
ds_read_b64_tr_b16 a[198:199], v137 offset:25600
v_mfma_f32_16x16x32_bf16 v[92:95], a[204:207], a[44:47], v[92:95]
s_waitcnt lgkmcnt(8)
v_xor_b32 v137, 0x8000, v137
s_add_u32 s41, s41, 4096
v_mfma_f32_16x16x32_bf16 v[32:35], a[208:211], a[32:35], v[32:35]
ds_read_b64_tr_b16 a[200:201], v138 offset:24576
v_mfma_f32_16x16x32_bf16 v[36:39], a[208:211], a[36:39], v[36:39]
v_mfma_f32_16x16x32_bf16 v[96:99], a[208:211], a[40:43], v[96:99]
ds_read_b64_tr_b16 a[202:203], v138 offset:25600
v_mfma_f32_16x16x32_bf16 v[100:103], a[208:211], a[44:47], v[100:103]
v_xor_b32 v138, 0x8000, v138
v_mfma_f32_16x16x32_bf16 v[40:43], a[212:215], a[32:35], v[40:43]
ds_read_b64_tr_b16 a[204:205], v139 offset:24576
v_mfma_f32_16x16x32_bf16 v[44:47], a[212:215], a[36:39], v[44:47]
v_mfma_f32_16x16x32_bf16 v[104:107], a[212:215], a[40:43], v[104:107]
ds_read_b64_tr_b16 a[206:207], v139 offset:25600
v_mfma_f32_16x16x32_bf16 v[108:111], a[212:215], a[44:47], v[108:111]
s_waitcnt lgkmcnt(8)
v_xor_b32 v139, 0x8000, v139
v_mfma_f32_16x16x32_bf16 v[48:51], a[216:219], a[32:35], v[48:51]
ds_read_b64_tr_b16 a[208:209], v140 offset:24576
v_mfma_f32_16x16x32_bf16 v[52:55], a[216:219], a[36:39], v[52:55]
v_mfma_f32_16x16x32_bf16 v[112:115], a[216:219], a[40:43], v[112:115]
ds_read_b64_tr_b16 a[210:211], v140 offset:25600
v_mfma_f32_16x16x32_bf16 v[116:119], a[216:219], a[44:47], v[116:119]
v_xor_b32 v140, 0x8000, v140
v_mfma_f32_16x16x32_bf16 v[56:59], a[220:223], a[32:35], v[56:59]
ds_read_b64_tr_b16 a[212:213], v141 offset:24576
v_mfma_f32_16x16x32_bf16 v[60:63], a[220:223], a[36:39], v[60:63]
v_mfma_f32_16x16x32_bf16 v[120:123], a[220:223], a[40:43], v[120:123]
ds_read_b64_tr_b16 a[214:215], v141 offset:25600
v_mfma_f32_16x16x32_bf16 v[124:127], a[220:223], a[44:47], v[124:127]
s_waitcnt vmcnt(12) lgkmcnt(8)
v_xor_b32 v141, 0x8000, v141
v_mfma_f32_16x16x32_bf16 v[0:3], a[192:195], a[48:51], v[0:3]
ds_read_b64_tr_b16 a[216:217], v142 offset:24576
v_mfma_f32_16x16x32_bf16 v[4:7], a[192:195], a[52:55], v[4:7]
buffer_load_dwordx4 a[32:35], v134, s[16:19], s40 offen offset:0
v_mfma_f32_16x16x32_bf16 v[64:67], a[192:195], a[56:59], v[64:67]
ds_read_b64_tr_b16 a[218:219], v142 offset:25600
v_mfma_f32_16x16x32_bf16 v[68:71], a[192:195], a[60:63], v[68:71]
v_xor_b32 v142, 0x8000, v142
v_mfma_f32_16x16x32_bf16 v[8:11], a[196:199], a[48:51], v[8:11]
ds_read_b64_tr_b16 a[220:221], v143 offset:24576
v_mfma_f32_16x16x32_bf16 v[12:15], a[196:199], a[52:55], v[12:15]
buffer_load_dwordx4 a[36:39], v134, s[16:19], s40 offen offset:256
v_mfma_f32_16x16x32_bf16 v[72:75], a[196:199], a[56:59], v[72:75]
ds_read_b64_tr_b16 a[222:223], v143 offset:25600
v_mfma_f32_16x16x32_bf16 v[76:79], a[196:199], a[60:63], v[76:79]
s_waitcnt lgkmcnt(8)
s_barrier
v_xor_b32 v143, 0x8000, v143
v_mfma_f32_16x16x32_bf16 v[16:19], a[200:203], a[48:51], v[16:19]
ds_read_b64_tr_b16 a[192:193], v136 offset:0
v_mfma_f32_16x16x32_bf16 v[20:23], a[200:203], a[52:55], v[20:23]
buffer_load_dwordx4 a[40:43], v134, s[16:19], s41 offen offset:0
v_mfma_f32_16x16x32_bf16 v[80:83], a[200:203], a[56:59], v[80:83]
ds_read_b64_tr_b16 a[194:195], v136 offset:1024
v_mfma_f32_16x16x32_bf16 v[84:87], a[200:203], a[60:63], v[84:87]
v_mfma_f32_16x16x32_bf16 v[24:27], a[204:207], a[48:51], v[24:27]
ds_read_b64_tr_b16 a[196:197], v137 offset:0
v_mfma_f32_16x16x32_bf16 v[28:31], a[204:207], a[52:55], v[28:31]
buffer_load_dwordx4 a[44:47], v134, s[16:19], s41 offen offset:256
v_mfma_f32_16x16x32_bf16 v[88:91], a[204:207], a[56:59], v[88:91]
ds_read_b64_tr_b16 a[198:199], v137 offset:1024
v_mfma_f32_16x16x32_bf16 v[92:95], a[204:207], a[60:63], v[92:95]
s_waitcnt lgkmcnt(8)
s_add_u32 m0, s43, 0
v_mfma_f32_16x16x32_bf16 v[32:35], a[208:211], a[48:51], v[32:35]
ds_read_b64_tr_b16 a[200:201], v138 offset:0
v_mfma_f32_16x16x32_bf16 v[36:39], a[208:211], a[52:55], v[36:39]
buffer_load_dwordx4 v130, s[12:15], s42 offen offset:0 lds
v_mfma_f32_16x16x32_bf16 v[96:99], a[208:211], a[56:59], v[96:99]
ds_read_b64_tr_b16 a[202:203], v138 offset:1024
v_mfma_f32_16x16x32_bf16 v[100:103], a[208:211], a[60:63], v[100:103]
v_mfma_f32_16x16x32_bf16 v[40:43], a[212:215], a[48:51], v[40:43]
ds_read_b64_tr_b16 a[204:205], v139 offset:0
v_mfma_f32_16x16x32_bf16 v[44:47], a[212:215], a[52:55], v[44:47]
buffer_load_dwordx4 v131, s[12:15], s42 offen offset:1024 lds
v_mfma_f32_16x16x32_bf16 v[104:107], a[212:215], a[56:59], v[104:107]
ds_read_b64_tr_b16 a[206:207], v139 offset:1024
v_mfma_f32_16x16x32_bf16 v[108:111], a[212:215], a[60:63], v[108:111]
s_waitcnt lgkmcnt(8)
v_mfma_f32_16x16x32_bf16 v[48:51], a[216:219], a[48:51], v[48:51]
ds_read_b64_tr_b16 a[208:209], v140 offset:0
v_mfma_f32_16x16x32_bf16 v[52:55], a[216:219], a[52:55], v[52:55]
buffer_load_dwordx4 v132, s[12:15], s42 offen offset:2048 lds
v_mfma_f32_16x16x32_bf16 v[112:115], a[216:219], a[56:59], v[112:115]
ds_read_b64_tr_b16 a[210:211], v140 offset:1024
v_mfma_f32_16x16x32_bf16 v[116:119], a[216:219], a[60:63], v[116:119]
v_mfma_f32_16x16x32_bf16 v[56:59], a[220:223], a[48:51], v[56:59]
ds_read_b64_tr_b16 a[212:213], v141 offset:0
v_mfma_f32_16x16x32_bf16 v[60:63], a[220:223], a[52:55], v[60:63]
buffer_load_dwordx4 v133, s[12:15], s42 offen offset:3072 lds
v_mfma_f32_16x16x32_bf16 v[120:123], a[220:223], a[56:59], v[120:123]
ds_read_b64_tr_b16 a[214:215], v141 offset:1024
v_mfma_f32_16x16x32_bf16 v[124:127], a[220:223], a[60:63], v[124:127]
s_waitcnt vmcnt(16) lgkmcnt(8)
s_add_u32 s42, s42, 131072
s_sub_u32 s46, s46, 1
s_cmp_lg_u32 s46, 0
s_cbranch_scc1 L_oproj_loop
v_mfma_f32_16x16x32_bf16 v[0:3], a[192:195], a[0:3], v[0:3]
ds_read_b64_tr_b16 a[216:217], v142 offset:0
v_mfma_f32_16x16x32_bf16 v[4:7], a[192:195], a[4:7], v[4:7]
buffer_load_dwordx4 a[48:51], v134, s[16:19], s40 offen offset:2048
v_mfma_f32_16x16x32_bf16 v[64:67], a[192:195], a[8:11], v[64:67]
ds_read_b64_tr_b16 a[218:219], v142 offset:1024
v_mfma_f32_16x16x32_bf16 v[68:71], a[192:195], a[12:15], v[68:71]
v_mfma_f32_16x16x32_bf16 v[8:11], a[196:199], a[0:3], v[8:11]
ds_read_b64_tr_b16 a[220:221], v143 offset:0
v_mfma_f32_16x16x32_bf16 v[12:15], a[196:199], a[4:7], v[12:15]
buffer_load_dwordx4 a[52:55], v134, s[16:19], s40 offen offset:2304
v_mfma_f32_16x16x32_bf16 v[72:75], a[196:199], a[8:11], v[72:75]
ds_read_b64_tr_b16 a[222:223], v143 offset:1024
v_mfma_f32_16x16x32_bf16 v[76:79], a[196:199], a[12:15], v[76:79]
s_waitcnt lgkmcnt(8)
s_add_u32 s40, s40, 4096
v_mfma_f32_16x16x32_bf16 v[16:19], a[200:203], a[0:3], v[16:19]
ds_read_b64_tr_b16 a[192:193], v136 offset:8192
v_mfma_f32_16x16x32_bf16 v[20:23], a[200:203], a[4:7], v[20:23]
buffer_load_dwordx4 a[56:59], v134, s[16:19], s41 offen offset:2048
v_mfma_f32_16x16x32_bf16 v[80:83], a[200:203], a[8:11], v[80:83]
ds_read_b64_tr_b16 a[194:195], v136 offset:9216
v_mfma_f32_16x16x32_bf16 v[84:87], a[200:203], a[12:15], v[84:87]
v_mfma_f32_16x16x32_bf16 v[24:27], a[204:207], a[0:3], v[24:27]
ds_read_b64_tr_b16 a[196:197], v137 offset:8192
v_mfma_f32_16x16x32_bf16 v[28:31], a[204:207], a[4:7], v[28:31]
buffer_load_dwordx4 a[60:63], v134, s[16:19], s41 offen offset:2304
v_mfma_f32_16x16x32_bf16 v[88:91], a[204:207], a[8:11], v[88:91]
ds_read_b64_tr_b16 a[198:199], v137 offset:9216
v_mfma_f32_16x16x32_bf16 v[92:95], a[204:207], a[12:15], v[92:95]
s_waitcnt lgkmcnt(8)
s_add_u32 s41, s41, 4096
v_mfma_f32_16x16x32_bf16 v[32:35], a[208:211], a[0:3], v[32:35]
ds_read_b64_tr_b16 a[200:201], v138 offset:8192
v_mfma_f32_16x16x32_bf16 v[36:39], a[208:211], a[4:7], v[36:39]
buffer_load_dwordx4 a[64:67], v134, s[16:19], s60 offen offset:0
v_mfma_f32_16x16x32_bf16 v[96:99], a[208:211], a[8:11], v[96:99]
ds_read_b64_tr_b16 a[202:203], v138 offset:9216
v_mfma_f32_16x16x32_bf16 v[100:103], a[208:211], a[12:15], v[100:103]
v_mfma_f32_16x16x32_bf16 v[40:43], a[212:215], a[0:3], v[40:43]
ds_read_b64_tr_b16 a[204:205], v139 offset:8192
v_mfma_f32_16x16x32_bf16 v[44:47], a[212:215], a[4:7], v[44:47]
buffer_load_dwordx4 a[68:71], v134, s[16:19], s60 offen offset:256
v_mfma_f32_16x16x32_bf16 v[104:107], a[212:215], a[8:11], v[104:107]
ds_read_b64_tr_b16 a[206:207], v139 offset:9216
v_mfma_f32_16x16x32_bf16 v[108:111], a[212:215], a[12:15], v[108:111]
s_waitcnt lgkmcnt(8)
v_mfma_f32_16x16x32_bf16 v[48:51], a[216:219], a[0:3], v[48:51]
ds_read_b64_tr_b16 a[208:209], v140 offset:8192
v_mfma_f32_16x16x32_bf16 v[52:55], a[216:219], a[4:7], v[52:55]
buffer_load_dwordx4 a[72:75], v134, s[16:19], s61 offen offset:0
v_mfma_f32_16x16x32_bf16 v[112:115], a[216:219], a[8:11], v[112:115]
ds_read_b64_tr_b16 a[210:211], v140 offset:9216
v_mfma_f32_16x16x32_bf16 v[116:119], a[216:219], a[12:15], v[116:119]
v_mfma_f32_16x16x32_bf16 v[56:59], a[220:223], a[0:3], v[56:59]
ds_read_b64_tr_b16 a[212:213], v141 offset:8192
v_mfma_f32_16x16x32_bf16 v[60:63], a[220:223], a[4:7], v[60:63]
buffer_load_dwordx4 a[76:79], v134, s[16:19], s61 offen offset:256
v_mfma_f32_16x16x32_bf16 v[120:123], a[220:223], a[8:11], v[120:123]
ds_read_b64_tr_b16 a[214:215], v141 offset:9216
v_mfma_f32_16x16x32_bf16 v[124:127], a[220:223], a[12:15], v[124:127]
s_waitcnt vmcnt(16) lgkmcnt(8)
v_mfma_f32_16x16x32_bf16 v[0:3], a[192:195], a[16:19], v[0:3]
ds_read_b64_tr_b16 a[216:217], v142 offset:8192
v_mfma_f32_16x16x32_bf16 v[4:7], a[192:195], a[20:23], v[4:7]
buffer_load_dwordx4 a[80:83], v134, s[16:19], s60 offen offset:2048
v_mfma_f32_16x16x32_bf16 v[64:67], a[192:195], a[24:27], v[64:67]
ds_read_b64_tr_b16 a[218:219], v142 offset:9216
v_mfma_f32_16x16x32_bf16 v[68:71], a[192:195], a[28:31], v[68:71]
v_mfma_f32_16x16x32_bf16 v[8:11], a[196:199], a[16:19], v[8:11]
ds_read_b64_tr_b16 a[220:221], v143 offset:8192
v_mfma_f32_16x16x32_bf16 v[12:15], a[196:199], a[20:23], v[12:15]
buffer_load_dwordx4 a[84:87], v134, s[16:19], s60 offen offset:2304
v_mfma_f32_16x16x32_bf16 v[72:75], a[196:199], a[24:27], v[72:75]
ds_read_b64_tr_b16 a[222:223], v143 offset:9216
v_mfma_f32_16x16x32_bf16 v[76:79], a[196:199], a[28:31], v[76:79]
s_waitcnt lgkmcnt(8)
s_barrier
s_add_u32 s60, s60, 4096
v_mfma_f32_16x16x32_bf16 v[16:19], a[200:203], a[16:19], v[16:19]
ds_read_b64_tr_b16 a[192:193], v136 offset:16384
v_mfma_f32_16x16x32_bf16 v[20:23], a[200:203], a[20:23], v[20:23]
buffer_load_dwordx4 a[88:91], v134, s[16:19], s61 offen offset:2048
v_mfma_f32_16x16x32_bf16 v[80:83], a[200:203], a[24:27], v[80:83]
ds_read_b64_tr_b16 a[194:195], v136 offset:17408
v_mfma_f32_16x16x32_bf16 v[84:87], a[200:203], a[28:31], v[84:87]
s_add_u32 m0, s43, 16384
v_mfma_f32_16x16x32_bf16 v[24:27], a[204:207], a[16:19], v[24:27]
ds_read_b64_tr_b16 a[196:197], v137 offset:16384
v_mfma_f32_16x16x32_bf16 v[28:31], a[204:207], a[20:23], v[28:31]
buffer_load_dwordx4 v130, s[12:15], s42 offen offset:0 lds
v_mfma_f32_16x16x32_bf16 v[88:91], a[204:207], a[24:27], v[88:91]
ds_read_b64_tr_b16 a[198:199], v137 offset:17408
v_mfma_f32_16x16x32_bf16 v[92:95], a[204:207], a[28:31], v[92:95]
s_waitcnt lgkmcnt(8)
v_mfma_f32_16x16x32_bf16 v[32:35], a[208:211], a[16:19], v[32:35]
ds_read_b64_tr_b16 a[200:201], v138 offset:16384
v_mfma_f32_16x16x32_bf16 v[36:39], a[208:211], a[20:23], v[36:39]
buffer_load_dwordx4 v131, s[12:15], s42 offen offset:1024 lds
v_mfma_f32_16x16x32_bf16 v[96:99], a[208:211], a[24:27], v[96:99]
ds_read_b64_tr_b16 a[202:203], v138 offset:17408
v_mfma_f32_16x16x32_bf16 v[100:103], a[208:211], a[28:31], v[100:103]
s_xor_b32 s43, s43, 0x8000
v_mfma_f32_16x16x32_bf16 v[40:43], a[212:215], a[16:19], v[40:43]
ds_read_b64_tr_b16 a[204:205], v139 offset:16384
v_mfma_f32_16x16x32_bf16 v[44:47], a[212:215], a[20:23], v[44:47]
buffer_load_dwordx4 v132, s[12:15], s42 offen offset:2048 lds
v_mfma_f32_16x16x32_bf16 v[104:107], a[212:215], a[24:27], v[104:107]
ds_read_b64_tr_b16 a[206:207], v139 offset:17408
v_mfma_f32_16x16x32_bf16 v[108:111], a[212:215], a[28:31], v[108:111]
s_waitcnt lgkmcnt(8)
v_mfma_f32_16x16x32_bf16 v[48:51], a[216:219], a[16:19], v[48:51]
ds_read_b64_tr_b16 a[208:209], v140 offset:16384
v_mfma_f32_16x16x32_bf16 v[52:55], a[216:219], a[20:23], v[52:55]
buffer_load_dwordx4 v133, s[12:15], s42 offen offset:3072 lds
v_mfma_f32_16x16x32_bf16 v[112:115], a[216:219], a[24:27], v[112:115]
ds_read_b64_tr_b16 a[210:211], v140 offset:17408
v_mfma_f32_16x16x32_bf16 v[116:119], a[216:219], a[28:31], v[116:119]
s_add_u32 s42, s42, 131072
v_mfma_f32_16x16x32_bf16 v[56:59], a[220:223], a[16:19], v[56:59]
ds_read_b64_tr_b16 a[212:213], v141 offset:16384
v_mfma_f32_16x16x32_bf16 v[60:63], a[220:223], a[20:23], v[60:63]
buffer_load_dwordx4 a[92:95], v134, s[16:19], s61 offen offset:2304
v_mfma_f32_16x16x32_bf16 v[120:123], a[220:223], a[24:27], v[120:123]
ds_read_b64_tr_b16 a[214:215], v141 offset:17408
v_mfma_f32_16x16x32_bf16 v[124:127], a[220:223], a[28:31], v[124:127]
s_waitcnt vmcnt(20) lgkmcnt(8)
s_add_u32 s61, s61, 4096
v_mfma_f32_16x16x32_bf16 v[0:3], a[192:195], a[32:35], v[0:3]
ds_read_b64_tr_b16 a[216:217], v142 offset:16384
v_mfma_f32_16x16x32_bf16 v[4:7], a[192:195], a[36:39], v[4:7]
buffer_load_dwordx4 a[96:99], v134, s[16:19], s60 offen offset:0
v_mfma_f32_16x16x32_bf16 v[64:67], a[192:195], a[40:43], v[64:67]
ds_read_b64_tr_b16 a[218:219], v142 offset:17408
v_mfma_f32_16x16x32_bf16 v[68:71], a[192:195], a[44:47], v[68:71]
v_mfma_f32_16x16x32_bf16 v[8:11], a[196:199], a[32:35], v[8:11]
ds_read_b64_tr_b16 a[220:221], v143 offset:16384
v_mfma_f32_16x16x32_bf16 v[12:15], a[196:199], a[36:39], v[12:15]
buffer_load_dwordx4 a[100:103], v134, s[16:19], s60 offen offset:256
v_mfma_f32_16x16x32_bf16 v[72:75], a[196:199], a[40:43], v[72:75]
ds_read_b64_tr_b16 a[222:223], v143 offset:17408
v_mfma_f32_16x16x32_bf16 v[76:79], a[196:199], a[44:47], v[76:79]
s_waitcnt lgkmcnt(8)
v_mfma_f32_16x16x32_bf16 v[16:19], a[200:203], a[32:35], v[16:19]
ds_read_b64_tr_b16 a[192:193], v136 offset:24576
v_mfma_f32_16x16x32_bf16 v[20:23], a[200:203], a[36:39], v[20:23]
buffer_load_dwordx4 a[104:107], v134, s[16:19], s61 offen offset:0
v_mfma_f32_16x16x32_bf16 v[80:83], a[200:203], a[40:43], v[80:83]
ds_read_b64_tr_b16 a[194:195], v136 offset:25600
v_mfma_f32_16x16x32_bf16 v[84:87], a[200:203], a[44:47], v[84:87]
v_xor_b32 v136, 0x8000, v136
v_mfma_f32_16x16x32_bf16 v[24:27], a[204:207], a[32:35], v[24:27]
ds_read_b64_tr_b16 a[196:197], v137 offset:24576
v_mfma_f32_16x16x32_bf16 v[28:31], a[204:207], a[36:39], v[28:31]
buffer_load_dwordx4 a[108:111], v134, s[16:19], s61 offen offset:256
v_mfma_f32_16x16x32_bf16 v[88:91], a[204:207], a[40:43], v[88:91]
ds_read_b64_tr_b16 a[198:199], v137 offset:25600
v_mfma_f32_16x16x32_bf16 v[92:95], a[204:207], a[44:47], v[92:95]
s_waitcnt lgkmcnt(8)
v_xor_b32 v137, 0x8000, v137
v_mfma_f32_16x16x32_bf16 v[32:35], a[208:211], a[32:35], v[32:35]
ds_read_b64_tr_b16 a[200:201], v138 offset:24576
v_mfma_f32_16x16x32_bf16 v[36:39], a[208:211], a[36:39], v[36:39]
buffer_load_dwordx4 a[112:115], v134, s[16:19], s60 offen offset:2048
v_mfma_f32_16x16x32_bf16 v[96:99], a[208:211], a[40:43], v[96:99]
ds_read_b64_tr_b16 a[202:203], v138 offset:25600
v_mfma_f32_16x16x32_bf16 v[100:103], a[208:211], a[44:47], v[100:103]
v_xor_b32 v138, 0x8000, v138
v_mfma_f32_16x16x32_bf16 v[40:43], a[212:215], a[32:35], v[40:43]
ds_read_b64_tr_b16 a[204:205], v139 offset:24576
v_mfma_f32_16x16x32_bf16 v[44:47], a[212:215], a[36:39], v[44:47]
buffer_load_dwordx4 a[116:119], v134, s[16:19], s60 offen offset:2304
v_mfma_f32_16x16x32_bf16 v[104:107], a[212:215], a[40:43], v[104:107]
ds_read_b64_tr_b16 a[206:207], v139 offset:25600
v_mfma_f32_16x16x32_bf16 v[108:111], a[212:215], a[44:47], v[108:111]
s_waitcnt lgkmcnt(8)
v_xor_b32 v139, 0x8000, v139
s_add_u32 s60, s60, 4096
v_mfma_f32_16x16x32_bf16 v[48:51], a[216:219], a[32:35], v[48:51]
ds_read_b64_tr_b16 a[208:209], v140 offset:24576
v_mfma_f32_16x16x32_bf16 v[52:55], a[216:219], a[36:39], v[52:55]
buffer_load_dwordx4 a[120:123], v134, s[16:19], s61 offen offset:2048
v_mfma_f32_16x16x32_bf16 v[112:115], a[216:219], a[40:43], v[112:115]
ds_read_b64_tr_b16 a[210:211], v140 offset:25600
v_mfma_f32_16x16x32_bf16 v[116:119], a[216:219], a[44:47], v[116:119]
v_xor_b32 v140, 0x8000, v140
v_mfma_f32_16x16x32_bf16 v[56:59], a[220:223], a[32:35], v[56:59]
ds_read_b64_tr_b16 a[212:213], v141 offset:24576
v_mfma_f32_16x16x32_bf16 v[60:63], a[220:223], a[36:39], v[60:63]
buffer_load_dwordx4 a[124:127], v134, s[16:19], s61 offen offset:2304
v_mfma_f32_16x16x32_bf16 v[120:123], a[220:223], a[40:43], v[120:123]
ds_read_b64_tr_b16 a[214:215], v141 offset:25600
v_mfma_f32_16x16x32_bf16 v[124:127], a[220:223], a[44:47], v[124:127]
s_waitcnt vmcnt(20) lgkmcnt(8)
v_xor_b32 v141, 0x8000, v141
s_add_u32 s61, s61, 4096
v_mfma_f32_16x16x32_bf16 v[0:3], a[192:195], a[48:51], v[0:3]
ds_read_b64_tr_b16 a[216:217], v142 offset:24576
v_mfma_f32_16x16x32_bf16 v[4:7], a[192:195], a[52:55], v[4:7]
buffer_load_dwordx4 v[160:163], v135, s[24:27], 0 offen
v_mfma_f32_16x16x32_bf16 v[64:67], a[192:195], a[56:59], v[64:67]
ds_read_b64_tr_b16 a[218:219], v142 offset:25600
v_mfma_f32_16x16x32_bf16 v[68:71], a[192:195], a[60:63], v[68:71]
v_xor_b32 v142, 0x8000, v142
v_mfma_f32_16x16x32_bf16 v[8:11], a[196:199], a[48:51], v[8:11]
ds_read_b64_tr_b16 a[220:221], v143 offset:24576
v_mfma_f32_16x16x32_bf16 v[12:15], a[196:199], a[52:55], v[12:15]
buffer_load_dwordx4 v[164:167], v135, s[24:27], s56 offen
v_mfma_f32_16x16x32_bf16 v[72:75], a[196:199], a[56:59], v[72:75]
ds_read_b64_tr_b16 a[222:223], v143 offset:25600
v_mfma_f32_16x16x32_bf16 v[76:79], a[196:199], a[60:63], v[76:79]
s_waitcnt lgkmcnt(8)
s_barrier
v_xor_b32 v143, 0x8000, v143
v_mfma_f32_16x16x32_bf16 v[16:19], a[200:203], a[48:51], v[16:19]
ds_read_b64_tr_b16 a[192:193], v136 offset:0
v_mfma_f32_16x16x32_bf16 v[20:23], a[200:203], a[52:55], v[20:23]
buffer_load_dwordx4 v[168:171], v135, s[24:27], s57 offen
v_mfma_f32_16x16x32_bf16 v[80:83], a[200:203], a[56:59], v[80:83]
ds_read_b64_tr_b16 a[194:195], v136 offset:1024
v_mfma_f32_16x16x32_bf16 v[84:87], a[200:203], a[60:63], v[84:87]
v_mfma_f32_16x16x32_bf16 v[24:27], a[204:207], a[48:51], v[24:27]
ds_read_b64_tr_b16 a[196:197], v137 offset:0
v_mfma_f32_16x16x32_bf16 v[28:31], a[204:207], a[52:55], v[28:31]
buffer_load_dwordx4 v[172:175], v135, s[24:27], s58 offen
v_mfma_f32_16x16x32_bf16 v[88:91], a[204:207], a[56:59], v[88:91]
ds_read_b64_tr_b16 a[198:199], v137 offset:1024
v_mfma_f32_16x16x32_bf16 v[92:95], a[204:207], a[60:63], v[92:95]
s_waitcnt lgkmcnt(8)
v_mfma_f32_16x16x32_bf16 v[32:35], a[208:211], a[48:51], v[32:35]
ds_read_b64_tr_b16 a[200:201], v136 offset:8192
v_mfma_f32_16x16x32_bf16 v[36:39], a[208:211], a[52:55], v[36:39]
v_mfma_f32_16x16x32_bf16 v[96:99], a[208:211], a[56:59], v[96:99]
ds_read_b64_tr_b16 a[202:203], v136 offset:9216
v_mfma_f32_16x16x32_bf16 v[100:103], a[208:211], a[60:63], v[100:103]
v_mfma_f32_16x16x32_bf16 v[40:43], a[212:215], a[48:51], v[40:43]
ds_read_b64_tr_b16 a[204:205], v137 offset:8192
v_mfma_f32_16x16x32_bf16 v[44:47], a[212:215], a[52:55], v[44:47]
v_mfma_f32_16x16x32_bf16 v[104:107], a[212:215], a[56:59], v[104:107]
ds_read_b64_tr_b16 a[206:207], v137 offset:9216
v_mfma_f32_16x16x32_bf16 v[108:111], a[212:215], a[60:63], v[108:111]
s_waitcnt lgkmcnt(8)
s_waitcnt vmcnt(13)
s_barrier
v_mfma_f32_16x16x32_bf16 v[48:51], a[216:219], a[48:51], v[48:51]
ds_read_b64_tr_b16 a[208:209], v136 offset:16384
v_mfma_f32_16x16x32_bf16 v[52:55], a[216:219], a[52:55], v[52:55]
v_mfma_f32_16x16x32_bf16 v[112:115], a[216:219], a[56:59], v[112:115]
ds_read_b64_tr_b16 a[210:211], v136 offset:17408
v_mfma_f32_16x16x32_bf16 v[116:119], a[216:219], a[60:63], v[116:119]
v_mfma_f32_16x16x32_bf16 v[56:59], a[220:223], a[48:51], v[56:59]
ds_read_b64_tr_b16 a[212:213], v137 offset:16384
v_mfma_f32_16x16x32_bf16 v[60:63], a[220:223], a[52:55], v[60:63]
v_mfma_f32_16x16x32_bf16 v[120:123], a[220:223], a[56:59], v[120:123]
ds_read_b64_tr_b16 a[214:215], v137 offset:17408
v_mfma_f32_16x16x32_bf16 v[124:127], a[220:223], a[60:63], v[124:127]
s_waitcnt lgkmcnt(8)
v_mfma_f32_16x16x32_bf16 v[0:3], a[192:195], a[64:67], v[0:3]
ds_read_b64_tr_b16 a[216:217], v136 offset:24576
v_mfma_f32_16x16x32_bf16 v[4:7], a[192:195], a[68:71], v[4:7]
v_mfma_f32_16x16x32_bf16 v[64:67], a[192:195], a[72:75], v[64:67]
ds_read_b64_tr_b16 a[218:219], v136 offset:25600
v_mfma_f32_16x16x32_bf16 v[68:71], a[192:195], a[76:79], v[68:71]
v_xor_b32 v136, 0x8000, v136
v_mfma_f32_16x16x32_bf16 v[8:11], a[196:199], a[64:67], v[8:11]
ds_read_b64_tr_b16 a[220:221], v137 offset:24576
v_mfma_f32_16x16x32_bf16 v[12:15], a[196:199], a[68:71], v[12:15]
v_mfma_f32_16x16x32_bf16 v[72:75], a[196:199], a[72:75], v[72:75]
ds_read_b64_tr_b16 a[222:223], v137 offset:25600
v_mfma_f32_16x16x32_bf16 v[76:79], a[196:199], a[76:79], v[76:79]
s_waitcnt vmcnt(12) lgkmcnt(8)
v_xor_b32 v137, 0x8000, v137
v_mfma_f32_16x16x32_bf16 v[0:3], a[200:203], a[80:83], v[0:3]
ds_read_b64_tr_b16 a[192:193], v138 offset:0
v_mfma_f32_16x16x32_bf16 v[4:7], a[200:203], a[84:87], v[4:7]
v_mfma_f32_16x16x32_bf16 v[64:67], a[200:203], a[88:91], v[64:67]
ds_read_b64_tr_b16 a[194:195], v138 offset:1024
v_mfma_f32_16x16x32_bf16 v[68:71], a[200:203], a[92:95], v[68:71]
v_mfma_f32_16x16x32_bf16 v[8:11], a[204:207], a[80:83], v[8:11]
ds_read_b64_tr_b16 a[196:197], v139 offset:0
v_mfma_f32_16x16x32_bf16 v[12:15], a[204:207], a[84:87], v[12:15]
v_mfma_f32_16x16x32_bf16 v[72:75], a[204:207], a[88:91], v[72:75]
ds_read_b64_tr_b16 a[198:199], v139 offset:1024
v_mfma_f32_16x16x32_bf16 v[76:79], a[204:207], a[92:95], v[76:79]
s_waitcnt vmcnt(8) lgkmcnt(8)
v_mfma_f32_16x16x32_bf16 v[0:3], a[208:211], a[96:99], v[0:3]
ds_read_b64_tr_b16 a[200:201], v138 offset:8192
v_mfma_f32_16x16x32_bf16 v[4:7], a[208:211], a[100:103], v[4:7]
v_mfma_f32_16x16x32_bf16 v[64:67], a[208:211], a[104:107], v[64:67]
ds_read_b64_tr_b16 a[202:203], v138 offset:9216
v_mfma_f32_16x16x32_bf16 v[68:71], a[208:211], a[108:111], v[68:71]
v_mfma_f32_16x16x32_bf16 v[8:11], a[212:215], a[96:99], v[8:11]
ds_read_b64_tr_b16 a[204:205], v139 offset:8192
v_mfma_f32_16x16x32_bf16 v[12:15], a[212:215], a[100:103], v[12:15]
v_mfma_f32_16x16x32_bf16 v[72:75], a[212:215], a[104:107], v[72:75]
ds_read_b64_tr_b16 a[206:207], v139 offset:9216
v_mfma_f32_16x16x32_bf16 v[76:79], a[212:215], a[108:111], v[76:79]
s_waitcnt vmcnt(4) lgkmcnt(8)
v_mfma_f32_16x16x32_bf16 v[0:3], a[216:219], a[112:115], v[0:3]
ds_read_b64_tr_b16 a[208:209], v138 offset:16384
v_mfma_f32_16x16x32_bf16 v[4:7], a[216:219], a[116:119], v[4:7]
v_mfma_f32_16x16x32_bf16 v[64:67], a[216:219], a[120:123], v[64:67]
ds_read_b64_tr_b16 a[210:211], v138 offset:17408
v_mfma_f32_16x16x32_bf16 v[68:71], a[216:219], a[124:127], v[68:71]
v_mfma_f32_16x16x32_bf16 v[8:11], a[220:223], a[112:115], v[8:11]
ds_read_b64_tr_b16 a[212:213], v139 offset:16384
v_mfma_f32_16x16x32_bf16 v[12:15], a[220:223], a[116:119], v[12:15]
v_mfma_f32_16x16x32_bf16 v[72:75], a[220:223], a[120:123], v[72:75]
ds_read_b64_tr_b16 a[214:215], v139 offset:17408
v_mfma_f32_16x16x32_bf16 v[76:79], a[220:223], a[124:127], v[76:79]
s_waitcnt lgkmcnt(8)
v_mfma_f32_16x16x32_bf16 v[16:19], a[192:195], a[64:67], v[16:19]
ds_read_b64_tr_b16 a[216:217], v138 offset:24576
v_mfma_f32_16x16x32_bf16 v[20:23], a[192:195], a[68:71], v[20:23]
v_mfma_f32_16x16x32_bf16 v[80:83], a[192:195], a[72:75], v[80:83]
ds_read_b64_tr_b16 a[218:219], v138 offset:25600
v_mfma_f32_16x16x32_bf16 v[84:87], a[192:195], a[76:79], v[84:87]
v_xor_b32 v138, 0x8000, v138
v_mfma_f32_16x16x32_bf16 v[24:27], a[196:199], a[64:67], v[24:27]
ds_read_b64_tr_b16 a[220:221], v139 offset:24576
v_mfma_f32_16x16x32_bf16 v[28:31], a[196:199], a[68:71], v[28:31]
v_cvt_pk_bf16_f32 v0, v0, v1
v_cvt_pk_bf16_f32 v1, v2, v3
v_mfma_f32_16x16x32_bf16 v[88:91], a[196:199], a[72:75], v[88:91]
ds_read_b64_tr_b16 a[222:223], v139 offset:25600
v_cvt_pk_bf16_f32 v2, v4, v5
v_mfma_f32_16x16x32_bf16 v[92:95], a[196:199], a[76:79], v[92:95]
s_waitcnt lgkmcnt(8)
v_xor_b32 v139, 0x8000, v139
v_cvt_pk_bf16_f32 v3, v6, v7
v_mfma_f32_16x16x32_bf16 v[16:19], a[200:203], a[80:83], v[16:19]
ds_read_b64_tr_b16 a[192:193], v140 offset:0
v_cvt_pk_bf16_f32 v8, v8, v9
v_mfma_f32_16x16x32_bf16 v[20:23], a[200:203], a[84:87], v[20:23]
v_cvt_pk_bf16_f32 v9, v10, v11
v_cvt_pk_bf16_f32 v10, v12, v13
v_mfma_f32_16x16x32_bf16 v[80:83], a[200:203], a[88:91], v[80:83]
ds_read_b64_tr_b16 a[194:195], v140 offset:1024
v_cvt_pk_bf16_f32 v11, v14, v15
v_mfma_f32_16x16x32_bf16 v[84:87], a[200:203], a[92:95], v[84:87]
v_permlane16_swap_b32 v0, v2
v_permlane16_swap_b32 v1, v3
v_mfma_f32_16x16x32_bf16 v[24:27], a[204:207], a[80:83], v[24:27]
ds_read_b64_tr_b16 a[196:197], v141 offset:0
v_mfma_f32_16x16x32_bf16 v[28:31], a[204:207], a[84:87], v[28:31]
buffer_store_dwordx4 v[0:3], v129, s[20:23], s44 offen offset:0 sc1
v_mfma_f32_16x16x32_bf16 v[88:91], a[204:207], a[88:91], v[88:91]
ds_read_b64_tr_b16 a[198:199], v141 offset:1024
s_nop 0
v_mfma_f32_16x16x32_bf16 v[92:95], a[204:207], a[92:95], v[92:95]
s_waitcnt lgkmcnt(8)
v_permlane16_swap_b32 v8, v10
v_permlane16_swap_b32 v9, v11
v_mfma_f32_16x16x32_bf16 v[16:19], a[208:211], a[96:99], v[16:19]
ds_read_b64_tr_b16 a[200:201], v140 offset:8192
v_mfma_f32_16x16x32_bf16 v[20:23], a[208:211], a[100:103], v[20:23]
buffer_store_dwordx4 v[8:11], v129, s[20:23], s44 offen offset:1024 sc1
v_mfma_f32_16x16x32_bf16 v[80:83], a[208:211], a[104:107], v[80:83]
ds_read_b64_tr_b16 a[202:203], v140 offset:9216
v_cvt_pk_bf16_f32 v64, v64, v65
v_mfma_f32_16x16x32_bf16 v[84:87], a[208:211], a[108:111], v[84:87]
v_cvt_pk_bf16_f32 v65, v66, v67
v_cvt_pk_bf16_f32 v66, v68, v69
v_mfma_f32_16x16x32_bf16 v[24:27], a[212:215], a[96:99], v[24:27]
ds_read_b64_tr_b16 a[204:205], v141 offset:8192
v_cvt_pk_bf16_f32 v67, v70, v71
v_mfma_f32_16x16x32_bf16 v[28:31], a[212:215], a[100:103], v[28:31]
v_cvt_pk_bf16_f32 v72, v72, v73
v_cvt_pk_bf16_f32 v73, v74, v75
v_mfma_f32_16x16x32_bf16 v[88:91], a[212:215], a[104:107], v[88:91]
ds_read_b64_tr_b16 a[206:207], v141 offset:9216
v_cvt_pk_bf16_f32 v74, v76, v77
v_mfma_f32_16x16x32_bf16 v[92:95], a[212:215], a[108:111], v[92:95]
s_waitcnt lgkmcnt(8)
v_cvt_pk_bf16_f32 v75, v78, v79
v_permlane16_swap_b32 v64, v66
v_mfma_f32_16x16x32_bf16 v[16:19], a[216:219], a[112:115], v[16:19]
ds_read_b64_tr_b16 a[208:209], v140 offset:16384
v_permlane16_swap_b32 v65, v67
v_mfma_f32_16x16x32_bf16 v[20:23], a[216:219], a[116:119], v[20:23]
buffer_store_dwordx4 v[64:67], v129, s[20:23], s47 offen offset:0 sc1
v_mfma_f32_16x16x32_bf16 v[80:83], a[216:219], a[120:123], v[80:83]
ds_read_b64_tr_b16 a[210:211], v140 offset:17408
s_nop 0
v_mfma_f32_16x16x32_bf16 v[84:87], a[216:219], a[124:127], v[84:87]
v_permlane16_swap_b32 v72, v74
v_permlane16_swap_b32 v73, v75
v_mfma_f32_16x16x32_bf16 v[24:27], a[220:223], a[112:115], v[24:27]
ds_read_b64_tr_b16 a[212:213], v141 offset:16384
v_mfma_f32_16x16x32_bf16 v[28:31], a[220:223], a[116:119], v[28:31]
buffer_store_dwordx4 v[72:75], v129, s[20:23], s47 offen offset:1024 sc1
v_mfma_f32_16x16x32_bf16 v[88:91], a[220:223], a[120:123], v[88:91]
ds_read_b64_tr_b16 a[214:215], v141 offset:17408
v_mfma_f32_16x16x32_bf16 v[92:95], a[220:223], a[124:127], v[92:95]
s_waitcnt lgkmcnt(8)
v_mfma_f32_16x16x32_bf16 v[32:35], a[192:195], a[64:67], v[32:35]
ds_read_b64_tr_b16 a[216:217], v140 offset:24576
v_mfma_f32_16x16x32_bf16 v[36:39], a[192:195], a[68:71], v[36:39]
v_mfma_f32_16x16x32_bf16 v[96:99], a[192:195], a[72:75], v[96:99]
ds_read_b64_tr_b16 a[218:219], v140 offset:25600
v_mfma_f32_16x16x32_bf16 v[100:103], a[192:195], a[76:79], v[100:103]
v_xor_b32 v140, 0x8000, v140
v_mfma_f32_16x16x32_bf16 v[40:43], a[196:199], a[64:67], v[40:43]
ds_read_b64_tr_b16 a[220:221], v141 offset:24576
v_mfma_f32_16x16x32_bf16 v[44:47], a[196:199], a[68:71], v[44:47]
v_cvt_pk_bf16_f32 v16, v16, v17
v_cvt_pk_bf16_f32 v17, v18, v19
v_mfma_f32_16x16x32_bf16 v[104:107], a[196:199], a[72:75], v[104:107]
ds_read_b64_tr_b16 a[222:223], v141 offset:25600
v_cvt_pk_bf16_f32 v18, v20, v21
v_mfma_f32_16x16x32_bf16 v[108:111], a[196:199], a[76:79], v[108:111]
s_waitcnt lgkmcnt(8)
v_xor_b32 v141, 0x8000, v141
v_cvt_pk_bf16_f32 v19, v22, v23
v_mfma_f32_16x16x32_bf16 v[32:35], a[200:203], a[80:83], v[32:35]
ds_read_b64_tr_b16 a[192:193], v142 offset:0
v_cvt_pk_bf16_f32 v24, v24, v25
v_mfma_f32_16x16x32_bf16 v[36:39], a[200:203], a[84:87], v[36:39]
v_cvt_pk_bf16_f32 v25, v26, v27
v_cvt_pk_bf16_f32 v26, v28, v29
v_mfma_f32_16x16x32_bf16 v[96:99], a[200:203], a[88:91], v[96:99]
ds_read_b64_tr_b16 a[194:195], v142 offset:1024
v_cvt_pk_bf16_f32 v27, v30, v31
v_mfma_f32_16x16x32_bf16 v[100:103], a[200:203], a[92:95], v[100:103]
v_permlane16_swap_b32 v16, v18
v_permlane16_swap_b32 v17, v19
v_mfma_f32_16x16x32_bf16 v[40:43], a[204:207], a[80:83], v[40:43]
ds_read_b64_tr_b16 a[196:197], v143 offset:0
v_mfma_f32_16x16x32_bf16 v[44:47], a[204:207], a[84:87], v[44:47]
buffer_store_dwordx4 v[16:19], v129, s[20:23], s44 offen offset:2048 sc1
v_mfma_f32_16x16x32_bf16 v[104:107], a[204:207], a[88:91], v[104:107]
ds_read_b64_tr_b16 a[198:199], v143 offset:1024
s_nop 0
v_mfma_f32_16x16x32_bf16 v[108:111], a[204:207], a[92:95], v[108:111]
s_waitcnt lgkmcnt(8)
v_permlane16_swap_b32 v24, v26
v_permlane16_swap_b32 v25, v27
v_mfma_f32_16x16x32_bf16 v[32:35], a[208:211], a[96:99], v[32:35]
ds_read_b64_tr_b16 a[200:201], v142 offset:8192
v_mfma_f32_16x16x32_bf16 v[36:39], a[208:211], a[100:103], v[36:39]
buffer_store_dwordx4 v[24:27], v129, s[20:23], s44 offen offset:3072 sc1
v_mfma_f32_16x16x32_bf16 v[96:99], a[208:211], a[104:107], v[96:99]
ds_read_b64_tr_b16 a[202:203], v142 offset:9216
v_cvt_pk_bf16_f32 v80, v80, v81
v_mfma_f32_16x16x32_bf16 v[100:103], a[208:211], a[108:111], v[100:103]
v_cvt_pk_bf16_f32 v81, v82, v83
v_cvt_pk_bf16_f32 v82, v84, v85
v_mfma_f32_16x16x32_bf16 v[40:43], a[212:215], a[96:99], v[40:43]
ds_read_b64_tr_b16 a[204:205], v143 offset:8192
v_cvt_pk_bf16_f32 v83, v86, v87
v_mfma_f32_16x16x32_bf16 v[44:47], a[212:215], a[100:103], v[44:47]
v_cvt_pk_bf16_f32 v88, v88, v89
v_cvt_pk_bf16_f32 v89, v90, v91
v_mfma_f32_16x16x32_bf16 v[104:107], a[212:215], a[104:107], v[104:107]
ds_read_b64_tr_b16 a[206:207], v143 offset:9216
v_cvt_pk_bf16_f32 v90, v92, v93
v_mfma_f32_16x16x32_bf16 v[108:111], a[212:215], a[108:111], v[108:111]
s_waitcnt lgkmcnt(8)
v_cvt_pk_bf16_f32 v91, v94, v95
v_permlane16_swap_b32 v80, v82
v_mfma_f32_16x16x32_bf16 v[32:35], a[216:219], a[112:115], v[32:35]
ds_read_b64_tr_b16 a[208:209], v142 offset:16384
v_permlane16_swap_b32 v81, v83
v_mfma_f32_16x16x32_bf16 v[36:39], a[216:219], a[116:119], v[36:39]
buffer_store_dwordx4 v[80:83], v129, s[20:23], s47 offen offset:2048 sc1
v_mfma_f32_16x16x32_bf16 v[96:99], a[216:219], a[120:123], v[96:99]
ds_read_b64_tr_b16 a[210:211], v142 offset:17408
s_nop 0
v_mfma_f32_16x16x32_bf16 v[100:103], a[216:219], a[124:127], v[100:103]
v_permlane16_swap_b32 v88, v90
v_permlane16_swap_b32 v89, v91
v_mfma_f32_16x16x32_bf16 v[40:43], a[220:223], a[112:115], v[40:43]
ds_read_b64_tr_b16 a[212:213], v143 offset:16384
v_mfma_f32_16x16x32_bf16 v[44:47], a[220:223], a[116:119], v[44:47]
buffer_store_dwordx4 v[88:91], v129, s[20:23], s47 offen offset:3072 sc1
v_mfma_f32_16x16x32_bf16 v[104:107], a[220:223], a[120:123], v[104:107]
ds_read_b64_tr_b16 a[214:215], v143 offset:17408
v_mfma_f32_16x16x32_bf16 v[108:111], a[220:223], a[124:127], v[108:111]
s_waitcnt lgkmcnt(8)
v_mfma_f32_16x16x32_bf16 v[48:51], a[192:195], a[64:67], v[48:51]
ds_read_b64_tr_b16 a[216:217], v142 offset:24576
v_mfma_f32_16x16x32_bf16 v[52:55], a[192:195], a[68:71], v[52:55]
v_mfma_f32_16x16x32_bf16 v[112:115], a[192:195], a[72:75], v[112:115]
ds_read_b64_tr_b16 a[218:219], v142 offset:25600
v_mfma_f32_16x16x32_bf16 v[116:119], a[192:195], a[76:79], v[116:119]
v_xor_b32 v142, 0x8000, v142
v_mfma_f32_16x16x32_bf16 v[56:59], a[196:199], a[64:67], v[56:59]
ds_read_b64_tr_b16 a[220:221], v143 offset:24576
v_mfma_f32_16x16x32_bf16 v[60:63], a[196:199], a[68:71], v[60:63]
v_cvt_pk_bf16_f32 v32, v32, v33
v_cvt_pk_bf16_f32 v33, v34, v35
v_mfma_f32_16x16x32_bf16 v[120:123], a[196:199], a[72:75], v[120:123]
ds_read_b64_tr_b16 a[222:223], v143 offset:25600
v_cvt_pk_bf16_f32 v34, v36, v37
v_mfma_f32_16x16x32_bf16 v[124:127], a[196:199], a[76:79], v[124:127]
s_waitcnt lgkmcnt(8)
v_xor_b32 v143, 0x8000, v143
v_cvt_pk_bf16_f32 v35, v38, v39
v_mfma_f32_16x16x32_bf16 v[48:51], a[200:203], a[80:83], v[48:51]
v_cvt_pk_bf16_f32 v40, v40, v41
v_cvt_pk_bf16_f32 v41, v42, v43
v_mfma_f32_16x16x32_bf16 v[52:55], a[200:203], a[84:87], v[52:55]
v_cvt_pk_bf16_f32 v42, v44, v45
v_cvt_pk_bf16_f32 v43, v46, v47
v_mfma_f32_16x16x32_bf16 v[112:115], a[200:203], a[88:91], v[112:115]
v_permlane16_swap_b32 v32, v34
v_permlane16_swap_b32 v33, v35
v_mfma_f32_16x16x32_bf16 v[116:119], a[200:203], a[92:95], v[116:119]
buffer_store_dwordx4 v[32:35], v129, s[20:23], s45 offen offset:0 sc1
v_mfma_f32_16x16x32_bf16 v[56:59], a[204:207], a[80:83], v[56:59]
s_nop 0
v_permlane16_swap_b32 v40, v42
v_mfma_f32_16x16x32_bf16 v[60:63], a[204:207], a[84:87], v[60:63]
v_permlane16_swap_b32 v41, v43
v_mfma_f32_16x16x32_bf16 v[120:123], a[204:207], a[88:91], v[120:123]
buffer_store_dwordx4 v[40:43], v129, s[20:23], s45 offen offset:1024 sc1
v_mfma_f32_16x16x32_bf16 v[124:127], a[204:207], a[92:95], v[124:127]
s_waitcnt lgkmcnt(4)
v_cvt_pk_bf16_f32 v96, v96, v97
v_cvt_pk_bf16_f32 v97, v98, v99
v_mfma_f32_16x16x32_bf16 v[48:51], a[208:211], a[96:99], v[48:51]
v_cvt_pk_bf16_f32 v98, v100, v101
v_cvt_pk_bf16_f32 v99, v102, v103
v_mfma_f32_16x16x32_bf16 v[52:55], a[208:211], a[100:103], v[52:55]
v_cvt_pk_bf16_f32 v104, v104, v105
v_cvt_pk_bf16_f32 v105, v106, v107
v_mfma_f32_16x16x32_bf16 v[112:115], a[208:211], a[104:107], v[112:115]
v_cvt_pk_bf16_f32 v106, v108, v109
v_cvt_pk_bf16_f32 v107, v110, v111
v_mfma_f32_16x16x32_bf16 v[116:119], a[208:211], a[108:111], v[116:119]
v_permlane16_swap_b32 v96, v98
v_permlane16_swap_b32 v97, v99
v_mfma_f32_16x16x32_bf16 v[56:59], a[212:215], a[96:99], v[56:59]
buffer_store_dwordx4 v[96:99], v129, s[20:23], s48 offen offset:0 sc1
v_mfma_f32_16x16x32_bf16 v[60:63], a[212:215], a[100:103], v[60:63]
s_nop 0
v_permlane16_swap_b32 v104, v106
v_mfma_f32_16x16x32_bf16 v[120:123], a[212:215], a[104:107], v[120:123]
v_permlane16_swap_b32 v105, v107
v_mfma_f32_16x16x32_bf16 v[124:127], a[212:215], a[108:111], v[124:127]
s_waitcnt lgkmcnt(0)
v_mfma_f32_16x16x32_bf16 v[48:51], a[216:219], a[112:115], v[48:51]
buffer_store_dwordx4 v[104:107], v129, s[20:23], s48 offen offset:1024 sc1
v_mfma_f32_16x16x32_bf16 v[52:55], a[216:219], a[116:119], v[52:55]
v_mfma_f32_16x16x32_bf16 v[112:115], a[216:219], a[120:123], v[112:115]
v_mfma_f32_16x16x32_bf16 v[116:119], a[216:219], a[124:127], v[116:119]
v_mfma_f32_16x16x32_bf16 v[56:59], a[220:223], a[112:115], v[56:59]
v_mfma_f32_16x16x32_bf16 v[60:63], a[220:223], a[116:119], v[60:63]
v_mfma_f32_16x16x32_bf16 v[120:123], a[220:223], a[120:123], v[120:123]
v_mfma_f32_16x16x32_bf16 v[124:127], a[220:223], a[124:127], v[124:127]
s_waitcnt vmcnt(12)
v_add_f32 v160, v160, v164
v_add_f32 v168, v168, v172
v_add_f32 v161, v161, v165
v_add_f32 v169, v169, v173
v_add_f32 v162, v162, v166
v_add_f32 v170, v170, v174
v_add_f32 v163, v163, v167
v_add_f32 v171, v171, v175
v_add_f32 v160, v160, v168
v_add_f32 v161, v161, v169
v_add_f32 v162, v162, v170
v_add_f32 v163, v163, v171
v_cvt_pk_bf16_f32 v160, 0, v160
v_cvt_pk_bf16_f32 v161, 0, v161
v_cvt_pk_bf16_f32 v162, 0, v162
v_cvt_pk_bf16_f32 v163, 0, v163
s_mov_b64 exec, 15
buffer_store_dwordx4 v[160:163], v135, s[52:55], 0 offen sc1
s_mov_b64 exec, -1
s_nop 15
v_cvt_pk_bf16_f32 v48, v48, v49
v_cvt_pk_bf16_f32 v49, v50, v51
v_cvt_pk_bf16_f32 v50, v52, v53
v_cvt_pk_bf16_f32 v51, v54, v55
v_cvt_pk_bf16_f32 v56, v56, v57
v_cvt_pk_bf16_f32 v57, v58, v59
v_cvt_pk_bf16_f32 v58, v60, v61
v_cvt_pk_bf16_f32 v59, v62, v63
v_permlane16_swap_b32 v48, v50
v_permlane16_swap_b32 v49, v51
buffer_store_dwordx4 v[48:51], v129, s[20:23], s45 offen offset:2048 sc1
s_nop 0
v_permlane16_swap_b32 v56, v58
v_permlane16_swap_b32 v57, v59
buffer_store_dwordx4 v[56:59], v129, s[20:23], s45 offen offset:3072 sc1
v_cvt_pk_bf16_f32 v112, v112, v113
v_cvt_pk_bf16_f32 v113, v114, v115
v_cvt_pk_bf16_f32 v114, v116, v117
v_cvt_pk_bf16_f32 v115, v118, v119
v_cvt_pk_bf16_f32 v120, v120, v121
v_cvt_pk_bf16_f32 v121, v122, v123
v_cvt_pk_bf16_f32 v122, v124, v125
v_cvt_pk_bf16_f32 v123, v126, v127
v_permlane16_swap_b32 v112, v114
v_permlane16_swap_b32 v113, v115
buffer_store_dwordx4 v[112:115], v129, s[20:23], s48 offen offset:2048 sc1
s_nop 0
v_permlane16_swap_b32 v120, v122
v_permlane16_swap_b32 v121, v123
buffer_store_dwordx4 v[120:123], v129, s[20:23], s48 offen offset:3072 sc1
L_oproj_end:
s_endpgm
.text
.globl lnb_kernel
.p2align 8
.type lnb_kernel,@function
lnb_kernel:
s_cmp_ge_u32 s2, 256
s_cbranch_scc1 L_lnb_end
s_load_dwordx2 s[4:5], s[0:1], 0
s_load_dwordx2 s[8:9], s[0:1], 104
v_and_b32 v1, 63, v0
v_lshrrev_b32 v2, 6, v0
v_and_b32 v3, 7, v1
v_lshrrev_b32 v4, 3, v1
s_lshr_b32 s24, s2, 2
s_lshl_b32 s24, s24, 16
s_and_b32 s25, s2, 3
s_lshl_b32 s25, s25, 7
s_add_u32 s24, s24, s25
v_lshrrev_b32 v6, 1, v4
v_lshl_add_u32 v6, v2, 3, v6
v_lshlrev_b32 v5, 10, v6
v_and_b32 v6, 1, v4
v_lshl_add_u32 v5, v6, 9, v5
v_lshl_add_u32 v5, v3, 4, v5
s_add_u32 s29, s24, 4096
v_lshl_add_u32 v7, v2, 4, v4
s_lshl_b32 s26, s2, 14
v_lshlrev_b32 v9, 11, v3
v_lshl_add_u32 v8, v7, 4, v9
v_lshlrev_b32 v10, 4, v0
s_waitcnt lgkmcnt(0)
s_add_u32 s44, s8, 30408704
s_addc_u32 s45, s9, 0
s_and_b32 s45, s45, 0xffff
s_mov_b32 s46, 17039360
s_mov_b32 s47, 0x20000
s_lshr_b32 s36, s2, 2
s_mul_i32 s36, s36, 66560
s_add_u32 s36, s36, s25
s_add_u32 s35, s36, 0
buffer_load_dwordx4 v[128:131], v5, s[44:47], s35 offen
s_add_u32 s35, s36, 4096
buffer_load_dwordx4 v[132:135], v5, s[44:47], s35 offen
s_add_u32 s35, s36, 4259840
buffer_load_dwordx4 v[136:139], v5, s[44:47], s35 offen
s_add_u32 s35, s36, 4263936
buffer_load_dwordx4 v[140:143], v5, s[44:47], s35 offen
s_add_u32 s35, s36, 8519680
buffer_load_dwordx4 v[144:147], v5, s[44:47], s35 offen
s_add_u32 s35, s36, 8523776
buffer_load_dwordx4 v[148:151], v5, s[44:47], s35 offen
s_add_u32 s35, s36, 12779520
buffer_load_dwordx4 v[152:155], v5, s[44:47], s35 offen
s_add_u32 s35, s36, 12783616
buffer_load_dwordx4 v[156:159], v5, s[44:47], s35 offen
s_mov_b32 s12, s4
s_and_b32 s13, s5, 0xffff
s_mov_b32 s14, 4194304
s_mov_b32 s15, 0x20000
s_add_u32 s48, s8, 26214400
s_addc_u32 s49, s9, 0
s_and_b32 s49, s49, 0xffff
s_mov_b32 s50, 4194304
s_mov_b32 s51, 0x20000
buffer_load_dwordx4 v[16:19], v8, s[12:15], s26 offen offset:0
buffer_load_dwordx4 v[20:23], v8, s[12:15], s26 offen offset:128
buffer_load_ushort v11, v9, s[12:15], s26 offen
s_mov_b32 s16, s8
s_and_b32 s17, s9, 0xffff
s_mov_b32 s18, 24576
s_mov_b32 s19, 0x20000
v_lshlrev_b32 v15, 5, v7
s_movk_i32 s31, 8192
buffer_load_dwordx4 v[96:99], v15, s[16:19], s31 offen offset:0
buffer_load_dwordx4 v[100:103], v15, s[16:19], s31 offen offset:16
buffer_load_dwordx4 v[104:107], v15, s[16:19], s31 offen offset:256
buffer_load_dwordx4 v[108:111], v15, s[16:19], s31 offen offset:272
s_movk_i32 s30, 12288
buffer_load_dwordx4 v[64:67], v10, s[16:19], s30 offen
s_mov_b32 s34, 0xffff0000
s_waitcnt vmcnt(8)
v_lshlrev_b32 v48, 16, v128
v_and_b32 v49, s34, v128
v_lshlrev_b32 v50, 16, v129
v_and_b32 v51, s34, v129
v_lshlrev_b32 v52, 16, v130
v_and_b32 v53, s34, v130
v_lshlrev_b32 v54, 16, v131
v_and_b32 v55, s34, v131
v_lshlrev_b32 v56, 16, v132
v_and_b32 v57, s34, v132
v_lshlrev_b32 v58, 16, v133
v_and_b32 v59, s34, v133
v_lshlrev_b32 v60, 16, v134
v_and_b32 v61, s34, v134
v_lshlrev_b32 v62, 16, v135
v_and_b32 v63, s34, v135
v_lshlrev_b32 v112, 16, v136
v_and_b32 v113, s34, v136
v_lshlrev_b32 v114, 16, v137
v_and_b32 v115, s34, v137
v_lshlrev_b32 v116, 16, v138
v_and_b32 v117, s34, v138
v_lshlrev_b32 v118, 16, v139
v_and_b32 v119, s34, v139
v_lshlrev_b32 v120, 16, v140
v_and_b32 v121, s34, v140
v_lshlrev_b32 v122, 16, v141
v_and_b32 v123, s34, v141
v_lshlrev_b32 v124, 16, v142
v_and_b32 v125, s34, v142
v_lshlrev_b32 v126, 16, v143
v_and_b32 v127, s34, v143
v_add_f32 v48, v48, v112
v_add_f32 v49, v49, v113
v_add_f32 v50, v50, v114
v_add_f32 v51, v51, v115
v_add_f32 v52, v52, v116
v_add_f32 v53, v53, v117
v_add_f32 v54, v54, v118
v_add_f32 v55, v55, v119
v_add_f32 v56, v56, v120
v_add_f32 v57, v57, v121
v_add_f32 v58, v58, v122
v_add_f32 v59, v59, v123
v_add_f32 v60, v60, v124
v_add_f32 v61, v61, v125
v_add_f32 v62, v62, v126
v_add_f32 v63, v63, v127
v_lshlrev_b32 v112, 16, v144
v_and_b32 v113, s34, v144
v_lshlrev_b32 v114, 16, v145
v_and_b32 v115, s34, v145
v_lshlrev_b32 v116, 16, v146
v_and_b32 v117, s34, v146
v_lshlrev_b32 v118, 16, v147
v_and_b32 v119, s34, v147
v_lshlrev_b32 v120, 16, v148
v_and_b32 v121, s34, v148
v_lshlrev_b32 v122, 16, v149
v_and_b32 v123, s34, v149
v_lshlrev_b32 v124, 16, v150
v_and_b32 v125, s34, v150
v_lshlrev_b32 v126, 16, v151
v_and_b32 v127, s34, v151
v_add_f32 v48, v48, v112
v_add_f32 v49, v49, v113
v_add_f32 v50, v50, v114
v_add_f32 v51, v51, v115
v_add_f32 v52, v52, v116
v_add_f32 v53, v53, v117
v_add_f32 v54, v54, v118
v_add_f32 v55, v55, v119
v_add_f32 v56, v56, v120
v_add_f32 v57, v57, v121
v_add_f32 v58, v58, v122
v_add_f32 v59, v59, v123
v_add_f32 v60, v60, v124
v_add_f32 v61, v61, v125
v_add_f32 v62, v62, v126
v_add_f32 v63, v63, v127
v_lshlrev_b32 v112, 16, v152
v_and_b32 v113, s34, v152
v_lshlrev_b32 v114, 16, v153
v_and_b32 v115, s34, v153
v_lshlrev_b32 v116, 16, v154
v_and_b32 v117, s34, v154
v_lshlrev_b32 v118, 16, v155
v_and_b32 v119, s34, v155
v_lshlrev_b32 v120, 16, v156
v_and_b32 v121, s34, v156
v_lshlrev_b32 v122, 16, v157
v_and_b32 v123, s34, v157
v_lshlrev_b32 v124, 16, v158
v_and_b32 v125, s34, v158
v_lshlrev_b32 v126, 16, v159
v_and_b32 v127, s34, v159
v_add_f32 v48, v48, v112
v_add_f32 v49, v49, v113
v_add_f32 v50, v50, v114
v_add_f32 v51, v51, v115
v_add_f32 v52, v52, v116
v_add_f32 v53, v53, v117
v_add_f32 v54, v54, v118
v_add_f32 v55, v55, v119
v_add_f32 v56, v56, v120
v_add_f32 v57, v57, v121
v_add_f32 v58, v58, v122
v_add_f32 v59, v59, v123
v_add_f32 v60, v60, v124
v_add_f32 v61, v61, v125
v_add_f32 v62, v62, v126
v_add_f32 v63, v63, v127
v_cvt_pk_bf16_f32 v48, 0, v48
v_cvt_pk_bf16_f32 v49, 0, v49
v_cvt_pk_bf16_f32 v50, 0, v50
v_cvt_pk_bf16_f32 v51, 0, v51
v_cvt_pk_bf16_f32 v52, 0, v52
v_cvt_pk_bf16_f32 v53, 0, v53
v_cvt_pk_bf16_f32 v54, 0, v54
v_cvt_pk_bf16_f32 v55, 0, v55
v_cvt_pk_bf16_f32 v56, 0, v56
v_cvt_pk_bf16_f32 v57, 0, v57
v_cvt_pk_bf16_f32 v58, 0, v58
v_cvt_pk_bf16_f32 v59, 0, v59
v_cvt_pk_bf16_f32 v60, 0, v60
v_cvt_pk_bf16_f32 v61, 0, v61
v_cvt_pk_bf16_f32 v62, 0, v62
v_cvt_pk_bf16_f32 v63, 0, v63
s_waitcnt vmcnt(1)
v_mul_f32 v48, v96, v48
v_mul_f32 v49, v97, v49
v_mul_f32 v50, v98, v50
v_mul_f32 v51, v99, v51
v_mul_f32 v52, v100, v52
v_mul_f32 v53, v101, v53
v_mul_f32 v54, v102, v54
v_mul_f32 v55, v103, v55
v_mul_f32 v56, v104, v56
v_mul_f32 v57, v105, v57
v_mul_f32 v58, v106, v58
v_mul_f32 v59, v107, v59
v_mul_f32 v60, v108, v60
v_mul_f32 v61, v109, v61
v_mul_f32 v62, v110, v62
v_mul_f32 v63, v111, v63
v_cvt_pk_bf16_f32 v48, 0, v48
v_cvt_pk_bf16_f32 v49, 0, v49
v_cvt_pk_bf16_f32 v50, 0, v50
v_cvt_pk_bf16_f32 v51, 0, v51
v_cvt_pk_bf16_f32 v52, 0, v52
v_cvt_pk_bf16_f32 v53, 0, v53
v_cvt_pk_bf16_f32 v54, 0, v54
v_cvt_pk_bf16_f32 v55, 0, v55
v_cvt_pk_bf16_f32 v56, 0, v56
v_cvt_pk_bf16_f32 v57, 0, v57
v_cvt_pk_bf16_f32 v58, 0, v58
v_cvt_pk_bf16_f32 v59, 0, v59
v_cvt_pk_bf16_f32 v60, 0, v60
v_cvt_pk_bf16_f32 v61, 0, v61
v_cvt_pk_bf16_f32 v62, 0, v62
v_cvt_pk_bf16_f32 v63, 0, v63
v_lshlrev_b32 v32, 16, v16
v_and_b32 v33, s34, v16
v_lshlrev_b32 v34, 16, v17
v_and_b32 v35, s34, v17
v_lshlrev_b32 v36, 16, v18
v_and_b32 v37, s34, v18
v_lshlrev_b32 v38, 16, v19
v_and_b32 v39, s34, v19
v_lshlrev_b32 v40, 16, v20
v_and_b32 v41, s34, v20
v_lshlrev_b32 v42, 16, v21
v_and_b32 v43, s34, v21
v_lshlrev_b32 v44, 16, v22
v_and_b32 v45, s34, v22
v_lshlrev_b32 v46, 16, v23
v_and_b32 v47, s34, v23
v_add_f32 v32, v32, v48
v_add_f32 v33, v33, v49
v_add_f32 v34, v34, v50
v_add_f32 v35, v35, v51
v_add_f32 v36, v36, v52
v_add_f32 v37, v37, v53
v_add_f32 v38, v38, v54
v_add_f32 v39, v39, v55
v_add_f32 v40, v40, v56
v_add_f32 v41, v41, v57
v_add_f32 v42, v42, v58
v_add_f32 v43, v43, v59
v_add_f32 v44, v44, v60
v_add_f32 v45, v45, v61
v_add_f32 v46, v46, v62
v_add_f32 v47, v47, v63
v_cvt_pk_bf16_f32 v16, v32, v33
v_cvt_pk_bf16_f32 v17, v34, v35
v_cvt_pk_bf16_f32 v18, v36, v37
v_cvt_pk_bf16_f32 v19, v38, v39
v_cvt_pk_bf16_f32 v20, v40, v41
v_cvt_pk_bf16_f32 v21, v42, v43
v_cvt_pk_bf16_f32 v22, v44, v45
v_cvt_pk_bf16_f32 v23, v46, v47
buffer_store_dwordx4 v[16:19], v5, s[48:51], s24 offen sc1
buffer_store_dwordx4 v[20:23], v5, s[48:51], s29 offen sc1
s_add_u32 s20, s8, 1048576
s_addc_u32 s21, s9, 0
s_and_b32 s21, s21, 0xffff
s_mov_b32 s22, 4194304
s_mov_b32 s23, 0x20000
s_mov_b32 s34, 0xffff0000
v_lshlrev_b32 v13, 6, v3
v_lshl_add_u32 v14, v2, 3, v13
v_lshlrev_b32 v15, 5, v7
v_cmp_lt_u32 vcc, 255, v0
v_lshlrev_b32 v11, 16, v11
v_lshlrev_b32 v32, 16, v16
v_and_b32 v33, s34, v16
v_lshlrev_b32 v34, 16, v17
v_and_b32 v35, s34, v17
v_lshlrev_b32 v36, 16, v18
v_and_b32 v37, s34, v18
v_lshlrev_b32 v38, 16, v19
v_and_b32 v39, s34, v19
v_lshlrev_b32 v40, 16, v20
v_and_b32 v41, s34, v20
v_lshlrev_b32 v42, 16, v21
v_and_b32 v43, s34, v21
v_lshlrev_b32 v44, 16, v22
v_and_b32 v45, s34, v22
v_lshlrev_b32 v46, 16, v23
v_and_b32 v47, s34, v23
v_sub_f32 v48, v32, v11
v_sub_f32 v49, v33, v11
v_sub_f32 v50, v34, v11
v_sub_f32 v51, v35, v11
v_sub_f32 v52, v36, v11
v_sub_f32 v53, v37, v11
v_sub_f32 v54, v38, v11
v_sub_f32 v55, v39, v11
v_sub_f32 v56, v40, v11
v_sub_f32 v57, v41, v11
v_sub_f32 v58, v42, v11
v_sub_f32 v59, v43, v11
v_sub_f32 v60, v44, v11
v_sub_f32 v61, v45, v11
v_sub_f32 v62, v46, v11
v_sub_f32 v63, v47, v11
v_add_f32 v24, v48, v49
v_add_f32 v25, v50, v51
v_mul_f32 v26, v48, v48
v_mul_f32 v27, v49, v49
v_fmac_f32 v26, v50, v50
v_fmac_f32 v27, v51, v51
v_fmac_f32 v26, v52, v52
v_fmac_f32 v27, v53, v53
v_fmac_f32 v26, v54, v54
v_fmac_f32 v27, v55, v55
v_fmac_f32 v26, v56, v56
v_fmac_f32 v27, v57, v57
v_fmac_f32 v26, v58, v58
v_fmac_f32 v27, v59, v59
v_fmac_f32 v26, v60, v60
v_fmac_f32 v27, v61, v61
v_fmac_f32 v26, v62, v62
v_fmac_f32 v27, v63, v63
v_add_f32 v24, v24, v52
v_add_f32 v25, v25, v53
v_add_f32 v24, v24, v54
v_add_f32 v25, v25, v55
v_add_f32 v24, v24, v56
v_add_f32 v25, v25, v57
v_add_f32 v24, v24, v58
v_add_f32 v25, v25, v59
v_add_f32 v24, v24, v60
v_add_f32 v25, v25, v61
v_add_f32 v24, v24, v62
v_add_f32 v25, v25, v63
v_add_f32 v24, v24, v25
v_add_f32 v25, v26, v27
s_nop 1
v_add_f32_dpp v24, v24, v24 row_ror:8 row_mask:0xf bank_mask:0xf
v_add_f32_dpp v25, v25, v25 row_ror:8 row_mask:0xf bank_mask:0xf
v_mov_b32 v26, v24
v_mov_b32 v27, v25
s_nop 1
v_permlane16_swap_b32 v24, v26
v_permlane16_swap_b32 v25, v27
s_nop 1
v_add_f32 v24, v24, v26
v_add_f32 v25, v25, v27
v_mov_b32 v26, v24
v_mov_b32 v27, v25
s_nop 1
v_permlane32_swap_b32 v24, v26
v_permlane32_swap_b32 v25, v27
s_nop 1
v_add_f32 v24, v24, v26
v_add_f32 v25, v25, v27
ds_write_b64 v14, v[24:25] offset:8192
s_waitcnt vmcnt(2)
v_add_f32 v68, 1.0, v64
v_add_f32 v69, 1.0, v65
v_add_f32 v70, 1.0, v66
v_add_f32 v71, 1.0, v67
v_cvt_pk_bf16_f32 v68, 0, v68
v_cvt_pk_bf16_f32 v69, 0, v69
v_cvt_pk_bf16_f32 v70, 0, v70
v_cvt_pk_bf16_f32 v71, 0, v71
v_cndmask_b32 v64, v64, v68, vcc
v_cndmask_b32 v65, v65, v69, vcc
v_cndmask_b32 v66, v66, v70, vcc
v_cndmask_b32 v67, v67, v71, vcc
ds_write_b128 v10, v[64:67]
s_waitcnt lgkmcnt(0)
s_barrier
ds_read_b128 v[48:51], v13 offset:8192
ds_read_b128 v[52:55], v13 offset:8208
ds_read_b128 v[56:59], v13 offset:8224
ds_read_b128 v[60:63], v13 offset:8240
ds_read_b128 v[112:115], v15 offset:4096
ds_read_b128 v[96:99], v15 offset:0
ds_read_b128 v[116:119], v15 offset:4112
ds_read_b128 v[100:103], v15 offset:16
ds_read_b128 v[120:123], v15 offset:4352
ds_read_b128 v[104:107], v15 offset:256
ds_read_b128 v[124:127], v15 offset:4368
ds_read_b128 v[108:111], v15 offset:272
s_waitcnt lgkmcnt(8)
v_add_f32 v48, v48, v52
v_add_f32 v49, v49, v53
v_add_f32 v50, v50, v54
v_add_f32 v51, v51, v55
v_add_f32 v48, v48, v56
v_add_f32 v49, v49, v57
v_add_f32 v50, v50, v58
v_add_f32 v51, v51, v59
v_add_f32 v48, v48, v60
v_add_f32 v49, v49, v61
v_add_f32 v50, v50, v62
v_add_f32 v51, v51, v63
v_add_f32 v48, v48, v50
v_add_f32 v49, v49, v51
v_mul_f32 v48, 0x3a800000, v48
v_mul_f32 v49, 0x3a800000, v49
v_fma_f32 v49, -v48, v48, v49
v_max_f32 v49, 0, v49
v_add_f32 v48, v48, v11
v_cvt_pk_bf16_f32 v49, 0, v49
v_add_f32 v49, 0x3727c5ac, v49
v_cvt_pk_bf16_f32 v49, 0, v49
v_sqrt_f32 v49, v49
v_cvt_pk_bf16_f32 v48, 0, v48
v_cvt_pk_bf16_f32 v49, 0, v49
v_rcp_f32 v49, v49
v_sub_f32 v32, v32, v48
v_sub_f32 v33, v33, v48
v_sub_f32 v34, v34, v48
v_sub_f32 v35, v35, v48
v_sub_f32 v36, v36, v48
v_sub_f32 v37, v37, v48
v_sub_f32 v38, v38, v48
v_sub_f32 v39, v39, v48
v_sub_f32 v40, v40, v48
v_sub_f32 v41, v41, v48
v_sub_f32 v42, v42, v48
v_sub_f32 v43, v43, v48
v_sub_f32 v44, v44, v48
v_sub_f32 v45, v45, v48
v_sub_f32 v46, v46, v48
v_sub_f32 v47, v47, v48
v_cvt_pk_bf16_f32 v32, 0, v32
v_cvt_pk_bf16_f32 v33, 0, v33
v_cvt_pk_bf16_f32 v34, 0, v34
v_cvt_pk_bf16_f32 v35, 0, v35
v_cvt_pk_bf16_f32 v36, 0, v36
v_cvt_pk_bf16_f32 v37, 0, v37
v_cvt_pk_bf16_f32 v38, 0, v38
v_cvt_pk_bf16_f32 v39, 0, v39
v_cvt_pk_bf16_f32 v40, 0, v40
v_cvt_pk_bf16_f32 v41, 0, v41
v_cvt_pk_bf16_f32 v42, 0, v42
v_cvt_pk_bf16_f32 v43, 0, v43
v_cvt_pk_bf16_f32 v44, 0, v44
v_cvt_pk_bf16_f32 v45, 0, v45
v_cvt_pk_bf16_f32 v46, 0, v46
v_cvt_pk_bf16_f32 v47, 0, v47
v_mul_f32 v32, v32, v49
v_mul_f32 v33, v33, v49
v_mul_f32 v34, v34, v49
v_mul_f32 v35, v35, v49
v_mul_f32 v36, v36, v49
v_mul_f32 v37, v37, v49
v_mul_f32 v38, v38, v49
v_mul_f32 v39, v39, v49
v_mul_f32 v40, v40, v49
v_mul_f32 v41, v41, v49
v_mul_f32 v42, v42, v49
v_mul_f32 v43, v43, v49
v_mul_f32 v44, v44, v49
v_mul_f32 v45, v45, v49
v_mul_f32 v46, v46, v49
v_mul_f32 v47, v47, v49
v_cvt_pk_bf16_f32 v32, 0, v32
v_cvt_pk_bf16_f32 v33, 0, v33
v_cvt_pk_bf16_f32 v34, 0, v34
v_cvt_pk_bf16_f32 v35, 0, v35
v_cvt_pk_bf16_f32 v36, 0, v36
v_cvt_pk_bf16_f32 v37, 0, v37
v_cvt_pk_bf16_f32 v38, 0, v38
v_cvt_pk_bf16_f32 v39, 0, v39
v_cvt_pk_bf16_f32 v40, 0, v40
v_cvt_pk_bf16_f32 v41, 0, v41
v_cvt_pk_bf16_f32 v42, 0, v42
v_cvt_pk_bf16_f32 v43, 0, v43
v_cvt_pk_bf16_f32 v44, 0, v44
v_cvt_pk_bf16_f32 v45, 0, v45
v_cvt_pk_bf16_f32 v46, 0, v46
v_cvt_pk_bf16_f32 v47, 0, v47
s_waitcnt lgkmcnt(0)
v_mul_f32 v32, v32, v112
v_mul_f32 v33, v33, v113
v_mul_f32 v34, v34, v114
v_mul_f32 v35, v35, v115
v_mul_f32 v36, v36, v116
v_mul_f32 v37, v37, v117
v_mul_f32 v38, v38, v118
v_mul_f32 v39, v39, v119
v_mul_f32 v40, v40, v120
v_mul_f32 v41, v41, v121
v_mul_f32 v42, v42, v122
v_mul_f32 v43, v43, v123
v_mul_f32 v44, v44, v124
v_mul_f32 v45, v45, v125
v_mul_f32 v46, v46, v126
v_mul_f32 v47, v47, v127
v_cvt_pk_bf16_f32 v32, 0, v32
v_cvt_pk_bf16_f32 v33, 0, v33
v_cvt_pk_bf16_f32 v34, 0, v34
v_cvt_pk_bf16_f32 v35, 0, v35
v_cvt_pk_bf16_f32 v36, 0, v36
v_cvt_pk_bf16_f32 v37, 0, v37
v_cvt_pk_bf16_f32 v38, 0, v38
v_cvt_pk_bf16_f32 v39, 0, v39
v_cvt_pk_bf16_f32 v40, 0, v40
v_cvt_pk_bf16_f32 v41, 0, v41
v_cvt_pk_bf16_f32 v42, 0, v42
v_cvt_pk_bf16_f32 v43, 0, v43
v_cvt_pk_bf16_f32 v44, 0, v44
v_cvt_pk_bf16_f32 v45, 0, v45
v_cvt_pk_bf16_f32 v46, 0, v46
v_cvt_pk_bf16_f32 v47, 0, v47
v_add_f32 v32, v32, v96
v_add_f32 v33, v33, v97
v_add_f32 v34, v34, v98
v_add_f32 v35, v35, v99
v_add_f32 v36, v36, v100
v_add_f32 v37, v37, v101
v_add_f32 v38, v38, v102
v_add_f32 v39, v39, v103
v_add_f32 v40, v40, v104
v_add_f32 v41, v41, v105
v_add_f32 v42, v42, v106
v_add_f32 v43, v43, v107
v_add_f32 v44, v44, v108
v_add_f32 v45, v45, v109
v_add_f32 v46, v46, v110
v_add_f32 v47, v47, v111
v_cvt_pk_bf16_f32 v128, v32, v33
v_cvt_pk_bf16_f32 v129, v34, v35
v_cvt_pk_bf16_f32 v130, v36, v37
v_cvt_pk_bf16_f32 v131, v38, v39
v_cvt_pk_bf16_f32 v132, v40, v41
v_cvt_pk_bf16_f32 v133, v42, v43
v_cvt_pk_bf16_f32 v134, v44, v45
v_cvt_pk_bf16_f32 v135, v46, v47
buffer_store_dwordx4 v[128:131], v5, s[20:23], s24 offen sc1
buffer_store_dwordx4 v[132:135], v5, s[20:23], s29 offen sc1
L_lnb_end:
s_endpgm
.text
.globl gateup_kernel
.p2align 8
.type gateup_kernel,@function
gateup_kernel:
s_cmp_ge_u32 s2, 256
s_cbranch_scc1 L_gateup_end
s_load_dwordx4 s[4:7], s[0:1], 48
s_load_dwordx2 s[8:9], s[0:1], 104
v_and_b32 v224, 63, v0
v_lshrrev_b32 v238, 6, v0
v_lshlrev_b32 v225, 4, v224
v_readfirstlane_b32 s33, v238
s_and_b32 s30, s2, 7
s_lshr_b32 s31, s2, 3
s_and_b32 s34, s30, 1
s_lshl_b32 s34, s34, 2
s_and_b32 s36, s31, 3
s_add_u32 s34, s34, s36
s_lshr_b32 s35, s30, 1
s_lshl_b32 s35, s35, 3
s_lshr_b32 s36, s31, 2
s_add_u32 s35, s35, s36
s_lshl_b32 s37, s34, 3
s_lshl_b32 s36, s33, 1
s_add_u32 s37, s37, s36
s_lshl_b32 s40, s37, 16
s_add_u32 s41, s40, 65536
s_movk_i32 s36, 4682
s_movk_i32 s38, 7168
v_add_u32 v238, 0, v224
v_mul_lo_u32 v239, v238, s36
v_lshrrev_b32 v239, 16, v239
v_mul_u32_u24 v240, 14, v239
v_sub_u32 v240, v238, v240
v_lshrrev_b32 v241, 1, v239
v_xor_b32 v241, v241, v239
v_and_b32 v241, 4, v241
v_mul_u32_u24 v241, 3, v241
v_xor_b32 v239, v239, v241
v_mul_lo_u32 v239, v239, s38
v_lshl_add_u32 v229, v240, 4, v239
v_add_u32 v238, 64, v224
v_mul_lo_u32 v239, v238, s36
v_lshrrev_b32 v239, 16, v239
v_mul_u32_u24 v240, 14, v239
v_sub_u32 v240, v238, v240
v_lshrrev_b32 v241, 1, v239
v_xor_b32 v241, v241, v239
v_and_b32 v241, 4, v241
v_mul_u32_u24 v241, 3, v241
v_xor_b32 v239, v239, v241
v_mul_lo_u32 v239, v239, s38
v_lshl_add_u32 v230, v240, 4, v239
v_subrev_u32 v230, 1024, v230
v_add_u32 v238, 128, v224
v_mul_lo_u32 v239, v238, s36
v_lshrrev_b32 v239, 16, v239
v_mul_u32_u24 v240, 14, v239
v_sub_u32 v240, v238, v240
v_lshrrev_b32 v241, 1, v239
v_xor_b32 v241, v241, v239
v_and_b32 v241, 4, v241
v_mul_u32_u24 v241, 3, v241
v_xor_b32 v239, v239, v241
v_mul_lo_u32 v239, v239, s38
v_lshl_add_u32 v231, v240, 4, v239
v_subrev_u32 v231, 2048, v231
v_add_u32 v238, 192, v224
v_mul_lo_u32 v239, v238, s36
v_lshrrev_b32 v239, 16, v239
v_mul_u32_u24 v240, 14, v239
v_sub_u32 v240, v238, v240
v_lshrrev_b32 v241, 1, v239
v_xor_b32 v241, v241, v239
v_and_b32 v241, 4, v241
v_mul_u32_u24 v241, 3, v241
v_xor_b32 v239, v239, v241
v_mul_lo_u32 v239, v239, s38
v_lshl_add_u32 v232, v240, 4, v239
v_subrev_u32 v232, 3072, v232
v_add_u32 v238, 256, v224
v_mul_lo_u32 v239, v238, s36
v_lshrrev_b32 v239, 16, v239
v_mul_u32_u24 v240, 14, v239
v_sub_u32 v240, v238, v240
v_lshrrev_b32 v241, 1, v239
v_xor_b32 v241, v241, v239
v_and_b32 v241, 4, v241
v_mul_u32_u24 v241, 3, v241
v_xor_b32 v239, v239, v241
v_mul_lo_u32 v239, v239, s38
v_lshl_add_u32 v233, v240, 4, v239
v_add_u32 v238, 320, v224
v_mul_lo_u32 v239, v238, s36
v_lshrrev_b32 v239, 16, v239
v_mul_u32_u24 v240, 14, v239
v_sub_u32 v240, v238, v240
v_lshrrev_b32 v241, 1, v239
v_xor_b32 v241, v241, v239
v_and_b32 v241, 4, v241
v_mul_u32_u24 v241, 3, v241
v_xor_b32 v239, v239, v241
v_mul_lo_u32 v239, v239, s38
v_lshl_add_u32 v234, v240, 4, v239
v_subrev_u32 v234, 1024, v234
v_add_u32 v238, 384, v224
v_mul_lo_u32 v239, v238, s36
v_lshrrev_b32 v239, 16, v239
v_mul_u32_u24 v240, 14, v239
v_sub_u32 v240, v238, v240
v_lshrrev_b32 v241, 1, v239
v_xor_b32 v241, v241, v239
v_and_b32 v241, 4, v241
v_mul_u32_u24 v241, 3, v241
v_xor_b32 v239, v239, v241
v_mul_lo_u32 v239, v239, s38
v_lshl_add_u32 v235, v240, 4, v239
v_subrev_u32 v235, 2048, v235
v_lshrrev_b32 v238, 4, v224
v_and_b32 v236, 15, v224
v_lshlrev_b32 v236, 4, v236
v_lshl_add_u32 v236, v238, 9, v236
s_mul_i32 s42, s35, 224
s_and_b32 s36, s33, 1
s_mul_i32 s39, s36, 229376
s_add_u32 s42, s42, s39
s_mul_i32 s43, s36, 7168
s_lshr_b32 s36, s33, 1
s_mul_i32 s39, s36, 14336
s_add_u32 s43, s43, s39
s_waitcnt lgkmcnt(0)
s_cmp_eq_u32 s36, 0
s_cselect_b32 s4, s4, s6
s_cselect_b32 s5, s5, s7
s_mov_b32 s12, s4
s_and_b32 s13, s5, 0xffff
s_mov_b32 s14, 7340032
s_mov_b32 s15, 0x20000
s_add_u32 s16, s8, 1048576
s_addc_u32 s17, s9, 0
s_and_b32 s17, s17, 0xffff
s_mov_b32 s18, 4194304
s_mov_b32 s19, 0x20000
s_add_u32 s60, s40, 49152
s_add_u32 s61, s41, 49152
s_add_u32 m0, s43, 0
s_nop 0
buffer_load_dwordx4 v229, s[12:15], s42 offen offset:0 lds
buffer_load_dwordx4 v230, s[12:15], s42 offen offset:1024 lds
buffer_load_dwordx4 v231, s[12:15], s42 offen offset:2048 lds
buffer_load_dwordx4 v232, s[12:15], s42 offen offset:3072 lds
s_add_u32 m0, s43, 4096
s_nop 0
buffer_load_dwordx4 v233, s[12:15], s42 offen offset:0 lds
buffer_load_dwordx4 v234, s[12:15], s42 offen offset:1024 lds
buffer_load_dwordx4 v235, s[12:15], s42 offen offset:2048 lds
s_add_u32 s42, s42, 458752
buffer_load_dwordx4 a[0:3], v236, s[16:19], s40 offen offset:0
buffer_load_dwordx4 a[4:7], v236, s[16:19], s40 offen offset:256
buffer_load_dwordx4 a[8:11], v236, s[16:19], s41 offen offset:0
buffer_load_dwordx4 a[12:15], v236, s[16:19], s41 offen offset:256
buffer_load_dwordx4 a[16:19], v236, s[16:19], s40 offen offset:2048
buffer_load_dwordx4 a[20:23], v236, s[16:19], s40 offen offset:2304
s_add_u32 s40, s40, 4096
buffer_load_dwordx4 a[24:27], v236, s[16:19], s41 offen offset:2048
buffer_load_dwordx4 a[28:31], v236, s[16:19], s41 offen offset:2304
s_add_u32 s41, s41, 4096
v_bfe_u32 v238, v224, 2, 3
v_lshrrev_b32 v239, 5, v224
v_lshl_add_u32 v238, v239, 4, v238
v_mul_u32_u24 v238, 224, v238
v_and_b32 v239, 3, v224
v_lshl_add_u32 v226, v239, 3, v238
v_add_u32 v227, 57344, v226
v_add_u32 v228, 114688, v226
v_mov_b32 v254, v226
s_add_u32 s20, s8, 8388608
s_addc_u32 s21, s9, 0
s_and_b32 s21, s21, 0xffff
s_mov_b32 s22, 14680064
s_mov_b32 s23, 0x20000
s_mul_i32 s44, s37, 229376
s_mul_i32 s39, s35, 7168
s_add_u32 s44, s44, s39
s_mov_b32 s50, 0xc0135761
s_mov_b32 s51, 0xbdd2d3e8
v_mov_b32 v237, s50
s_add_u32 s45, s44, 229376
s_add_u32 s47, s44, 4096
s_add_u32 s48, s45, 4096
s_waitcnt vmcnt(8)
s_barrier
ds_read_b64_tr_b16 a[192:193], v226 offset:0
ds_read_b64_tr_b16 a[194:195], v226 offset:1792
ds_read_b64_tr_b16 a[196:197], v226 offset:14336
ds_read_b64_tr_b16 a[198:199], v226 offset:16128
ds_read_b64_tr_b16 a[200:201], v226 offset:32
ds_read_b64_tr_b16 a[202:203], v226 offset:1824
ds_read_b64_tr_b16 a[204:205], v226 offset:14368
ds_read_b64_tr_b16 a[206:207], v226 offset:16160
ds_read_b64_tr_b16 a[208:209], v226 offset:64
ds_read_b64_tr_b16 a[210:211], v226 offset:1856
ds_read_b64_tr_b16 a[212:213], v226 offset:14400
ds_read_b64_tr_b16 a[214:215], v226 offset:16192
s_waitcnt vmcnt(4) lgkmcnt(8)
v_mfma_f32_16x16x32_bf16 v[0:3], a[192:195], a[0:3], 0
ds_read_b64_tr_b16 a[216:217], v226 offset:96
v_mfma_f32_16x16x32_bf16 v[4:7], a[192:195], a[4:7], 0
buffer_load_dwordx4 a[32:35], v236, s[16:19], s40 offen offset:0
v_mfma_f32_16x16x32_bf16 v[112:115], a[192:195], a[8:11], 0
ds_read_b64_tr_b16 a[218:219], v226 offset:1888
v_mfma_f32_16x16x32_bf16 v[116:119], a[192:195], a[12:15], 0
s_add_u32 m0, s43, 28672
v_mfma_f32_16x16x32_bf16 v[8:11], a[196:199], a[0:3], 0
ds_read_b64_tr_b16 a[220:221], v226 offset:14432
v_mfma_f32_16x16x32_bf16 v[12:15], a[196:199], a[4:7], 0
buffer_load_dwordx4 v229, s[12:15], s42 offen offset:0 lds
v_mfma_f32_16x16x32_bf16 v[120:123], a[196:199], a[8:11], 0
ds_read_b64_tr_b16 a[222:223], v226 offset:16224
v_mfma_f32_16x16x32_bf16 v[124:127], a[196:199], a[12:15], 0
s_waitcnt lgkmcnt(8)
v_mfma_f32_16x16x32_bf16 v[16:19], a[200:203], a[0:3], 0
ds_read_b64_tr_b16 a[192:193], v226 offset:128
v_mfma_f32_16x16x32_bf16 v[20:23], a[200:203], a[4:7], 0
v_mfma_f32_16x16x32_bf16 v[128:131], a[200:203], a[8:11], 0
ds_read_b64_tr_b16 a[194:195], v226 offset:1920
v_mfma_f32_16x16x32_bf16 v[132:135], a[200:203], a[12:15], 0
v_mfma_f32_16x16x32_bf16 v[24:27], a[204:207], a[0:3], 0
ds_read_b64_tr_b16 a[196:197], v226 offset:14464
v_mfma_f32_16x16x32_bf16 v[28:31], a[204:207], a[4:7], 0
buffer_load_dwordx4 v230, s[12:15], s42 offen offset:1024 lds
v_mfma_f32_16x16x32_bf16 v[136:139], a[204:207], a[8:11], 0
ds_read_b64_tr_b16 a[198:199], v226 offset:16256
v_mfma_f32_16x16x32_bf16 v[140:143], a[204:207], a[12:15], 0
s_waitcnt lgkmcnt(8)
v_mfma_f32_16x16x32_bf16 v[32:35], a[208:211], a[0:3], 0
ds_read_b64_tr_b16 a[200:201], v226 offset:160
v_mfma_f32_16x16x32_bf16 v[36:39], a[208:211], a[4:7], 0
buffer_load_dwordx4 v231, s[12:15], s42 offen offset:2048 lds
v_mfma_f32_16x16x32_bf16 v[144:147], a[208:211], a[8:11], 0
ds_read_b64_tr_b16 a[202:203], v226 offset:1952
v_mfma_f32_16x16x32_bf16 v[148:151], a[208:211], a[12:15], 0
v_mfma_f32_16x16x32_bf16 v[40:43], a[212:215], a[0:3], 0
ds_read_b64_tr_b16 a[204:205], v226 offset:14496
v_mfma_f32_16x16x32_bf16 v[44:47], a[212:215], a[4:7], 0
v_mfma_f32_16x16x32_bf16 v[152:155], a[212:215], a[8:11], 0
ds_read_b64_tr_b16 a[206:207], v226 offset:16288
v_mfma_f32_16x16x32_bf16 v[156:159], a[212:215], a[12:15], 0
s_waitcnt lgkmcnt(8)
v_mfma_f32_16x16x32_bf16 v[48:51], a[216:219], a[0:3], 0
ds_read_b64_tr_b16 a[208:209], v226 offset:192
v_mfma_f32_16x16x32_bf16 v[52:55], a[216:219], a[4:7], 0
buffer_load_dwordx4 v232, s[12:15], s42 offen offset:3072 lds
v_mfma_f32_16x16x32_bf16 v[160:163], a[216:219], a[8:11], 0
ds_read_b64_tr_b16 a[210:211], v226 offset:1984
v_mfma_f32_16x16x32_bf16 v[164:167], a[216:219], a[12:15], 0
s_add_u32 m0, s43, 32768
v_mfma_f32_16x16x32_bf16 v[56:59], a[220:223], a[0:3], 0
ds_read_b64_tr_b16 a[212:213], v226 offset:14528
v_mfma_f32_16x16x32_bf16 v[60:63], a[220:223], a[4:7], 0
buffer_load_dwordx4 v233, s[12:15], s42 offen offset:0 lds
v_mfma_f32_16x16x32_bf16 v[168:171], a[220:223], a[8:11], 0
ds_read_b64_tr_b16 a[214:215], v226 offset:16320
v_mfma_f32_16x16x32_bf16 v[172:175], a[220:223], a[12:15], 0
s_waitcnt lgkmcnt(8)
v_mfma_f32_16x16x32_bf16 v[64:67], a[192:195], a[0:3], 0
ds_read_b64_tr_b16 a[216:217], v226 offset:7168
v_mfma_f32_16x16x32_bf16 v[68:71], a[192:195], a[4:7], 0
v_mfma_f32_16x16x32_bf16 v[176:179], a[192:195], a[8:11], 0
ds_read_b64_tr_b16 a[218:219], v226 offset:8960
v_mfma_f32_16x16x32_bf16 v[180:183], a[192:195], a[12:15], 0
v_mfma_f32_16x16x32_bf16 v[72:75], a[196:199], a[0:3], 0
ds_read_b64_tr_b16 a[220:221], v226 offset:21504
v_mfma_f32_16x16x32_bf16 v[76:79], a[196:199], a[4:7], 0
buffer_load_dwordx4 v234, s[12:15], s42 offen offset:1024 lds
v_mfma_f32_16x16x32_bf16 v[184:187], a[196:199], a[8:11], 0
ds_read_b64_tr_b16 a[222:223], v226 offset:23296
v_mfma_f32_16x16x32_bf16 v[188:191], a[196:199], a[12:15], 0
s_waitcnt lgkmcnt(8)
v_mfma_f32_16x16x32_bf16 v[80:83], a[200:203], a[0:3], 0
ds_read_b64_tr_b16 a[192:193], v226 offset:7200
v_mfma_f32_16x16x32_bf16 v[84:87], a[200:203], a[4:7], 0
buffer_load_dwordx4 v235, s[12:15], s42 offen offset:2048 lds
v_mfma_f32_16x16x32_bf16 v[192:195], a[200:203], a[8:11], 0
ds_read_b64_tr_b16 a[194:195], v226 offset:8992
v_mfma_f32_16x16x32_bf16 v[196:199], a[200:203], a[12:15], 0
s_add_u32 s42, s42, 458752
v_mfma_f32_16x16x32_bf16 v[88:91], a[204:207], a[0:3], 0
ds_read_b64_tr_b16 a[196:197], v226 offset:21536
v_mfma_f32_16x16x32_bf16 v[92:95], a[204:207], a[4:7], 0
v_mfma_f32_16x16x32_bf16 v[200:203], a[204:207], a[8:11], 0
ds_read_b64_tr_b16 a[198:199], v226 offset:23328
v_mfma_f32_16x16x32_bf16 v[204:207], a[204:207], a[12:15], 0
s_waitcnt lgkmcnt(8)
v_mfma_f32_16x16x32_bf16 v[96:99], a[208:211], a[0:3], 0
ds_read_b64_tr_b16 a[200:201], v226 offset:7232
v_mfma_f32_16x16x32_bf16 v[100:103], a[208:211], a[4:7], 0
buffer_load_dwordx4 a[36:39], v236, s[16:19], s40 offen offset:256
v_mfma_f32_16x16x32_bf16 v[208:211], a[208:211], a[8:11], 0
ds_read_b64_tr_b16 a[202:203], v226 offset:9024
v_mfma_f32_16x16x32_bf16 v[212:215], a[208:211], a[12:15], 0
v_mfma_f32_16x16x32_bf16 v[104:107], a[212:215], a[0:3], 0
ds_read_b64_tr_b16 a[204:205], v226 offset:21568
v_mfma_f32_16x16x32_bf16 v[108:111], a[212:215], a[4:7], 0
buffer_load_dwordx4 a[40:43], v236, s[16:19], s41 offen offset:0
v_mfma_f32_16x16x32_bf16 v[216:219], a[212:215], a[8:11], 0
ds_read_b64_tr_b16 a[206:207], v226 offset:23360
v_mfma_f32_16x16x32_bf16 v[220:223], a[212:215], a[12:15], 0
s_waitcnt vmcnt(10) lgkmcnt(8)
v_mfma_f32_16x16x32_bf16 v[0:3], a[216:219], a[16:19], v[0:3]
ds_read_b64_tr_b16 a[208:209], v226 offset:7264
v_mfma_f32_16x16x32_bf16 v[4:7], a[216:219], a[20:23], v[4:7]
v_mfma_f32_16x16x32_bf16 v[112:115], a[216:219], a[24:27], v[112:115]
ds_read_b64_tr_b16 a[210:211], v226 offset:9056
v_mfma_f32_16x16x32_bf16 v[116:119], a[216:219], a[28:31], v[116:119]
v_mfma_f32_16x16x32_bf16 v[8:11], a[220:223], a[16:19], v[8:11]
ds_read_b64_tr_b16 a[212:213], v226 offset:21600
v_mfma_f32_16x16x32_bf16 v[12:15], a[220:223], a[20:23], v[12:15]
buffer_load_dwordx4 a[44:47], v236, s[16:19], s41 offen offset:256
v_mfma_f32_16x16x32_bf16 v[120:123], a[220:223], a[24:27], v[120:123]
ds_read_b64_tr_b16 a[214:215], v226 offset:23392
v_mfma_f32_16x16x32_bf16 v[124:127], a[220:223], a[28:31], v[124:127]
s_waitcnt lgkmcnt(8)
v_mfma_f32_16x16x32_bf16 v[16:19], a[192:195], a[16:19], v[16:19]
ds_read_b64_tr_b16 a[216:217], v226 offset:7296
v_mfma_f32_16x16x32_bf16 v[20:23], a[192:195], a[20:23], v[20:23]
buffer_load_dwordx4 a[48:51], v236, s[16:19], s40 offen offset:2048
v_mfma_f32_16x16x32_bf16 v[128:131], a[192:195], a[24:27], v[128:131]
ds_read_b64_tr_b16 a[218:219], v226 offset:9088
v_mfma_f32_16x16x32_bf16 v[132:135], a[192:195], a[28:31], v[132:135]
v_mfma_f32_16x16x32_bf16 v[24:27], a[196:199], a[16:19], v[24:27]
ds_read_b64_tr_b16 a[220:221], v226 offset:21632
v_mfma_f32_16x16x32_bf16 v[28:31], a[196:199], a[20:23], v[28:31]
v_mfma_f32_16x16x32_bf16 v[136:139], a[196:199], a[24:27], v[136:139]
ds_read_b64_tr_b16 a[222:223], v226 offset:23424
v_mfma_f32_16x16x32_bf16 v[140:143], a[196:199], a[28:31], v[140:143]
s_waitcnt lgkmcnt(8)
v_mfma_f32_16x16x32_bf16 v[32:35], a[200:203], a[16:19], v[32:35]
ds_read_b64_tr_b16 a[192:193], v226 offset:7328
v_mfma_f32_16x16x32_bf16 v[36:39], a[200:203], a[20:23], v[36:39]
buffer_load_dwordx4 a[52:55], v236, s[16:19], s40 offen offset:2304
v_mfma_f32_16x16x32_bf16 v[144:147], a[200:203], a[24:27], v[144:147]
ds_read_b64_tr_b16 a[194:195], v226 offset:9120
v_mfma_f32_16x16x32_bf16 v[148:151], a[200:203], a[28:31], v[148:151]
s_add_u32 s40, s40, 4096
v_mfma_f32_16x16x32_bf16 v[40:43], a[204:207], a[16:19], v[40:43]
ds_read_b64_tr_b16 a[196:197], v226 offset:21664
v_mfma_f32_16x16x32_bf16 v[44:47], a[204:207], a[20:23], v[44:47]
buffer_load_dwordx4 a[56:59], v236, s[16:19], s41 offen offset:2048
v_mfma_f32_16x16x32_bf16 v[152:155], a[204:207], a[24:27], v[152:155]
ds_read_b64_tr_b16 a[198:199], v226 offset:23456
v_mfma_f32_16x16x32_bf16 v[156:159], a[204:207], a[28:31], v[156:159]
s_waitcnt lgkmcnt(8)
v_mfma_f32_16x16x32_bf16 v[48:51], a[208:211], a[16:19], v[48:51]
ds_read_b64_tr_b16 a[200:201], v226 offset:7360
v_mfma_f32_16x16x32_bf16 v[52:55], a[208:211], a[20:23], v[52:55]
v_mfma_f32_16x16x32_bf16 v[160:163], a[208:211], a[24:27], v[160:163]
ds_read_b64_tr_b16 a[202:203], v226 offset:9152
v_mfma_f32_16x16x32_bf16 v[164:167], a[208:211], a[28:31], v[164:167]
v_mfma_f32_16x16x32_bf16 v[56:59], a[212:215], a[16:19], v[56:59]
ds_read_b64_tr_b16 a[204:205], v226 offset:21696
v_mfma_f32_16x16x32_bf16 v[60:63], a[212:215], a[20:23], v[60:63]
buffer_load_dwordx4 a[60:63], v236, s[16:19], s41 offen offset:2304
v_mfma_f32_16x16x32_bf16 v[168:171], a[212:215], a[24:27], v[168:171]
ds_read_b64_tr_b16 a[206:207], v226 offset:23488
v_mfma_f32_16x16x32_bf16 v[172:175], a[212:215], a[28:31], v[172:175]
s_waitcnt lgkmcnt(8)
s_waitcnt vmcnt(7)
s_barrier
s_add_u32 s41, s41, 4096
s_add_u32 m0, s43, 57344
v_mfma_f32_16x16x32_bf16 v[64:67], a[216:219], a[16:19], v[64:67]
ds_read_b64_tr_b16 a[208:209], v226 offset:28672
v_mfma_f32_16x16x32_bf16 v[68:71], a[216:219], a[20:23], v[68:71]
buffer_load_dwordx4 v229, s[12:15], s42 offen offset:0 lds
v_mfma_f32_16x16x32_bf16 v[176:179], a[216:219], a[24:27], v[176:179]
ds_read_b64_tr_b16 a[210:211], v226 offset:30464
v_mfma_f32_16x16x32_bf16 v[180:183], a[216:219], a[28:31], v[180:183]
v_mfma_f32_16x16x32_bf16 v[72:75], a[220:223], a[16:19], v[72:75]
ds_read_b64_tr_b16 a[212:213], v226 offset:43008
v_mfma_f32_16x16x32_bf16 v[76:79], a[220:223], a[20:23], v[76:79]
v_mfma_f32_16x16x32_bf16 v[184:187], a[220:223], a[24:27], v[184:187]
ds_read_b64_tr_b16 a[214:215], v226 offset:44800
v_mfma_f32_16x16x32_bf16 v[188:191], a[220:223], a[28:31], v[188:191]
s_waitcnt lgkmcnt(8)
v_mfma_f32_16x16x32_bf16 v[80:83], a[192:195], a[16:19], v[80:83]
ds_read_b64_tr_b16 a[216:217], v226 offset:28704
v_mfma_f32_16x16x32_bf16 v[84:87], a[192:195], a[20:23], v[84:87]
buffer_load_dwordx4 v230, s[12:15], s42 offen offset:1024 lds
v_mfma_f32_16x16x32_bf16 v[192:195], a[192:195], a[24:27], v[192:195]
ds_read_b64_tr_b16 a[218:219], v226 offset:30496
v_mfma_f32_16x16x32_bf16 v[196:199], a[192:195], a[28:31], v[196:199]
v_mfma_f32_16x16x32_bf16 v[88:91], a[196:199], a[16:19], v[88:91]
ds_read_b64_tr_b16 a[220:221], v226 offset:43040
v_mfma_f32_16x16x32_bf16 v[92:95], a[196:199], a[20:23], v[92:95]
buffer_load_dwordx4 v231, s[12:15], s42 offen offset:2048 lds
v_mfma_f32_16x16x32_bf16 v[200:203], a[196:199], a[24:27], v[200:203]
ds_read_b64_tr_b16 a[222:223], v226 offset:44832
v_mfma_f32_16x16x32_bf16 v[204:207], a[196:199], a[28:31], v[204:207]
s_waitcnt lgkmcnt(8)
v_mfma_f32_16x16x32_bf16 v[96:99], a[200:203], a[16:19], v[96:99]
ds_read_b64_tr_b16 a[192:193], v226 offset:28736
v_mfma_f32_16x16x32_bf16 v[100:103], a[200:203], a[20:23], v[100:103]
v_mfma_f32_16x16x32_bf16 v[208:211], a[200:203], a[24:27], v[208:211]
ds_read_b64_tr_b16 a[194:195], v226 offset:30528
v_mfma_f32_16x16x32_bf16 v[212:215], a[200:203], a[28:31], v[212:215]
v_mfma_f32_16x16x32_bf16 v[104:107], a[204:207], a[16:19], v[104:107]
ds_read_b64_tr_b16 a[196:197], v226 offset:43072
v_mfma_f32_16x16x32_bf16 v[108:111], a[204:207], a[20:23], v[108:111]
buffer_load_dwordx4 v232, s[12:15], s42 offen offset:3072 lds
v_mfma_f32_16x16x32_bf16 v[216:219], a[204:207], a[24:27], v[216:219]
ds_read_b64_tr_b16 a[198:199], v226 offset:44864
v_mfma_f32_16x16x32_bf16 v[220:223], a[204:207], a[28:31], v[220:223]
s_waitcnt vmcnt(8) lgkmcnt(8)
s_add_u32 m0, s43, 61440
v_mfma_f32_16x16x32_bf16 v[0:3], a[208:211], a[32:35], v[0:3]
ds_read_b64_tr_b16 a[200:201], v226 offset:28768
v_mfma_f32_16x16x32_bf16 v[4:7], a[208:211], a[36:39], v[4:7]
buffer_load_dwordx4 v233, s[12:15], s42 offen offset:0 lds
v_mfma_f32_16x16x32_bf16 v[112:115], a[208:211], a[40:43], v[112:115]
ds_read_b64_tr_b16 a[202:203], v226 offset:30560
v_mfma_f32_16x16x32_bf16 v[116:119], a[208:211], a[44:47], v[116:119]
v_mfma_f32_16x16x32_bf16 v[8:11], a[212:215], a[32:35], v[8:11]
ds_read_b64_tr_b16 a[204:205], v226 offset:43104
v_mfma_f32_16x16x32_bf16 v[12:15], a[212:215], a[36:39], v[12:15]
v_mfma_f32_16x16x32_bf16 v[120:123], a[212:215], a[40:43], v[120:123]
ds_read_b64_tr_b16 a[206:207], v226 offset:44896
v_mfma_f32_16x16x32_bf16 v[124:127], a[212:215], a[44:47], v[124:127]
s_waitcnt lgkmcnt(8)
v_mfma_f32_16x16x32_bf16 v[16:19], a[216:219], a[32:35], v[16:19]
ds_read_b64_tr_b16 a[208:209], v226 offset:28800
v_mfma_f32_16x16x32_bf16 v[20:23], a[216:219], a[36:39], v[20:23]
buffer_load_dwordx4 v234, s[12:15], s42 offen offset:1024 lds
v_mfma_f32_16x16x32_bf16 v[128:131], a[216:219], a[40:43], v[128:131]
ds_read_b64_tr_b16 a[210:211], v226 offset:30592
v_mfma_f32_16x16x32_bf16 v[132:135], a[216:219], a[44:47], v[132:135]
v_mfma_f32_16x16x32_bf16 v[24:27], a[220:223], a[32:35], v[24:27]
ds_read_b64_tr_b16 a[212:213], v226 offset:43136
v_mfma_f32_16x16x32_bf16 v[28:31], a[220:223], a[36:39], v[28:31]
buffer_load_dwordx4 v235, s[12:15], s42 offen offset:2048 lds
v_mfma_f32_16x16x32_bf16 v[136:139], a[220:223], a[40:43], v[136:139]
ds_read_b64_tr_b16 a[214:215], v226 offset:44928
v_mfma_f32_16x16x32_bf16 v[140:143], a[220:223], a[44:47], v[140:143]
s_waitcnt lgkmcnt(8)
s_add_u32 s42, s42, 458752
v_mfma_f32_16x16x32_bf16 v[32:35], a[192:195], a[32:35], v[32:35]
ds_read_b64_tr_b16 a[216:217], v226 offset:28832
v_mfma_f32_16x16x32_bf16 v[36:39], a[192:195], a[36:39], v[36:39]
v_mfma_f32_16x16x32_bf16 v[144:147], a[192:195], a[40:43], v[144:147]
ds_read_b64_tr_b16 a[218:219], v226 offset:30624
v_mfma_f32_16x16x32_bf16 v[148:151], a[192:195], a[44:47], v[148:151]
v_mfma_f32_16x16x32_bf16 v[40:43], a[196:199], a[32:35], v[40:43]
ds_read_b64_tr_b16 a[220:221], v226 offset:43168
v_mfma_f32_16x16x32_bf16 v[44:47], a[196:199], a[36:39], v[44:47]
buffer_load_dwordx4 a[64:67], v236, s[16:19], s40 offen offset:0
v_mfma_f32_16x16x32_bf16 v[152:155], a[196:199], a[40:43], v[152:155]
ds_read_b64_tr_b16 a[222:223], v226 offset:44960
v_mfma_f32_16x16x32_bf16 v[156:159], a[196:199], a[44:47], v[156:159]
s_waitcnt lgkmcnt(8)
v_mfma_f32_16x16x32_bf16 v[48:51], a[200:203], a[32:35], v[48:51]
ds_read_b64_tr_b16 a[192:193], v226 offset:28864
v_mfma_f32_16x16x32_bf16 v[52:55], a[200:203], a[36:39], v[52:55]
buffer_load_dwordx4 a[68:71], v236, s[16:19], s40 offen offset:256
v_mfma_f32_16x16x32_bf16 v[160:163], a[200:203], a[40:43], v[160:163]
ds_read_b64_tr_b16 a[194:195], v226 offset:30656
v_mfma_f32_16x16x32_bf16 v[164:167], a[200:203], a[44:47], v[164:167]
v_mfma_f32_16x16x32_bf16 v[56:59], a[204:207], a[32:35], v[56:59]
ds_read_b64_tr_b16 a[196:197], v226 offset:43200
v_mfma_f32_16x16x32_bf16 v[60:63], a[204:207], a[36:39], v[60:63]
v_mfma_f32_16x16x32_bf16 v[168:171], a[204:207], a[40:43], v[168:171]
ds_read_b64_tr_b16 a[198:199], v226 offset:44992
v_mfma_f32_16x16x32_bf16 v[172:175], a[204:207], a[44:47], v[172:175]
s_waitcnt lgkmcnt(8)
v_mfma_f32_16x16x32_bf16 v[64:67], a[208:211], a[32:35], v[64:67]
ds_read_b64_tr_b16 a[200:201], v226 offset:35840
v_mfma_f32_16x16x32_bf16 v[68:71], a[208:211], a[36:39], v[68:71]
buffer_load_dwordx4 a[72:75], v236, s[16:19], s41 offen offset:0
v_mfma_f32_16x16x32_bf16 v[176:179], a[208:211], a[40:43], v[176:179]
ds_read_b64_tr_b16 a[202:203], v226 offset:37632
v_mfma_f32_16x16x32_bf16 v[180:183], a[208:211], a[44:47], v[180:183]
v_mfma_f32_16x16x32_bf16 v[72:75], a[212:215], a[32:35], v[72:75]
ds_read_b64_tr_b16 a[204:205], v226 offset:50176
v_mfma_f32_16x16x32_bf16 v[76:79], a[212:215], a[36:39], v[76:79]
buffer_load_dwordx4 a[76:79], v236, s[16:19], s41 offen offset:256
v_mfma_f32_16x16x32_bf16 v[184:187], a[212:215], a[40:43], v[184:187]
ds_read_b64_tr_b16 a[206:207], v226 offset:51968
v_mfma_f32_16x16x32_bf16 v[188:191], a[212:215], a[44:47], v[188:191]
s_waitcnt lgkmcnt(8)
v_mfma_f32_16x16x32_bf16 v[80:83], a[216:219], a[32:35], v[80:83]
ds_read_b64_tr_b16 a[208:209], v226 offset:35872
v_mfma_f32_16x16x32_bf16 v[84:87], a[216:219], a[36:39], v[84:87]
v_mfma_f32_16x16x32_bf16 v[192:195], a[216:219], a[40:43], v[192:195]
ds_read_b64_tr_b16 a[210:211], v226 offset:37664
v_mfma_f32_16x16x32_bf16 v[196:199], a[216:219], a[44:47], v[196:199]
v_mfma_f32_16x16x32_bf16 v[88:91], a[220:223], a[32:35], v[88:91]
ds_read_b64_tr_b16 a[212:213], v226 offset:50208
v_mfma_f32_16x16x32_bf16 v[92:95], a[220:223], a[36:39], v[92:95]
buffer_load_dwordx4 a[80:83], v236, s[16:19], s40 offen offset:2048
v_mfma_f32_16x16x32_bf16 v[200:203], a[220:223], a[40:43], v[200:203]
ds_read_b64_tr_b16 a[214:215], v226 offset:52000
v_mfma_f32_16x16x32_bf16 v[204:207], a[220:223], a[44:47], v[204:207]
s_waitcnt lgkmcnt(8)
v_mfma_f32_16x16x32_bf16 v[96:99], a[192:195], a[32:35], v[96:99]
ds_read_b64_tr_b16 a[216:217], v226 offset:35904
v_mfma_f32_16x16x32_bf16 v[100:103], a[192:195], a[36:39], v[100:103]
buffer_load_dwordx4 a[84:87], v236, s[16:19], s40 offen offset:2304
v_mfma_f32_16x16x32_bf16 v[208:211], a[192:195], a[40:43], v[208:211]
ds_read_b64_tr_b16 a[218:219], v226 offset:37696
v_mfma_f32_16x16x32_bf16 v[212:215], a[192:195], a[44:47], v[212:215]
s_add_u32 s40, s40, 4096
v_mfma_f32_16x16x32_bf16 v[104:107], a[196:199], a[32:35], v[104:107]
ds_read_b64_tr_b16 a[220:221], v226 offset:50240
v_mfma_f32_16x16x32_bf16 v[108:111], a[196:199], a[36:39], v[108:111]
v_mfma_f32_16x16x32_bf16 v[216:219], a[196:199], a[40:43], v[216:219]
ds_read_b64_tr_b16 a[222:223], v226 offset:52032
v_mfma_f32_16x16x32_bf16 v[220:223], a[196:199], a[44:47], v[220:223]
s_waitcnt vmcnt(13) lgkmcnt(8)
v_mfma_f32_16x16x32_bf16 v[0:3], a[200:203], a[48:51], v[0:3]
ds_read_b64_tr_b16 a[192:193], v226 offset:35936
v_mfma_f32_16x16x32_bf16 v[4:7], a[200:203], a[52:55], v[4:7]
buffer_load_dwordx4 a[88:91], v236, s[16:19], s41 offen offset:2048
v_mfma_f32_16x16x32_bf16 v[112:115], a[200:203], a[56:59], v[112:115]
ds_read_b64_tr_b16 a[194:195], v226 offset:37728
v_mfma_f32_16x16x32_bf16 v[116:119], a[200:203], a[60:63], v[116:119]
v_mfma_f32_16x16x32_bf16 v[8:11], a[204:207], a[48:51], v[8:11]
ds_read_b64_tr_b16 a[196:197], v226 offset:50272
v_mfma_f32_16x16x32_bf16 v[12:15], a[204:207], a[52:55], v[12:15]
buffer_load_dwordx4 a[92:95], v236, s[16:19], s41 offen offset:2304
v_mfma_f32_16x16x32_bf16 v[120:123], a[204:207], a[56:59], v[120:123]
ds_read_b64_tr_b16 a[198:199], v226 offset:52064
v_mfma_f32_16x16x32_bf16 v[124:127], a[204:207], a[60:63], v[124:127]
s_waitcnt lgkmcnt(8)
s_add_u32 s41, s41, 4096
v_mfma_f32_16x16x32_bf16 v[16:19], a[208:211], a[48:51], v[16:19]
ds_read_b64_tr_b16 a[200:201], v226 offset:35968
v_mfma_f32_16x16x32_bf16 v[20:23], a[208:211], a[52:55], v[20:23]
v_mfma_f32_16x16x32_bf16 v[128:131], a[208:211], a[56:59], v[128:131]
ds_read_b64_tr_b16 a[202:203], v226 offset:37760
v_mfma_f32_16x16x32_bf16 v[132:135], a[208:211], a[60:63], v[132:135]
s_add_u32 m0, s43, 86016
v_mfma_f32_16x16x32_bf16 v[24:27], a[212:215], a[48:51], v[24:27]
ds_read_b64_tr_b16 a[204:205], v226 offset:50304
v_mfma_f32_16x16x32_bf16 v[28:31], a[212:215], a[52:55], v[28:31]
buffer_load_dwordx4 v229, s[12:15], s42 offen offset:0 lds
v_mfma_f32_16x16x32_bf16 v[136:139], a[212:215], a[56:59], v[136:139]
ds_read_b64_tr_b16 a[206:207], v226 offset:52096
v_mfma_f32_16x16x32_bf16 v[140:143], a[212:215], a[60:63], v[140:143]
s_waitcnt lgkmcnt(8)
v_mfma_f32_16x16x32_bf16 v[32:35], a[216:219], a[48:51], v[32:35]
ds_read_b64_tr_b16 a[208:209], v226 offset:36000
v_mfma_f32_16x16x32_bf16 v[36:39], a[216:219], a[52:55], v[36:39]
buffer_load_dwordx4 v230, s[12:15], s42 offen offset:1024 lds
v_mfma_f32_16x16x32_bf16 v[144:147], a[216:219], a[56:59], v[144:147]
ds_read_b64_tr_b16 a[210:211], v226 offset:37792
v_mfma_f32_16x16x32_bf16 v[148:151], a[216:219], a[60:63], v[148:151]
v_mfma_f32_16x16x32_bf16 v[40:43], a[220:223], a[48:51], v[40:43]
ds_read_b64_tr_b16 a[212:213], v226 offset:50336
v_mfma_f32_16x16x32_bf16 v[44:47], a[220:223], a[52:55], v[44:47]
v_mfma_f32_16x16x32_bf16 v[152:155], a[220:223], a[56:59], v[152:155]
ds_read_b64_tr_b16 a[214:215], v226 offset:52128
v_mfma_f32_16x16x32_bf16 v[156:159], a[220:223], a[60:63], v[156:159]
s_waitcnt lgkmcnt(8)
v_mfma_f32_16x16x32_bf16 v[48:51], a[192:195], a[48:51], v[48:51]
ds_read_b64_tr_b16 a[216:217], v226 offset:36032
v_mfma_f32_16x16x32_bf16 v[52:55], a[192:195], a[52:55], v[52:55]
buffer_load_dwordx4 v231, s[12:15], s42 offen offset:2048 lds
v_mfma_f32_16x16x32_bf16 v[160:163], a[192:195], a[56:59], v[160:163]
ds_read_b64_tr_b16 a[218:219], v226 offset:37824
v_mfma_f32_16x16x32_bf16 v[164:167], a[192:195], a[60:63], v[164:167]
v_mfma_f32_16x16x32_bf16 v[56:59], a[196:199], a[48:51], v[56:59]
ds_read_b64_tr_b16 a[220:221], v226 offset:50368
v_mfma_f32_16x16x32_bf16 v[60:63], a[196:199], a[52:55], v[60:63]
buffer_load_dwordx4 v232, s[12:15], s42 offen offset:3072 lds
v_mfma_f32_16x16x32_bf16 v[168:171], a[196:199], a[56:59], v[168:171]
ds_read_b64_tr_b16 a[222:223], v226 offset:52160
v_mfma_f32_16x16x32_bf16 v[172:175], a[196:199], a[60:63], v[172:175]
s_waitcnt lgkmcnt(8)
s_waitcnt vmcnt(12)
s_barrier
v_mfma_f32_16x16x32_bf16 v[64:67], a[200:203], a[48:51], v[64:67]
ds_read_b64_tr_b16 a[192:193], v227 offset:0
v_mfma_f32_16x16x32_bf16 v[68:71], a[200:203], a[52:55], v[68:71]
v_mfma_f32_16x16x32_bf16 v[176:179], a[200:203], a[56:59], v[176:179]
ds_read_b64_tr_b16 a[194:195], v227 offset:1792
v_mfma_f32_16x16x32_bf16 v[180:183], a[200:203], a[60:63], v[180:183]
s_add_u32 m0, s43, 90112
v_mfma_f32_16x16x32_bf16 v[72:75], a[204:207], a[48:51], v[72:75]
ds_read_b64_tr_b16 a[196:197], v227 offset:14336
v_mfma_f32_16x16x32_bf16 v[76:79], a[204:207], a[52:55], v[76:79]
buffer_load_dwordx4 v233, s[12:15], s42 offen offset:0 lds
v_mfma_f32_16x16x32_bf16 v[184:187], a[204:207], a[56:59], v[184:187]
ds_read_b64_tr_b16 a[198:199], v227 offset:16128
v_mfma_f32_16x16x32_bf16 v[188:191], a[204:207], a[60:63], v[188:191]
s_waitcnt lgkmcnt(8)
v_mfma_f32_16x16x32_bf16 v[80:83], a[208:211], a[48:51], v[80:83]
ds_read_b64_tr_b16 a[200:201], v227 offset:32
v_mfma_f32_16x16x32_bf16 v[84:87], a[208:211], a[52:55], v[84:87]
buffer_load_dwordx4 v234, s[12:15], s42 offen offset:1024 lds
v_mfma_f32_16x16x32_bf16 v[192:195], a[208:211], a[56:59], v[192:195]
ds_read_b64_tr_b16 a[202:203], v227 offset:1824
v_mfma_f32_16x16x32_bf16 v[196:199], a[208:211], a[60:63], v[196:199]
v_mfma_f32_16x16x32_bf16 v[88:91], a[212:215], a[48:51], v[88:91]
ds_read_b64_tr_b16 a[204:205], v227 offset:14368
v_mfma_f32_16x16x32_bf16 v[92:95], a[212:215], a[52:55], v[92:95]
v_mfma_f32_16x16x32_bf16 v[200:203], a[212:215], a[56:59], v[200:203]
ds_read_b64_tr_b16 a[206:207], v227 offset:16160
v_mfma_f32_16x16x32_bf16 v[204:207], a[212:215], a[60:63], v[204:207]
s_waitcnt lgkmcnt(8)
v_mfma_f32_16x16x32_bf16 v[96:99], a[216:219], a[48:51], v[96:99]
ds_read_b64_tr_b16 a[208:209], v227 offset:64
v_mfma_f32_16x16x32_bf16 v[100:103], a[216:219], a[52:55], v[100:103]
buffer_load_dwordx4 v235, s[12:15], s42 offen offset:2048 lds
v_mfma_f32_16x16x32_bf16 v[208:211], a[216:219], a[56:59], v[208:211]
ds_read_b64_tr_b16 a[210:211], v227 offset:1856
v_mfma_f32_16x16x32_bf16 v[212:215], a[216:219], a[60:63], v[212:215]
s_add_u32 s42, s42, 458752
v_mfma_f32_16x16x32_bf16 v[104:107], a[220:223], a[48:51], v[104:107]
ds_read_b64_tr_b16 a[212:213], v227 offset:14400
v_mfma_f32_16x16x32_bf16 v[108:111], a[220:223], a[52:55], v[108:111]
buffer_load_dwordx4 a[96:99], v236, s[16:19], s40 offen offset:0
v_mfma_f32_16x16x32_bf16 v[216:219], a[220:223], a[56:59], v[216:219]
ds_read_b64_tr_b16 a[214:215], v227 offset:16192
v_mfma_f32_16x16x32_bf16 v[220:223], a[220:223], a[60:63], v[220:223]
s_waitcnt vmcnt(12) lgkmcnt(8)
v_mfma_f32_16x16x32_bf16 v[0:3], a[192:195], a[64:67], v[0:3]
ds_read_b64_tr_b16 a[216:217], v227 offset:96
v_mfma_f32_16x16x32_bf16 v[4:7], a[192:195], a[68:71], v[4:7]
buffer_load_dwordx4 a[100:103], v236, s[16:19], s40 offen offset:256
v_mfma_f32_16x16x32_bf16 v[112:115], a[192:195], a[72:75], v[112:115]
ds_read_b64_tr_b16 a[218:219], v227 offset:1888
v_mfma_f32_16x16x32_bf16 v[116:119], a[192:195], a[76:79], v[116:119]
v_mfma_f32_16x16x32_bf16 v[8:11], a[196:199], a[64:67], v[8:11]
ds_read_b64_tr_b16 a[220:221], v227 offset:14432
v_mfma_f32_16x16x32_bf16 v[12:15], a[196:199], a[68:71], v[12:15]
buffer_load_dwordx4 a[104:107], v236, s[16:19], s41 offen offset:0
v_mfma_f32_16x16x32_bf16 v[120:123], a[196:199], a[72:75], v[120:123]
ds_read_b64_tr_b16 a[222:223], v227 offset:16224
v_mfma_f32_16x16x32_bf16 v[124:127], a[196:199], a[76:79], v[124:127]
s_waitcnt lgkmcnt(8)
v_mfma_f32_16x16x32_bf16 v[16:19], a[200:203], a[64:67], v[16:19]
ds_read_b64_tr_b16 a[192:193], v227 offset:128
v_mfma_f32_16x16x32_bf16 v[20:23], a[200:203], a[68:71], v[20:23]
v_mfma_f32_16x16x32_bf16 v[128:131], a[200:203], a[72:75], v[128:131]
ds_read_b64_tr_b16 a[194:195], v227 offset:1920
v_mfma_f32_16x16x32_bf16 v[132:135], a[200:203], a[76:79], v[132:135]
v_mfma_f32_16x16x32_bf16 v[24:27], a[204:207], a[64:67], v[24:27]
ds_read_b64_tr_b16 a[196:197], v227 offset:14464
v_mfma_f32_16x16x32_bf16 v[28:31], a[204:207], a[68:71], v[28:31]
buffer_load_dwordx4 a[108:111], v236, s[16:19], s41 offen offset:256
v_mfma_f32_16x16x32_bf16 v[136:139], a[204:207], a[72:75], v[136:139]
ds_read_b64_tr_b16 a[198:199], v227 offset:16256
v_mfma_f32_16x16x32_bf16 v[140:143], a[204:207], a[76:79], v[140:143]
s_waitcnt lgkmcnt(8)
v_mfma_f32_16x16x32_bf16 v[32:35], a[208:211], a[64:67], v[32:35]
ds_read_b64_tr_b16 a[200:201], v227 offset:160
v_mfma_f32_16x16x32_bf16 v[36:39], a[208:211], a[68:71], v[36:39]
buffer_load_dwordx4 a[112:115], v236, s[16:19], s40 offen offset:2048
v_mfma_f32_16x16x32_bf16 v[144:147], a[208:211], a[72:75], v[144:147]
ds_read_b64_tr_b16 a[202:203], v227 offset:1952
v_mfma_f32_16x16x32_bf16 v[148:151], a[208:211], a[76:79], v[148:151]
v_mfma_f32_16x16x32_bf16 v[40:43], a[212:215], a[64:67], v[40:43]
ds_read_b64_tr_b16 a[204:205], v227 offset:14496
v_mfma_f32_16x16x32_bf16 v[44:47], a[212:215], a[68:71], v[44:47]
v_mfma_f32_16x16x32_bf16 v[152:155], a[212:215], a[72:75], v[152:155]
ds_read_b64_tr_b16 a[206:207], v227 offset:16288
v_mfma_f32_16x16x32_bf16 v[156:159], a[212:215], a[76:79], v[156:159]
s_waitcnt lgkmcnt(8)
v_mfma_f32_16x16x32_bf16 v[48:51], a[216:219], a[64:67], v[48:51]
ds_read_b64_tr_b16 a[208:209], v227 offset:192
v_mfma_f32_16x16x32_bf16 v[52:55], a[216:219], a[68:71], v[52:55]
buffer_load_dwordx4 a[116:119], v236, s[16:19], s40 offen offset:2304
v_mfma_f32_16x16x32_bf16 v[160:163], a[216:219], a[72:75], v[160:163]
ds_read_b64_tr_b16 a[210:211], v227 offset:1984
v_mfma_f32_16x16x32_bf16 v[164:167], a[216:219], a[76:79], v[164:167]
s_add_u32 s40, s40, 4096
v_mfma_f32_16x16x32_bf16 v[56:59], a[220:223], a[64:67], v[56:59]
ds_read_b64_tr_b16 a[212:213], v227 offset:14528
v_mfma_f32_16x16x32_bf16 v[60:63], a[220:223], a[68:71], v[60:63]
buffer_load_dwordx4 a[120:123], v236, s[16:19], s41 offen offset:2048
v_mfma_f32_16x16x32_bf16 v[168:171], a[220:223], a[72:75], v[168:171]
ds_read_b64_tr_b16 a[214:215], v227 offset:16320
v_mfma_f32_16x16x32_bf16 v[172:175], a[220:223], a[76:79], v[172:175]
s_waitcnt lgkmcnt(8)
v_mfma_f32_16x16x32_bf16 v[64:67], a[192:195], a[64:67], v[64:67]
ds_read_b64_tr_b16 a[216:217], v227 offset:7168
v_mfma_f32_16x16x32_bf16 v[68:71], a[192:195], a[68:71], v[68:71]
v_mfma_f32_16x16x32_bf16 v[176:179], a[192:195], a[72:75], v[176:179]
ds_read_b64_tr_b16 a[218:219], v227 offset:8960
v_mfma_f32_16x16x32_bf16 v[180:183], a[192:195], a[76:79], v[180:183]
v_mfma_f32_16x16x32_bf16 v[72:75], a[196:199], a[64:67], v[72:75]
ds_read_b64_tr_b16 a[220:221], v227 offset:21504
v_mfma_f32_16x16x32_bf16 v[76:79], a[196:199], a[68:71], v[76:79]
buffer_load_dwordx4 a[124:127], v236, s[16:19], s41 offen offset:2304
v_mfma_f32_16x16x32_bf16 v[184:187], a[196:199], a[72:75], v[184:187]
ds_read_b64_tr_b16 a[222:223], v227 offset:23296
v_mfma_f32_16x16x32_bf16 v[188:191], a[196:199], a[76:79], v[188:191]
s_waitcnt lgkmcnt(8)
s_add_u32 s41, s41, 4096
s_add_u32 m0, s43, 114688
v_mfma_f32_16x16x32_bf16 v[80:83], a[200:203], a[64:67], v[80:83]
ds_read_b64_tr_b16 a[192:193], v227 offset:7200
v_mfma_f32_16x16x32_bf16 v[84:87], a[200:203], a[68:71], v[84:87]
buffer_load_dwordx4 v229, s[12:15], s42 offen offset:0 lds
v_mfma_f32_16x16x32_bf16 v[192:195], a[200:203], a[72:75], v[192:195]
ds_read_b64_tr_b16 a[194:195], v227 offset:8992
v_mfma_f32_16x16x32_bf16 v[196:199], a[200:203], a[76:79], v[196:199]
v_mfma_f32_16x16x32_bf16 v[88:91], a[204:207], a[64:67], v[88:91]
ds_read_b64_tr_b16 a[196:197], v227 offset:21536
v_mfma_f32_16x16x32_bf16 v[92:95], a[204:207], a[68:71], v[92:95]
v_mfma_f32_16x16x32_bf16 v[200:203], a[204:207], a[72:75], v[200:203]
ds_read_b64_tr_b16 a[198:199], v227 offset:23328
v_mfma_f32_16x16x32_bf16 v[204:207], a[204:207], a[76:79], v[204:207]
s_waitcnt lgkmcnt(8)
v_mfma_f32_16x16x32_bf16 v[96:99], a[208:211], a[64:67], v[96:99]
ds_read_b64_tr_b16 a[200:201], v227 offset:7232
v_mfma_f32_16x16x32_bf16 v[100:103], a[208:211], a[68:71], v[100:103]
buffer_load_dwordx4 v230, s[12:15], s42 offen offset:1024 lds
v_mfma_f32_16x16x32_bf16 v[208:211], a[208:211], a[72:75], v[208:211]
ds_read_b64_tr_b16 a[202:203], v227 offset:9024
v_mfma_f32_16x16x32_bf16 v[212:215], a[208:211], a[76:79], v[212:215]
v_mfma_f32_16x16x32_bf16 v[104:107], a[212:215], a[64:67], v[104:107]
ds_read_b64_tr_b16 a[204:205], v227 offset:21568
v_mfma_f32_16x16x32_bf16 v[108:111], a[212:215], a[68:71], v[108:111]
buffer_load_dwordx4 v231, s[12:15], s42 offen offset:2048 lds
v_mfma_f32_16x16x32_bf16 v[216:219], a[212:215], a[72:75], v[216:219]
ds_read_b64_tr_b16 a[206:207], v227 offset:23360
v_mfma_f32_16x16x32_bf16 v[220:223], a[212:215], a[76:79], v[220:223]
s_waitcnt vmcnt(18) lgkmcnt(8)
v_mfma_f32_16x16x32_bf16 v[0:3], a[216:219], a[80:83], v[0:3]
ds_read_b64_tr_b16 a[208:209], v227 offset:7264
v_mfma_f32_16x16x32_bf16 v[4:7], a[216:219], a[84:87], v[4:7]
v_mfma_f32_16x16x32_bf16 v[112:115], a[216:219], a[88:91], v[112:115]
ds_read_b64_tr_b16 a[210:211], v227 offset:9056
v_mfma_f32_16x16x32_bf16 v[116:119], a[216:219], a[92:95], v[116:119]
v_mfma_f32_16x16x32_bf16 v[8:11], a[220:223], a[80:83], v[8:11]
ds_read_b64_tr_b16 a[212:213], v227 offset:21600
v_mfma_f32_16x16x32_bf16 v[12:15], a[220:223], a[84:87], v[12:15]
buffer_load_dwordx4 v232, s[12:15], s42 offen offset:3072 lds
v_mfma_f32_16x16x32_bf16 v[120:123], a[220:223], a[88:91], v[120:123]
ds_read_b64_tr_b16 a[214:215], v227 offset:23392
v_mfma_f32_16x16x32_bf16 v[124:127], a[220:223], a[92:95], v[124:127]
s_waitcnt lgkmcnt(8)
s_add_u32 m0, s43, 118784
v_mfma_f32_16x16x32_bf16 v[16:19], a[192:195], a[80:83], v[16:19]
ds_read_b64_tr_b16 a[216:217], v227 offset:7296
v_mfma_f32_16x16x32_bf16 v[20:23], a[192:195], a[84:87], v[20:23]
buffer_load_dwordx4 v233, s[12:15], s42 offen offset:0 lds
v_mfma_f32_16x16x32_bf16 v[128:131], a[192:195], a[88:91], v[128:131]
ds_read_b64_tr_b16 a[218:219], v227 offset:9088
v_mfma_f32_16x16x32_bf16 v[132:135], a[192:195], a[92:95], v[132:135]
v_mfma_f32_16x16x32_bf16 v[24:27], a[196:199], a[80:83], v[24:27]
ds_read_b64_tr_b16 a[220:221], v227 offset:21632
v_mfma_f32_16x16x32_bf16 v[28:31], a[196:199], a[84:87], v[28:31]
v_mfma_f32_16x16x32_bf16 v[136:139], a[196:199], a[88:91], v[136:139]
ds_read_b64_tr_b16 a[222:223], v227 offset:23424
v_mfma_f32_16x16x32_bf16 v[140:143], a[196:199], a[92:95], v[140:143]
s_waitcnt lgkmcnt(8)
v_mfma_f32_16x16x32_bf16 v[32:35], a[200:203], a[80:83], v[32:35]
ds_read_b64_tr_b16 a[192:193], v227 offset:7328
v_mfma_f32_16x16x32_bf16 v[36:39], a[200:203], a[84:87], v[36:39]
buffer_load_dwordx4 v234, s[12:15], s42 offen offset:1024 lds
v_mfma_f32_16x16x32_bf16 v[144:147], a[200:203], a[88:91], v[144:147]
ds_read_b64_tr_b16 a[194:195], v227 offset:9120
v_mfma_f32_16x16x32_bf16 v[148:151], a[200:203], a[92:95], v[148:151]
v_mfma_f32_16x16x32_bf16 v[40:43], a[204:207], a[80:83], v[40:43]
ds_read_b64_tr_b16 a[196:197], v227 offset:21664
v_mfma_f32_16x16x32_bf16 v[44:47], a[204:207], a[84:87], v[44:47]
buffer_load_dwordx4 v235, s[12:15], s42 offen offset:2048 lds
v_mfma_f32_16x16x32_bf16 v[152:155], a[204:207], a[88:91], v[152:155]
ds_read_b64_tr_b16 a[198:199], v227 offset:23456
v_mfma_f32_16x16x32_bf16 v[156:159], a[204:207], a[92:95], v[156:159]
s_waitcnt lgkmcnt(8)
s_add_u32 s42, s42, 458752
v_mfma_f32_16x16x32_bf16 v[48:51], a[208:211], a[80:83], v[48:51]
ds_read_b64_tr_b16 a[200:201], v227 offset:7360
v_mfma_f32_16x16x32_bf16 v[52:55], a[208:211], a[84:87], v[52:55]
v_mfma_f32_16x16x32_bf16 v[160:163], a[208:211], a[88:91], v[160:163]
ds_read_b64_tr_b16 a[202:203], v227 offset:9152
v_mfma_f32_16x16x32_bf16 v[164:167], a[208:211], a[92:95], v[164:167]
v_mfma_f32_16x16x32_bf16 v[56:59], a[212:215], a[80:83], v[56:59]
ds_read_b64_tr_b16 a[204:205], v227 offset:21696
v_mfma_f32_16x16x32_bf16 v[60:63], a[212:215], a[84:87], v[60:63]
buffer_load_dwordx4 a[128:131], v236, s[16:19], s40 offen offset:0
v_mfma_f32_16x16x32_bf16 v[168:171], a[212:215], a[88:91], v[168:171]
ds_read_b64_tr_b16 a[206:207], v227 offset:23488
v_mfma_f32_16x16x32_bf16 v[172:175], a[212:215], a[92:95], v[172:175]
s_waitcnt lgkmcnt(8)
s_waitcnt vmcnt(16)
s_barrier
v_mfma_f32_16x16x32_bf16 v[64:67], a[216:219], a[80:83], v[64:67]
ds_read_b64_tr_b16 a[208:209], v227 offset:28672
v_mfma_f32_16x16x32_bf16 v[68:71], a[216:219], a[84:87], v[68:71]
buffer_load_dwordx4 a[132:135], v236, s[16:19], s40 offen offset:256
v_mfma_f32_16x16x32_bf16 v[176:179], a[216:219], a[88:91], v[176:179]
ds_read_b64_tr_b16 a[210:211], v227 offset:30464
v_mfma_f32_16x16x32_bf16 v[180:183], a[216:219], a[92:95], v[180:183]
v_mfma_f32_16x16x32_bf16 v[72:75], a[220:223], a[80:83], v[72:75]
ds_read_b64_tr_b16 a[212:213], v227 offset:43008
v_mfma_f32_16x16x32_bf16 v[76:79], a[220:223], a[84:87], v[76:79]
v_mfma_f32_16x16x32_bf16 v[184:187], a[220:223], a[88:91], v[184:187]
ds_read_b64_tr_b16 a[214:215], v227 offset:44800
v_mfma_f32_16x16x32_bf16 v[188:191], a[220:223], a[92:95], v[188:191]
s_waitcnt lgkmcnt(8)
v_mfma_f32_16x16x32_bf16 v[80:83], a[192:195], a[80:83], v[80:83]
ds_read_b64_tr_b16 a[216:217], v227 offset:28704
v_mfma_f32_16x16x32_bf16 v[84:87], a[192:195], a[84:87], v[84:87]
buffer_load_dwordx4 a[136:139], v236, s[16:19], s41 offen offset:0
v_mfma_f32_16x16x32_bf16 v[192:195], a[192:195], a[88:91], v[192:195]
ds_read_b64_tr_b16 a[218:219], v227 offset:30496
v_mfma_f32_16x16x32_bf16 v[196:199], a[192:195], a[92:95], v[196:199]
v_mfma_f32_16x16x32_bf16 v[88:91], a[196:199], a[80:83], v[88:91]
ds_read_b64_tr_b16 a[220:221], v227 offset:43040
v_mfma_f32_16x16x32_bf16 v[92:95], a[196:199], a[84:87], v[92:95]
buffer_load_dwordx4 a[140:143], v236, s[16:19], s41 offen offset:256
v_mfma_f32_16x16x32_bf16 v[200:203], a[196:199], a[88:91], v[200:203]
ds_read_b64_tr_b16 a[222:223], v227 offset:44832
v_mfma_f32_16x16x32_bf16 v[204:207], a[196:199], a[92:95], v[204:207]
s_waitcnt lgkmcnt(8)
v_mfma_f32_16x16x32_bf16 v[96:99], a[200:203], a[80:83], v[96:99]
ds_read_b64_tr_b16 a[192:193], v227 offset:28736
v_mfma_f32_16x16x32_bf16 v[100:103], a[200:203], a[84:87], v[100:103]
v_mfma_f32_16x16x32_bf16 v[208:211], a[200:203], a[88:91], v[208:211]
ds_read_b64_tr_b16 a[194:195], v227 offset:30528
v_mfma_f32_16x16x32_bf16 v[212:215], a[200:203], a[92:95], v[212:215]
v_mfma_f32_16x16x32_bf16 v[104:107], a[204:207], a[80:83], v[104:107]
ds_read_b64_tr_b16 a[196:197], v227 offset:43072
v_mfma_f32_16x16x32_bf16 v[108:111], a[204:207], a[84:87], v[108:111]
buffer_load_dwordx4 a[144:147], v236, s[16:19], s40 offen offset:2048
v_mfma_f32_16x16x32_bf16 v[216:219], a[204:207], a[88:91], v[216:219]
ds_read_b64_tr_b16 a[198:199], v227 offset:44864
v_mfma_f32_16x16x32_bf16 v[220:223], a[204:207], a[92:95], v[220:223]
s_waitcnt vmcnt(16) lgkmcnt(8)
v_mfma_f32_16x16x32_bf16 v[0:3], a[208:211], a[96:99], v[0:3]
ds_read_b64_tr_b16 a[200:201], v227 offset:28768
v_mfma_f32_16x16x32_bf16 v[4:7], a[208:211], a[100:103], v[4:7]
buffer_load_dwordx4 a[148:151], v236, s[16:19], s40 offen offset:2304
v_mfma_f32_16x16x32_bf16 v[112:115], a[208:211], a[104:107], v[112:115]
ds_read_b64_tr_b16 a[202:203], v227 offset:30560
v_mfma_f32_16x16x32_bf16 v[116:119], a[208:211], a[108:111], v[116:119]
s_add_u32 s40, s40, 4096
v_mfma_f32_16x16x32_bf16 v[8:11], a[212:215], a[96:99], v[8:11]
ds_read_b64_tr_b16 a[204:205], v227 offset:43104
v_mfma_f32_16x16x32_bf16 v[12:15], a[212:215], a[100:103], v[12:15]
v_mfma_f32_16x16x32_bf16 v[120:123], a[212:215], a[104:107], v[120:123]
ds_read_b64_tr_b16 a[206:207], v227 offset:44896
v_mfma_f32_16x16x32_bf16 v[124:127], a[212:215], a[108:111], v[124:127]
s_waitcnt lgkmcnt(8)
v_mfma_f32_16x16x32_bf16 v[16:19], a[216:219], a[96:99], v[16:19]
ds_read_b64_tr_b16 a[208:209], v227 offset:28800
v_mfma_f32_16x16x32_bf16 v[20:23], a[216:219], a[100:103], v[20:23]
buffer_load_dwordx4 a[152:155], v236, s[16:19], s41 offen offset:2048
v_mfma_f32_16x16x32_bf16 v[128:131], a[216:219], a[104:107], v[128:131]
ds_read_b64_tr_b16 a[210:211], v227 offset:30592
v_mfma_f32_16x16x32_bf16 v[132:135], a[216:219], a[108:111], v[132:135]
v_mfma_f32_16x16x32_bf16 v[24:27], a[220:223], a[96:99], v[24:27]
ds_read_b64_tr_b16 a[212:213], v227 offset:43136
v_mfma_f32_16x16x32_bf16 v[28:31], a[220:223], a[100:103], v[28:31]
buffer_load_dwordx4 a[156:159], v236, s[16:19], s41 offen offset:2304
v_mfma_f32_16x16x32_bf16 v[136:139], a[220:223], a[104:107], v[136:139]
ds_read_b64_tr_b16 a[214:215], v227 offset:44928
v_mfma_f32_16x16x32_bf16 v[140:143], a[220:223], a[108:111], v[140:143]
s_waitcnt lgkmcnt(8)
s_add_u32 s41, s41, 4096
v_mfma_f32_16x16x32_bf16 v[32:35], a[192:195], a[96:99], v[32:35]
ds_read_b64_tr_b16 a[216:217], v227 offset:28832
v_mfma_f32_16x16x32_bf16 v[36:39], a[192:195], a[100:103], v[36:39]
v_mfma_f32_16x16x32_bf16 v[144:147], a[192:195], a[104:107], v[144:147]
ds_read_b64_tr_b16 a[218:219], v227 offset:30624
v_mfma_f32_16x16x32_bf16 v[148:151], a[192:195], a[108:111], v[148:151]
s_add_u32 m0, s43, 0
v_mfma_f32_16x16x32_bf16 v[40:43], a[196:199], a[96:99], v[40:43]
ds_read_b64_tr_b16 a[220:221], v227 offset:43168
v_mfma_f32_16x16x32_bf16 v[44:47], a[196:199], a[100:103], v[44:47]
buffer_load_dwordx4 v229, s[12:15], s42 offen offset:0 lds
v_mfma_f32_16x16x32_bf16 v[152:155], a[196:199], a[104:107], v[152:155]
ds_read_b64_tr_b16 a[222:223], v227 offset:44960
v_mfma_f32_16x16x32_bf16 v[156:159], a[196:199], a[108:111], v[156:159]
s_waitcnt lgkmcnt(8)
v_mfma_f32_16x16x32_bf16 v[48:51], a[200:203], a[96:99], v[48:51]
ds_read_b64_tr_b16 a[192:193], v227 offset:28864
v_mfma_f32_16x16x32_bf16 v[52:55], a[200:203], a[100:103], v[52:55]
buffer_load_dwordx4 v230, s[12:15], s42 offen offset:1024 lds
v_mfma_f32_16x16x32_bf16 v[160:163], a[200:203], a[104:107], v[160:163]
ds_read_b64_tr_b16 a[194:195], v227 offset:30656
v_mfma_f32_16x16x32_bf16 v[164:167], a[200:203], a[108:111], v[164:167]
v_mfma_f32_16x16x32_bf16 v[56:59], a[204:207], a[96:99], v[56:59]
ds_read_b64_tr_b16 a[196:197], v227 offset:43200
v_mfma_f32_16x16x32_bf16 v[60:63], a[204:207], a[100:103], v[60:63]
v_mfma_f32_16x16x32_bf16 v[168:171], a[204:207], a[104:107], v[168:171]
ds_read_b64_tr_b16 a[198:199], v227 offset:44992
v_mfma_f32_16x16x32_bf16 v[172:175], a[204:207], a[108:111], v[172:175]
s_waitcnt lgkmcnt(8)
v_mfma_f32_16x16x32_bf16 v[64:67], a[208:211], a[96:99], v[64:67]
ds_read_b64_tr_b16 a[200:201], v227 offset:35840
v_mfma_f32_16x16x32_bf16 v[68:71], a[208:211], a[100:103], v[68:71]
buffer_load_dwordx4 v231, s[12:15], s42 offen offset:2048 lds
v_mfma_f32_16x16x32_bf16 v[176:179], a[208:211], a[104:107], v[176:179]
ds_read_b64_tr_b16 a[202:203], v227 offset:37632
v_mfma_f32_16x16x32_bf16 v[180:183], a[208:211], a[108:111], v[180:183]
v_mfma_f32_16x16x32_bf16 v[72:75], a[212:215], a[96:99], v[72:75]
ds_read_b64_tr_b16 a[204:205], v227 offset:50176
v_mfma_f32_16x16x32_bf16 v[76:79], a[212:215], a[100:103], v[76:79]
buffer_load_dwordx4 v232, s[12:15], s42 offen offset:3072 lds
v_mfma_f32_16x16x32_bf16 v[184:187], a[212:215], a[104:107], v[184:187]
ds_read_b64_tr_b16 a[206:207], v227 offset:51968
v_mfma_f32_16x16x32_bf16 v[188:191], a[212:215], a[108:111], v[188:191]
s_waitcnt lgkmcnt(8)
v_mfma_f32_16x16x32_bf16 v[80:83], a[216:219], a[96:99], v[80:83]
ds_read_b64_tr_b16 a[208:209], v227 offset:35872
v_mfma_f32_16x16x32_bf16 v[84:87], a[216:219], a[100:103], v[84:87]
v_mfma_f32_16x16x32_bf16 v[192:195], a[216:219], a[104:107], v[192:195]
ds_read_b64_tr_b16 a[210:211], v227 offset:37664
v_mfma_f32_16x16x32_bf16 v[196:199], a[216:219], a[108:111], v[196:199]
s_add_u32 m0, s43, 4096
v_mfma_f32_16x16x32_bf16 v[88:91], a[220:223], a[96:99], v[88:91]
ds_read_b64_tr_b16 a[212:213], v227 offset:50208
v_mfma_f32_16x16x32_bf16 v[92:95], a[220:223], a[100:103], v[92:95]
buffer_load_dwordx4 v233, s[12:15], s42 offen offset:0 lds
v_mfma_f32_16x16x32_bf16 v[200:203], a[220:223], a[104:107], v[200:203]
ds_read_b64_tr_b16 a[214:215], v227 offset:52000
v_mfma_f32_16x16x32_bf16 v[204:207], a[220:223], a[108:111], v[204:207]
s_waitcnt lgkmcnt(8)
v_mfma_f32_16x16x32_bf16 v[96:99], a[192:195], a[96:99], v[96:99]
ds_read_b64_tr_b16 a[216:217], v227 offset:35904
v_mfma_f32_16x16x32_bf16 v[100:103], a[192:195], a[100:103], v[100:103]
buffer_load_dwordx4 v234, s[12:15], s42 offen offset:1024 lds
v_mfma_f32_16x16x32_bf16 v[208:211], a[192:195], a[104:107], v[208:211]
ds_read_b64_tr_b16 a[218:219], v227 offset:37696
v_mfma_f32_16x16x32_bf16 v[212:215], a[192:195], a[108:111], v[212:215]
v_mfma_f32_16x16x32_bf16 v[104:107], a[196:199], a[96:99], v[104:107]
ds_read_b64_tr_b16 a[220:221], v227 offset:50240
v_mfma_f32_16x16x32_bf16 v[108:111], a[196:199], a[100:103], v[108:111]
v_mfma_f32_16x16x32_bf16 v[216:219], a[196:199], a[104:107], v[216:219]
ds_read_b64_tr_b16 a[222:223], v227 offset:52032
v_mfma_f32_16x16x32_bf16 v[220:223], a[196:199], a[108:111], v[220:223]
s_waitcnt vmcnt(21) lgkmcnt(8)
v_mfma_f32_16x16x32_bf16 v[0:3], a[200:203], a[112:115], v[0:3]
ds_read_b64_tr_b16 a[192:193], v227 offset:35936
v_mfma_f32_16x16x32_bf16 v[4:7], a[200:203], a[116:119], v[4:7]
buffer_load_dwordx4 v235, s[12:15], s42 offen offset:2048 lds
v_mfma_f32_16x16x32_bf16 v[112:115], a[200:203], a[120:123], v[112:115]
ds_read_b64_tr_b16 a[194:195], v227 offset:37728
v_mfma_f32_16x16x32_bf16 v[116:119], a[200:203], a[124:127], v[116:119]
s_add_u32 s42, s42, 458752
v_mfma_f32_16x16x32_bf16 v[8:11], a[204:207], a[112:115], v[8:11]
ds_read_b64_tr_b16 a[196:197], v227 offset:50272
v_mfma_f32_16x16x32_bf16 v[12:15], a[204:207], a[116:119], v[12:15]
buffer_load_dwordx4 a[0:3], v236, s[16:19], s40 offen offset:0
v_mfma_f32_16x16x32_bf16 v[120:123], a[204:207], a[120:123], v[120:123]
ds_read_b64_tr_b16 a[198:199], v227 offset:52064
v_mfma_f32_16x16x32_bf16 v[124:127], a[204:207], a[124:127], v[124:127]
s_waitcnt lgkmcnt(8)
v_mfma_f32_16x16x32_bf16 v[16:19], a[208:211], a[112:115], v[16:19]
ds_read_b64_tr_b16 a[200:201], v227 offset:35968
v_mfma_f32_16x16x32_bf16 v[20:23], a[208:211], a[116:119], v[20:23]
v_mfma_f32_16x16x32_bf16 v[128:131], a[208:211], a[120:123], v[128:131]
ds_read_b64_tr_b16 a[202:203], v227 offset:37760
v_mfma_f32_16x16x32_bf16 v[132:135], a[208:211], a[124:127], v[132:135]
v_mfma_f32_16x16x32_bf16 v[24:27], a[212:215], a[112:115], v[24:27]
ds_read_b64_tr_b16 a[204:205], v227 offset:50304
v_mfma_f32_16x16x32_bf16 v[28:31], a[212:215], a[116:119], v[28:31]
buffer_load_dwordx4 a[4:7], v236, s[16:19], s40 offen offset:256
v_mfma_f32_16x16x32_bf16 v[136:139], a[212:215], a[120:123], v[136:139]
ds_read_b64_tr_b16 a[206:207], v227 offset:52096
v_mfma_f32_16x16x32_bf16 v[140:143], a[212:215], a[124:127], v[140:143]
s_waitcnt lgkmcnt(8)
v_mfma_f32_16x16x32_bf16 v[32:35], a[216:219], a[112:115], v[32:35]
ds_read_b64_tr_b16 a[208:209], v227 offset:36000
v_mfma_f32_16x16x32_bf16 v[36:39], a[216:219], a[116:119], v[36:39]
buffer_load_dwordx4 a[8:11], v236, s[16:19], s41 offen offset:0
v_mfma_f32_16x16x32_bf16 v[144:147], a[216:219], a[120:123], v[144:147]
ds_read_b64_tr_b16 a[210:211], v227 offset:37792
v_mfma_f32_16x16x32_bf16 v[148:151], a[216:219], a[124:127], v[148:151]
v_mfma_f32_16x16x32_bf16 v[40:43], a[220:223], a[112:115], v[40:43]
ds_read_b64_tr_b16 a[212:213], v227 offset:50336
v_mfma_f32_16x16x32_bf16 v[44:47], a[220:223], a[116:119], v[44:47]
v_mfma_f32_16x16x32_bf16 v[152:155], a[220:223], a[120:123], v[152:155]
ds_read_b64_tr_b16 a[214:215], v227 offset:52128
v_mfma_f32_16x16x32_bf16 v[156:159], a[220:223], a[124:127], v[156:159]
s_waitcnt lgkmcnt(8)
v_mfma_f32_16x16x32_bf16 v[48:51], a[192:195], a[112:115], v[48:51]
ds_read_b64_tr_b16 a[216:217], v227 offset:36032
v_mfma_f32_16x16x32_bf16 v[52:55], a[192:195], a[116:119], v[52:55]
buffer_load_dwordx4 a[12:15], v236, s[16:19], s41 offen offset:256
v_mfma_f32_16x16x32_bf16 v[160:163], a[192:195], a[120:123], v[160:163]
ds_read_b64_tr_b16 a[218:219], v227 offset:37824
v_mfma_f32_16x16x32_bf16 v[164:167], a[192:195], a[124:127], v[164:167]
v_mfma_f32_16x16x32_bf16 v[56:59], a[196:199], a[112:115], v[56:59]
ds_read_b64_tr_b16 a[220:221], v227 offset:50368
v_mfma_f32_16x16x32_bf16 v[60:63], a[196:199], a[116:119], v[60:63]
buffer_load_dwordx4 a[16:19], v236, s[16:19], s40 offen offset:2048
v_mfma_f32_16x16x32_bf16 v[168:171], a[196:199], a[120:123], v[168:171]
ds_read_b64_tr_b16 a[222:223], v227 offset:52160
v_mfma_f32_16x16x32_bf16 v[172:175], a[196:199], a[124:127], v[172:175]
s_waitcnt lgkmcnt(8)
s_waitcnt vmcnt(20)
s_barrier
v_mfma_f32_16x16x32_bf16 v[64:67], a[200:203], a[112:115], v[64:67]
ds_read_b64_tr_b16 a[192:193], v228 offset:0
v_mfma_f32_16x16x32_bf16 v[68:71], a[200:203], a[116:119], v[68:71]
v_mfma_f32_16x16x32_bf16 v[176:179], a[200:203], a[120:123], v[176:179]
ds_read_b64_tr_b16 a[194:195], v228 offset:1792
v_mfma_f32_16x16x32_bf16 v[180:183], a[200:203], a[124:127], v[180:183]
v_mfma_f32_16x16x32_bf16 v[72:75], a[204:207], a[112:115], v[72:75]
ds_read_b64_tr_b16 a[196:197], v228 offset:14336
v_mfma_f32_16x16x32_bf16 v[76:79], a[204:207], a[116:119], v[76:79]
buffer_load_dwordx4 a[20:23], v236, s[16:19], s40 offen offset:2304
v_mfma_f32_16x16x32_bf16 v[184:187], a[204:207], a[120:123], v[184:187]
ds_read_b64_tr_b16 a[198:199], v228 offset:16128
v_mfma_f32_16x16x32_bf16 v[188:191], a[204:207], a[124:127], v[188:191]
s_waitcnt lgkmcnt(8)
s_add_u32 s40, s40, 4096
v_mfma_f32_16x16x32_bf16 v[80:83], a[208:211], a[112:115], v[80:83]
ds_read_b64_tr_b16 a[200:201], v228 offset:32
v_mfma_f32_16x16x32_bf16 v[84:87], a[208:211], a[116:119], v[84:87]
buffer_load_dwordx4 a[24:27], v236, s[16:19], s41 offen offset:2048
v_mfma_f32_16x16x32_bf16 v[192:195], a[208:211], a[120:123], v[192:195]
ds_read_b64_tr_b16 a[202:203], v228 offset:1824
v_mfma_f32_16x16x32_bf16 v[196:199], a[208:211], a[124:127], v[196:199]
v_mfma_f32_16x16x32_bf16 v[88:91], a[212:215], a[112:115], v[88:91]
ds_read_b64_tr_b16 a[204:205], v228 offset:14368
v_mfma_f32_16x16x32_bf16 v[92:95], a[212:215], a[116:119], v[92:95]
v_mfma_f32_16x16x32_bf16 v[200:203], a[212:215], a[120:123], v[200:203]
ds_read_b64_tr_b16 a[206:207], v228 offset:16160
v_mfma_f32_16x16x32_bf16 v[204:207], a[212:215], a[124:127], v[204:207]
s_waitcnt lgkmcnt(8)
v_mfma_f32_16x16x32_bf16 v[96:99], a[216:219], a[112:115], v[96:99]
ds_read_b64_tr_b16 a[208:209], v228 offset:64
v_mfma_f32_16x16x32_bf16 v[100:103], a[216:219], a[116:119], v[100:103]
buffer_load_dwordx4 a[28:31], v236, s[16:19], s41 offen offset:2304
v_mfma_f32_16x16x32_bf16 v[208:211], a[216:219], a[120:123], v[208:211]
ds_read_b64_tr_b16 a[210:211], v228 offset:1856
v_mfma_f32_16x16x32_bf16 v[212:215], a[216:219], a[124:127], v[212:215]
s_add_u32 s41, s41, 4096
s_add_u32 m0, s43, 28672
v_mfma_f32_16x16x32_bf16 v[104:107], a[220:223], a[112:115], v[104:107]
ds_read_b64_tr_b16 a[212:213], v228 offset:14400
v_mfma_f32_16x16x32_bf16 v[108:111], a[220:223], a[116:119], v[108:111]
buffer_load_dwordx4 v229, s[12:15], s42 offen offset:0 lds
v_mfma_f32_16x16x32_bf16 v[216:219], a[220:223], a[120:123], v[216:219]
ds_read_b64_tr_b16 a[214:215], v228 offset:16192
v_mfma_f32_16x16x32_bf16 v[220:223], a[220:223], a[124:127], v[220:223]
s_waitcnt vmcnt(20) lgkmcnt(8)
v_mfma_f32_16x16x32_bf16 v[0:3], a[192:195], a[128:131], v[0:3]
ds_read_b64_tr_b16 a[216:217], v228 offset:96
v_mfma_f32_16x16x32_bf16 v[4:7], a[192:195], a[132:135], v[4:7]
v_mfma_f32_16x16x32_bf16 v[112:115], a[192:195], a[136:139], v[112:115]
ds_read_b64_tr_b16 a[218:219], v228 offset:1888
v_mfma_f32_16x16x32_bf16 v[116:119], a[192:195], a[140:143], v[116:119]
v_mfma_f32_16x16x32_bf16 v[8:11], a[196:199], a[128:131], v[8:11]
ds_read_b64_tr_b16 a[220:221], v228 offset:14432
v_mfma_f32_16x16x32_bf16 v[12:15], a[196:199], a[132:135], v[12:15]
buffer_load_dwordx4 v230, s[12:15], s42 offen offset:1024 lds
v_mfma_f32_16x16x32_bf16 v[120:123], a[196:199], a[136:139], v[120:123]
ds_read_b64_tr_b16 a[222:223], v228 offset:16224
v_mfma_f32_16x16x32_bf16 v[124:127], a[196:199], a[140:143], v[124:127]
s_waitcnt lgkmcnt(8)
v_mfma_f32_16x16x32_bf16 v[16:19], a[200:203], a[128:131], v[16:19]
ds_read_b64_tr_b16 a[192:193], v228 offset:128
v_mfma_f32_16x16x32_bf16 v[20:23], a[200:203], a[132:135], v[20:23]
buffer_load_dwordx4 v231, s[12:15], s42 offen offset:2048 lds
v_mfma_f32_16x16x32_bf16 v[128:131], a[200:203], a[136:139], v[128:131]
ds_read_b64_tr_b16 a[194:195], v228 offset:1920
v_mfma_f32_16x16x32_bf16 v[132:135], a[200:203], a[140:143], v[132:135]
v_mfma_f32_16x16x32_bf16 v[24:27], a[204:207], a[128:131], v[24:27]
ds_read_b64_tr_b16 a[196:197], v228 offset:14464
v_mfma_f32_16x16x32_bf16 v[28:31], a[204:207], a[132:135], v[28:31]
v_mfma_f32_16x16x32_bf16 v[136:139], a[204:207], a[136:139], v[136:139]
ds_read_b64_tr_b16 a[198:199], v228 offset:16256
v_mfma_f32_16x16x32_bf16 v[140:143], a[204:207], a[140:143], v[140:143]
s_waitcnt lgkmcnt(8)
v_mfma_f32_16x16x32_bf16 v[32:35], a[208:211], a[128:131], v[32:35]
ds_read_b64_tr_b16 a[200:201], v228 offset:160
v_mfma_f32_16x16x32_bf16 v[36:39], a[208:211], a[132:135], v[36:39]
buffer_load_dwordx4 v232, s[12:15], s42 offen offset:3072 lds
v_mfma_f32_16x16x32_bf16 v[144:147], a[208:211], a[136:139], v[144:147]
ds_read_b64_tr_b16 a[202:203], v228 offset:1952
v_mfma_f32_16x16x32_bf16 v[148:151], a[208:211], a[140:143], v[148:151]
s_add_u32 m0, s43, 32768
v_mfma_f32_16x16x32_bf16 v[40:43], a[212:215], a[128:131], v[40:43]
ds_read_b64_tr_b16 a[204:205], v228 offset:14496
v_mfma_f32_16x16x32_bf16 v[44:47], a[212:215], a[132:135], v[44:47]
buffer_load_dwordx4 v233, s[12:15], s42 offen offset:0 lds
v_mfma_f32_16x16x32_bf16 v[152:155], a[212:215], a[136:139], v[152:155]
ds_read_b64_tr_b16 a[206:207], v228 offset:16288
v_mfma_f32_16x16x32_bf16 v[156:159], a[212:215], a[140:143], v[156:159]
s_waitcnt lgkmcnt(8)
v_mfma_f32_16x16x32_bf16 v[48:51], a[216:219], a[128:131], v[48:51]
ds_read_b64_tr_b16 a[208:209], v228 offset:192
v_mfma_f32_16x16x32_bf16 v[52:55], a[216:219], a[132:135], v[52:55]
v_mfma_f32_16x16x32_bf16 v[160:163], a[216:219], a[136:139], v[160:163]
ds_read_b64_tr_b16 a[210:211], v228 offset:1984
v_mfma_f32_16x16x32_bf16 v[164:167], a[216:219], a[140:143], v[164:167]
v_mfma_f32_16x16x32_bf16 v[56:59], a[220:223], a[128:131], v[56:59]
ds_read_b64_tr_b16 a[212:213], v228 offset:14528
v_mfma_f32_16x16x32_bf16 v[60:63], a[220:223], a[132:135], v[60:63]
buffer_load_dwordx4 v234, s[12:15], s42 offen offset:1024 lds
v_mfma_f32_16x16x32_bf16 v[168:171], a[220:223], a[136:139], v[168:171]
ds_read_b64_tr_b16 a[214:215], v228 offset:16320
v_mfma_f32_16x16x32_bf16 v[172:175], a[220:223], a[140:143], v[172:175]
s_waitcnt lgkmcnt(8)
v_mfma_f32_16x16x32_bf16 v[64:67], a[192:195], a[128:131], v[64:67]
ds_read_b64_tr_b16 a[216:217], v228 offset:7168
v_mfma_f32_16x16x32_bf16 v[68:71], a[192:195], a[132:135], v[68:71]
buffer_load_dwordx4 v235, s[12:15], s42 offen offset:2048 lds
v_mfma_f32_16x16x32_bf16 v[176:179], a[192:195], a[136:139], v[176:179]
ds_read_b64_tr_b16 a[218:219], v228 offset:8960
v_mfma_f32_16x16x32_bf16 v[180:183], a[192:195], a[140:143], v[180:183]
s_add_u32 s42, s42, 458752
v_mfma_f32_16x16x32_bf16 v[72:75], a[196:199], a[128:131], v[72:75]
ds_read_b64_tr_b16 a[220:221], v228 offset:21504
v_mfma_f32_16x16x32_bf16 v[76:79], a[196:199], a[132:135], v[76:79]
v_mfma_f32_16x16x32_bf16 v[184:187], a[196:199], a[136:139], v[184:187]
ds_read_b64_tr_b16 a[222:223], v228 offset:23296
v_mfma_f32_16x16x32_bf16 v[188:191], a[196:199], a[140:143], v[188:191]
s_waitcnt lgkmcnt(8)
v_mfma_f32_16x16x32_bf16 v[80:83], a[200:203], a[128:131], v[80:83]
ds_read_b64_tr_b16 a[192:193], v228 offset:7200
v_mfma_f32_16x16x32_bf16 v[84:87], a[200:203], a[132:135], v[84:87]
buffer_load_dwordx4 a[32:35], v236, s[16:19], s40 offen offset:0
v_mfma_f32_16x16x32_bf16 v[192:195], a[200:203], a[136:139], v[192:195]
ds_read_b64_tr_b16 a[194:195], v228 offset:8992
v_mfma_f32_16x16x32_bf16 v[196:199], a[200:203], a[140:143], v[196:199]
v_mfma_f32_16x16x32_bf16 v[88:91], a[204:207], a[128:131], v[88:91]
ds_read_b64_tr_b16 a[196:197], v228 offset:21536
v_mfma_f32_16x16x32_bf16 v[92:95], a[204:207], a[132:135], v[92:95]
buffer_load_dwordx4 a[36:39], v236, s[16:19], s40 offen offset:256
v_mfma_f32_16x16x32_bf16 v[200:203], a[204:207], a[136:139], v[200:203]
ds_read_b64_tr_b16 a[198:199], v228 offset:23328
v_mfma_f32_16x16x32_bf16 v[204:207], a[204:207], a[140:143], v[204:207]
s_waitcnt lgkmcnt(8)
v_mfma_f32_16x16x32_bf16 v[96:99], a[208:211], a[128:131], v[96:99]
ds_read_b64_tr_b16 a[200:201], v228 offset:7232
v_mfma_f32_16x16x32_bf16 v[100:103], a[208:211], a[132:135], v[100:103]
v_mfma_f32_16x16x32_bf16 v[208:211], a[208:211], a[136:139], v[208:211]
ds_read_b64_tr_b16 a[202:203], v228 offset:9024
v_mfma_f32_16x16x32_bf16 v[212:215], a[208:211], a[140:143], v[212:215]
v_mfma_f32_16x16x32_bf16 v[104:107], a[212:215], a[128:131], v[104:107]
ds_read_b64_tr_b16 a[204:205], v228 offset:21568
v_mfma_f32_16x16x32_bf16 v[108:111], a[212:215], a[132:135], v[108:111]
buffer_load_dwordx4 a[40:43], v236, s[16:19], s41 offen offset:0
v_mfma_f32_16x16x32_bf16 v[216:219], a[212:215], a[136:139], v[216:219]
ds_read_b64_tr_b16 a[206:207], v228 offset:23360
v_mfma_f32_16x16x32_bf16 v[220:223], a[212:215], a[140:143], v[220:223]
s_waitcnt vmcnt(25) lgkmcnt(8)
v_mfma_f32_16x16x32_bf16 v[0:3], a[216:219], a[144:147], v[0:3]
ds_read_b64_tr_b16 a[208:209], v228 offset:7264
v_mfma_f32_16x16x32_bf16 v[4:7], a[216:219], a[148:151], v[4:7]
buffer_load_dwordx4 a[44:47], v236, s[16:19], s41 offen offset:256
v_mfma_f32_16x16x32_bf16 v[112:115], a[216:219], a[152:155], v[112:115]
ds_read_b64_tr_b16 a[210:211], v228 offset:9056
v_mfma_f32_16x16x32_bf16 v[116:119], a[216:219], a[156:159], v[116:119]
v_mfma_f32_16x16x32_bf16 v[8:11], a[220:223], a[144:147], v[8:11]
ds_read_b64_tr_b16 a[212:213], v228 offset:21600
v_mfma_f32_16x16x32_bf16 v[12:15], a[220:223], a[148:151], v[12:15]
v_mfma_f32_16x16x32_bf16 v[120:123], a[220:223], a[152:155], v[120:123]
ds_read_b64_tr_b16 a[214:215], v228 offset:23392
v_mfma_f32_16x16x32_bf16 v[124:127], a[220:223], a[156:159], v[124:127]
s_waitcnt lgkmcnt(8)
v_mfma_f32_16x16x32_bf16 v[16:19], a[192:195], a[144:147], v[16:19]
ds_read_b64_tr_b16 a[216:217], v228 offset:7296
v_mfma_f32_16x16x32_bf16 v[20:23], a[192:195], a[148:151], v[20:23]
buffer_load_dwordx4 a[48:51], v236, s[16:19], s40 offen offset:2048
v_mfma_f32_16x16x32_bf16 v[128:131], a[192:195], a[152:155], v[128:131]
ds_read_b64_tr_b16 a[218:219], v228 offset:9088
v_mfma_f32_16x16x32_bf16 v[132:135], a[192:195], a[156:159], v[132:135]
v_mfma_f32_16x16x32_bf16 v[24:27], a[196:199], a[144:147], v[24:27]
ds_read_b64_tr_b16 a[220:221], v228 offset:21632
v_mfma_f32_16x16x32_bf16 v[28:31], a[196:199], a[148:151], v[28:31]
buffer_load_dwordx4 a[52:55], v236, s[16:19], s40 offen offset:2304
v_mfma_f32_16x16x32_bf16 v[136:139], a[196:199], a[152:155], v[136:139]
ds_read_b64_tr_b16 a[222:223], v228 offset:23424
v_mfma_f32_16x16x32_bf16 v[140:143], a[196:199], a[156:159], v[140:143]
s_waitcnt lgkmcnt(8)
s_add_u32 s40, s40, 4096
v_mfma_f32_16x16x32_bf16 v[32:35], a[200:203], a[144:147], v[32:35]
ds_read_b64_tr_b16 a[192:193], v228 offset:7328
v_mfma_f32_16x16x32_bf16 v[36:39], a[200:203], a[148:151], v[36:39]
v_mfma_f32_16x16x32_bf16 v[144:147], a[200:203], a[152:155], v[144:147]
ds_read_b64_tr_b16 a[194:195], v228 offset:9120
v_mfma_f32_16x16x32_bf16 v[148:151], a[200:203], a[156:159], v[148:151]
v_mfma_f32_16x16x32_bf16 v[40:43], a[204:207], a[144:147], v[40:43]
ds_read_b64_tr_b16 a[196:197], v228 offset:21664
v_mfma_f32_16x16x32_bf16 v[44:47], a[204:207], a[148:151], v[44:47]
buffer_load_dwordx4 a[56:59], v236, s[16:19], s41 offen offset:2048
v_mfma_f32_16x16x32_bf16 v[152:155], a[204:207], a[152:155], v[152:155]
ds_read_b64_tr_b16 a[198:199], v228 offset:23456
v_mfma_f32_16x16x32_bf16 v[156:159], a[204:207], a[156:159], v[156:159]
s_waitcnt lgkmcnt(8)
v_mfma_f32_16x16x32_bf16 v[48:51], a[208:211], a[144:147], v[48:51]
ds_read_b64_tr_b16 a[200:201], v228 offset:7360
v_mfma_f32_16x16x32_bf16 v[52:55], a[208:211], a[148:151], v[52:55]
buffer_load_dwordx4 a[60:63], v236, s[16:19], s41 offen offset:2304
v_mfma_f32_16x16x32_bf16 v[160:163], a[208:211], a[152:155], v[160:163]
ds_read_b64_tr_b16 a[202:203], v228 offset:9152
v_mfma_f32_16x16x32_bf16 v[164:167], a[208:211], a[156:159], v[164:167]
s_add_u32 s41, s41, 4096
v_mfma_f32_16x16x32_bf16 v[56:59], a[212:215], a[144:147], v[56:59]
ds_read_b64_tr_b16 a[204:205], v228 offset:21696
v_mfma_f32_16x16x32_bf16 v[60:63], a[212:215], a[148:151], v[60:63]
v_mfma_f32_16x16x32_bf16 v[168:171], a[212:215], a[152:155], v[168:171]
ds_read_b64_tr_b16 a[206:207], v228 offset:23488
v_mfma_f32_16x16x32_bf16 v[172:175], a[212:215], a[156:159], v[172:175]
s_waitcnt lgkmcnt(8)
s_waitcnt vmcnt(23)
s_barrier
s_add_u32 m0, s43, 57344
v_mfma_f32_16x16x32_bf16 v[64:67], a[216:219], a[144:147], v[64:67]
ds_read_b64_tr_b16 a[208:209], v226 offset:0
v_mfma_f32_16x16x32_bf16 v[68:71], a[216:219], a[148:151], v[68:71]
buffer_load_dwordx4 v229, s[12:15], s42 offen offset:0 lds
v_mfma_f32_16x16x32_bf16 v[176:179], a[216:219], a[152:155], v[176:179]
ds_read_b64_tr_b16 a[210:211], v226 offset:1792
v_mfma_f32_16x16x32_bf16 v[180:183], a[216:219], a[156:159], v[180:183]
v_mfma_f32_16x16x32_bf16 v[72:75], a[220:223], a[144:147], v[72:75]
ds_read_b64_tr_b16 a[212:213], v226 offset:14336
v_mfma_f32_16x16x32_bf16 v[76:79], a[220:223], a[148:151], v[76:79]
buffer_load_dwordx4 v230, s[12:15], s42 offen offset:1024 lds
v_mfma_f32_16x16x32_bf16 v[184:187], a[220:223], a[152:155], v[184:187]
ds_read_b64_tr_b16 a[214:215], v226 offset:16128
v_mfma_f32_16x16x32_bf16 v[188:191], a[220:223], a[156:159], v[188:191]
s_waitcnt lgkmcnt(8)
v_mfma_f32_16x16x32_bf16 v[80:83], a[192:195], a[144:147], v[80:83]
ds_read_b64_tr_b16 a[216:217], v226 offset:32
v_mfma_f32_16x16x32_bf16 v[84:87], a[192:195], a[148:151], v[84:87]
v_mfma_f32_16x16x32_bf16 v[192:195], a[192:195], a[152:155], v[192:195]
ds_read_b64_tr_b16 a[218:219], v226 offset:1824
v_mfma_f32_16x16x32_bf16 v[196:199], a[192:195], a[156:159], v[196:199]
v_mfma_f32_16x16x32_bf16 v[88:91], a[196:199], a[144:147], v[88:91]
ds_read_b64_tr_b16 a[220:221], v226 offset:14368
v_mfma_f32_16x16x32_bf16 v[92:95], a[196:199], a[148:151], v[92:95]
buffer_load_dwordx4 v231, s[12:15], s42 offen offset:2048 lds
v_mfma_f32_16x16x32_bf16 v[200:203], a[196:199], a[152:155], v[200:203]
ds_read_b64_tr_b16 a[222:223], v226 offset:16160
v_mfma_f32_16x16x32_bf16 v[204:207], a[196:199], a[156:159], v[204:207]
s_waitcnt lgkmcnt(8)
v_mfma_f32_16x16x32_bf16 v[96:99], a[200:203], a[144:147], v[96:99]
ds_read_b64_tr_b16 a[192:193], v226 offset:64
v_mfma_f32_16x16x32_bf16 v[100:103], a[200:203], a[148:151], v[100:103]
buffer_load_dwordx4 v232, s[12:15], s42 offen offset:3072 lds
v_mfma_f32_16x16x32_bf16 v[208:211], a[200:203], a[152:155], v[208:211]
ds_read_b64_tr_b16 a[194:195], v226 offset:1856
v_mfma_f32_16x16x32_bf16 v[212:215], a[200:203], a[156:159], v[212:215]
v_mfma_f32_16x16x32_bf16 v[104:107], a[204:207], a[144:147], v[104:107]
ds_read_b64_tr_b16 a[196:197], v226 offset:14400
v_mfma_f32_16x16x32_bf16 v[108:111], a[204:207], a[148:151], v[108:111]
v_mfma_f32_16x16x32_bf16 v[216:219], a[204:207], a[152:155], v[216:219]
ds_read_b64_tr_b16 a[198:199], v226 offset:16192
v_mfma_f32_16x16x32_bf16 v[220:223], a[204:207], a[156:159], v[220:223]
s_waitcnt vmcnt(23) lgkmcnt(8)
s_add_u32 m0, s43, 61440
v_mfma_f32_16x16x32_bf16 v[0:3], a[208:211], a[0:3], v[0:3]
ds_read_b64_tr_b16 a[200:201], v226 offset:96
v_mfma_f32_16x16x32_bf16 v[4:7], a[208:211], a[4:7], v[4:7]
buffer_load_dwordx4 v233, s[12:15], s42 offen offset:0 lds
v_mfma_f32_16x16x32_bf16 v[112:115], a[208:211], a[8:11], v[112:115]
ds_read_b64_tr_b16 a[202:203], v226 offset:1888
v_mfma_f32_16x16x32_bf16 v[116:119], a[208:211], a[12:15], v[116:119]
v_mfma_f32_16x16x32_bf16 v[8:11], a[212:215], a[0:3], v[8:11]
ds_read_b64_tr_b16 a[204:205], v226 offset:14432
v_mfma_f32_16x16x32_bf16 v[12:15], a[212:215], a[4:7], v[12:15]
buffer_load_dwordx4 v234, s[12:15], s42 offen offset:1024 lds
v_mfma_f32_16x16x32_bf16 v[120:123], a[212:215], a[8:11], v[120:123]
ds_read_b64_tr_b16 a[206:207], v226 offset:16224
v_mfma_f32_16x16x32_bf16 v[124:127], a[212:215], a[12:15], v[124:127]
s_waitcnt lgkmcnt(8)
v_mfma_f32_16x16x32_bf16 v[16:19], a[216:219], a[0:3], v[16:19]
ds_read_b64_tr_b16 a[208:209], v226 offset:128
v_mfma_f32_16x16x32_bf16 v[20:23], a[216:219], a[4:7], v[20:23]
v_mfma_f32_16x16x32_bf16 v[128:131], a[216:219], a[8:11], v[128:131]
ds_read_b64_tr_b16 a[210:211], v226 offset:1920
v_mfma_f32_16x16x32_bf16 v[132:135], a[216:219], a[12:15], v[132:135]
v_mfma_f32_16x16x32_bf16 v[24:27], a[220:223], a[0:3], v[24:27]
ds_read_b64_tr_b16 a[212:213], v226 offset:14464
v_mfma_f32_16x16x32_bf16 v[28:31], a[220:223], a[4:7], v[28:31]
buffer_load_dwordx4 v235, s[12:15], s42 offen offset:2048 lds
v_mfma_f32_16x16x32_bf16 v[136:139], a[220:223], a[8:11], v[136:139]
ds_read_b64_tr_b16 a[214:215], v226 offset:16256
v_mfma_f32_16x16x32_bf16 v[140:143], a[220:223], a[12:15], v[140:143]
s_waitcnt lgkmcnt(8)
s_add_u32 s42, s42, 458752
v_mfma_f32_16x16x32_bf16 v[32:35], a[192:195], a[0:3], v[32:35]
ds_read_b64_tr_b16 a[216:217], v226 offset:160
v_mfma_f32_16x16x32_bf16 v[36:39], a[192:195], a[4:7], v[36:39]
buffer_load_dwordx4 a[64:67], v236, s[16:19], s40 offen offset:0
v_mfma_f32_16x16x32_bf16 v[144:147], a[192:195], a[8:11], v[144:147]
ds_read_b64_tr_b16 a[218:219], v226 offset:1952
v_mfma_f32_16x16x32_bf16 v[148:151], a[192:195], a[12:15], v[148:151]
v_mfma_f32_16x16x32_bf16 v[40:43], a[196:199], a[0:3], v[40:43]
ds_read_b64_tr_b16 a[220:221], v226 offset:14496
v_mfma_f32_16x16x32_bf16 v[44:47], a[196:199], a[4:7], v[44:47]
v_mfma_f32_16x16x32_bf16 v[152:155], a[196:199], a[8:11], v[152:155]
ds_read_b64_tr_b16 a[222:223], v226 offset:16288
v_mfma_f32_16x16x32_bf16 v[156:159], a[196:199], a[12:15], v[156:159]
s_waitcnt lgkmcnt(8)
v_mfma_f32_16x16x32_bf16 v[48:51], a[200:203], a[0:3], v[48:51]
ds_read_b64_tr_b16 a[192:193], v226 offset:192
v_mfma_f32_16x16x32_bf16 v[52:55], a[200:203], a[4:7], v[52:55]
buffer_load_dwordx4 a[68:71], v236, s[16:19], s40 offen offset:256
v_mfma_f32_16x16x32_bf16 v[160:163], a[200:203], a[8:11], v[160:163]
ds_read_b64_tr_b16 a[194:195], v226 offset:1984
v_mfma_f32_16x16x32_bf16 v[164:167], a[200:203], a[12:15], v[164:167]
v_mfma_f32_16x16x32_bf16 v[56:59], a[204:207], a[0:3], v[56:59]
ds_read_b64_tr_b16 a[196:197], v226 offset:14528
v_mfma_f32_16x16x32_bf16 v[60:63], a[204:207], a[4:7], v[60:63]
buffer_load_dwordx4 a[72:75], v236, s[16:19], s41 offen offset:0
v_mfma_f32_16x16x32_bf16 v[168:171], a[204:207], a[8:11], v[168:171]
ds_read_b64_tr_b16 a[198:199], v226 offset:16320
v_mfma_f32_16x16x32_bf16 v[172:175], a[204:207], a[12:15], v[172:175]
s_waitcnt lgkmcnt(8)
v_mfma_f32_16x16x32_bf16 v[64:67], a[208:211], a[0:3], v[64:67]
ds_read_b64_tr_b16 a[200:201], v226 offset:7168
v_mfma_f32_16x16x32_bf16 v[68:71], a[208:211], a[4:7], v[68:71]
v_mfma_f32_16x16x32_bf16 v[176:179], a[208:211], a[8:11], v[176:179]
ds_read_b64_tr_b16 a[202:203], v226 offset:8960
v_mfma_f32_16x16x32_bf16 v[180:183], a[208:211], a[12:15], v[180:183]
v_mfma_f32_16x16x32_bf16 v[72:75], a[212:215], a[0:3], v[72:75]
ds_read_b64_tr_b16 a[204:205], v226 offset:21504
v_mfma_f32_16x16x32_bf16 v[76:79], a[212:215], a[4:7], v[76:79]
buffer_load_dwordx4 a[76:79], v236, s[16:19], s41 offen offset:256
v_mfma_f32_16x16x32_bf16 v[184:187], a[212:215], a[8:11], v[184:187]
ds_read_b64_tr_b16 a[206:207], v226 offset:23296
v_mfma_f32_16x16x32_bf16 v[188:191], a[212:215], a[12:15], v[188:191]
s_waitcnt lgkmcnt(8)
v_mfma_f32_16x16x32_bf16 v[80:83], a[216:219], a[0:3], v[80:83]
ds_read_b64_tr_b16 a[208:209], v226 offset:7200
v_mfma_f32_16x16x32_bf16 v[84:87], a[216:219], a[4:7], v[84:87]
buffer_load_dwordx4 a[80:83], v236, s[16:19], s40 offen offset:2048
v_mfma_f32_16x16x32_bf16 v[192:195], a[216:219], a[8:11], v[192:195]
ds_read_b64_tr_b16 a[210:211], v226 offset:8992
v_mfma_f32_16x16x32_bf16 v[196:199], a[216:219], a[12:15], v[196:199]
v_mfma_f32_16x16x32_bf16 v[88:91], a[220:223], a[0:3], v[88:91]
ds_read_b64_tr_b16 a[212:213], v226 offset:21536
v_mfma_f32_16x16x32_bf16 v[92:95], a[220:223], a[4:7], v[92:95]
v_mfma_f32_16x16x32_bf16 v[200:203], a[220:223], a[8:11], v[200:203]
ds_read_b64_tr_b16 a[214:215], v226 offset:23328
v_mfma_f32_16x16x32_bf16 v[204:207], a[220:223], a[12:15], v[204:207]
s_waitcnt lgkmcnt(8)
v_mfma_f32_16x16x32_bf16 v[96:99], a[192:195], a[0:3], v[96:99]
ds_read_b64_tr_b16 a[216:217], v226 offset:7232
v_mfma_f32_16x16x32_bf16 v[100:103], a[192:195], a[4:7], v[100:103]
buffer_load_dwordx4 a[84:87], v236, s[16:19], s40 offen offset:2304
v_mfma_f32_16x16x32_bf16 v[208:211], a[192:195], a[8:11], v[208:211]
ds_read_b64_tr_b16 a[218:219], v226 offset:9024
v_mfma_f32_16x16x32_bf16 v[212:215], a[192:195], a[12:15], v[212:215]
s_add_u32 s40, s40, 4096
v_mfma_f32_16x16x32_bf16 v[104:107], a[196:199], a[0:3], v[104:107]
ds_read_b64_tr_b16 a[220:221], v226 offset:21568
v_mfma_f32_16x16x32_bf16 v[108:111], a[196:199], a[4:7], v[108:111]
buffer_load_dwordx4 a[88:91], v236, s[16:19], s41 offen offset:2048
v_mfma_f32_16x16x32_bf16 v[216:219], a[196:199], a[8:11], v[216:219]
ds_read_b64_tr_b16 a[222:223], v226 offset:23360
v_mfma_f32_16x16x32_bf16 v[220:223], a[196:199], a[12:15], v[220:223]
s_waitcnt vmcnt(29) lgkmcnt(8)
v_mfma_f32_16x16x32_bf16 v[0:3], a[200:203], a[16:19], v[0:3]
ds_read_b64_tr_b16 a[192:193], v226 offset:7264
v_mfma_f32_16x16x32_bf16 v[4:7], a[200:203], a[20:23], v[4:7]
v_mfma_f32_16x16x32_bf16 v[112:115], a[200:203], a[24:27], v[112:115]
ds_read_b64_tr_b16 a[194:195], v226 offset:9056
v_mfma_f32_16x16x32_bf16 v[116:119], a[200:203], a[28:31], v[116:119]
v_mfma_f32_16x16x32_bf16 v[8:11], a[204:207], a[16:19], v[8:11]
ds_read_b64_tr_b16 a[196:197], v226 offset:21600
v_mfma_f32_16x16x32_bf16 v[12:15], a[204:207], a[20:23], v[12:15]
buffer_load_dwordx4 a[92:95], v236, s[16:19], s41 offen offset:2304
v_mfma_f32_16x16x32_bf16 v[120:123], a[204:207], a[24:27], v[120:123]
ds_read_b64_tr_b16 a[198:199], v226 offset:23392
v_mfma_f32_16x16x32_bf16 v[124:127], a[204:207], a[28:31], v[124:127]
s_waitcnt lgkmcnt(8)
s_add_u32 s41, s41, 4096
s_add_u32 m0, s43, 86016
v_mfma_f32_16x16x32_bf16 v[16:19], a[208:211], a[16:19], v[16:19]
ds_read_b64_tr_b16 a[200:201], v226 offset:7296
v_mfma_f32_16x16x32_bf16 v[20:23], a[208:211], a[20:23], v[20:23]
buffer_load_dwordx4 v229, s[12:15], s42 offen offset:0 lds
v_mfma_f32_16x16x32_bf16 v[128:131], a[208:211], a[24:27], v[128:131]
ds_read_b64_tr_b16 a[202:203], v226 offset:9088
v_mfma_f32_16x16x32_bf16 v[132:135], a[208:211], a[28:31], v[132:135]
v_mfma_f32_16x16x32_bf16 v[24:27], a[212:215], a[16:19], v[24:27]
ds_read_b64_tr_b16 a[204:205], v226 offset:21632
v_mfma_f32_16x16x32_bf16 v[28:31], a[212:215], a[20:23], v[28:31]
v_mfma_f32_16x16x32_bf16 v[136:139], a[212:215], a[24:27], v[136:139]
ds_read_b64_tr_b16 a[206:207], v226 offset:23424
v_mfma_f32_16x16x32_bf16 v[140:143], a[212:215], a[28:31], v[140:143]
s_waitcnt lgkmcnt(8)
v_mfma_f32_16x16x32_bf16 v[32:35], a[216:219], a[16:19], v[32:35]
ds_read_b64_tr_b16 a[208:209], v226 offset:7328
v_mfma_f32_16x16x32_bf16 v[36:39], a[216:219], a[20:23], v[36:39]
buffer_load_dwordx4 v230, s[12:15], s42 offen offset:1024 lds
v_mfma_f32_16x16x32_bf16 v[144:147], a[216:219], a[24:27], v[144:147]
ds_read_b64_tr_b16 a[210:211], v226 offset:9120
v_mfma_f32_16x16x32_bf16 v[148:151], a[216:219], a[28:31], v[148:151]
v_mfma_f32_16x16x32_bf16 v[40:43], a[220:223], a[16:19], v[40:43]
ds_read_b64_tr_b16 a[212:213], v226 offset:21664
v_mfma_f32_16x16x32_bf16 v[44:47], a[220:223], a[20:23], v[44:47]
buffer_load_dwordx4 v231, s[12:15], s42 offen offset:2048 lds
v_mfma_f32_16x16x32_bf16 v[152:155], a[220:223], a[24:27], v[152:155]
ds_read_b64_tr_b16 a[214:215], v226 offset:23456
v_mfma_f32_16x16x32_bf16 v[156:159], a[220:223], a[28:31], v[156:159]
s_waitcnt lgkmcnt(8)
v_mfma_f32_16x16x32_bf16 v[48:51], a[192:195], a[16:19], v[48:51]
ds_read_b64_tr_b16 a[216:217], v226 offset:7360
v_mfma_f32_16x16x32_bf16 v[52:55], a[192:195], a[20:23], v[52:55]
v_mfma_f32_16x16x32_bf16 v[160:163], a[192:195], a[24:27], v[160:163]
ds_read_b64_tr_b16 a[218:219], v226 offset:9152
v_mfma_f32_16x16x32_bf16 v[164:167], a[192:195], a[28:31], v[164:167]
v_mfma_f32_16x16x32_bf16 v[56:59], a[196:199], a[16:19], v[56:59]
ds_read_b64_tr_b16 a[220:221], v226 offset:21696
v_mfma_f32_16x16x32_bf16 v[60:63], a[196:199], a[20:23], v[60:63]
buffer_load_dwordx4 v232, s[12:15], s42 offen offset:3072 lds
v_mfma_f32_16x16x32_bf16 v[168:171], a[196:199], a[24:27], v[168:171]
ds_read_b64_tr_b16 a[222:223], v226 offset:23488
v_mfma_f32_16x16x32_bf16 v[172:175], a[196:199], a[28:31], v[172:175]
s_waitcnt lgkmcnt(8)
s_waitcnt vmcnt(27)
s_barrier
s_add_u32 m0, s43, 90112
v_mfma_f32_16x16x32_bf16 v[64:67], a[200:203], a[16:19], v[64:67]
ds_read_b64_tr_b16 a[192:193], v226 offset:28672
v_mfma_f32_16x16x32_bf16 v[68:71], a[200:203], a[20:23], v[68:71]
buffer_load_dwordx4 v233, s[12:15], s42 offen offset:0 lds
v_mfma_f32_16x16x32_bf16 v[176:179], a[200:203], a[24:27], v[176:179]
ds_read_b64_tr_b16 a[194:195], v226 offset:30464
v_mfma_f32_16x16x32_bf16 v[180:183], a[200:203], a[28:31], v[180:183]
v_mfma_f32_16x16x32_bf16 v[72:75], a[204:207], a[16:19], v[72:75]
ds_read_b64_tr_b16 a[196:197], v226 offset:43008
v_mfma_f32_16x16x32_bf16 v[76:79], a[204:207], a[20:23], v[76:79]
v_mfma_f32_16x16x32_bf16 v[184:187], a[204:207], a[24:27], v[184:187]
ds_read_b64_tr_b16 a[198:199], v226 offset:44800
v_mfma_f32_16x16x32_bf16 v[188:191], a[204:207], a[28:31], v[188:191]
s_waitcnt lgkmcnt(8)
v_mfma_f32_16x16x32_bf16 v[80:83], a[208:211], a[16:19], v[80:83]
ds_read_b64_tr_b16 a[200:201], v226 offset:28704
v_mfma_f32_16x16x32_bf16 v[84:87], a[208:211], a[20:23], v[84:87]
buffer_load_dwordx4 v234, s[12:15], s42 offen offset:1024 lds
v_mfma_f32_16x16x32_bf16 v[192:195], a[208:211], a[24:27], v[192:195]
ds_read_b64_tr_b16 a[202:203], v226 offset:30496
v_mfma_f32_16x16x32_bf16 v[196:199], a[208:211], a[28:31], v[196:199]
v_mfma_f32_16x16x32_bf16 v[88:91], a[212:215], a[16:19], v[88:91]
ds_read_b64_tr_b16 a[204:205], v226 offset:43040
v_mfma_f32_16x16x32_bf16 v[92:95], a[212:215], a[20:23], v[92:95]
buffer_load_dwordx4 v235, s[12:15], s42 offen offset:2048 lds
v_mfma_f32_16x16x32_bf16 v[200:203], a[212:215], a[24:27], v[200:203]
ds_read_b64_tr_b16 a[206:207], v226 offset:44832
v_mfma_f32_16x16x32_bf16 v[204:207], a[212:215], a[28:31], v[204:207]
s_waitcnt lgkmcnt(8)
s_add_u32 s42, s42, 458752
v_mfma_f32_16x16x32_bf16 v[96:99], a[216:219], a[16:19], v[96:99]
ds_read_b64_tr_b16 a[208:209], v226 offset:28736
v_mfma_f32_16x16x32_bf16 v[100:103], a[216:219], a[20:23], v[100:103]
v_mfma_f32_16x16x32_bf16 v[208:211], a[216:219], a[24:27], v[208:211]
ds_read_b64_tr_b16 a[210:211], v226 offset:30528
v_mfma_f32_16x16x32_bf16 v[212:215], a[216:219], a[28:31], v[212:215]
v_mfma_f32_16x16x32_bf16 v[104:107], a[220:223], a[16:19], v[104:107]
ds_read_b64_tr_b16 a[212:213], v226 offset:43072
v_mfma_f32_16x16x32_bf16 v[108:111], a[220:223], a[20:23], v[108:111]
buffer_load_dwordx4 a[96:99], v236, s[16:19], s40 offen offset:0
v_mfma_f32_16x16x32_bf16 v[216:219], a[220:223], a[24:27], v[216:219]
ds_read_b64_tr_b16 a[214:215], v226 offset:44864
v_mfma_f32_16x16x32_bf16 v[220:223], a[220:223], a[28:31], v[220:223]
s_waitcnt vmcnt(27) lgkmcnt(8)
v_mfma_f32_16x16x32_bf16 v[0:3], a[192:195], a[32:35], v[0:3]
ds_read_b64_tr_b16 a[216:217], v226 offset:28768
v_mfma_f32_16x16x32_bf16 v[4:7], a[192:195], a[36:39], v[4:7]
buffer_load_dwordx4 a[100:103], v236, s[16:19], s40 offen offset:256
v_mfma_f32_16x16x32_bf16 v[112:115], a[192:195], a[40:43], v[112:115]
ds_read_b64_tr_b16 a[218:219], v226 offset:30560
v_mfma_f32_16x16x32_bf16 v[116:119], a[192:195], a[44:47], v[116:119]
v_mfma_f32_16x16x32_bf16 v[8:11], a[196:199], a[32:35], v[8:11]
ds_read_b64_tr_b16 a[220:221], v226 offset:43104
v_mfma_f32_16x16x32_bf16 v[12:15], a[196:199], a[36:39], v[12:15]
v_mfma_f32_16x16x32_bf16 v[120:123], a[196:199], a[40:43], v[120:123]
ds_read_b64_tr_b16 a[222:223], v226 offset:44896
v_mfma_f32_16x16x32_bf16 v[124:127], a[196:199], a[44:47], v[124:127]
s_waitcnt lgkmcnt(8)
v_mfma_f32_16x16x32_bf16 v[16:19], a[200:203], a[32:35], v[16:19]
ds_read_b64_tr_b16 a[192:193], v226 offset:28800
v_mfma_f32_16x16x32_bf16 v[20:23], a[200:203], a[36:39], v[20:23]
buffer_load_dwordx4 a[104:107], v236, s[16:19], s41 offen offset:0
v_mfma_f32_16x16x32_bf16 v[128:131], a[200:203], a[40:43], v[128:131]
ds_read_b64_tr_b16 a[194:195], v226 offset:30592
v_mfma_f32_16x16x32_bf16 v[132:135], a[200:203], a[44:47], v[132:135]
v_mfma_f32_16x16x32_bf16 v[24:27], a[204:207], a[32:35], v[24:27]
ds_read_b64_tr_b16 a[196:197], v226 offset:43136
v_mfma_f32_16x16x32_bf16 v[28:31], a[204:207], a[36:39], v[28:31]
buffer_load_dwordx4 a[108:111], v236, s[16:19], s41 offen offset:256
v_mfma_f32_16x16x32_bf16 v[136:139], a[204:207], a[40:43], v[136:139]
ds_read_b64_tr_b16 a[198:199], v226 offset:44928
v_mfma_f32_16x16x32_bf16 v[140:143], a[204:207], a[44:47], v[140:143]
s_waitcnt lgkmcnt(8)
v_mfma_f32_16x16x32_bf16 v[32:35], a[208:211], a[32:35], v[32:35]
ds_read_b64_tr_b16 a[200:201], v226 offset:28832
v_mfma_f32_16x16x32_bf16 v[36:39], a[208:211], a[36:39], v[36:39]
v_mfma_f32_16x16x32_bf16 v[144:147], a[208:211], a[40:43], v[144:147]
ds_read_b64_tr_b16 a[202:203], v226 offset:30624
v_mfma_f32_16x16x32_bf16 v[148:151], a[208:211], a[44:47], v[148:151]
v_mfma_f32_16x16x32_bf16 v[40:43], a[212:215], a[32:35], v[40:43]
ds_read_b64_tr_b16 a[204:205], v226 offset:43168
v_mfma_f32_16x16x32_bf16 v[44:47], a[212:215], a[36:39], v[44:47]
buffer_load_dwordx4 a[112:115], v236, s[16:19], s40 offen offset:2048
v_mfma_f32_16x16x32_bf16 v[152:155], a[212:215], a[40:43], v[152:155]
ds_read_b64_tr_b16 a[206:207], v226 offset:44960
v_mfma_f32_16x16x32_bf16 v[156:159], a[212:215], a[44:47], v[156:159]
s_waitcnt lgkmcnt(8)
v_mfma_f32_16x16x32_bf16 v[48:51], a[216:219], a[32:35], v[48:51]
ds_read_b64_tr_b16 a[208:209], v226 offset:28864
v_mfma_f32_16x16x32_bf16 v[52:55], a[216:219], a[36:39], v[52:55]
buffer_load_dwordx4 a[116:119], v236, s[16:19], s40 offen offset:2304
v_mfma_f32_16x16x32_bf16 v[160:163], a[216:219], a[40:43], v[160:163]
ds_read_b64_tr_b16 a[210:211], v226 offset:30656
v_mfma_f32_16x16x32_bf16 v[164:167], a[216:219], a[44:47], v[164:167]
s_add_u32 s40, s40, 4096
v_mfma_f32_16x16x32_bf16 v[56:59], a[220:223], a[32:35], v[56:59]
ds_read_b64_tr_b16 a[212:213], v226 offset:43200
v_mfma_f32_16x16x32_bf16 v[60:63], a[220:223], a[36:39], v[60:63]
v_mfma_f32_16x16x32_bf16 v[168:171], a[220:223], a[40:43], v[168:171]
ds_read_b64_tr_b16 a[214:215], v226 offset:44992
v_mfma_f32_16x16x32_bf16 v[172:175], a[220:223], a[44:47], v[172:175]
s_waitcnt lgkmcnt(8)
v_mfma_f32_16x16x32_bf16 v[64:67], a[192:195], a[32:35], v[64:67]
ds_read_b64_tr_b16 a[216:217], v226 offset:35840
v_mfma_f32_16x16x32_bf16 v[68:71], a[192:195], a[36:39], v[68:71]
buffer_load_dwordx4 a[120:123], v236, s[16:19], s41 offen offset:2048
v_mfma_f32_16x16x32_bf16 v[176:179], a[192:195], a[40:43], v[176:179]
ds_read_b64_tr_b16 a[218:219], v226 offset:37632
v_mfma_f32_16x16x32_bf16 v[180:183], a[192:195], a[44:47], v[180:183]
v_mfma_f32_16x16x32_bf16 v[72:75], a[196:199], a[32:35], v[72:75]
ds_read_b64_tr_b16 a[220:221], v226 offset:50176
v_mfma_f32_16x16x32_bf16 v[76:79], a[196:199], a[36:39], v[76:79]
buffer_load_dwordx4 a[124:127], v236, s[16:19], s41 offen offset:2304
v_mfma_f32_16x16x32_bf16 v[184:187], a[196:199], a[40:43], v[184:187]
ds_read_b64_tr_b16 a[222:223], v226 offset:51968
v_mfma_f32_16x16x32_bf16 v[188:191], a[196:199], a[44:47], v[188:191]
s_waitcnt lgkmcnt(8)
s_add_u32 s41, s41, 4096
v_mfma_f32_16x16x32_bf16 v[80:83], a[200:203], a[32:35], v[80:83]
ds_read_b64_tr_b16 a[192:193], v226 offset:35872
v_mfma_f32_16x16x32_bf16 v[84:87], a[200:203], a[36:39], v[84:87]
v_mfma_f32_16x16x32_bf16 v[192:195], a[200:203], a[40:43], v[192:195]
ds_read_b64_tr_b16 a[194:195], v226 offset:37664
v_mfma_f32_16x16x32_bf16 v[196:199], a[200:203], a[44:47], v[196:199]
s_add_u32 m0, s43, 114688
v_mfma_f32_16x16x32_bf16 v[88:91], a[204:207], a[32:35], v[88:91]
ds_read_b64_tr_b16 a[196:197], v226 offset:50208
v_mfma_f32_16x16x32_bf16 v[92:95], a[204:207], a[36:39], v[92:95]
buffer_load_dwordx4 v229, s[12:15], s42 offen offset:0 lds
v_mfma_f32_16x16x32_bf16 v[200:203], a[204:207], a[40:43], v[200:203]
ds_read_b64_tr_b16 a[198:199], v226 offset:52000
v_mfma_f32_16x16x32_bf16 v[204:207], a[204:207], a[44:47], v[204:207]
s_waitcnt lgkmcnt(8)
v_mfma_f32_16x16x32_bf16 v[96:99], a[208:211], a[32:35], v[96:99]
ds_read_b64_tr_b16 a[200:201], v226 offset:35904
v_mfma_f32_16x16x32_bf16 v[100:103], a[208:211], a[36:39], v[100:103]
buffer_load_dwordx4 v230, s[12:15], s42 offen offset:1024 lds
v_mfma_f32_16x16x32_bf16 v[208:211], a[208:211], a[40:43], v[208:211]
ds_read_b64_tr_b16 a[202:203], v226 offset:37696
v_mfma_f32_16x16x32_bf16 v[212:215], a[208:211], a[44:47], v[212:215]
v_mfma_f32_16x16x32_bf16 v[104:107], a[212:215], a[32:35], v[104:107]
ds_read_b64_tr_b16 a[204:205], v226 offset:50240
v_mfma_f32_16x16x32_bf16 v[108:111], a[212:215], a[36:39], v[108:111]
v_mfma_f32_16x16x32_bf16 v[216:219], a[212:215], a[40:43], v[216:219]
ds_read_b64_tr_b16 a[206:207], v226 offset:52032
v_mfma_f32_16x16x32_bf16 v[220:223], a[212:215], a[44:47], v[220:223]
s_waitcnt vmcnt(32) lgkmcnt(8)
v_mfma_f32_16x16x32_bf16 v[0:3], a[216:219], a[48:51], v[0:3]
ds_read_b64_tr_b16 a[208:209], v226 offset:35936
v_mfma_f32_16x16x32_bf16 v[4:7], a[216:219], a[52:55], v[4:7]
buffer_load_dwordx4 v231, s[12:15], s42 offen offset:2048 lds
v_mfma_f32_16x16x32_bf16 v[112:115], a[216:219], a[56:59], v[112:115]
ds_read_b64_tr_b16 a[210:211], v226 offset:37728
v_mfma_f32_16x16x32_bf16 v[116:119], a[216:219], a[60:63], v[116:119]
v_mfma_f32_16x16x32_bf16 v[8:11], a[220:223], a[48:51], v[8:11]
ds_read_b64_tr_b16 a[212:213], v226 offset:50272
v_mfma_f32_16x16x32_bf16 v[12:15], a[220:223], a[52:55], v[12:15]
buffer_load_dwordx4 v232, s[12:15], s42 offen offset:3072 lds
v_mfma_f32_16x16x32_bf16 v[120:123], a[220:223], a[56:59], v[120:123]
ds_read_b64_tr_b16 a[214:215], v226 offset:52064
v_mfma_f32_16x16x32_bf16 v[124:127], a[220:223], a[60:63], v[124:127]
s_waitcnt lgkmcnt(8)
v_mfma_f32_16x16x32_bf16 v[16:19], a[192:195], a[48:51], v[16:19]
ds_read_b64_tr_b16 a[216:217], v226 offset:35968
v_mfma_f32_16x16x32_bf16 v[20:23], a[192:195], a[52:55], v[20:23]
v_mfma_f32_16x16x32_bf16 v[128:131], a[192:195], a[56:59], v[128:131]
ds_read_b64_tr_b16 a[218:219], v226 offset:37760
v_mfma_f32_16x16x32_bf16 v[132:135], a[192:195], a[60:63], v[132:135]
s_add_u32 m0, s43, 118784
v_mfma_f32_16x16x32_bf16 v[24:27], a[196:199], a[48:51], v[24:27]
ds_read_b64_tr_b16 a[220:221], v226 offset:50304
v_mfma_f32_16x16x32_bf16 v[28:31], a[196:199], a[52:55], v[28:31]
buffer_load_dwordx4 v233, s[12:15], s42 offen offset:0 lds
v_mfma_f32_16x16x32_bf16 v[136:139], a[196:199], a[56:59], v[136:139]
ds_read_b64_tr_b16 a[222:223], v226 offset:52096
v_mfma_f32_16x16x32_bf16 v[140:143], a[196:199], a[60:63], v[140:143]
s_waitcnt lgkmcnt(8)
v_mfma_f32_16x16x32_bf16 v[32:35], a[200:203], a[48:51], v[32:35]
ds_read_b64_tr_b16 a[192:193], v226 offset:36000
v_mfma_f32_16x16x32_bf16 v[36:39], a[200:203], a[52:55], v[36:39]
buffer_load_dwordx4 v234, s[12:15], s42 offen offset:1024 lds
v_mfma_f32_16x16x32_bf16 v[144:147], a[200:203], a[56:59], v[144:147]
ds_read_b64_tr_b16 a[194:195], v226 offset:37792
v_mfma_f32_16x16x32_bf16 v[148:151], a[200:203], a[60:63], v[148:151]
v_mfma_f32_16x16x32_bf16 v[40:43], a[204:207], a[48:51], v[40:43]
ds_read_b64_tr_b16 a[196:197], v226 offset:50336
v_mfma_f32_16x16x32_bf16 v[44:47], a[204:207], a[52:55], v[44:47]
v_mfma_f32_16x16x32_bf16 v[152:155], a[204:207], a[56:59], v[152:155]
ds_read_b64_tr_b16 a[198:199], v226 offset:52128
v_mfma_f32_16x16x32_bf16 v[156:159], a[204:207], a[60:63], v[156:159]
s_waitcnt lgkmcnt(8)
v_mfma_f32_16x16x32_bf16 v[48:51], a[208:211], a[48:51], v[48:51]
ds_read_b64_tr_b16 a[200:201], v226 offset:36032
v_mfma_f32_16x16x32_bf16 v[52:55], a[208:211], a[52:55], v[52:55]
buffer_load_dwordx4 v235, s[12:15], s42 offen offset:2048 lds
v_mfma_f32_16x16x32_bf16 v[160:163], a[208:211], a[56:59], v[160:163]
ds_read_b64_tr_b16 a[202:203], v226 offset:37824
v_mfma_f32_16x16x32_bf16 v[164:167], a[208:211], a[60:63], v[164:167]
s_add_u32 s42, s42, 458752
v_mfma_f32_16x16x32_bf16 v[56:59], a[212:215], a[48:51], v[56:59]
ds_read_b64_tr_b16 a[204:205], v226 offset:50368
v_mfma_f32_16x16x32_bf16 v[60:63], a[212:215], a[52:55], v[60:63]
buffer_load_dwordx4 a[128:131], v236, s[16:19], s40 offen offset:0
v_mfma_f32_16x16x32_bf16 v[168:171], a[212:215], a[56:59], v[168:171]
ds_read_b64_tr_b16 a[206:207], v226 offset:52160
v_mfma_f32_16x16x32_bf16 v[172:175], a[212:215], a[60:63], v[172:175]
s_waitcnt lgkmcnt(8)
s_waitcnt vmcnt(31)
s_barrier
v_mfma_f32_16x16x32_bf16 v[64:67], a[216:219], a[48:51], v[64:67]
ds_read_b64_tr_b16 a[208:209], v227 offset:0
v_mfma_f32_16x16x32_bf16 v[68:71], a[216:219], a[52:55], v[68:71]
v_mfma_f32_16x16x32_bf16 v[176:179], a[216:219], a[56:59], v[176:179]
ds_read_b64_tr_b16 a[210:211], v227 offset:1792
v_mfma_f32_16x16x32_bf16 v[180:183], a[216:219], a[60:63], v[180:183]
v_mfma_f32_16x16x32_bf16 v[72:75], a[220:223], a[48:51], v[72:75]
ds_read_b64_tr_b16 a[212:213], v227 offset:14336
v_mfma_f32_16x16x32_bf16 v[76:79], a[220:223], a[52:55], v[76:79]
buffer_load_dwordx4 a[132:135], v236, s[16:19], s40 offen offset:256
v_mfma_f32_16x16x32_bf16 v[184:187], a[220:223], a[56:59], v[184:187]
ds_read_b64_tr_b16 a[214:215], v227 offset:16128
v_mfma_f32_16x16x32_bf16 v[188:191], a[220:223], a[60:63], v[188:191]
s_waitcnt lgkmcnt(8)
v_mfma_f32_16x16x32_bf16 v[80:83], a[192:195], a[48:51], v[80:83]
ds_read_b64_tr_b16 a[216:217], v227 offset:32
v_mfma_f32_16x16x32_bf16 v[84:87], a[192:195], a[52:55], v[84:87]
buffer_load_dwordx4 a[136:139], v236, s[16:19], s41 offen offset:0
v_mfma_f32_16x16x32_bf16 v[192:195], a[192:195], a[56:59], v[192:195]
ds_read_b64_tr_b16 a[218:219], v227 offset:1824
v_mfma_f32_16x16x32_bf16 v[196:199], a[192:195], a[60:63], v[196:199]
v_mfma_f32_16x16x32_bf16 v[88:91], a[196:199], a[48:51], v[88:91]
ds_read_b64_tr_b16 a[220:221], v227 offset:14368
v_mfma_f32_16x16x32_bf16 v[92:95], a[196:199], a[52:55], v[92:95]
v_mfma_f32_16x16x32_bf16 v[200:203], a[196:199], a[56:59], v[200:203]
ds_read_b64_tr_b16 a[222:223], v227 offset:16160
v_mfma_f32_16x16x32_bf16 v[204:207], a[196:199], a[60:63], v[204:207]
s_waitcnt lgkmcnt(8)
v_mfma_f32_16x16x32_bf16 v[96:99], a[200:203], a[48:51], v[96:99]
ds_read_b64_tr_b16 a[192:193], v227 offset:64
v_mfma_f32_16x16x32_bf16 v[100:103], a[200:203], a[52:55], v[100:103]
buffer_load_dwordx4 a[140:143], v236, s[16:19], s41 offen offset:256
v_mfma_f32_16x16x32_bf16 v[208:211], a[200:203], a[56:59], v[208:211]
ds_read_b64_tr_b16 a[194:195], v227 offset:1856
v_mfma_f32_16x16x32_bf16 v[212:215], a[200:203], a[60:63], v[212:215]
v_mfma_f32_16x16x32_bf16 v[104:107], a[204:207], a[48:51], v[104:107]
ds_read_b64_tr_b16 a[196:197], v227 offset:14400
v_mfma_f32_16x16x32_bf16 v[108:111], a[204:207], a[52:55], v[108:111]
buffer_load_dwordx4 a[144:147], v236, s[16:19], s40 offen offset:2048
v_mfma_f32_16x16x32_bf16 v[216:219], a[204:207], a[56:59], v[216:219]
ds_read_b64_tr_b16 a[198:199], v227 offset:16192
v_mfma_f32_16x16x32_bf16 v[220:223], a[204:207], a[60:63], v[220:223]
s_waitcnt vmcnt(31) lgkmcnt(8)
v_mfma_f32_16x16x32_bf16 v[0:3], a[208:211], a[64:67], v[0:3]
ds_read_b64_tr_b16 a[200:201], v227 offset:96
v_mfma_f32_16x16x32_bf16 v[4:7], a[208:211], a[68:71], v[4:7]
v_mfma_f32_16x16x32_bf16 v[112:115], a[208:211], a[72:75], v[112:115]
ds_read_b64_tr_b16 a[202:203], v227 offset:1888
v_mfma_f32_16x16x32_bf16 v[116:119], a[208:211], a[76:79], v[116:119]
v_mfma_f32_16x16x32_bf16 v[8:11], a[212:215], a[64:67], v[8:11]
ds_read_b64_tr_b16 a[204:205], v227 offset:14432
v_mfma_f32_16x16x32_bf16 v[12:15], a[212:215], a[68:71], v[12:15]
buffer_load_dwordx4 a[148:151], v236, s[16:19], s40 offen offset:2304
v_mfma_f32_16x16x32_bf16 v[120:123], a[212:215], a[72:75], v[120:123]
ds_read_b64_tr_b16 a[206:207], v227 offset:16224
v_mfma_f32_16x16x32_bf16 v[124:127], a[212:215], a[76:79], v[124:127]
s_waitcnt lgkmcnt(8)
s_add_u32 s40, s40, 4096
v_mfma_f32_16x16x32_bf16 v[16:19], a[216:219], a[64:67], v[16:19]
ds_read_b64_tr_b16 a[208:209], v227 offset:128
v_mfma_f32_16x16x32_bf16 v[20:23], a[216:219], a[68:71], v[20:23]
buffer_load_dwordx4 a[152:155], v236, s[16:19], s41 offen offset:2048
v_mfma_f32_16x16x32_bf16 v[128:131], a[216:219], a[72:75], v[128:131]
ds_read_b64_tr_b16 a[210:211], v227 offset:1920
v_mfma_f32_16x16x32_bf16 v[132:135], a[216:219], a[76:79], v[132:135]
v_mfma_f32_16x16x32_bf16 v[24:27], a[220:223], a[64:67], v[24:27]
ds_read_b64_tr_b16 a[212:213], v227 offset:14464
v_mfma_f32_16x16x32_bf16 v[28:31], a[220:223], a[68:71], v[28:31]
v_mfma_f32_16x16x32_bf16 v[136:139], a[220:223], a[72:75], v[136:139]
ds_read_b64_tr_b16 a[214:215], v227 offset:16256
v_mfma_f32_16x16x32_bf16 v[140:143], a[220:223], a[76:79], v[140:143]
s_waitcnt lgkmcnt(8)
v_mfma_f32_16x16x32_bf16 v[32:35], a[192:195], a[64:67], v[32:35]
ds_read_b64_tr_b16 a[216:217], v227 offset:160
v_mfma_f32_16x16x32_bf16 v[36:39], a[192:195], a[68:71], v[36:39]
buffer_load_dwordx4 a[156:159], v236, s[16:19], s41 offen offset:2304
v_mfma_f32_16x16x32_bf16 v[144:147], a[192:195], a[72:75], v[144:147]
ds_read_b64_tr_b16 a[218:219], v227 offset:1952
v_mfma_f32_16x16x32_bf16 v[148:151], a[192:195], a[76:79], v[148:151]
s_add_u32 s41, s41, 4096
s_add_u32 m0, s43, 0
v_mfma_f32_16x16x32_bf16 v[40:43], a[196:199], a[64:67], v[40:43]
ds_read_b64_tr_b16 a[220:221], v227 offset:14496
v_mfma_f32_16x16x32_bf16 v[44:47], a[196:199], a[68:71], v[44:47]
buffer_load_dwordx4 v229, s[12:15], s42 offen offset:0 lds
v_mfma_f32_16x16x32_bf16 v[152:155], a[196:199], a[72:75], v[152:155]
ds_read_b64_tr_b16 a[222:223], v227 offset:16288
v_mfma_f32_16x16x32_bf16 v[156:159], a[196:199], a[76:79], v[156:159]
s_waitcnt lgkmcnt(8)
v_mfma_f32_16x16x32_bf16 v[48:51], a[200:203], a[64:67], v[48:51]
ds_read_b64_tr_b16 a[192:193], v227 offset:192
v_mfma_f32_16x16x32_bf16 v[52:55], a[200:203], a[68:71], v[52:55]
v_mfma_f32_16x16x32_bf16 v[160:163], a[200:203], a[72:75], v[160:163]
ds_read_b64_tr_b16 a[194:195], v227 offset:1984
v_mfma_f32_16x16x32_bf16 v[164:167], a[200:203], a[76:79], v[164:167]
v_mfma_f32_16x16x32_bf16 v[56:59], a[204:207], a[64:67], v[56:59]
ds_read_b64_tr_b16 a[196:197], v227 offset:14528
v_mfma_f32_16x16x32_bf16 v[60:63], a[204:207], a[68:71], v[60:63]
buffer_load_dwordx4 v230, s[12:15], s42 offen offset:1024 lds
v_mfma_f32_16x16x32_bf16 v[168:171], a[204:207], a[72:75], v[168:171]
ds_read_b64_tr_b16 a[198:199], v227 offset:16320
v_mfma_f32_16x16x32_bf16 v[172:175], a[204:207], a[76:79], v[172:175]
s_waitcnt lgkmcnt(8)
v_mfma_f32_16x16x32_bf16 v[64:67], a[208:211], a[64:67], v[64:67]
ds_read_b64_tr_b16 a[200:201], v227 offset:7168
v_mfma_f32_16x16x32_bf16 v[68:71], a[208:211], a[68:71], v[68:71]
buffer_load_dwordx4 v231, s[12:15], s42 offen offset:2048 lds
v_mfma_f32_16x16x32_bf16 v[176:179], a[208:211], a[72:75], v[176:179]
ds_read_b64_tr_b16 a[202:203], v227 offset:8960
v_mfma_f32_16x16x32_bf16 v[180:183], a[208:211], a[76:79], v[180:183]
v_mfma_f32_16x16x32_bf16 v[72:75], a[212:215], a[64:67], v[72:75]
ds_read_b64_tr_b16 a[204:205], v227 offset:21504
v_mfma_f32_16x16x32_bf16 v[76:79], a[212:215], a[68:71], v[76:79]
v_mfma_f32_16x16x32_bf16 v[184:187], a[212:215], a[72:75], v[184:187]
ds_read_b64_tr_b16 a[206:207], v227 offset:23296
v_mfma_f32_16x16x32_bf16 v[188:191], a[212:215], a[76:79], v[188:191]
s_waitcnt lgkmcnt(8)
v_mfma_f32_16x16x32_bf16 v[80:83], a[216:219], a[64:67], v[80:83]
ds_read_b64_tr_b16 a[208:209], v227 offset:7200
v_mfma_f32_16x16x32_bf16 v[84:87], a[216:219], a[68:71], v[84:87]
buffer_load_dwordx4 v232, s[12:15], s42 offen offset:3072 lds
v_mfma_f32_16x16x32_bf16 v[192:195], a[216:219], a[72:75], v[192:195]
ds_read_b64_tr_b16 a[210:211], v227 offset:8992
v_mfma_f32_16x16x32_bf16 v[196:199], a[216:219], a[76:79], v[196:199]
s_add_u32 m0, s43, 4096
v_mfma_f32_16x16x32_bf16 v[88:91], a[220:223], a[64:67], v[88:91]
ds_read_b64_tr_b16 a[212:213], v227 offset:21536
v_mfma_f32_16x16x32_bf16 v[92:95], a[220:223], a[68:71], v[92:95]
buffer_load_dwordx4 v233, s[12:15], s42 offen offset:0 lds
v_mfma_f32_16x16x32_bf16 v[200:203], a[220:223], a[72:75], v[200:203]
ds_read_b64_tr_b16 a[214:215], v227 offset:23328
v_mfma_f32_16x16x32_bf16 v[204:207], a[220:223], a[76:79], v[204:207]
s_waitcnt lgkmcnt(8)
v_mfma_f32_16x16x32_bf16 v[96:99], a[192:195], a[64:67], v[96:99]
ds_read_b64_tr_b16 a[216:217], v227 offset:7232
v_mfma_f32_16x16x32_bf16 v[100:103], a[192:195], a[68:71], v[100:103]
v_mfma_f32_16x16x32_bf16 v[208:211], a[192:195], a[72:75], v[208:211]
ds_read_b64_tr_b16 a[218:219], v227 offset:9024
v_mfma_f32_16x16x32_bf16 v[212:215], a[192:195], a[76:79], v[212:215]
v_mfma_f32_16x16x32_bf16 v[104:107], a[196:199], a[64:67], v[104:107]
ds_read_b64_tr_b16 a[220:221], v227 offset:21568
v_mfma_f32_16x16x32_bf16 v[108:111], a[196:199], a[68:71], v[108:111]
buffer_load_dwordx4 v234, s[12:15], s42 offen offset:1024 lds
v_mfma_f32_16x16x32_bf16 v[216:219], a[196:199], a[72:75], v[216:219]
ds_read_b64_tr_b16 a[222:223], v227 offset:23360
v_mfma_f32_16x16x32_bf16 v[220:223], a[196:199], a[76:79], v[220:223]
s_waitcnt vmcnt(36) lgkmcnt(8)
v_mfma_f32_16x16x32_bf16 v[0:3], a[200:203], a[80:83], v[0:3]
ds_read_b64_tr_b16 a[192:193], v227 offset:7264
v_mfma_f32_16x16x32_bf16 v[4:7], a[200:203], a[84:87], v[4:7]
buffer_load_dwordx4 v235, s[12:15], s42 offen offset:2048 lds
v_mfma_f32_16x16x32_bf16 v[112:115], a[200:203], a[88:91], v[112:115]
ds_read_b64_tr_b16 a[194:195], v227 offset:9056
v_mfma_f32_16x16x32_bf16 v[116:119], a[200:203], a[92:95], v[116:119]
s_add_u32 s42, s42, 458752
v_mfma_f32_16x16x32_bf16 v[8:11], a[204:207], a[80:83], v[8:11]
ds_read_b64_tr_b16 a[196:197], v227 offset:21600
v_mfma_f32_16x16x32_bf16 v[12:15], a[204:207], a[84:87], v[12:15]
v_mfma_f32_16x16x32_bf16 v[120:123], a[204:207], a[88:91], v[120:123]
ds_read_b64_tr_b16 a[198:199], v227 offset:23392
v_mfma_f32_16x16x32_bf16 v[124:127], a[204:207], a[92:95], v[124:127]
s_waitcnt lgkmcnt(8)
v_mfma_f32_16x16x32_bf16 v[16:19], a[208:211], a[80:83], v[16:19]
ds_read_b64_tr_b16 a[200:201], v227 offset:7296
v_mfma_f32_16x16x32_bf16 v[20:23], a[208:211], a[84:87], v[20:23]
buffer_load_dwordx4 a[0:3], v236, s[16:19], s40 offen offset:0
v_mfma_f32_16x16x32_bf16 v[128:131], a[208:211], a[88:91], v[128:131]
ds_read_b64_tr_b16 a[202:203], v227 offset:9088
v_mfma_f32_16x16x32_bf16 v[132:135], a[208:211], a[92:95], v[132:135]
v_mfma_f32_16x16x32_bf16 v[24:27], a[212:215], a[80:83], v[24:27]
ds_read_b64_tr_b16 a[204:205], v227 offset:21632
v_mfma_f32_16x16x32_bf16 v[28:31], a[212:215], a[84:87], v[28:31]
buffer_load_dwordx4 a[4:7], v236, s[16:19], s40 offen offset:256
v_mfma_f32_16x16x32_bf16 v[136:139], a[212:215], a[88:91], v[136:139]
ds_read_b64_tr_b16 a[206:207], v227 offset:23424
v_mfma_f32_16x16x32_bf16 v[140:143], a[212:215], a[92:95], v[140:143]
s_waitcnt lgkmcnt(8)
v_mfma_f32_16x16x32_bf16 v[32:35], a[216:219], a[80:83], v[32:35]
ds_read_b64_tr_b16 a[208:209], v227 offset:7328
v_mfma_f32_16x16x32_bf16 v[36:39], a[216:219], a[84:87], v[36:39]
v_mfma_f32_16x16x32_bf16 v[144:147], a[216:219], a[88:91], v[144:147]
ds_read_b64_tr_b16 a[210:211], v227 offset:9120
v_mfma_f32_16x16x32_bf16 v[148:151], a[216:219], a[92:95], v[148:151]
v_mfma_f32_16x16x32_bf16 v[40:43], a[220:223], a[80:83], v[40:43]
ds_read_b64_tr_b16 a[212:213], v227 offset:21664
v_mfma_f32_16x16x32_bf16 v[44:47], a[220:223], a[84:87], v[44:47]
buffer_load_dwordx4 a[8:11], v236, s[16:19], s41 offen offset:0
v_mfma_f32_16x16x32_bf16 v[152:155], a[220:223], a[88:91], v[152:155]
ds_read_b64_tr_b16 a[214:215], v227 offset:23456
v_mfma_f32_16x16x32_bf16 v[156:159], a[220:223], a[92:95], v[156:159]
s_waitcnt lgkmcnt(8)
v_mfma_f32_16x16x32_bf16 v[48:51], a[192:195], a[80:83], v[48:51]
ds_read_b64_tr_b16 a[216:217], v227 offset:7360
v_mfma_f32_16x16x32_bf16 v[52:55], a[192:195], a[84:87], v[52:55]
buffer_load_dwordx4 a[12:15], v236, s[16:19], s41 offen offset:256
v_mfma_f32_16x16x32_bf16 v[160:163], a[192:195], a[88:91], v[160:163]
ds_read_b64_tr_b16 a[218:219], v227 offset:9152
v_mfma_f32_16x16x32_bf16 v[164:167], a[192:195], a[92:95], v[164:167]
v_mfma_f32_16x16x32_bf16 v[56:59], a[196:199], a[80:83], v[56:59]
ds_read_b64_tr_b16 a[220:221], v227 offset:21696
v_mfma_f32_16x16x32_bf16 v[60:63], a[196:199], a[84:87], v[60:63]
v_mfma_f32_16x16x32_bf16 v[168:171], a[196:199], a[88:91], v[168:171]
ds_read_b64_tr_b16 a[222:223], v227 offset:23488
v_mfma_f32_16x16x32_bf16 v[172:175], a[196:199], a[92:95], v[172:175]
s_waitcnt lgkmcnt(8)
s_waitcnt vmcnt(34)
s_barrier
v_mfma_f32_16x16x32_bf16 v[64:67], a[200:203], a[80:83], v[64:67]
ds_read_b64_tr_b16 a[192:193], v227 offset:28672
v_mfma_f32_16x16x32_bf16 v[68:71], a[200:203], a[84:87], v[68:71]
buffer_load_dwordx4 a[16:19], v236, s[16:19], s40 offen offset:2048
v_mfma_f32_16x16x32_bf16 v[176:179], a[200:203], a[88:91], v[176:179]
ds_read_b64_tr_b16 a[194:195], v227 offset:30464
v_mfma_f32_16x16x32_bf16 v[180:183], a[200:203], a[92:95], v[180:183]
v_mfma_f32_16x16x32_bf16 v[72:75], a[204:207], a[80:83], v[72:75]
ds_read_b64_tr_b16 a[196:197], v227 offset:43008
v_mfma_f32_16x16x32_bf16 v[76:79], a[204:207], a[84:87], v[76:79]
buffer_load_dwordx4 a[20:23], v236, s[16:19], s40 offen offset:2304
v_mfma_f32_16x16x32_bf16 v[184:187], a[204:207], a[88:91], v[184:187]
ds_read_b64_tr_b16 a[198:199], v227 offset:44800
v_mfma_f32_16x16x32_bf16 v[188:191], a[204:207], a[92:95], v[188:191]
s_waitcnt lgkmcnt(8)
s_add_u32 s40, s40, 4096
v_mfma_f32_16x16x32_bf16 v[80:83], a[208:211], a[80:83], v[80:83]
ds_read_b64_tr_b16 a[200:201], v227 offset:28704
v_mfma_f32_16x16x32_bf16 v[84:87], a[208:211], a[84:87], v[84:87]
v_mfma_f32_16x16x32_bf16 v[192:195], a[208:211], a[88:91], v[192:195]
ds_read_b64_tr_b16 a[202:203], v227 offset:30496
v_mfma_f32_16x16x32_bf16 v[196:199], a[208:211], a[92:95], v[196:199]
v_mfma_f32_16x16x32_bf16 v[88:91], a[212:215], a[80:83], v[88:91]
ds_read_b64_tr_b16 a[204:205], v227 offset:43040
v_mfma_f32_16x16x32_bf16 v[92:95], a[212:215], a[84:87], v[92:95]
buffer_load_dwordx4 a[24:27], v236, s[16:19], s41 offen offset:2048
v_mfma_f32_16x16x32_bf16 v[200:203], a[212:215], a[88:91], v[200:203]
ds_read_b64_tr_b16 a[206:207], v227 offset:44832
v_mfma_f32_16x16x32_bf16 v[204:207], a[212:215], a[92:95], v[204:207]
s_waitcnt lgkmcnt(8)
v_mfma_f32_16x16x32_bf16 v[96:99], a[216:219], a[80:83], v[96:99]
ds_read_b64_tr_b16 a[208:209], v227 offset:28736
v_mfma_f32_16x16x32_bf16 v[100:103], a[216:219], a[84:87], v[100:103]
buffer_load_dwordx4 a[28:31], v236, s[16:19], s41 offen offset:2304
v_mfma_f32_16x16x32_bf16 v[208:211], a[216:219], a[88:91], v[208:211]
ds_read_b64_tr_b16 a[210:211], v227 offset:30528
v_mfma_f32_16x16x32_bf16 v[212:215], a[216:219], a[92:95], v[212:215]
s_add_u32 s41, s41, 4096
v_mfma_f32_16x16x32_bf16 v[104:107], a[220:223], a[80:83], v[104:107]
ds_read_b64_tr_b16 a[212:213], v227 offset:43072
v_mfma_f32_16x16x32_bf16 v[108:111], a[220:223], a[84:87], v[108:111]
v_mfma_f32_16x16x32_bf16 v[216:219], a[220:223], a[88:91], v[216:219]
ds_read_b64_tr_b16 a[214:215], v227 offset:44864
v_mfma_f32_16x16x32_bf16 v[220:223], a[220:223], a[92:95], v[220:223]
s_waitcnt vmcnt(34) lgkmcnt(8)
s_add_u32 m0, s43, 28672
v_mfma_f32_16x16x32_bf16 v[0:3], a[192:195], a[96:99], v[0:3]
ds_read_b64_tr_b16 a[216:217], v227 offset:28768
v_mfma_f32_16x16x32_bf16 v[4:7], a[192:195], a[100:103], v[4:7]
buffer_load_dwordx4 v229, s[12:15], s42 offen offset:0 lds
v_mfma_f32_16x16x32_bf16 v[112:115], a[192:195], a[104:107], v[112:115]
ds_read_b64_tr_b16 a[218:219], v227 offset:30560
v_mfma_f32_16x16x32_bf16 v[116:119], a[192:195], a[108:111], v[116:119]
v_mfma_f32_16x16x32_bf16 v[8:11], a[196:199], a[96:99], v[8:11]
ds_read_b64_tr_b16 a[220:221], v227 offset:43104
v_mfma_f32_16x16x32_bf16 v[12:15], a[196:199], a[100:103], v[12:15]
buffer_load_dwordx4 v230, s[12:15], s42 offen offset:1024 lds
v_mfma_f32_16x16x32_bf16 v[120:123], a[196:199], a[104:107], v[120:123]
ds_read_b64_tr_b16 a[222:223], v227 offset:44896
v_mfma_f32_16x16x32_bf16 v[124:127], a[196:199], a[108:111], v[124:127]
s_waitcnt lgkmcnt(8)
v_mfma_f32_16x16x32_bf16 v[16:19], a[200:203], a[96:99], v[16:19]
ds_read_b64_tr_b16 a[192:193], v227 offset:28800
v_mfma_f32_16x16x32_bf16 v[20:23], a[200:203], a[100:103], v[20:23]
v_mfma_f32_16x16x32_bf16 v[128:131], a[200:203], a[104:107], v[128:131]
ds_read_b64_tr_b16 a[194:195], v227 offset:30592
v_mfma_f32_16x16x32_bf16 v[132:135], a[200:203], a[108:111], v[132:135]
v_mfma_f32_16x16x32_bf16 v[24:27], a[204:207], a[96:99], v[24:27]
ds_read_b64_tr_b16 a[196:197], v227 offset:43136
v_mfma_f32_16x16x32_bf16 v[28:31], a[204:207], a[100:103], v[28:31]
buffer_load_dwordx4 v231, s[12:15], s42 offen offset:2048 lds
v_mfma_f32_16x16x32_bf16 v[136:139], a[204:207], a[104:107], v[136:139]
ds_read_b64_tr_b16 a[198:199], v227 offset:44928
v_mfma_f32_16x16x32_bf16 v[140:143], a[204:207], a[108:111], v[140:143]
s_waitcnt lgkmcnt(8)
v_mfma_f32_16x16x32_bf16 v[32:35], a[208:211], a[96:99], v[32:35]
ds_read_b64_tr_b16 a[200:201], v227 offset:28832
v_mfma_f32_16x16x32_bf16 v[36:39], a[208:211], a[100:103], v[36:39]
buffer_load_dwordx4 v232, s[12:15], s42 offen offset:3072 lds
v_mfma_f32_16x16x32_bf16 v[144:147], a[208:211], a[104:107], v[144:147]
ds_read_b64_tr_b16 a[202:203], v227 offset:30624
v_mfma_f32_16x16x32_bf16 v[148:151], a[208:211], a[108:111], v[148:151]
v_mfma_f32_16x16x32_bf16 v[40:43], a[212:215], a[96:99], v[40:43]
ds_read_b64_tr_b16 a[204:205], v227 offset:43168
v_mfma_f32_16x16x32_bf16 v[44:47], a[212:215], a[100:103], v[44:47]
v_mfma_f32_16x16x32_bf16 v[152:155], a[212:215], a[104:107], v[152:155]
ds_read_b64_tr_b16 a[206:207], v227 offset:44960
v_mfma_f32_16x16x32_bf16 v[156:159], a[212:215], a[108:111], v[156:159]
s_waitcnt lgkmcnt(8)
s_add_u32 m0, s43, 32768
v_mfma_f32_16x16x32_bf16 v[48:51], a[216:219], a[96:99], v[48:51]
ds_read_b64_tr_b16 a[208:209], v227 offset:28864
v_mfma_f32_16x16x32_bf16 v[52:55], a[216:219], a[100:103], v[52:55]
buffer_load_dwordx4 v233, s[12:15], s42 offen offset:0 lds
v_mfma_f32_16x16x32_bf16 v[160:163], a[216:219], a[104:107], v[160:163]
ds_read_b64_tr_b16 a[210:211], v227 offset:30656
v_mfma_f32_16x16x32_bf16 v[164:167], a[216:219], a[108:111], v[164:167]
v_mfma_f32_16x16x32_bf16 v[56:59], a[220:223], a[96:99], v[56:59]
ds_read_b64_tr_b16 a[212:213], v227 offset:43200
v_mfma_f32_16x16x32_bf16 v[60:63], a[220:223], a[100:103], v[60:63]
buffer_load_dwordx4 v234, s[12:15], s42 offen offset:1024 lds
v_mfma_f32_16x16x32_bf16 v[168:171], a[220:223], a[104:107], v[168:171]
ds_read_b64_tr_b16 a[214:215], v227 offset:44992
v_mfma_f32_16x16x32_bf16 v[172:175], a[220:223], a[108:111], v[172:175]
s_waitcnt lgkmcnt(8)
v_mfma_f32_16x16x32_bf16 v[64:67], a[192:195], a[96:99], v[64:67]
ds_read_b64_tr_b16 a[216:217], v227 offset:35840
v_mfma_f32_16x16x32_bf16 v[68:71], a[192:195], a[100:103], v[68:71]
v_mfma_f32_16x16x32_bf16 v[176:179], a[192:195], a[104:107], v[176:179]
ds_read_b64_tr_b16 a[218:219], v227 offset:37632
v_mfma_f32_16x16x32_bf16 v[180:183], a[192:195], a[108:111], v[180:183]
v_mfma_f32_16x16x32_bf16 v[72:75], a[196:199], a[96:99], v[72:75]
ds_read_b64_tr_b16 a[220:221], v227 offset:50176
v_mfma_f32_16x16x32_bf16 v[76:79], a[196:199], a[100:103], v[76:79]
buffer_load_dwordx4 v235, s[12:15], s42 offen offset:2048 lds
v_mfma_f32_16x16x32_bf16 v[184:187], a[196:199], a[104:107], v[184:187]
ds_read_b64_tr_b16 a[222:223], v227 offset:51968
v_mfma_f32_16x16x32_bf16 v[188:191], a[196:199], a[108:111], v[188:191]
s_waitcnt lgkmcnt(8)
s_add_u32 s42, s42, 458752
v_mfma_f32_16x16x32_bf16 v[80:83], a[200:203], a[96:99], v[80:83]
ds_read_b64_tr_b16 a[192:193], v227 offset:35872
v_mfma_f32_16x16x32_bf16 v[84:87], a[200:203], a[100:103], v[84:87]
buffer_load_dwordx4 a[32:35], v236, s[16:19], s40 offen offset:0
v_mfma_f32_16x16x32_bf16 v[192:195], a[200:203], a[104:107], v[192:195]
ds_read_b64_tr_b16 a[194:195], v227 offset:37664
v_mfma_f32_16x16x32_bf16 v[196:199], a[200:203], a[108:111], v[196:199]
v_mfma_f32_16x16x32_bf16 v[88:91], a[204:207], a[96:99], v[88:91]
ds_read_b64_tr_b16 a[196:197], v227 offset:50208
v_mfma_f32_16x16x32_bf16 v[92:95], a[204:207], a[100:103], v[92:95]
v_mfma_f32_16x16x32_bf16 v[200:203], a[204:207], a[104:107], v[200:203]
ds_read_b64_tr_b16 a[198:199], v227 offset:52000
v_mfma_f32_16x16x32_bf16 v[204:207], a[204:207], a[108:111], v[204:207]
s_waitcnt lgkmcnt(8)
v_mfma_f32_16x16x32_bf16 v[96:99], a[208:211], a[96:99], v[96:99]
ds_read_b64_tr_b16 a[200:201], v227 offset:35904
v_mfma_f32_16x16x32_bf16 v[100:103], a[208:211], a[100:103], v[100:103]
buffer_load_dwordx4 a[36:39], v236, s[16:19], s40 offen offset:256
v_mfma_f32_16x16x32_bf16 v[208:211], a[208:211], a[104:107], v[208:211]
ds_read_b64_tr_b16 a[202:203], v227 offset:37696
v_mfma_f32_16x16x32_bf16 v[212:215], a[208:211], a[108:111], v[212:215]
v_mfma_f32_16x16x32_bf16 v[104:107], a[212:215], a[96:99], v[104:107]
ds_read_b64_tr_b16 a[204:205], v227 offset:50240
v_mfma_f32_16x16x32_bf16 v[108:111], a[212:215], a[100:103], v[108:111]
buffer_load_dwordx4 a[40:43], v236, s[16:19], s41 offen offset:0
v_mfma_f32_16x16x32_bf16 v[216:219], a[212:215], a[104:107], v[216:219]
ds_read_b64_tr_b16 a[206:207], v227 offset:52032
v_mfma_f32_16x16x32_bf16 v[220:223], a[212:215], a[108:111], v[220:223]
s_waitcnt vmcnt(40) lgkmcnt(8)
v_mfma_f32_16x16x32_bf16 v[0:3], a[216:219], a[112:115], v[0:3]
ds_read_b64_tr_b16 a[208:209], v227 offset:35936
v_mfma_f32_16x16x32_bf16 v[4:7], a[216:219], a[116:119], v[4:7]
v_mfma_f32_16x16x32_bf16 v[112:115], a[216:219], a[120:123], v[112:115]
ds_read_b64_tr_b16 a[210:211], v227 offset:37728
v_mfma_f32_16x16x32_bf16 v[116:119], a[216:219], a[124:127], v[116:119]
v_mfma_f32_16x16x32_bf16 v[8:11], a[220:223], a[112:115], v[8:11]
ds_read_b64_tr_b16 a[212:213], v227 offset:50272
v_mfma_f32_16x16x32_bf16 v[12:15], a[220:223], a[116:119], v[12:15]
buffer_load_dwordx4 a[44:47], v236, s[16:19], s41 offen offset:256
v_mfma_f32_16x16x32_bf16 v[120:123], a[220:223], a[120:123], v[120:123]
ds_read_b64_tr_b16 a[214:215], v227 offset:52064
v_mfma_f32_16x16x32_bf16 v[124:127], a[220:223], a[124:127], v[124:127]
s_waitcnt lgkmcnt(8)
v_mfma_f32_16x16x32_bf16 v[16:19], a[192:195], a[112:115], v[16:19]
ds_read_b64_tr_b16 a[216:217], v227 offset:35968
v_mfma_f32_16x16x32_bf16 v[20:23], a[192:195], a[116:119], v[20:23]
buffer_load_dwordx4 a[48:51], v236, s[16:19], s40 offen offset:2048
v_mfma_f32_16x16x32_bf16 v[128:131], a[192:195], a[120:123], v[128:131]
ds_read_b64_tr_b16 a[218:219], v227 offset:37760
v_mfma_f32_16x16x32_bf16 v[132:135], a[192:195], a[124:127], v[132:135]
v_mfma_f32_16x16x32_bf16 v[24:27], a[196:199], a[112:115], v[24:27]
ds_read_b64_tr_b16 a[220:221], v227 offset:50304
v_mfma_f32_16x16x32_bf16 v[28:31], a[196:199], a[116:119], v[28:31]
v_mfma_f32_16x16x32_bf16 v[136:139], a[196:199], a[120:123], v[136:139]
ds_read_b64_tr_b16 a[222:223], v227 offset:52096
v_mfma_f32_16x16x32_bf16 v[140:143], a[196:199], a[124:127], v[140:143]
s_waitcnt lgkmcnt(8)
v_mfma_f32_16x16x32_bf16 v[32:35], a[200:203], a[112:115], v[32:35]
ds_read_b64_tr_b16 a[192:193], v227 offset:36000
v_mfma_f32_16x16x32_bf16 v[36:39], a[200:203], a[116:119], v[36:39]
buffer_load_dwordx4 a[52:55], v236, s[16:19], s40 offen offset:2304
v_mfma_f32_16x16x32_bf16 v[144:147], a[200:203], a[120:123], v[144:147]
ds_read_b64_tr_b16 a[194:195], v227 offset:37792
v_mfma_f32_16x16x32_bf16 v[148:151], a[200:203], a[124:127], v[148:151]
s_add_u32 s40, s40, 4096
v_mfma_f32_16x16x32_bf16 v[40:43], a[204:207], a[112:115], v[40:43]
ds_read_b64_tr_b16 a[196:197], v227 offset:50336
v_mfma_f32_16x16x32_bf16 v[44:47], a[204:207], a[116:119], v[44:47]
buffer_load_dwordx4 a[56:59], v236, s[16:19], s41 offen offset:2048
v_mfma_f32_16x16x32_bf16 v[152:155], a[204:207], a[120:123], v[152:155]
ds_read_b64_tr_b16 a[198:199], v227 offset:52128
v_mfma_f32_16x16x32_bf16 v[156:159], a[204:207], a[124:127], v[156:159]
s_waitcnt lgkmcnt(8)
v_mfma_f32_16x16x32_bf16 v[48:51], a[208:211], a[112:115], v[48:51]
ds_read_b64_tr_b16 a[200:201], v227 offset:36032
v_mfma_f32_16x16x32_bf16 v[52:55], a[208:211], a[116:119], v[52:55]
v_mfma_f32_16x16x32_bf16 v[160:163], a[208:211], a[120:123], v[160:163]
ds_read_b64_tr_b16 a[202:203], v227 offset:37824
v_mfma_f32_16x16x32_bf16 v[164:167], a[208:211], a[124:127], v[164:167]
v_mfma_f32_16x16x32_bf16 v[56:59], a[212:215], a[112:115], v[56:59]
ds_read_b64_tr_b16 a[204:205], v227 offset:50368
v_mfma_f32_16x16x32_bf16 v[60:63], a[212:215], a[116:119], v[60:63]
buffer_load_dwordx4 a[60:63], v236, s[16:19], s41 offen offset:2304
v_mfma_f32_16x16x32_bf16 v[168:171], a[212:215], a[120:123], v[168:171]
ds_read_b64_tr_b16 a[206:207], v227 offset:52160
v_mfma_f32_16x16x32_bf16 v[172:175], a[212:215], a[124:127], v[172:175]
s_waitcnt lgkmcnt(8)
s_waitcnt vmcnt(38)
s_barrier
s_add_u32 s41, s41, 4096
v_mfma_f32_16x16x32_bf16 v[64:67], a[216:219], a[112:115], v[64:67]
ds_read_b64_tr_b16 a[208:209], v228 offset:0
v_mfma_f32_16x16x32_bf16 v[68:71], a[216:219], a[116:119], v[68:71]
buffer_load_dwordx4 a[64:67], v236, s[16:19], s40 offen offset:0
v_mfma_f32_16x16x32_bf16 v[176:179], a[216:219], a[120:123], v[176:179]
ds_read_b64_tr_b16 a[210:211], v228 offset:1792
v_mfma_f32_16x16x32_bf16 v[180:183], a[216:219], a[124:127], v[180:183]
v_mfma_f32_16x16x32_bf16 v[72:75], a[220:223], a[112:115], v[72:75]
ds_read_b64_tr_b16 a[212:213], v228 offset:14336
v_mfma_f32_16x16x32_bf16 v[76:79], a[220:223], a[116:119], v[76:79]
v_mfma_f32_16x16x32_bf16 v[184:187], a[220:223], a[120:123], v[184:187]
ds_read_b64_tr_b16 a[214:215], v228 offset:16128
v_mfma_f32_16x16x32_bf16 v[188:191], a[220:223], a[124:127], v[188:191]
s_waitcnt lgkmcnt(8)
s_add_u32 m0, s43, 57344
v_mfma_f32_16x16x32_bf16 v[80:83], a[192:195], a[112:115], v[80:83]
ds_read_b64_tr_b16 a[216:217], v228 offset:32
v_mfma_f32_16x16x32_bf16 v[84:87], a[192:195], a[116:119], v[84:87]
buffer_load_dwordx4 v229, s[12:15], s42 offen offset:0 lds
v_mfma_f32_16x16x32_bf16 v[192:195], a[192:195], a[120:123], v[192:195]
ds_read_b64_tr_b16 a[218:219], v228 offset:1824
v_mfma_f32_16x16x32_bf16 v[196:199], a[192:195], a[124:127], v[196:199]
v_mfma_f32_16x16x32_bf16 v[88:91], a[196:199], a[112:115], v[88:91]
ds_read_b64_tr_b16 a[220:221], v228 offset:14368
v_mfma_f32_16x16x32_bf16 v[92:95], a[196:199], a[116:119], v[92:95]
buffer_load_dwordx4 v230, s[12:15], s42 offen offset:1024 lds
v_mfma_f32_16x16x32_bf16 v[200:203], a[196:199], a[120:123], v[200:203]
ds_read_b64_tr_b16 a[222:223], v228 offset:16160
v_mfma_f32_16x16x32_bf16 v[204:207], a[196:199], a[124:127], v[204:207]
s_waitcnt lgkmcnt(8)
v_mfma_f32_16x16x32_bf16 v[96:99], a[200:203], a[112:115], v[96:99]
ds_read_b64_tr_b16 a[192:193], v228 offset:64
v_mfma_f32_16x16x32_bf16 v[100:103], a[200:203], a[116:119], v[100:103]
v_mfma_f32_16x16x32_bf16 v[208:211], a[200:203], a[120:123], v[208:211]
ds_read_b64_tr_b16 a[194:195], v228 offset:1856
v_mfma_f32_16x16x32_bf16 v[212:215], a[200:203], a[124:127], v[212:215]
v_mfma_f32_16x16x32_bf16 v[104:107], a[204:207], a[112:115], v[104:107]
ds_read_b64_tr_b16 a[196:197], v228 offset:14400
v_mfma_f32_16x16x32_bf16 v[108:111], a[204:207], a[116:119], v[108:111]
buffer_load_dwordx4 v231, s[12:15], s42 offen offset:2048 lds
v_mfma_f32_16x16x32_bf16 v[216:219], a[204:207], a[120:123], v[216:219]
ds_read_b64_tr_b16 a[198:199], v228 offset:16192
v_mfma_f32_16x16x32_bf16 v[220:223], a[204:207], a[124:127], v[220:223]
s_waitcnt vmcnt(38) lgkmcnt(8)
v_mfma_f32_16x16x32_bf16 v[0:3], a[208:211], a[128:131], v[0:3]
ds_read_b64_tr_b16 a[200:201], v228 offset:96
v_mfma_f32_16x16x32_bf16 v[4:7], a[208:211], a[132:135], v[4:7]
buffer_load_dwordx4 v232, s[12:15], s42 offen offset:3072 lds
v_mfma_f32_16x16x32_bf16 v[112:115], a[208:211], a[136:139], v[112:115]
ds_read_b64_tr_b16 a[202:203], v228 offset:1888
v_mfma_f32_16x16x32_bf16 v[116:119], a[208:211], a[140:143], v[116:119]
v_mfma_f32_16x16x32_bf16 v[8:11], a[212:215], a[128:131], v[8:11]
ds_read_b64_tr_b16 a[204:205], v228 offset:14432
v_mfma_f32_16x16x32_bf16 v[12:15], a[212:215], a[132:135], v[12:15]
v_mfma_f32_16x16x32_bf16 v[120:123], a[212:215], a[136:139], v[120:123]
ds_read_b64_tr_b16 a[206:207], v228 offset:16224
v_mfma_f32_16x16x32_bf16 v[124:127], a[212:215], a[140:143], v[124:127]
s_waitcnt lgkmcnt(8)
s_add_u32 m0, s43, 61440
v_mfma_f32_16x16x32_bf16 v[16:19], a[216:219], a[128:131], v[16:19]
ds_read_b64_tr_b16 a[208:209], v228 offset:128
v_mfma_f32_16x16x32_bf16 v[20:23], a[216:219], a[132:135], v[20:23]
buffer_load_dwordx4 v233, s[12:15], s42 offen offset:0 lds
v_mfma_f32_16x16x32_bf16 v[128:131], a[216:219], a[136:139], v[128:131]
ds_read_b64_tr_b16 a[210:211], v228 offset:1920
v_mfma_f32_16x16x32_bf16 v[132:135], a[216:219], a[140:143], v[132:135]
v_mfma_f32_16x16x32_bf16 v[24:27], a[220:223], a[128:131], v[24:27]
ds_read_b64_tr_b16 a[212:213], v228 offset:14464
v_mfma_f32_16x16x32_bf16 v[28:31], a[220:223], a[132:135], v[28:31]
buffer_load_dwordx4 v234, s[12:15], s42 offen offset:1024 lds
v_mfma_f32_16x16x32_bf16 v[136:139], a[220:223], a[136:139], v[136:139]
ds_read_b64_tr_b16 a[214:215], v228 offset:16256
v_mfma_f32_16x16x32_bf16 v[140:143], a[220:223], a[140:143], v[140:143]
s_waitcnt lgkmcnt(8)
v_mfma_f32_16x16x32_bf16 v[32:35], a[192:195], a[128:131], v[32:35]
ds_read_b64_tr_b16 a[216:217], v228 offset:160
v_mfma_f32_16x16x32_bf16 v[36:39], a[192:195], a[132:135], v[36:39]
v_mfma_f32_16x16x32_bf16 v[144:147], a[192:195], a[136:139], v[144:147]
ds_read_b64_tr_b16 a[218:219], v228 offset:1952
v_mfma_f32_16x16x32_bf16 v[148:151], a[192:195], a[140:143], v[148:151]
v_mfma_f32_16x16x32_bf16 v[40:43], a[196:199], a[128:131], v[40:43]
ds_read_b64_tr_b16 a[220:221], v228 offset:14496
v_mfma_f32_16x16x32_bf16 v[44:47], a[196:199], a[132:135], v[44:47]
buffer_load_dwordx4 v235, s[12:15], s42 offen offset:2048 lds
v_mfma_f32_16x16x32_bf16 v[152:155], a[196:199], a[136:139], v[152:155]
ds_read_b64_tr_b16 a[222:223], v228 offset:16288
v_mfma_f32_16x16x32_bf16 v[156:159], a[196:199], a[140:143], v[156:159]
s_waitcnt lgkmcnt(8)
s_add_u32 s42, s42, 458752
v_mfma_f32_16x16x32_bf16 v[48:51], a[200:203], a[128:131], v[48:51]
ds_read_b64_tr_b16 a[192:193], v228 offset:192
v_mfma_f32_16x16x32_bf16 v[52:55], a[200:203], a[132:135], v[52:55]
buffer_load_dwordx4 a[68:71], v236, s[16:19], s40 offen offset:256
v_mfma_f32_16x16x32_bf16 v[160:163], a[200:203], a[136:139], v[160:163]
ds_read_b64_tr_b16 a[194:195], v228 offset:1984
v_mfma_f32_16x16x32_bf16 v[164:167], a[200:203], a[140:143], v[164:167]
v_mfma_f32_16x16x32_bf16 v[56:59], a[204:207], a[128:131], v[56:59]
ds_read_b64_tr_b16 a[196:197], v228 offset:14528
v_mfma_f32_16x16x32_bf16 v[60:63], a[204:207], a[132:135], v[60:63]
v_mfma_f32_16x16x32_bf16 v[168:171], a[204:207], a[136:139], v[168:171]
ds_read_b64_tr_b16 a[198:199], v228 offset:16320
v_mfma_f32_16x16x32_bf16 v[172:175], a[204:207], a[140:143], v[172:175]
s_waitcnt lgkmcnt(8)
v_mfma_f32_16x16x32_bf16 v[64:67], a[208:211], a[128:131], v[64:67]
ds_read_b64_tr_b16 a[200:201], v228 offset:7168
v_mfma_f32_16x16x32_bf16 v[68:71], a[208:211], a[132:135], v[68:71]
buffer_load_dwordx4 a[72:75], v236, s[16:19], s41 offen offset:0
v_mfma_f32_16x16x32_bf16 v[176:179], a[208:211], a[136:139], v[176:179]
ds_read_b64_tr_b16 a[202:203], v228 offset:8960
v_mfma_f32_16x16x32_bf16 v[180:183], a[208:211], a[140:143], v[180:183]
v_mfma_f32_16x16x32_bf16 v[72:75], a[212:215], a[128:131], v[72:75]
ds_read_b64_tr_b16 a[204:205], v228 offset:21504
v_mfma_f32_16x16x32_bf16 v[76:79], a[212:215], a[132:135], v[76:79]
buffer_load_dwordx4 a[76:79], v236, s[16:19], s41 offen offset:256
v_mfma_f32_16x16x32_bf16 v[184:187], a[212:215], a[136:139], v[184:187]
ds_read_b64_tr_b16 a[206:207], v228 offset:23296
v_mfma_f32_16x16x32_bf16 v[188:191], a[212:215], a[140:143], v[188:191]
s_waitcnt lgkmcnt(8)
v_mfma_f32_16x16x32_bf16 v[80:83], a[216:219], a[128:131], v[80:83]
ds_read_b64_tr_b16 a[208:209], v228 offset:7200
v_mfma_f32_16x16x32_bf16 v[84:87], a[216:219], a[132:135], v[84:87]
v_mfma_f32_16x16x32_bf16 v[192:195], a[216:219], a[136:139], v[192:195]
ds_read_b64_tr_b16 a[210:211], v228 offset:8992
v_mfma_f32_16x16x32_bf16 v[196:199], a[216:219], a[140:143], v[196:199]
v_mfma_f32_16x16x32_bf16 v[88:91], a[220:223], a[128:131], v[88:91]
ds_read_b64_tr_b16 a[212:213], v228 offset:21536
v_mfma_f32_16x16x32_bf16 v[92:95], a[220:223], a[132:135], v[92:95]
buffer_load_dwordx4 a[80:83], v236, s[16:19], s40 offen offset:2048
v_mfma_f32_16x16x32_bf16 v[200:203], a[220:223], a[136:139], v[200:203]
ds_read_b64_tr_b16 a[214:215], v228 offset:23328
v_mfma_f32_16x16x32_bf16 v[204:207], a[220:223], a[140:143], v[204:207]
s_waitcnt lgkmcnt(8)
v_mfma_f32_16x16x32_bf16 v[96:99], a[192:195], a[128:131], v[96:99]
ds_read_b64_tr_b16 a[216:217], v228 offset:7232
v_mfma_f32_16x16x32_bf16 v[100:103], a[192:195], a[132:135], v[100:103]
buffer_load_dwordx4 a[84:87], v236, s[16:19], s40 offen offset:2304
v_mfma_f32_16x16x32_bf16 v[208:211], a[192:195], a[136:139], v[208:211]
ds_read_b64_tr_b16 a[218:219], v228 offset:9024
v_mfma_f32_16x16x32_bf16 v[212:215], a[192:195], a[140:143], v[212:215]
s_add_u32 s40, s40, 4096
v_mfma_f32_16x16x32_bf16 v[104:107], a[196:199], a[128:131], v[104:107]
ds_read_b64_tr_b16 a[220:221], v228 offset:21568
v_mfma_f32_16x16x32_bf16 v[108:111], a[196:199], a[132:135], v[108:111]
v_mfma_f32_16x16x32_bf16 v[216:219], a[196:199], a[136:139], v[216:219]
ds_read_b64_tr_b16 a[222:223], v228 offset:23360
v_mfma_f32_16x16x32_bf16 v[220:223], a[196:199], a[140:143], v[220:223]
s_waitcnt vmcnt(43) lgkmcnt(8)
v_mfma_f32_16x16x32_bf16 v[0:3], a[200:203], a[144:147], v[0:3]
ds_read_b64_tr_b16 a[192:193], v228 offset:7264
v_mfma_f32_16x16x32_bf16 v[4:7], a[200:203], a[148:151], v[4:7]
buffer_load_dwordx4 a[88:91], v236, s[16:19], s41 offen offset:2048
v_mfma_f32_16x16x32_bf16 v[112:115], a[200:203], a[152:155], v[112:115]
ds_read_b64_tr_b16 a[194:195], v228 offset:9056
v_mfma_f32_16x16x32_bf16 v[116:119], a[200:203], a[156:159], v[116:119]
v_mfma_f32_16x16x32_bf16 v[8:11], a[204:207], a[144:147], v[8:11]
ds_read_b64_tr_b16 a[196:197], v228 offset:21600
v_mfma_f32_16x16x32_bf16 v[12:15], a[204:207], a[148:151], v[12:15]
buffer_load_dwordx4 a[92:95], v236, s[16:19], s41 offen offset:2304
v_mfma_f32_16x16x32_bf16 v[120:123], a[204:207], a[152:155], v[120:123]
ds_read_b64_tr_b16 a[198:199], v228 offset:23392
v_mfma_f32_16x16x32_bf16 v[124:127], a[204:207], a[156:159], v[124:127]
s_waitcnt lgkmcnt(8)
s_add_u32 s41, s41, 4096
v_mfma_f32_16x16x32_bf16 v[16:19], a[208:211], a[144:147], v[16:19]
ds_read_b64_tr_b16 a[200:201], v228 offset:7296
v_mfma_f32_16x16x32_bf16 v[20:23], a[208:211], a[148:151], v[20:23]
v_mfma_f32_16x16x32_bf16 v[128:131], a[208:211], a[152:155], v[128:131]
ds_read_b64_tr_b16 a[202:203], v228 offset:9088
v_mfma_f32_16x16x32_bf16 v[132:135], a[208:211], a[156:159], v[132:135]
v_mfma_f32_16x16x32_bf16 v[24:27], a[212:215], a[144:147], v[24:27]
ds_read_b64_tr_b16 a[204:205], v228 offset:21632
v_mfma_f32_16x16x32_bf16 v[28:31], a[212:215], a[148:151], v[28:31]
buffer_load_dwordx4 a[96:99], v236, s[16:19], s40 offen offset:0
v_mfma_f32_16x16x32_bf16 v[136:139], a[212:215], a[152:155], v[136:139]
ds_read_b64_tr_b16 a[206:207], v228 offset:23424
v_mfma_f32_16x16x32_bf16 v[140:143], a[212:215], a[156:159], v[140:143]
s_waitcnt lgkmcnt(8)
v_mfma_f32_16x16x32_bf16 v[32:35], a[216:219], a[144:147], v[32:35]
ds_read_b64_tr_b16 a[208:209], v228 offset:7328
v_mfma_f32_16x16x32_bf16 v[36:39], a[216:219], a[148:151], v[36:39]
buffer_load_dwordx4 a[100:103], v236, s[16:19], s40 offen offset:256
v_mfma_f32_16x16x32_bf16 v[144:147], a[216:219], a[152:155], v[144:147]
ds_read_b64_tr_b16 a[210:211], v228 offset:9120
v_mfma_f32_16x16x32_bf16 v[148:151], a[216:219], a[156:159], v[148:151]
v_mfma_f32_16x16x32_bf16 v[40:43], a[220:223], a[144:147], v[40:43]
ds_read_b64_tr_b16 a[212:213], v228 offset:21664
v_mfma_f32_16x16x32_bf16 v[44:47], a[220:223], a[148:151], v[44:47]
v_mfma_f32_16x16x32_bf16 v[152:155], a[220:223], a[152:155], v[152:155]
ds_read_b64_tr_b16 a[214:215], v228 offset:23456
v_mfma_f32_16x16x32_bf16 v[156:159], a[220:223], a[156:159], v[156:159]
s_waitcnt lgkmcnt(8)
v_mfma_f32_16x16x32_bf16 v[48:51], a[192:195], a[144:147], v[48:51]
ds_read_b64_tr_b16 a[216:217], v228 offset:7360
v_mfma_f32_16x16x32_bf16 v[52:55], a[192:195], a[148:151], v[52:55]
buffer_load_dwordx4 a[104:107], v236, s[16:19], s41 offen offset:0
v_mfma_f32_16x16x32_bf16 v[160:163], a[192:195], a[152:155], v[160:163]
ds_read_b64_tr_b16 a[218:219], v228 offset:9152
v_mfma_f32_16x16x32_bf16 v[164:167], a[192:195], a[156:159], v[164:167]
v_mfma_f32_16x16x32_bf16 v[56:59], a[196:199], a[144:147], v[56:59]
ds_read_b64_tr_b16 a[220:221], v228 offset:21696
v_mfma_f32_16x16x32_bf16 v[60:63], a[196:199], a[148:151], v[60:63]
buffer_load_dwordx4 a[108:111], v236, s[16:19], s41 offen offset:256
v_mfma_f32_16x16x32_bf16 v[168:171], a[196:199], a[152:155], v[168:171]
ds_read_b64_tr_b16 a[222:223], v228 offset:23488
v_mfma_f32_16x16x32_bf16 v[172:175], a[196:199], a[156:159], v[172:175]
s_waitcnt lgkmcnt(8)
s_waitcnt vmcnt(42)
s_barrier
v_mfma_f32_16x16x32_bf16 v[64:67], a[200:203], a[144:147], v[64:67]
ds_read_b64_tr_b16 a[192:193], v226 offset:0
v_mfma_f32_16x16x32_bf16 v[68:71], a[200:203], a[148:151], v[68:71]
v_mfma_f32_16x16x32_bf16 v[176:179], a[200:203], a[152:155], v[176:179]
ds_read_b64_tr_b16 a[194:195], v226 offset:1792
v_mfma_f32_16x16x32_bf16 v[180:183], a[200:203], a[156:159], v[180:183]
s_add_u32 m0, s43, 86016
v_mfma_f32_16x16x32_bf16 v[72:75], a[204:207], a[144:147], v[72:75]
ds_read_b64_tr_b16 a[196:197], v226 offset:14336
v_mfma_f32_16x16x32_bf16 v[76:79], a[204:207], a[148:151], v[76:79]
buffer_load_dwordx4 v229, s[12:15], s42 offen offset:0 lds
v_mfma_f32_16x16x32_bf16 v[184:187], a[204:207], a[152:155], v[184:187]
ds_read_b64_tr_b16 a[198:199], v226 offset:16128
v_mfma_f32_16x16x32_bf16 v[188:191], a[204:207], a[156:159], v[188:191]
s_waitcnt lgkmcnt(8)
v_mfma_f32_16x16x32_bf16 v[80:83], a[208:211], a[144:147], v[80:83]
ds_read_b64_tr_b16 a[200:201], v226 offset:32
v_mfma_f32_16x16x32_bf16 v[84:87], a[208:211], a[148:151], v[84:87]
buffer_load_dwordx4 v230, s[12:15], s42 offen offset:1024 lds
v_mfma_f32_16x16x32_bf16 v[192:195], a[208:211], a[152:155], v[192:195]
ds_read_b64_tr_b16 a[202:203], v226 offset:1824
v_mfma_f32_16x16x32_bf16 v[196:199], a[208:211], a[156:159], v[196:199]
v_mfma_f32_16x16x32_bf16 v[88:91], a[212:215], a[144:147], v[88:91]
ds_read_b64_tr_b16 a[204:205], v226 offset:14368
v_mfma_f32_16x16x32_bf16 v[92:95], a[212:215], a[148:151], v[92:95]
v_mfma_f32_16x16x32_bf16 v[200:203], a[212:215], a[152:155], v[200:203]
ds_read_b64_tr_b16 a[206:207], v226 offset:16160
v_mfma_f32_16x16x32_bf16 v[204:207], a[212:215], a[156:159], v[204:207]
s_waitcnt lgkmcnt(8)
v_mfma_f32_16x16x32_bf16 v[96:99], a[216:219], a[144:147], v[96:99]
ds_read_b64_tr_b16 a[208:209], v226 offset:64
v_mfma_f32_16x16x32_bf16 v[100:103], a[216:219], a[148:151], v[100:103]
buffer_load_dwordx4 v231, s[12:15], s42 offen offset:2048 lds
v_mfma_f32_16x16x32_bf16 v[208:211], a[216:219], a[152:155], v[208:211]
ds_read_b64_tr_b16 a[210:211], v226 offset:1856
v_mfma_f32_16x16x32_bf16 v[212:215], a[216:219], a[156:159], v[212:215]
v_mfma_f32_16x16x32_bf16 v[104:107], a[220:223], a[144:147], v[104:107]
ds_read_b64_tr_b16 a[212:213], v226 offset:14400
v_mfma_f32_16x16x32_bf16 v[108:111], a[220:223], a[148:151], v[108:111]
buffer_load_dwordx4 v232, s[12:15], s42 offen offset:3072 lds
v_mfma_f32_16x16x32_bf16 v[216:219], a[220:223], a[152:155], v[216:219]
ds_read_b64_tr_b16 a[214:215], v226 offset:16192
v_mfma_f32_16x16x32_bf16 v[220:223], a[220:223], a[156:159], v[220:223]
s_waitcnt vmcnt(42) lgkmcnt(8)
v_mfma_f32_16x16x32_bf16 v[0:3], a[192:195], a[0:3], v[0:3]
ds_read_b64_tr_b16 a[216:217], v226 offset:96
v_mfma_f32_16x16x32_bf16 v[4:7], a[192:195], a[4:7], v[4:7]
v_mfma_f32_16x16x32_bf16 v[112:115], a[192:195], a[8:11], v[112:115]
ds_read_b64_tr_b16 a[218:219], v226 offset:1888
v_mfma_f32_16x16x32_bf16 v[116:119], a[192:195], a[12:15], v[116:119]
s_add_u32 m0, s43, 90112
v_mfma_f32_16x16x32_bf16 v[8:11], a[196:199], a[0:3], v[8:11]
ds_read_b64_tr_b16 a[220:221], v226 offset:14432
v_mfma_f32_16x16x32_bf16 v[12:15], a[196:199], a[4:7], v[12:15]
buffer_load_dwordx4 v233, s[12:15], s42 offen offset:0 lds
v_mfma_f32_16x16x32_bf16 v[120:123], a[196:199], a[8:11], v[120:123]
ds_read_b64_tr_b16 a[222:223], v226 offset:16224
v_mfma_f32_16x16x32_bf16 v[124:127], a[196:199], a[12:15], v[124:127]
s_waitcnt lgkmcnt(8)
v_mfma_f32_16x16x32_bf16 v[16:19], a[200:203], a[0:3], v[16:19]
ds_read_b64_tr_b16 a[192:193], v226 offset:128
v_mfma_f32_16x16x32_bf16 v[20:23], a[200:203], a[4:7], v[20:23]
buffer_load_dwordx4 v234, s[12:15], s42 offen offset:1024 lds
v_mfma_f32_16x16x32_bf16 v[128:131], a[200:203], a[8:11], v[128:131]
ds_read_b64_tr_b16 a[194:195], v226 offset:1920
v_mfma_f32_16x16x32_bf16 v[132:135], a[200:203], a[12:15], v[132:135]
v_mfma_f32_16x16x32_bf16 v[24:27], a[204:207], a[0:3], v[24:27]
ds_read_b64_tr_b16 a[196:197], v226 offset:14464
v_mfma_f32_16x16x32_bf16 v[28:31], a[204:207], a[4:7], v[28:31]
v_mfma_f32_16x16x32_bf16 v[136:139], a[204:207], a[8:11], v[136:139]
ds_read_b64_tr_b16 a[198:199], v226 offset:16256
v_mfma_f32_16x16x32_bf16 v[140:143], a[204:207], a[12:15], v[140:143]
s_waitcnt lgkmcnt(8)
v_mfma_f32_16x16x32_bf16 v[32:35], a[208:211], a[0:3], v[32:35]
ds_read_b64_tr_b16 a[200:201], v226 offset:160
v_mfma_f32_16x16x32_bf16 v[36:39], a[208:211], a[4:7], v[36:39]
buffer_load_dwordx4 v235, s[12:15], s42 offen offset:2048 lds
v_mfma_f32_16x16x32_bf16 v[144:147], a[208:211], a[8:11], v[144:147]
ds_read_b64_tr_b16 a[202:203], v226 offset:1952
v_mfma_f32_16x16x32_bf16 v[148:151], a[208:211], a[12:15], v[148:151]
s_add_u32 s42, s42, 458752
v_mfma_f32_16x16x32_bf16 v[40:43], a[212:215], a[0:3], v[40:43]
ds_read_b64_tr_b16 a[204:205], v226 offset:14496
v_mfma_f32_16x16x32_bf16 v[44:47], a[212:215], a[4:7], v[44:47]
buffer_load_dwordx4 a[112:115], v236, s[16:19], s40 offen offset:2048
v_mfma_f32_16x16x32_bf16 v[152:155], a[212:215], a[8:11], v[152:155]
ds_read_b64_tr_b16 a[206:207], v226 offset:16288
v_mfma_f32_16x16x32_bf16 v[156:159], a[212:215], a[12:15], v[156:159]
s_waitcnt lgkmcnt(8)
v_mfma_f32_16x16x32_bf16 v[48:51], a[216:219], a[0:3], v[48:51]
ds_read_b64_tr_b16 a[208:209], v226 offset:192
v_mfma_f32_16x16x32_bf16 v[52:55], a[216:219], a[4:7], v[52:55]
v_mfma_f32_16x16x32_bf16 v[160:163], a[216:219], a[8:11], v[160:163]
ds_read_b64_tr_b16 a[210:211], v226 offset:1984
v_mfma_f32_16x16x32_bf16 v[164:167], a[216:219], a[12:15], v[164:167]
v_mfma_f32_16x16x32_bf16 v[56:59], a[220:223], a[0:3], v[56:59]
ds_read_b64_tr_b16 a[212:213], v226 offset:14528
v_mfma_f32_16x16x32_bf16 v[60:63], a[220:223], a[4:7], v[60:63]
buffer_load_dwordx4 a[116:119], v236, s[16:19], s40 offen offset:2304
v_mfma_f32_16x16x32_bf16 v[168:171], a[220:223], a[8:11], v[168:171]
ds_read_b64_tr_b16 a[214:215], v226 offset:16320
v_mfma_f32_16x16x32_bf16 v[172:175], a[220:223], a[12:15], v[172:175]
s_waitcnt lgkmcnt(8)
s_add_u32 s40, s40, 4096
v_mfma_f32_16x16x32_bf16 v[64:67], a[192:195], a[0:3], v[64:67]
ds_read_b64_tr_b16 a[216:217], v226 offset:7168
v_mfma_f32_16x16x32_bf16 v[68:71], a[192:195], a[4:7], v[68:71]
buffer_load_dwordx4 a[120:123], v236, s[16:19], s41 offen offset:2048
v_mfma_f32_16x16x32_bf16 v[176:179], a[192:195], a[8:11], v[176:179]
ds_read_b64_tr_b16 a[218:219], v226 offset:8960
v_mfma_f32_16x16x32_bf16 v[180:183], a[192:195], a[12:15], v[180:183]
v_mfma_f32_16x16x32_bf16 v[72:75], a[196:199], a[0:3], v[72:75]
ds_read_b64_tr_b16 a[220:221], v226 offset:21504
v_mfma_f32_16x16x32_bf16 v[76:79], a[196:199], a[4:7], v[76:79]
v_mfma_f32_16x16x32_bf16 v[184:187], a[196:199], a[8:11], v[184:187]
ds_read_b64_tr_b16 a[222:223], v226 offset:23296
v_mfma_f32_16x16x32_bf16 v[188:191], a[196:199], a[12:15], v[188:191]
s_waitcnt lgkmcnt(8)
v_mfma_f32_16x16x32_bf16 v[80:83], a[200:203], a[0:3], v[80:83]
ds_read_b64_tr_b16 a[192:193], v226 offset:7200
v_mfma_f32_16x16x32_bf16 v[84:87], a[200:203], a[4:7], v[84:87]
buffer_load_dwordx4 a[124:127], v236, s[16:19], s41 offen offset:2304
v_mfma_f32_16x16x32_bf16 v[192:195], a[200:203], a[8:11], v[192:195]
ds_read_b64_tr_b16 a[194:195], v226 offset:8992
v_mfma_f32_16x16x32_bf16 v[196:199], a[200:203], a[12:15], v[196:199]
s_add_u32 s41, s41, 4096
v_mfma_f32_16x16x32_bf16 v[88:91], a[204:207], a[0:3], v[88:91]
ds_read_b64_tr_b16 a[196:197], v226 offset:21536
v_mfma_f32_16x16x32_bf16 v[92:95], a[204:207], a[4:7], v[92:95]
buffer_load_dwordx4 a[128:131], v236, s[16:19], s40 offen offset:0
v_mfma_f32_16x16x32_bf16 v[200:203], a[204:207], a[8:11], v[200:203]
ds_read_b64_tr_b16 a[198:199], v226 offset:23328
v_mfma_f32_16x16x32_bf16 v[204:207], a[204:207], a[12:15], v[204:207]
s_waitcnt lgkmcnt(8)
v_mfma_f32_16x16x32_bf16 v[96:99], a[208:211], a[0:3], v[96:99]
ds_read_b64_tr_b16 a[200:201], v226 offset:7232
v_mfma_f32_16x16x32_bf16 v[100:103], a[208:211], a[4:7], v[100:103]
v_mfma_f32_16x16x32_bf16 v[208:211], a[208:211], a[8:11], v[208:211]
ds_read_b64_tr_b16 a[202:203], v226 offset:9024
v_mfma_f32_16x16x32_bf16 v[212:215], a[208:211], a[12:15], v[212:215]
v_mfma_f32_16x16x32_bf16 v[104:107], a[212:215], a[0:3], v[104:107]
ds_read_b64_tr_b16 a[204:205], v226 offset:21568
v_mfma_f32_16x16x32_bf16 v[108:111], a[212:215], a[4:7], v[108:111]
buffer_load_dwordx4 a[132:135], v236, s[16:19], s40 offen offset:256
v_mfma_f32_16x16x32_bf16 v[216:219], a[212:215], a[8:11], v[216:219]
ds_read_b64_tr_b16 a[206:207], v226 offset:23360
v_mfma_f32_16x16x32_bf16 v[220:223], a[212:215], a[12:15], v[220:223]
s_waitcnt vmcnt(47) lgkmcnt(8)
v_mfma_f32_16x16x32_bf16 v[0:3], a[216:219], a[16:19], v[0:3]
ds_read_b64_tr_b16 a[208:209], v226 offset:7264
v_mfma_f32_16x16x32_bf16 v[4:7], a[216:219], a[20:23], v[4:7]
buffer_load_dwordx4 a[136:139], v236, s[16:19], s41 offen offset:0
v_mfma_f32_16x16x32_bf16 v[112:115], a[216:219], a[24:27], v[112:115]
ds_read_b64_tr_b16 a[210:211], v226 offset:9056
v_mfma_f32_16x16x32_bf16 v[116:119], a[216:219], a[28:31], v[116:119]
v_mfma_f32_16x16x32_bf16 v[8:11], a[220:223], a[16:19], v[8:11]
ds_read_b64_tr_b16 a[212:213], v226 offset:21600
v_mfma_f32_16x16x32_bf16 v[12:15], a[220:223], a[20:23], v[12:15]
v_mfma_f32_16x16x32_bf16 v[120:123], a[220:223], a[24:27], v[120:123]
ds_read_b64_tr_b16 a[214:215], v226 offset:23392
v_mfma_f32_16x16x32_bf16 v[124:127], a[220:223], a[28:31], v[124:127]
s_waitcnt lgkmcnt(8)
v_mfma_f32_16x16x32_bf16 v[16:19], a[192:195], a[16:19], v[16:19]
ds_read_b64_tr_b16 a[216:217], v226 offset:7296
v_mfma_f32_16x16x32_bf16 v[20:23], a[192:195], a[20:23], v[20:23]
buffer_load_dwordx4 a[140:143], v236, s[16:19], s41 offen offset:256
v_mfma_f32_16x16x32_bf16 v[128:131], a[192:195], a[24:27], v[128:131]
ds_read_b64_tr_b16 a[218:219], v226 offset:9088
v_mfma_f32_16x16x32_bf16 v[132:135], a[192:195], a[28:31], v[132:135]
v_mfma_f32_16x16x32_bf16 v[24:27], a[196:199], a[16:19], v[24:27]
ds_read_b64_tr_b16 a[220:221], v226 offset:21632
v_mfma_f32_16x16x32_bf16 v[28:31], a[196:199], a[20:23], v[28:31]
buffer_load_dwordx4 a[144:147], v236, s[16:19], s40 offen offset:2048
v_mfma_f32_16x16x32_bf16 v[136:139], a[196:199], a[24:27], v[136:139]
ds_read_b64_tr_b16 a[222:223], v226 offset:23424
v_mfma_f32_16x16x32_bf16 v[140:143], a[196:199], a[28:31], v[140:143]
s_waitcnt lgkmcnt(8)
v_mfma_f32_16x16x32_bf16 v[32:35], a[200:203], a[16:19], v[32:35]
ds_read_b64_tr_b16 a[192:193], v226 offset:7328
v_mfma_f32_16x16x32_bf16 v[36:39], a[200:203], a[20:23], v[36:39]
v_mfma_f32_16x16x32_bf16 v[144:147], a[200:203], a[24:27], v[144:147]
ds_read_b64_tr_b16 a[194:195], v226 offset:9120
v_mfma_f32_16x16x32_bf16 v[148:151], a[200:203], a[28:31], v[148:151]
v_mfma_f32_16x16x32_bf16 v[40:43], a[204:207], a[16:19], v[40:43]
ds_read_b64_tr_b16 a[196:197], v226 offset:21664
v_mfma_f32_16x16x32_bf16 v[44:47], a[204:207], a[20:23], v[44:47]
buffer_load_dwordx4 a[148:151], v236, s[16:19], s40 offen offset:2304
v_mfma_f32_16x16x32_bf16 v[152:155], a[204:207], a[24:27], v[152:155]
ds_read_b64_tr_b16 a[198:199], v226 offset:23456
v_mfma_f32_16x16x32_bf16 v[156:159], a[204:207], a[28:31], v[156:159]
s_waitcnt lgkmcnt(8)
s_add_u32 s40, s40, 4096
v_mfma_f32_16x16x32_bf16 v[48:51], a[208:211], a[16:19], v[48:51]
ds_read_b64_tr_b16 a[200:201], v226 offset:7360
v_mfma_f32_16x16x32_bf16 v[52:55], a[208:211], a[20:23], v[52:55]
buffer_load_dwordx4 a[152:155], v236, s[16:19], s41 offen offset:2048
v_mfma_f32_16x16x32_bf16 v[160:163], a[208:211], a[24:27], v[160:163]
ds_read_b64_tr_b16 a[202:203], v226 offset:9152
v_mfma_f32_16x16x32_bf16 v[164:167], a[208:211], a[28:31], v[164:167]
v_mfma_f32_16x16x32_bf16 v[56:59], a[212:215], a[16:19], v[56:59]
ds_read_b64_tr_b16 a[204:205], v226 offset:21696
v_mfma_f32_16x16x32_bf16 v[60:63], a[212:215], a[20:23], v[60:63]
v_mfma_f32_16x16x32_bf16 v[168:171], a[212:215], a[24:27], v[168:171]
ds_read_b64_tr_b16 a[206:207], v226 offset:23488
v_mfma_f32_16x16x32_bf16 v[172:175], a[212:215], a[28:31], v[172:175]
s_waitcnt lgkmcnt(8)
s_waitcnt vmcnt(45)
s_barrier
v_mfma_f32_16x16x32_bf16 v[64:67], a[216:219], a[16:19], v[64:67]
ds_read_b64_tr_b16 a[208:209], v226 offset:28672
v_mfma_f32_16x16x32_bf16 v[68:71], a[216:219], a[20:23], v[68:71]
buffer_load_dwordx4 a[156:159], v236, s[16:19], s41 offen offset:2304
v_mfma_f32_16x16x32_bf16 v[176:179], a[216:219], a[24:27], v[176:179]
ds_read_b64_tr_b16 a[210:211], v226 offset:30464
v_mfma_f32_16x16x32_bf16 v[180:183], a[216:219], a[28:31], v[180:183]
s_add_u32 s41, s41, 4096
s_add_u32 m0, s43, 114688
v_mfma_f32_16x16x32_bf16 v[72:75], a[220:223], a[16:19], v[72:75]
ds_read_b64_tr_b16 a[212:213], v226 offset:43008
v_mfma_f32_16x16x32_bf16 v[76:79], a[220:223], a[20:23], v[76:79]
buffer_load_dwordx4 v229, s[12:15], s42 offen offset:0 lds
v_mfma_f32_16x16x32_bf16 v[184:187], a[220:223], a[24:27], v[184:187]
ds_read_b64_tr_b16 a[214:215], v226 offset:44800
v_mfma_f32_16x16x32_bf16 v[188:191], a[220:223], a[28:31], v[188:191]
s_waitcnt lgkmcnt(8)
v_mfma_f32_16x16x32_bf16 v[80:83], a[192:195], a[16:19], v[80:83]
ds_read_b64_tr_b16 a[216:217], v226 offset:28704
v_mfma_f32_16x16x32_bf16 v[84:87], a[192:195], a[20:23], v[84:87]
v_mfma_f32_16x16x32_bf16 v[192:195], a[192:195], a[24:27], v[192:195]
ds_read_b64_tr_b16 a[218:219], v226 offset:30496
v_mfma_f32_16x16x32_bf16 v[196:199], a[192:195], a[28:31], v[196:199]
v_mfma_f32_16x16x32_bf16 v[88:91], a[196:199], a[16:19], v[88:91]
ds_read_b64_tr_b16 a[220:221], v226 offset:43040
v_mfma_f32_16x16x32_bf16 v[92:95], a[196:199], a[20:23], v[92:95]
buffer_load_dwordx4 v230, s[12:15], s42 offen offset:1024 lds
v_mfma_f32_16x16x32_bf16 v[200:203], a[196:199], a[24:27], v[200:203]
ds_read_b64_tr_b16 a[222:223], v226 offset:44832
v_mfma_f32_16x16x32_bf16 v[204:207], a[196:199], a[28:31], v[204:207]
s_waitcnt lgkmcnt(8)
v_mfma_f32_16x16x32_bf16 v[96:99], a[200:203], a[16:19], v[96:99]
ds_read_b64_tr_b16 a[192:193], v226 offset:28736
v_mfma_f32_16x16x32_bf16 v[100:103], a[200:203], a[20:23], v[100:103]
buffer_load_dwordx4 v231, s[12:15], s42 offen offset:2048 lds
v_mfma_f32_16x16x32_bf16 v[208:211], a[200:203], a[24:27], v[208:211]
ds_read_b64_tr_b16 a[194:195], v226 offset:30528
v_mfma_f32_16x16x32_bf16 v[212:215], a[200:203], a[28:31], v[212:215]
v_mfma_f32_16x16x32_bf16 v[104:107], a[204:207], a[16:19], v[104:107]
ds_read_b64_tr_b16 a[196:197], v226 offset:43072
v_mfma_f32_16x16x32_bf16 v[108:111], a[204:207], a[20:23], v[108:111]
v_mfma_f32_16x16x32_bf16 v[216:219], a[204:207], a[24:27], v[216:219]
ds_read_b64_tr_b16 a[198:199], v226 offset:44864
v_mfma_f32_16x16x32_bf16 v[220:223], a[204:207], a[28:31], v[220:223]
s_waitcnt vmcnt(45) lgkmcnt(8)
s_barrier
v_mfma_f32_16x16x32_bf16 v[0:3], a[208:211], a[32:35], v[0:3]
ds_read_b64_tr_b16 a[200:201], v226 offset:28768
v_mfma_f32_16x16x32_bf16 v[4:7], a[208:211], a[36:39], v[4:7]
buffer_load_dwordx4 v232, s[12:15], s42 offen offset:3072 lds
v_mfma_f32_16x16x32_bf16 v[112:115], a[208:211], a[40:43], v[112:115]
ds_read_b64_tr_b16 a[202:203], v226 offset:30560
v_mfma_f32_16x16x32_bf16 v[116:119], a[208:211], a[44:47], v[116:119]
s_add_u32 m0, s43, 118784
v_mfma_f32_16x16x32_bf16 v[8:11], a[212:215], a[32:35], v[8:11]
ds_read_b64_tr_b16 a[204:205], v226 offset:43104
v_mfma_f32_16x16x32_bf16 v[12:15], a[212:215], a[36:39], v[12:15]
buffer_load_dwordx4 v233, s[12:15], s42 offen offset:0 lds
v_mfma_f32_16x16x32_bf16 v[120:123], a[212:215], a[40:43], v[120:123]
ds_read_b64_tr_b16 a[206:207], v226 offset:44896
v_mfma_f32_16x16x32_bf16 v[124:127], a[212:215], a[44:47], v[124:127]
s_waitcnt lgkmcnt(8)
v_mfma_f32_16x16x32_bf16 v[16:19], a[216:219], a[32:35], v[16:19]
ds_read_b64_tr_b16 a[208:209], v226 offset:28800
v_mfma_f32_16x16x32_bf16 v[20:23], a[216:219], a[36:39], v[20:23]
v_mfma_f32_16x16x32_bf16 v[128:131], a[216:219], a[40:43], v[128:131]
ds_read_b64_tr_b16 a[210:211], v226 offset:30592
v_mfma_f32_16x16x32_bf16 v[132:135], a[216:219], a[44:47], v[132:135]
v_mfma_f32_16x16x32_bf16 v[24:27], a[220:223], a[32:35], v[24:27]
ds_read_b64_tr_b16 a[212:213], v226 offset:43136
v_mfma_f32_16x16x32_bf16 v[28:31], a[220:223], a[36:39], v[28:31]
buffer_load_dwordx4 v234, s[12:15], s42 offen offset:1024 lds
v_mfma_f32_16x16x32_bf16 v[136:139], a[220:223], a[40:43], v[136:139]
ds_read_b64_tr_b16 a[214:215], v226 offset:44928
v_mfma_f32_16x16x32_bf16 v[140:143], a[220:223], a[44:47], v[140:143]
s_waitcnt lgkmcnt(8)
v_mfma_f32_16x16x32_bf16 v[32:35], a[192:195], a[32:35], v[32:35]
ds_read_b64_tr_b16 a[216:217], v226 offset:28832
v_mfma_f32_16x16x32_bf16 v[36:39], a[192:195], a[36:39], v[36:39]
buffer_load_dwordx4 v235, s[12:15], s42 offen offset:2048 lds
v_mfma_f32_16x16x32_bf16 v[144:147], a[192:195], a[40:43], v[144:147]
ds_read_b64_tr_b16 a[218:219], v226 offset:30624
v_mfma_f32_16x16x32_bf16 v[148:151], a[192:195], a[44:47], v[148:151]
s_add_u32 s42, s42, 458752
v_mfma_f32_16x16x32_bf16 v[40:43], a[196:199], a[32:35], v[40:43]
ds_read_b64_tr_b16 a[220:221], v226 offset:43168
v_mfma_f32_16x16x32_bf16 v[44:47], a[196:199], a[36:39], v[44:47]
v_mfma_f32_16x16x32_bf16 v[152:155], a[196:199], a[40:43], v[152:155]
ds_read_b64_tr_b16 a[222:223], v226 offset:44960
v_mfma_f32_16x16x32_bf16 v[156:159], a[196:199], a[44:47], v[156:159]
s_waitcnt lgkmcnt(8)
s_add_u32 m0, s43, 0
v_mfma_f32_16x16x32_bf16 v[48:51], a[200:203], a[32:35], v[48:51]
ds_read_b64_tr_b16 a[192:193], v226 offset:28864
v_mfma_f32_16x16x32_bf16 v[52:55], a[200:203], a[36:39], v[52:55]
buffer_load_dwordx4 v229, s[12:15], s42 offen offset:0 lds
v_mfma_f32_16x16x32_bf16 v[160:163], a[200:203], a[40:43], v[160:163]
ds_read_b64_tr_b16 a[194:195], v226 offset:30656
v_mfma_f32_16x16x32_bf16 v[164:167], a[200:203], a[44:47], v[164:167]
v_mfma_f32_16x16x32_bf16 v[56:59], a[204:207], a[32:35], v[56:59]
ds_read_b64_tr_b16 a[196:197], v226 offset:43200
v_mfma_f32_16x16x32_bf16 v[60:63], a[204:207], a[36:39], v[60:63]
buffer_load_dwordx4 v230, s[12:15], s42 offen offset:1024 lds
v_mfma_f32_16x16x32_bf16 v[168:171], a[204:207], a[40:43], v[168:171]
ds_read_b64_tr_b16 a[198:199], v226 offset:44992
v_mfma_f32_16x16x32_bf16 v[172:175], a[204:207], a[44:47], v[172:175]
s_waitcnt lgkmcnt(8)
v_mfma_f32_16x16x32_bf16 v[64:67], a[208:211], a[32:35], v[64:67]
ds_read_b64_tr_b16 a[200:201], v226 offset:35840
v_mfma_f32_16x16x32_bf16 v[68:71], a[208:211], a[36:39], v[68:71]
v_mfma_f32_16x16x32_bf16 v[176:179], a[208:211], a[40:43], v[176:179]
ds_read_b64_tr_b16 a[202:203], v226 offset:37632
v_mfma_f32_16x16x32_bf16 v[180:183], a[208:211], a[44:47], v[180:183]
v_mfma_f32_16x16x32_bf16 v[72:75], a[212:215], a[32:35], v[72:75]
ds_read_b64_tr_b16 a[204:205], v226 offset:50176
v_mfma_f32_16x16x32_bf16 v[76:79], a[212:215], a[36:39], v[76:79]
buffer_load_dwordx4 v231, s[12:15], s42 offen offset:2048 lds
v_mfma_f32_16x16x32_bf16 v[184:187], a[212:215], a[40:43], v[184:187]
ds_read_b64_tr_b16 a[206:207], v226 offset:51968
v_mfma_f32_16x16x32_bf16 v[188:191], a[212:215], a[44:47], v[188:191]
s_waitcnt lgkmcnt(8)
v_mfma_f32_16x16x32_bf16 v[80:83], a[216:219], a[32:35], v[80:83]
ds_read_b64_tr_b16 a[208:209], v226 offset:35872
v_mfma_f32_16x16x32_bf16 v[84:87], a[216:219], a[36:39], v[84:87]
buffer_load_dwordx4 v232, s[12:15], s42 offen offset:3072 lds
v_mfma_f32_16x16x32_bf16 v[192:195], a[216:219], a[40:43], v[192:195]
ds_read_b64_tr_b16 a[210:211], v226 offset:37664
v_mfma_f32_16x16x32_bf16 v[196:199], a[216:219], a[44:47], v[196:199]
v_mfma_f32_16x16x32_bf16 v[88:91], a[220:223], a[32:35], v[88:91]
ds_read_b64_tr_b16 a[212:213], v226 offset:50208
v_mfma_f32_16x16x32_bf16 v[92:95], a[220:223], a[36:39], v[92:95]
v_mfma_f32_16x16x32_bf16 v[200:203], a[220:223], a[40:43], v[200:203]
ds_read_b64_tr_b16 a[214:215], v226 offset:52000
v_mfma_f32_16x16x32_bf16 v[204:207], a[220:223], a[44:47], v[204:207]
s_waitcnt lgkmcnt(8)
s_add_u32 m0, s43, 4096
v_mfma_f32_16x16x32_bf16 v[96:99], a[192:195], a[32:35], v[96:99]
ds_read_b64_tr_b16 a[216:217], v226 offset:35904
v_mfma_f32_16x16x32_bf16 v[100:103], a[192:195], a[36:39], v[100:103]
buffer_load_dwordx4 v233, s[12:15], s42 offen offset:0 lds
v_mfma_f32_16x16x32_bf16 v[208:211], a[192:195], a[40:43], v[208:211]
ds_read_b64_tr_b16 a[218:219], v226 offset:37696
v_mfma_f32_16x16x32_bf16 v[212:215], a[192:195], a[44:47], v[212:215]
v_mfma_f32_16x16x32_bf16 v[104:107], a[196:199], a[32:35], v[104:107]
ds_read_b64_tr_b16 a[220:221], v226 offset:50240
v_mfma_f32_16x16x32_bf16 v[108:111], a[196:199], a[36:39], v[108:111]
buffer_load_dwordx4 v234, s[12:15], s42 offen offset:1024 lds
v_mfma_f32_16x16x32_bf16 v[216:219], a[196:199], a[40:43], v[216:219]
ds_read_b64_tr_b16 a[222:223], v226 offset:52032
v_mfma_f32_16x16x32_bf16 v[220:223], a[196:199], a[44:47], v[220:223]
s_waitcnt vmcnt(51) lgkmcnt(8)
v_mfma_f32_16x16x32_bf16 v[0:3], a[200:203], a[48:51], v[0:3]
ds_read_b64_tr_b16 a[192:193], v226 offset:35936
v_mfma_f32_16x16x32_bf16 v[4:7], a[200:203], a[52:55], v[4:7]
v_mfma_f32_16x16x32_bf16 v[112:115], a[200:203], a[56:59], v[112:115]
ds_read_b64_tr_b16 a[194:195], v226 offset:37728
v_mfma_f32_16x16x32_bf16 v[116:119], a[200:203], a[60:63], v[116:119]
v_mfma_f32_16x16x32_bf16 v[8:11], a[204:207], a[48:51], v[8:11]
ds_read_b64_tr_b16 a[196:197], v226 offset:50272
v_mfma_f32_16x16x32_bf16 v[12:15], a[204:207], a[52:55], v[12:15]
buffer_load_dwordx4 v235, s[12:15], s42 offen offset:2048 lds
v_mfma_f32_16x16x32_bf16 v[120:123], a[204:207], a[56:59], v[120:123]
ds_read_b64_tr_b16 a[198:199], v226 offset:52064
v_mfma_f32_16x16x32_bf16 v[124:127], a[204:207], a[60:63], v[124:127]
s_waitcnt lgkmcnt(8)
s_add_u32 s42, s42, 458752
v_mfma_f32_16x16x32_bf16 v[16:19], a[208:211], a[48:51], v[16:19]
ds_read_b64_tr_b16 a[200:201], v226 offset:35968
v_mfma_f32_16x16x32_bf16 v[20:23], a[208:211], a[52:55], v[20:23]
buffer_load_dwordx4 a[0:3], v236, s[16:19], s40 offen offset:0
v_mfma_f32_16x16x32_bf16 v[128:131], a[208:211], a[56:59], v[128:131]
ds_read_b64_tr_b16 a[202:203], v226 offset:37760
v_mfma_f32_16x16x32_bf16 v[132:135], a[208:211], a[60:63], v[132:135]
v_mfma_f32_16x16x32_bf16 v[24:27], a[212:215], a[48:51], v[24:27]
ds_read_b64_tr_b16 a[204:205], v226 offset:50304
v_mfma_f32_16x16x32_bf16 v[28:31], a[212:215], a[52:55], v[28:31]
v_mfma_f32_16x16x32_bf16 v[136:139], a[212:215], a[56:59], v[136:139]
ds_read_b64_tr_b16 a[206:207], v226 offset:52096
v_mfma_f32_16x16x32_bf16 v[140:143], a[212:215], a[60:63], v[140:143]
s_waitcnt lgkmcnt(8)
v_mfma_f32_16x16x32_bf16 v[32:35], a[216:219], a[48:51], v[32:35]
ds_read_b64_tr_b16 a[208:209], v226 offset:36000
v_mfma_f32_16x16x32_bf16 v[36:39], a[216:219], a[52:55], v[36:39]
buffer_load_dwordx4 a[4:7], v236, s[16:19], s40 offen offset:256
v_mfma_f32_16x16x32_bf16 v[144:147], a[216:219], a[56:59], v[144:147]
ds_read_b64_tr_b16 a[210:211], v226 offset:37792
v_mfma_f32_16x16x32_bf16 v[148:151], a[216:219], a[60:63], v[148:151]
v_mfma_f32_16x16x32_bf16 v[40:43], a[220:223], a[48:51], v[40:43]
ds_read_b64_tr_b16 a[212:213], v226 offset:50336
v_mfma_f32_16x16x32_bf16 v[44:47], a[220:223], a[52:55], v[44:47]
buffer_load_dwordx4 a[8:11], v236, s[16:19], s41 offen offset:0
v_mfma_f32_16x16x32_bf16 v[152:155], a[220:223], a[56:59], v[152:155]
ds_read_b64_tr_b16 a[214:215], v226 offset:52128
v_mfma_f32_16x16x32_bf16 v[156:159], a[220:223], a[60:63], v[156:159]
s_waitcnt lgkmcnt(8)
v_mfma_f32_16x16x32_bf16 v[48:51], a[192:195], a[48:51], v[48:51]
ds_read_b64_tr_b16 a[216:217], v226 offset:36032
v_mfma_f32_16x16x32_bf16 v[52:55], a[192:195], a[52:55], v[52:55]
v_mfma_f32_16x16x32_bf16 v[160:163], a[192:195], a[56:59], v[160:163]
ds_read_b64_tr_b16 a[218:219], v226 offset:37824
v_mfma_f32_16x16x32_bf16 v[164:167], a[192:195], a[60:63], v[164:167]
v_mfma_f32_16x16x32_bf16 v[56:59], a[196:199], a[48:51], v[56:59]
ds_read_b64_tr_b16 a[220:221], v226 offset:50368
v_mfma_f32_16x16x32_bf16 v[60:63], a[196:199], a[52:55], v[60:63]
buffer_load_dwordx4 a[12:15], v236, s[16:19], s41 offen offset:256
v_mfma_f32_16x16x32_bf16 v[168:171], a[196:199], a[56:59], v[168:171]
ds_read_b64_tr_b16 a[222:223], v226 offset:52160
v_mfma_f32_16x16x32_bf16 v[172:175], a[196:199], a[60:63], v[172:175]
s_waitcnt lgkmcnt(8)
s_waitcnt vmcnt(48)
s_barrier
v_mfma_f32_16x16x32_bf16 v[64:67], a[200:203], a[48:51], v[64:67]
ds_read_b64_tr_b16 a[192:193], v227 offset:0
v_mfma_f32_16x16x32_bf16 v[68:71], a[200:203], a[52:55], v[68:71]
buffer_load_dwordx4 a[16:19], v236, s[16:19], s40 offen offset:2048
v_mfma_f32_16x16x32_bf16 v[176:179], a[200:203], a[56:59], v[176:179]
ds_read_b64_tr_b16 a[194:195], v227 offset:1792
v_mfma_f32_16x16x32_bf16 v[180:183], a[200:203], a[60:63], v[180:183]
v_mfma_f32_16x16x32_bf16 v[72:75], a[204:207], a[48:51], v[72:75]
ds_read_b64_tr_b16 a[196:197], v227 offset:14336
v_mfma_f32_16x16x32_bf16 v[76:79], a[204:207], a[52:55], v[76:79]
v_mfma_f32_16x16x32_bf16 v[184:187], a[204:207], a[56:59], v[184:187]
ds_read_b64_tr_b16 a[198:199], v227 offset:16128
v_mfma_f32_16x16x32_bf16 v[188:191], a[204:207], a[60:63], v[188:191]
s_waitcnt lgkmcnt(8)
v_mfma_f32_16x16x32_bf16 v[80:83], a[208:211], a[48:51], v[80:83]
ds_read_b64_tr_b16 a[200:201], v227 offset:7168
v_mfma_f32_16x16x32_bf16 v[84:87], a[208:211], a[52:55], v[84:87]
buffer_load_dwordx4 a[20:23], v236, s[16:19], s40 offen offset:2304
v_mfma_f32_16x16x32_bf16 v[192:195], a[208:211], a[56:59], v[192:195]
ds_read_b64_tr_b16 a[202:203], v227 offset:8960
v_mfma_f32_16x16x32_bf16 v[196:199], a[208:211], a[60:63], v[196:199]
s_add_u32 s40, s40, 4096
v_mfma_f32_16x16x32_bf16 v[88:91], a[212:215], a[48:51], v[88:91]
ds_read_b64_tr_b16 a[204:205], v227 offset:21504
v_mfma_f32_16x16x32_bf16 v[92:95], a[212:215], a[52:55], v[92:95]
buffer_load_dwordx4 a[24:27], v236, s[16:19], s41 offen offset:2048
v_mfma_f32_16x16x32_bf16 v[200:203], a[212:215], a[56:59], v[200:203]
ds_read_b64_tr_b16 a[206:207], v227 offset:23296
v_mfma_f32_16x16x32_bf16 v[204:207], a[212:215], a[60:63], v[204:207]
s_waitcnt lgkmcnt(8)
s_waitcnt vmcnt(33)
s_barrier
v_mfma_f32_16x16x32_bf16 v[96:99], a[216:219], a[48:51], v[96:99]
ds_read_b64_tr_b16 a[208:209], v227 offset:28672
v_mfma_f32_16x16x32_bf16 v[100:103], a[216:219], a[52:55], v[100:103]
v_mfma_f32_16x16x32_bf16 v[208:211], a[216:219], a[56:59], v[208:211]
ds_read_b64_tr_b16 a[210:211], v227 offset:30464
v_mfma_f32_16x16x32_bf16 v[212:215], a[216:219], a[60:63], v[212:215]
v_mfma_f32_16x16x32_bf16 v[104:107], a[220:223], a[48:51], v[104:107]
ds_read_b64_tr_b16 a[212:213], v227 offset:43008
v_mfma_f32_16x16x32_bf16 v[108:111], a[220:223], a[52:55], v[108:111]
buffer_load_dwordx4 a[28:31], v236, s[16:19], s41 offen offset:2304
v_mfma_f32_16x16x32_bf16 v[216:219], a[220:223], a[56:59], v[216:219]
ds_read_b64_tr_b16 a[214:215], v227 offset:44800
v_mfma_f32_16x16x32_bf16 v[220:223], a[220:223], a[60:63], v[220:223]
s_waitcnt lgkmcnt(8)
s_add_u32 s41, s41, 4096
v_mfma_f32_16x16x32_bf16 v[0:3], a[192:195], a[64:67], v[0:3]
ds_read_b64_tr_b16 a[216:217], v227 offset:35840
v_mfma_f32_16x16x32_bf16 v[4:7], a[192:195], a[68:71], v[4:7]
v_mfma_f32_16x16x32_bf16 v[112:115], a[192:195], a[72:75], v[112:115]
ds_read_b64_tr_b16 a[218:219], v227 offset:37632
v_mfma_f32_16x16x32_bf16 v[116:119], a[192:195], a[76:79], v[116:119]
v_mfma_f32_16x16x32_bf16 v[8:11], a[196:199], a[64:67], v[8:11]
ds_read_b64_tr_b16 a[220:221], v227 offset:50176
v_mfma_f32_16x16x32_bf16 v[12:15], a[196:199], a[68:71], v[12:15]
v_mfma_f32_16x16x32_bf16 v[120:123], a[196:199], a[72:75], v[120:123]
ds_read_b64_tr_b16 a[222:223], v227 offset:51968
v_mfma_f32_16x16x32_bf16 v[124:127], a[196:199], a[76:79], v[124:127]
s_waitcnt lgkmcnt(8)
s_waitcnt vmcnt(15)
s_barrier
v_mfma_f32_16x16x32_bf16 v[0:3], a[200:203], a[80:83], v[0:3]
ds_read_b64_tr_b16 a[192:193], v228 offset:0
v_mfma_f32_16x16x32_bf16 v[4:7], a[200:203], a[84:87], v[4:7]
v_mfma_f32_16x16x32_bf16 v[112:115], a[200:203], a[88:91], v[112:115]
ds_read_b64_tr_b16 a[194:195], v228 offset:1792
v_mfma_f32_16x16x32_bf16 v[116:119], a[200:203], a[92:95], v[116:119]
v_mfma_f32_16x16x32_bf16 v[8:11], a[204:207], a[80:83], v[8:11]
ds_read_b64_tr_b16 a[196:197], v228 offset:14336
v_mfma_f32_16x16x32_bf16 v[12:15], a[204:207], a[84:87], v[12:15]
v_mfma_f32_16x16x32_bf16 v[120:123], a[204:207], a[88:91], v[120:123]
ds_read_b64_tr_b16 a[198:199], v228 offset:16128
v_mfma_f32_16x16x32_bf16 v[124:127], a[204:207], a[92:95], v[124:127]
s_waitcnt lgkmcnt(8)
v_mfma_f32_16x16x32_bf16 v[0:3], a[208:211], a[96:99], v[0:3]
ds_read_b64_tr_b16 a[200:201], v228 offset:7168
v_mfma_f32_16x16x32_bf16 v[4:7], a[208:211], a[100:103], v[4:7]
v_mfma_f32_16x16x32_bf16 v[112:115], a[208:211], a[104:107], v[112:115]
ds_read_b64_tr_b16 a[202:203], v228 offset:8960
v_mfma_f32_16x16x32_bf16 v[116:119], a[208:211], a[108:111], v[116:119]
v_mfma_f32_16x16x32_bf16 v[8:11], a[212:215], a[96:99], v[8:11]
ds_read_b64_tr_b16 a[204:205], v228 offset:21504
v_mfma_f32_16x16x32_bf16 v[12:15], a[212:215], a[100:103], v[12:15]
v_mfma_f32_16x16x32_bf16 v[120:123], a[212:215], a[104:107], v[120:123]
ds_read_b64_tr_b16 a[206:207], v228 offset:23296
v_mfma_f32_16x16x32_bf16 v[124:127], a[212:215], a[108:111], v[124:127]
s_waitcnt lgkmcnt(8)
s_waitcnt vmcnt(8)
s_barrier
v_mfma_f32_16x16x32_bf16 v[0:3], a[216:219], a[112:115], v[0:3]
ds_read_b64_tr_b16 a[208:209], v226 offset:0
v_mfma_f32_16x16x32_bf16 v[4:7], a[216:219], a[116:119], v[4:7]
v_mfma_f32_16x16x32_bf16 v[112:115], a[216:219], a[120:123], v[112:115]
ds_read_b64_tr_b16 a[210:211], v226 offset:1792
v_mfma_f32_16x16x32_bf16 v[116:119], a[216:219], a[124:127], v[116:119]
v_mfma_f32_16x16x32_bf16 v[8:11], a[220:223], a[112:115], v[8:11]
ds_read_b64_tr_b16 a[212:213], v226 offset:14336
v_mfma_f32_16x16x32_bf16 v[12:15], a[220:223], a[116:119], v[12:15]
v_mfma_f32_16x16x32_bf16 v[120:123], a[220:223], a[120:123], v[120:123]
ds_read_b64_tr_b16 a[214:215], v226 offset:16128
v_mfma_f32_16x16x32_bf16 v[124:127], a[220:223], a[124:127], v[124:127]
s_waitcnt lgkmcnt(8)
v_mfma_f32_16x16x32_bf16 v[0:3], a[192:195], a[128:131], v[0:3]
ds_read_b64_tr_b16 a[216:217], v226 offset:7168
v_mfma_f32_16x16x32_bf16 v[4:7], a[192:195], a[132:135], v[4:7]
v_mfma_f32_16x16x32_bf16 v[112:115], a[192:195], a[136:139], v[112:115]
ds_read_b64_tr_b16 a[218:219], v226 offset:8960
v_mfma_f32_16x16x32_bf16 v[116:119], a[192:195], a[140:143], v[116:119]
v_mfma_f32_16x16x32_bf16 v[8:11], a[196:199], a[128:131], v[8:11]
ds_read_b64_tr_b16 a[220:221], v226 offset:21504
v_mfma_f32_16x16x32_bf16 v[12:15], a[196:199], a[132:135], v[12:15]
v_mfma_f32_16x16x32_bf16 v[120:123], a[196:199], a[136:139], v[120:123]
ds_read_b64_tr_b16 a[222:223], v226 offset:23296
v_mfma_f32_16x16x32_bf16 v[124:127], a[196:199], a[140:143], v[124:127]
s_waitcnt lgkmcnt(8)
v_mfma_f32_16x16x32_bf16 v[0:3], a[200:203], a[144:147], v[0:3]
ds_read_b64_tr_b16 a[192:193], v227 offset:32
v_mfma_f32_16x16x32_bf16 v[4:7], a[200:203], a[148:151], v[4:7]
v_mfma_f32_16x16x32_bf16 v[112:115], a[200:203], a[152:155], v[112:115]
ds_read_b64_tr_b16 a[194:195], v227 offset:1824
v_mfma_f32_16x16x32_bf16 v[116:119], a[200:203], a[156:159], v[116:119]
v_mfma_f32_16x16x32_bf16 v[8:11], a[204:207], a[144:147], v[8:11]
ds_read_b64_tr_b16 a[196:197], v227 offset:14368
v_mfma_f32_16x16x32_bf16 v[12:15], a[204:207], a[148:151], v[12:15]
v_mfma_f32_16x16x32_bf16 v[120:123], a[204:207], a[152:155], v[120:123]
ds_read_b64_tr_b16 a[198:199], v227 offset:16160
v_mfma_f32_16x16x32_bf16 v[124:127], a[204:207], a[156:159], v[124:127]
s_waitcnt vmcnt(4) lgkmcnt(8)
v_mfma_f32_16x16x32_bf16 v[0:3], a[208:211], a[0:3], v[0:3]
ds_read_b64_tr_b16 a[200:201], v227 offset:7200
v_mfma_f32_16x16x32_bf16 v[4:7], a[208:211], a[4:7], v[4:7]
v_mfma_f32_16x16x32_bf16 v[112:115], a[208:211], a[8:11], v[112:115]
ds_read_b64_tr_b16 a[202:203], v227 offset:8992
v_mfma_f32_16x16x32_bf16 v[116:119], a[208:211], a[12:15], v[116:119]
v_mfma_f32_16x16x32_bf16 v[8:11], a[212:215], a[0:3], v[8:11]
ds_read_b64_tr_b16 a[204:205], v227 offset:21536
v_mfma_f32_16x16x32_bf16 v[12:15], a[212:215], a[4:7], v[12:15]
v_mfma_f32_16x16x32_bf16 v[120:123], a[212:215], a[8:11], v[120:123]
ds_read_b64_tr_b16 a[206:207], v227 offset:23328
v_mfma_f32_16x16x32_bf16 v[124:127], a[212:215], a[12:15], v[124:127]
s_waitcnt vmcnt(0) lgkmcnt(8)
v_mfma_f32_16x16x32_bf16 v[0:3], a[216:219], a[16:19], v[0:3]
ds_read_b64_tr_b16 a[208:209], v227 offset:28704
v_mfma_f32_16x16x32_bf16 v[4:7], a[216:219], a[20:23], v[4:7]
v_mfma_f32_16x16x32_bf16 v[112:115], a[216:219], a[24:27], v[112:115]
ds_read_b64_tr_b16 a[210:211], v227 offset:30496
v_mfma_f32_16x16x32_bf16 v[116:119], a[216:219], a[28:31], v[116:119]
v_mfma_f32_16x16x32_bf16 v[8:11], a[220:223], a[16:19], v[8:11]
ds_read_b64_tr_b16 a[212:213], v227 offset:43040
v_mfma_f32_16x16x32_bf16 v[12:15], a[220:223], a[20:23], v[12:15]
v_mfma_f32_16x16x32_bf16 v[120:123], a[220:223], a[24:27], v[120:123]
ds_read_b64_tr_b16 a[214:215], v227 offset:44832
v_mfma_f32_16x16x32_bf16 v[124:127], a[220:223], a[28:31], v[124:127]
s_waitcnt lgkmcnt(8)
v_mfma_f32_16x16x32_bf16 v[16:19], a[192:195], a[64:67], v[16:19]
ds_read_b64_tr_b16 a[216:217], v227 offset:35872
v_mfma_f32_16x16x32_bf16 v[20:23], a[192:195], a[68:71], v[20:23]
v_mfma_f32_16x16x32_bf16 v[128:131], a[192:195], a[72:75], v[128:131]
ds_read_b64_tr_b16 a[218:219], v227 offset:37664
v_mfma_f32_16x16x32_bf16 v[132:135], a[192:195], a[76:79], v[132:135]
v_mfma_f32_16x16x32_bf16 v[24:27], a[196:199], a[64:67], v[24:27]
ds_read_b64_tr_b16 a[220:221], v227 offset:50208
v_mfma_f32_16x16x32_bf16 v[28:31], a[196:199], a[68:71], v[28:31]
v_mul_f32 v238, v0, v0
v_mul_f32 v239, v1, v1
v_mul_f32 v240, v2, v2
v_mfma_f32_16x16x32_bf16 v[136:139], a[196:199], a[72:75], v[136:139]
ds_read_b64_tr_b16 a[222:223], v227 offset:52000
v_mul_f32 v241, v3, v3
v_mul_f32 v242, v4, v4
v_mfma_f32_16x16x32_bf16 v[140:143], a[196:199], a[76:79], v[140:143]
s_waitcnt lgkmcnt(8)
v_mul_f32 v243, v5, v5
v_mul_f32 v244, v6, v6
v_mul_f32 v245, v7, v7
v_mfma_f32_16x16x32_bf16 v[16:19], a[200:203], a[80:83], v[16:19]
ds_read_b64_tr_b16 a[192:193], v228 offset:32
v_fma_f32 v238, v238, s51, v237
v_fma_f32 v239, v239, s51, v237
v_mfma_f32_16x16x32_bf16 v[20:23], a[200:203], a[84:87], v[20:23]
v_fma_f32 v240, v240, s51, v237
v_fma_f32 v241, v241, s51, v237
v_fma_f32 v242, v242, s51, v237
v_mfma_f32_16x16x32_bf16 v[128:131], a[200:203], a[88:91], v[128:131]
ds_read_b64_tr_b16 a[194:195], v228 offset:1824
v_fma_f32 v243, v243, s51, v237
v_fma_f32 v244, v244, s51, v237
v_mfma_f32_16x16x32_bf16 v[132:135], a[200:203], a[92:95], v[132:135]
v_fma_f32 v245, v245, s51, v237
v_mul_f32 v238, v238, v0
v_mul_f32 v8, v0, v8
v_mfma_f32_16x16x32_bf16 v[24:27], a[204:207], a[80:83], v[24:27]
ds_read_b64_tr_b16 a[196:197], v228 offset:14368
v_exp_f32 v238, v238
v_mfma_f32_16x16x32_bf16 v[28:31], a[204:207], a[84:87], v[28:31]
v_mul_f32 v239, v239, v1
v_exp_f32 v239, v239
v_mfma_f32_16x16x32_bf16 v[136:139], a[204:207], a[88:91], v[136:139]
ds_read_b64_tr_b16 a[198:199], v228 offset:16160
v_mul_f32 v9, v1, v9
v_mul_f32 v240, v240, v2
v_mfma_f32_16x16x32_bf16 v[140:143], a[204:207], a[92:95], v[140:143]
s_waitcnt lgkmcnt(8)
v_exp_f32 v240, v240
v_mul_f32 v10, v2, v10
v_mfma_f32_16x16x32_bf16 v[16:19], a[208:211], a[96:99], v[16:19]
ds_read_b64_tr_b16 a[200:201], v228 offset:7200
v_mul_f32 v241, v241, v3
v_mul_f32 v11, v3, v11
v_mfma_f32_16x16x32_bf16 v[20:23], a[208:211], a[100:103], v[20:23]
v_exp_f32 v241, v241
v_mul_f32 v242, v242, v4
v_mfma_f32_16x16x32_bf16 v[128:131], a[208:211], a[104:107], v[128:131]
ds_read_b64_tr_b16 a[202:203], v228 offset:8992
v_exp_f32 v242, v242
v_mfma_f32_16x16x32_bf16 v[132:135], a[208:211], a[108:111], v[132:135]
v_mul_f32 v12, v4, v12
v_mul_f32 v243, v243, v5
v_mul_f32 v13, v5, v13
v_mfma_f32_16x16x32_bf16 v[24:27], a[212:215], a[96:99], v[24:27]
ds_read_b64_tr_b16 a[204:205], v228 offset:21536
v_exp_f32 v243, v243
v_mfma_f32_16x16x32_bf16 v[28:31], a[212:215], a[100:103], v[28:31]
v_mul_f32 v244, v244, v6
v_exp_f32 v244, v244
v_mfma_f32_16x16x32_bf16 v[136:139], a[212:215], a[104:107], v[136:139]
ds_read_b64_tr_b16 a[206:207], v228 offset:23328
v_mul_f32 v14, v6, v14
v_mul_f32 v245, v245, v7
v_mfma_f32_16x16x32_bf16 v[140:143], a[212:215], a[108:111], v[140:143]
s_waitcnt lgkmcnt(8)
v_exp_f32 v245, v245
v_mul_f32 v15, v7, v15
v_mfma_f32_16x16x32_bf16 v[16:19], a[216:219], a[112:115], v[16:19]
ds_read_b64_tr_b16 a[208:209], v226 offset:32
v_add_f32 v238, 1.0, v238
v_add_f32 v239, 1.0, v239
v_mfma_f32_16x16x32_bf16 v[20:23], a[216:219], a[116:119], v[20:23]
v_rcp_f32 v238, v238
v_add_f32 v240, 1.0, v240
v_mfma_f32_16x16x32_bf16 v[128:131], a[216:219], a[120:123], v[128:131]
ds_read_b64_tr_b16 a[210:211], v226 offset:1824
v_rcp_f32 v239, v239
v_mfma_f32_16x16x32_bf16 v[132:135], a[216:219], a[124:127], v[132:135]
v_rcp_f32 v240, v240
v_add_f32 v241, 1.0, v241
v_mfma_f32_16x16x32_bf16 v[24:27], a[220:223], a[112:115], v[24:27]
ds_read_b64_tr_b16 a[212:213], v226 offset:14368
v_rcp_f32 v241, v241
v_mfma_f32_16x16x32_bf16 v[28:31], a[220:223], a[116:119], v[28:31]
v_mul_f32 v0, v8, v238
v_add_f32 v242, 1.0, v242
v_mul_f32 v1, v9, v239
v_mfma_f32_16x16x32_bf16 v[136:139], a[220:223], a[120:123], v[136:139]
ds_read_b64_tr_b16 a[214:215], v226 offset:16160
v_rcp_f32 v242, v242
v_mfma_f32_16x16x32_bf16 v[140:143], a[220:223], a[124:127], v[140:143]
s_waitcnt lgkmcnt(8)
v_add_f32 v243, 1.0, v243
v_rcp_f32 v243, v243
v_mfma_f32_16x16x32_bf16 v[16:19], a[192:195], a[128:131], v[16:19]
ds_read_b64_tr_b16 a[216:217], v226 offset:7200
v_mul_f32 v2, v10, v240
v_add_f32 v244, 1.0, v244
v_mfma_f32_16x16x32_bf16 v[20:23], a[192:195], a[132:135], v[20:23]
v_rcp_f32 v244, v244
v_mul_f32 v3, v11, v241
v_mfma_f32_16x16x32_bf16 v[128:131], a[192:195], a[136:139], v[128:131]
ds_read_b64_tr_b16 a[218:219], v226 offset:8992
v_add_f32 v245, 1.0, v245
v_mul_f32 v4, v12, v242
v_mfma_f32_16x16x32_bf16 v[132:135], a[192:195], a[140:143], v[132:135]
v_rcp_f32 v245, v245
v_mul_f32 v5, v13, v243
v_mfma_f32_16x16x32_bf16 v[24:27], a[196:199], a[128:131], v[24:27]
ds_read_b64_tr_b16 a[220:221], v226 offset:21536
v_mul_f32 v6, v14, v244
v_mul_f32 v7, v15, v245
v_mfma_f32_16x16x32_bf16 v[28:31], a[196:199], a[132:135], v[28:31]
v_cvt_pk_bf16_f32 v8, v0, v1
v_cvt_pk_bf16_f32 v9, v2, v3
v_cvt_pk_bf16_f32 v10, v4, v5
v_mfma_f32_16x16x32_bf16 v[136:139], a[196:199], a[136:139], v[136:139]
ds_read_b64_tr_b16 a[222:223], v226 offset:23328
v_cvt_pk_bf16_f32 v11, v6, v7
s_nop 1
v_mfma_f32_16x16x32_bf16 v[140:143], a[196:199], a[140:143], v[140:143]
s_waitcnt lgkmcnt(8)
v_permlane16_swap_b32 v8, v10
v_permlane16_swap_b32 v9, v11
v_mfma_f32_16x16x32_bf16 v[16:19], a[200:203], a[144:147], v[16:19]
ds_read_b64_tr_b16 a[192:193], v227 offset:64
v_mfma_f32_16x16x32_bf16 v[20:23], a[200:203], a[148:151], v[20:23]
buffer_store_dwordx4 v[8:11], v225, s[20:23], s44 offen offset:0 sc1
v_mfma_f32_16x16x32_bf16 v[128:131], a[200:203], a[152:155], v[128:131]
ds_read_b64_tr_b16 a[194:195], v227 offset:1856
v_mul_f32 v246, v112, v112
v_mul_f32 v247, v113, v113
v_mfma_f32_16x16x32_bf16 v[132:135], a[200:203], a[156:159], v[132:135]
v_mul_f32 v248, v114, v114
v_mul_f32 v249, v115, v115
v_mul_f32 v250, v116, v116
v_mfma_f32_16x16x32_bf16 v[24:27], a[204:207], a[144:147], v[24:27]
ds_read_b64_tr_b16 a[196:197], v227 offset:14400
v_mul_f32 v251, v117, v117
v_mul_f32 v252, v118, v118
v_mfma_f32_16x16x32_bf16 v[28:31], a[204:207], a[148:151], v[28:31]
v_mul_f32 v253, v119, v119
v_fma_f32 v246, v246, s51, v237
v_fma_f32 v247, v247, s51, v237
v_mfma_f32_16x16x32_bf16 v[136:139], a[204:207], a[152:155], v[136:139]
ds_read_b64_tr_b16 a[198:199], v227 offset:16192
v_fma_f32 v248, v248, s51, v237
v_fma_f32 v249, v249, s51, v237
v_mfma_f32_16x16x32_bf16 v[140:143], a[204:207], a[156:159], v[140:143]
s_waitcnt lgkmcnt(8)
v_fma_f32 v250, v250, s51, v237
v_fma_f32 v251, v251, s51, v237
v_fma_f32 v252, v252, s51, v237
v_mfma_f32_16x16x32_bf16 v[16:19], a[208:211], a[0:3], v[16:19]
ds_read_b64_tr_b16 a[200:201], v227 offset:7232
v_fma_f32 v253, v253, s51, v237
v_mul_f32 v246, v246, v112
v_mfma_f32_16x16x32_bf16 v[20:23], a[208:211], a[4:7], v[20:23]
v_exp_f32 v246, v246
v_mul_f32 v120, v112, v120
v_mfma_f32_16x16x32_bf16 v[128:131], a[208:211], a[8:11], v[128:131]
ds_read_b64_tr_b16 a[202:203], v227 offset:9024
v_mul_f32 v247, v247, v113
v_mul_f32 v121, v113, v121
v_mfma_f32_16x16x32_bf16 v[132:135], a[208:211], a[12:15], v[132:135]
v_exp_f32 v247, v247
v_mul_f32 v248, v248, v114
v_mfma_f32_16x16x32_bf16 v[24:27], a[212:215], a[0:3], v[24:27]
ds_read_b64_tr_b16 a[204:205], v227 offset:21568
v_exp_f32 v248, v248
v_mfma_f32_16x16x32_bf16 v[28:31], a[212:215], a[4:7], v[28:31]
v_mul_f32 v122, v114, v122
v_mul_f32 v249, v249, v115
v_mul_f32 v123, v115, v123
v_mfma_f32_16x16x32_bf16 v[136:139], a[212:215], a[8:11], v[136:139]
ds_read_b64_tr_b16 a[206:207], v227 offset:23360
v_exp_f32 v249, v249
v_mfma_f32_16x16x32_bf16 v[140:143], a[212:215], a[12:15], v[140:143]
s_waitcnt lgkmcnt(8)
v_mul_f32 v250, v250, v116
v_exp_f32 v250, v250
v_mfma_f32_16x16x32_bf16 v[16:19], a[216:219], a[16:19], v[16:19]
ds_read_b64_tr_b16 a[208:209], v227 offset:28736
v_mul_f32 v124, v116, v124
v_mul_f32 v251, v251, v117
v_mfma_f32_16x16x32_bf16 v[20:23], a[216:219], a[20:23], v[20:23]
v_exp_f32 v251, v251
v_mul_f32 v125, v117, v125
v_mfma_f32_16x16x32_bf16 v[128:131], a[216:219], a[24:27], v[128:131]
ds_read_b64_tr_b16 a[210:211], v227 offset:30528
v_mul_f32 v252, v252, v118
v_mul_f32 v126, v118, v126
v_mfma_f32_16x16x32_bf16 v[132:135], a[216:219], a[28:31], v[132:135]
v_exp_f32 v252, v252
v_mul_f32 v253, v253, v119
v_mfma_f32_16x16x32_bf16 v[24:27], a[220:223], a[16:19], v[24:27]
ds_read_b64_tr_b16 a[212:213], v227 offset:43072
v_exp_f32 v253, v253
v_mfma_f32_16x16x32_bf16 v[28:31], a[220:223], a[20:23], v[28:31]
v_mul_f32 v127, v119, v127
v_add_f32 v246, 1.0, v246
v_add_f32 v247, 1.0, v247
v_mfma_f32_16x16x32_bf16 v[136:139], a[220:223], a[24:27], v[136:139]
ds_read_b64_tr_b16 a[214:215], v227 offset:44864
v_rcp_f32 v246, v246
v_mfma_f32_16x16x32_bf16 v[140:143], a[220:223], a[28:31], v[140:143]
s_waitcnt lgkmcnt(8)
v_rcp_f32 v247, v247
v_add_f32 v248, 1.0, v248
v_mfma_f32_16x16x32_bf16 v[32:35], a[192:195], a[64:67], v[32:35]
ds_read_b64_tr_b16 a[216:217], v227 offset:35904
v_rcp_f32 v248, v248
v_mfma_f32_16x16x32_bf16 v[36:39], a[192:195], a[68:71], v[36:39]
v_add_f32 v249, 1.0, v249
v_rcp_f32 v249, v249
v_mfma_f32_16x16x32_bf16 v[144:147], a[192:195], a[72:75], v[144:147]
ds_read_b64_tr_b16 a[218:219], v227 offset:37696
v_mul_f32 v112, v120, v246
v_add_f32 v250, 1.0, v250
v_mfma_f32_16x16x32_bf16 v[148:151], a[192:195], a[76:79], v[148:151]
v_rcp_f32 v250, v250
v_mul_f32 v113, v121, v247
v_mfma_f32_16x16x32_bf16 v[40:43], a[196:199], a[64:67], v[40:43]
ds_read_b64_tr_b16 a[220:221], v227 offset:50240
v_add_f32 v251, 1.0, v251
v_mul_f32 v114, v122, v248
v_mfma_f32_16x16x32_bf16 v[44:47], a[196:199], a[68:71], v[44:47]
v_rcp_f32 v251, v251
v_add_f32 v252, 1.0, v252
v_mfma_f32_16x16x32_bf16 v[152:155], a[196:199], a[72:75], v[152:155]
ds_read_b64_tr_b16 a[222:223], v227 offset:52032
v_rcp_f32 v252, v252
v_mfma_f32_16x16x32_bf16 v[156:159], a[196:199], a[76:79], v[156:159]
s_waitcnt lgkmcnt(8)
v_mul_f32 v115, v123, v249
v_add_f32 v253, 1.0, v253
v_mul_f32 v116, v124, v250
v_mfma_f32_16x16x32_bf16 v[32:35], a[200:203], a[80:83], v[32:35]
ds_read_b64_tr_b16 a[192:193], v228 offset:64
v_rcp_f32 v253, v253
v_mfma_f32_16x16x32_bf16 v[36:39], a[200:203], a[84:87], v[36:39]
v_mul_f32 v117, v125, v251
v_mul_f32 v118, v126, v252
v_mul_f32 v119, v127, v253
v_mfma_f32_16x16x32_bf16 v[144:147], a[200:203], a[88:91], v[144:147]
ds_read_b64_tr_b16 a[194:195], v228 offset:1856
v_cvt_pk_bf16_f32 v120, v112, v113
v_cvt_pk_bf16_f32 v121, v114, v115
v_mfma_f32_16x16x32_bf16 v[148:151], a[200:203], a[92:95], v[148:151]
v_cvt_pk_bf16_f32 v122, v116, v117
v_cvt_pk_bf16_f32 v123, v118, v119
s_nop 1
v_mfma_f32_16x16x32_bf16 v[40:43], a[204:207], a[80:83], v[40:43]
ds_read_b64_tr_b16 a[196:197], v228 offset:14400
v_permlane16_swap_b32 v120, v122
v_permlane16_swap_b32 v121, v123
v_mfma_f32_16x16x32_bf16 v[44:47], a[204:207], a[84:87], v[44:47]
buffer_store_dwordx4 v[120:123], v225, s[20:23], s45 offen offset:0 sc1
v_mfma_f32_16x16x32_bf16 v[152:155], a[204:207], a[88:91], v[152:155]
ds_read_b64_tr_b16 a[198:199], v228 offset:16192
v_mul_f32 v238, v16, v16
v_mul_f32 v239, v17, v17
v_mfma_f32_16x16x32_bf16 v[156:159], a[204:207], a[92:95], v[156:159]
s_waitcnt lgkmcnt(8)
v_mul_f32 v240, v18, v18
v_mul_f32 v241, v19, v19
v_mul_f32 v242, v20, v20
v_mfma_f32_16x16x32_bf16 v[32:35], a[208:211], a[96:99], v[32:35]
ds_read_b64_tr_b16 a[200:201], v228 offset:7232
v_mul_f32 v243, v21, v21
v_mul_f32 v244, v22, v22
v_mfma_f32_16x16x32_bf16 v[36:39], a[208:211], a[100:103], v[36:39]
v_mul_f32 v245, v23, v23
v_fma_f32 v238, v238, s51, v237
v_fma_f32 v239, v239, s51, v237
v_mfma_f32_16x16x32_bf16 v[144:147], a[208:211], a[104:107], v[144:147]
ds_read_b64_tr_b16 a[202:203], v228 offset:9024
v_fma_f32 v240, v240, s51, v237
v_fma_f32 v241, v241, s51, v237
v_mfma_f32_16x16x32_bf16 v[148:151], a[208:211], a[108:111], v[148:151]
v_fma_f32 v242, v242, s51, v237
v_fma_f32 v243, v243, s51, v237
v_fma_f32 v244, v244, s51, v237
v_mfma_f32_16x16x32_bf16 v[40:43], a[212:215], a[96:99], v[40:43]
ds_read_b64_tr_b16 a[204:205], v228 offset:21568
v_fma_f32 v245, v245, s51, v237
v_mul_f32 v238, v238, v16
v_mfma_f32_16x16x32_bf16 v[44:47], a[212:215], a[100:103], v[44:47]
v_exp_f32 v238, v238
v_mul_f32 v24, v16, v24
v_mfma_f32_16x16x32_bf16 v[152:155], a[212:215], a[104:107], v[152:155]
ds_read_b64_tr_b16 a[206:207], v228 offset:23360
v_mul_f32 v239, v239, v17
v_mul_f32 v25, v17, v25
v_mfma_f32_16x16x32_bf16 v[156:159], a[212:215], a[108:111], v[156:159]
s_waitcnt lgkmcnt(8)
v_exp_f32 v239, v239
v_mul_f32 v240, v240, v18
v_mfma_f32_16x16x32_bf16 v[32:35], a[216:219], a[112:115], v[32:35]
ds_read_b64_tr_b16 a[208:209], v226 offset:64
v_exp_f32 v240, v240
v_mfma_f32_16x16x32_bf16 v[36:39], a[216:219], a[116:119], v[36:39]
v_mul_f32 v26, v18, v26
v_mul_f32 v241, v241, v19
v_mul_f32 v27, v19, v27
v_mfma_f32_16x16x32_bf16 v[144:147], a[216:219], a[120:123], v[144:147]
ds_read_b64_tr_b16 a[210:211], v226 offset:1856
v_exp_f32 v241, v241
v_mfma_f32_16x16x32_bf16 v[148:151], a[216:219], a[124:127], v[148:151]
v_mul_f32 v242, v242, v20
v_exp_f32 v242, v242
v_mfma_f32_16x16x32_bf16 v[40:43], a[220:223], a[112:115], v[40:43]
ds_read_b64_tr_b16 a[212:213], v226 offset:14400
v_mul_f32 v28, v20, v28
v_mul_f32 v243, v243, v21
v_mfma_f32_16x16x32_bf16 v[44:47], a[220:223], a[116:119], v[44:47]
v_exp_f32 v243, v243
v_mul_f32 v29, v21, v29
v_mfma_f32_16x16x32_bf16 v[152:155], a[220:223], a[120:123], v[152:155]
ds_read_b64_tr_b16 a[214:215], v226 offset:16192
v_mul_f32 v244, v244, v22
v_mul_f32 v30, v22, v30
v_mfma_f32_16x16x32_bf16 v[156:159], a[220:223], a[124:127], v[156:159]
s_waitcnt lgkmcnt(8)
v_exp_f32 v244, v244
v_mul_f32 v245, v245, v23
v_mfma_f32_16x16x32_bf16 v[32:35], a[192:195], a[128:131], v[32:35]
ds_read_b64_tr_b16 a[216:217], v226 offset:7232
v_exp_f32 v245, v245
v_mfma_f32_16x16x32_bf16 v[36:39], a[192:195], a[132:135], v[36:39]
v_mul_f32 v31, v23, v31
v_add_f32 v238, 1.0, v238
v_add_f32 v239, 1.0, v239
v_mfma_f32_16x16x32_bf16 v[144:147], a[192:195], a[136:139], v[144:147]
ds_read_b64_tr_b16 a[218:219], v226 offset:9024
v_rcp_f32 v238, v238
v_mfma_f32_16x16x32_bf16 v[148:151], a[192:195], a[140:143], v[148:151]
v_rcp_f32 v239, v239
v_add_f32 v240, 1.0, v240
v_mfma_f32_16x16x32_bf16 v[40:43], a[196:199], a[128:131], v[40:43]
ds_read_b64_tr_b16 a[220:221], v226 offset:21568
v_rcp_f32 v240, v240
v_mfma_f32_16x16x32_bf16 v[44:47], a[196:199], a[132:135], v[44:47]
v_add_f32 v241, 1.0, v241
v_rcp_f32 v241, v241
v_mfma_f32_16x16x32_bf16 v[152:155], a[196:199], a[136:139], v[152:155]
ds_read_b64_tr_b16 a[222:223], v226 offset:23360
v_mul_f32 v16, v24, v238
v_add_f32 v242, 1.0, v242
v_mfma_f32_16x16x32_bf16 v[156:159], a[196:199], a[140:143], v[156:159]
s_waitcnt lgkmcnt(8)
v_rcp_f32 v242, v242
v_mul_f32 v17, v25, v239
v_mfma_f32_16x16x32_bf16 v[32:35], a[200:203], a[144:147], v[32:35]
ds_read_b64_tr_b16 a[192:193], v227 offset:96
v_add_f32 v243, 1.0, v243
v_mul_f32 v18, v26, v240
v_mfma_f32_16x16x32_bf16 v[36:39], a[200:203], a[148:151], v[36:39]
v_rcp_f32 v243, v243
v_add_f32 v244, 1.0, v244
v_mfma_f32_16x16x32_bf16 v[144:147], a[200:203], a[152:155], v[144:147]
ds_read_b64_tr_b16 a[194:195], v227 offset:1888
v_rcp_f32 v244, v244
v_mfma_f32_16x16x32_bf16 v[148:151], a[200:203], a[156:159], v[148:151]
v_mul_f32 v19, v27, v241
v_add_f32 v245, 1.0, v245
v_mul_f32 v20, v28, v242
v_mfma_f32_16x16x32_bf16 v[40:43], a[204:207], a[144:147], v[40:43]
ds_read_b64_tr_b16 a[196:197], v227 offset:14432
v_rcp_f32 v245, v245
v_mfma_f32_16x16x32_bf16 v[44:47], a[204:207], a[148:151], v[44:47]
v_mul_f32 v21, v29, v243
v_mul_f32 v22, v30, v244
v_mul_f32 v23, v31, v245
v_mfma_f32_16x16x32_bf16 v[152:155], a[204:207], a[152:155], v[152:155]
ds_read_b64_tr_b16 a[198:199], v227 offset:16224
v_cvt_pk_bf16_f32 v24, v16, v17
v_cvt_pk_bf16_f32 v25, v18, v19
v_mfma_f32_16x16x32_bf16 v[156:159], a[204:207], a[156:159], v[156:159]
s_waitcnt lgkmcnt(8)
v_cvt_pk_bf16_f32 v26, v20, v21
v_cvt_pk_bf16_f32 v27, v22, v23
s_nop 1
v_mfma_f32_16x16x32_bf16 v[32:35], a[208:211], a[0:3], v[32:35]
ds_read_b64_tr_b16 a[200:201], v227 offset:7264
v_permlane16_swap_b32 v24, v26
v_permlane16_swap_b32 v25, v27
v_mfma_f32_16x16x32_bf16 v[36:39], a[208:211], a[4:7], v[36:39]
buffer_store_dwordx4 v[24:27], v225, s[20:23], s44 offen offset:1024 sc1
v_mfma_f32_16x16x32_bf16 v[144:147], a[208:211], a[8:11], v[144:147]
ds_read_b64_tr_b16 a[202:203], v227 offset:9056
v_mul_f32 v246, v128, v128
v_mul_f32 v247, v129, v129
v_mfma_f32_16x16x32_bf16 v[148:151], a[208:211], a[12:15], v[148:151]
v_mul_f32 v248, v130, v130
v_mul_f32 v249, v131, v131
v_mul_f32 v250, v132, v132
v_mfma_f32_16x16x32_bf16 v[40:43], a[212:215], a[0:3], v[40:43]
ds_read_b64_tr_b16 a[204:205], v227 offset:21600
v_mul_f32 v251, v133, v133
v_mul_f32 v252, v134, v134
v_mfma_f32_16x16x32_bf16 v[44:47], a[212:215], a[4:7], v[44:47]
v_mul_f32 v253, v135, v135
v_fma_f32 v246, v246, s51, v237
v_fma_f32 v247, v247, s51, v237
v_mfma_f32_16x16x32_bf16 v[152:155], a[212:215], a[8:11], v[152:155]
ds_read_b64_tr_b16 a[206:207], v227 offset:23392
v_fma_f32 v248, v248, s51, v237
v_fma_f32 v249, v249, s51, v237
v_mfma_f32_16x16x32_bf16 v[156:159], a[212:215], a[12:15], v[156:159]
s_waitcnt lgkmcnt(8)
v_fma_f32 v250, v250, s51, v237
v_fma_f32 v251, v251, s51, v237
v_fma_f32 v252, v252, s51, v237
v_mfma_f32_16x16x32_bf16 v[32:35], a[216:219], a[16:19], v[32:35]
ds_read_b64_tr_b16 a[208:209], v227 offset:28768
v_fma_f32 v253, v253, s51, v237
v_mul_f32 v246, v246, v128
v_mfma_f32_16x16x32_bf16 v[36:39], a[216:219], a[20:23], v[36:39]
v_exp_f32 v246, v246
v_mul_f32 v136, v128, v136
v_mfma_f32_16x16x32_bf16 v[144:147], a[216:219], a[24:27], v[144:147]
ds_read_b64_tr_b16 a[210:211], v227 offset:30560
v_mul_f32 v247, v247, v129
v_mul_f32 v137, v129, v137
v_mfma_f32_16x16x32_bf16 v[148:151], a[216:219], a[28:31], v[148:151]
v_exp_f32 v247, v247
v_mul_f32 v248, v248, v130
v_mfma_f32_16x16x32_bf16 v[40:43], a[220:223], a[16:19], v[40:43]
ds_read_b64_tr_b16 a[212:213], v227 offset:43104
v_exp_f32 v248, v248
v_mfma_f32_16x16x32_bf16 v[44:47], a[220:223], a[20:23], v[44:47]
v_mul_f32 v138, v130, v138
v_mul_f32 v249, v249, v131
v_mul_f32 v139, v131, v139
v_mfma_f32_16x16x32_bf16 v[152:155], a[220:223], a[24:27], v[152:155]
ds_read_b64_tr_b16 a[214:215], v227 offset:44896
v_exp_f32 v249, v249
v_mfma_f32_16x16x32_bf16 v[156:159], a[220:223], a[28:31], v[156:159]
s_waitcnt lgkmcnt(8)
v_mul_f32 v250, v250, v132
v_exp_f32 v250, v250
v_mfma_f32_16x16x32_bf16 v[48:51], a[192:195], a[64:67], v[48:51]
ds_read_b64_tr_b16 a[216:217], v227 offset:35936
v_mul_f32 v140, v132, v140
v_mul_f32 v251, v251, v133
v_mfma_f32_16x16x32_bf16 v[52:55], a[192:195], a[68:71], v[52:55]
v_exp_f32 v251, v251
v_mul_f32 v141, v133, v141
v_mfma_f32_16x16x32_bf16 v[160:163], a[192:195], a[72:75], v[160:163]
ds_read_b64_tr_b16 a[218:219], v227 offset:37728
v_mul_f32 v252, v252, v134
v_mul_f32 v142, v134, v142
v_mfma_f32_16x16x32_bf16 v[164:167], a[192:195], a[76:79], v[164:167]
v_exp_f32 v252, v252
v_mul_f32 v253, v253, v135
v_mfma_f32_16x16x32_bf16 v[56:59], a[196:199], a[64:67], v[56:59]
ds_read_b64_tr_b16 a[220:221], v227 offset:50272
v_exp_f32 v253, v253
v_mfma_f32_16x16x32_bf16 v[60:63], a[196:199], a[68:71], v[60:63]
v_mul_f32 v143, v135, v143
v_add_f32 v246, 1.0, v246
v_add_f32 v247, 1.0, v247
v_mfma_f32_16x16x32_bf16 v[168:171], a[196:199], a[72:75], v[168:171]
ds_read_b64_tr_b16 a[222:223], v227 offset:52064
v_rcp_f32 v246, v246
v_mfma_f32_16x16x32_bf16 v[172:175], a[196:199], a[76:79], v[172:175]
s_waitcnt lgkmcnt(8)
v_rcp_f32 v247, v247
v_add_f32 v248, 1.0, v248
v_mfma_f32_16x16x32_bf16 v[48:51], a[200:203], a[80:83], v[48:51]
ds_read_b64_tr_b16 a[192:193], v228 offset:96
v_rcp_f32 v248, v248
v_mfma_f32_16x16x32_bf16 v[52:55], a[200:203], a[84:87], v[52:55]
v_add_f32 v249, 1.0, v249
v_rcp_f32 v249, v249
v_mfma_f32_16x16x32_bf16 v[160:163], a[200:203], a[88:91], v[160:163]
ds_read_b64_tr_b16 a[194:195], v228 offset:1888
v_mul_f32 v128, v136, v246
v_add_f32 v250, 1.0, v250
v_mfma_f32_16x16x32_bf16 v[164:167], a[200:203], a[92:95], v[164:167]
v_rcp_f32 v250, v250
v_mul_f32 v129, v137, v247
v_mfma_f32_16x16x32_bf16 v[56:59], a[204:207], a[80:83], v[56:59]
ds_read_b64_tr_b16 a[196:197], v228 offset:14432
v_add_f32 v251, 1.0, v251
v_mul_f32 v130, v138, v248
v_mfma_f32_16x16x32_bf16 v[60:63], a[204:207], a[84:87], v[60:63]
v_rcp_f32 v251, v251
v_add_f32 v252, 1.0, v252
v_mfma_f32_16x16x32_bf16 v[168:171], a[204:207], a[88:91], v[168:171]
ds_read_b64_tr_b16 a[198:199], v228 offset:16224
v_rcp_f32 v252, v252
v_mfma_f32_16x16x32_bf16 v[172:175], a[204:207], a[92:95], v[172:175]
s_waitcnt lgkmcnt(8)
v_mul_f32 v131, v139, v249
v_add_f32 v253, 1.0, v253
v_mul_f32 v132, v140, v250
v_mfma_f32_16x16x32_bf16 v[48:51], a[208:211], a[96:99], v[48:51]
ds_read_b64_tr_b16 a[200:201], v228 offset:7264
v_rcp_f32 v253, v253
v_mfma_f32_16x16x32_bf16 v[52:55], a[208:211], a[100:103], v[52:55]
v_mul_f32 v133, v141, v251
v_mul_f32 v134, v142, v252
v_mul_f32 v135, v143, v253
v_mfma_f32_16x16x32_bf16 v[160:163], a[208:211], a[104:107], v[160:163]
ds_read_b64_tr_b16 a[202:203], v228 offset:9056
v_cvt_pk_bf16_f32 v136, v128, v129
v_cvt_pk_bf16_f32 v137, v130, v131
v_mfma_f32_16x16x32_bf16 v[164:167], a[208:211], a[108:111], v[164:167]
v_cvt_pk_bf16_f32 v138, v132, v133
v_cvt_pk_bf16_f32 v139, v134, v135
s_nop 1
v_mfma_f32_16x16x32_bf16 v[56:59], a[212:215], a[96:99], v[56:59]
ds_read_b64_tr_b16 a[204:205], v228 offset:21600
v_permlane16_swap_b32 v136, v138
v_permlane16_swap_b32 v137, v139
v_mfma_f32_16x16x32_bf16 v[60:63], a[212:215], a[100:103], v[60:63]
buffer_store_dwordx4 v[136:139], v225, s[20:23], s45 offen offset:1024 sc1
v_mfma_f32_16x16x32_bf16 v[168:171], a[212:215], a[104:107], v[168:171]
ds_read_b64_tr_b16 a[206:207], v228 offset:23392
v_mul_f32 v238, v32, v32
v_mul_f32 v239, v33, v33
v_mfma_f32_16x16x32_bf16 v[172:175], a[212:215], a[108:111], v[172:175]
s_waitcnt lgkmcnt(8)
v_mul_f32 v240, v34, v34
v_mul_f32 v241, v35, v35
v_mul_f32 v242, v36, v36
v_mfma_f32_16x16x32_bf16 v[48:51], a[216:219], a[112:115], v[48:51]
ds_read_b64_tr_b16 a[208:209], v226 offset:96
v_mul_f32 v243, v37, v37
v_mul_f32 v244, v38, v38
v_mfma_f32_16x16x32_bf16 v[52:55], a[216:219], a[116:119], v[52:55]
v_mul_f32 v245, v39, v39
v_fma_f32 v238, v238, s51, v237
v_fma_f32 v239, v239, s51, v237
v_mfma_f32_16x16x32_bf16 v[160:163], a[216:219], a[120:123], v[160:163]
ds_read_b64_tr_b16 a[210:211], v226 offset:1888
v_fma_f32 v240, v240, s51, v237
v_fma_f32 v241, v241, s51, v237
v_mfma_f32_16x16x32_bf16 v[164:167], a[216:219], a[124:127], v[164:167]
v_fma_f32 v242, v242, s51, v237
v_fma_f32 v243, v243, s51, v237
v_fma_f32 v244, v244, s51, v237
v_mfma_f32_16x16x32_bf16 v[56:59], a[220:223], a[112:115], v[56:59]
ds_read_b64_tr_b16 a[212:213], v226 offset:14432
v_fma_f32 v245, v245, s51, v237
v_mul_f32 v238, v238, v32
v_mfma_f32_16x16x32_bf16 v[60:63], a[220:223], a[116:119], v[60:63]
v_exp_f32 v238, v238
v_mul_f32 v40, v32, v40
v_mfma_f32_16x16x32_bf16 v[168:171], a[220:223], a[120:123], v[168:171]
ds_read_b64_tr_b16 a[214:215], v226 offset:16224
v_mul_f32 v239, v239, v33
v_mul_f32 v41, v33, v41
v_mfma_f32_16x16x32_bf16 v[172:175], a[220:223], a[124:127], v[172:175]
s_waitcnt lgkmcnt(8)
v_exp_f32 v239, v239
v_mul_f32 v240, v240, v34
v_mfma_f32_16x16x32_bf16 v[48:51], a[192:195], a[128:131], v[48:51]
ds_read_b64_tr_b16 a[216:217], v226 offset:7264
v_exp_f32 v240, v240
v_mfma_f32_16x16x32_bf16 v[52:55], a[192:195], a[132:135], v[52:55]
v_mul_f32 v42, v34, v42
v_mul_f32 v241, v241, v35
v_mul_f32 v43, v35, v43
v_mfma_f32_16x16x32_bf16 v[160:163], a[192:195], a[136:139], v[160:163]
ds_read_b64_tr_b16 a[218:219], v226 offset:9056
v_exp_f32 v241, v241
v_mfma_f32_16x16x32_bf16 v[164:167], a[192:195], a[140:143], v[164:167]
v_mul_f32 v242, v242, v36
v_exp_f32 v242, v242
v_mfma_f32_16x16x32_bf16 v[56:59], a[196:199], a[128:131], v[56:59]
ds_read_b64_tr_b16 a[220:221], v226 offset:21600
v_mul_f32 v44, v36, v44
v_mul_f32 v243, v243, v37
v_mfma_f32_16x16x32_bf16 v[60:63], a[196:199], a[132:135], v[60:63]
v_exp_f32 v243, v243
v_mul_f32 v45, v37, v45
v_mfma_f32_16x16x32_bf16 v[168:171], a[196:199], a[136:139], v[168:171]
ds_read_b64_tr_b16 a[222:223], v226 offset:23392
v_mul_f32 v244, v244, v38
v_mul_f32 v46, v38, v46
v_mfma_f32_16x16x32_bf16 v[172:175], a[196:199], a[140:143], v[172:175]
s_waitcnt lgkmcnt(8)
v_exp_f32 v244, v244
v_mul_f32 v245, v245, v39
v_mfma_f32_16x16x32_bf16 v[48:51], a[200:203], a[144:147], v[48:51]
ds_read_b64_tr_b16 a[192:193], v227 offset:128
v_exp_f32 v245, v245
v_mfma_f32_16x16x32_bf16 v[52:55], a[200:203], a[148:151], v[52:55]
v_mul_f32 v47, v39, v47
v_add_f32 v238, 1.0, v238
v_add_f32 v239, 1.0, v239
v_mfma_f32_16x16x32_bf16 v[160:163], a[200:203], a[152:155], v[160:163]
ds_read_b64_tr_b16 a[194:195], v227 offset:1920
v_rcp_f32 v238, v238
v_mfma_f32_16x16x32_bf16 v[164:167], a[200:203], a[156:159], v[164:167]
v_rcp_f32 v239, v239
v_add_f32 v240, 1.0, v240
v_mfma_f32_16x16x32_bf16 v[56:59], a[204:207], a[144:147], v[56:59]
ds_read_b64_tr_b16 a[196:197], v227 offset:14464
v_rcp_f32 v240, v240
v_mfma_f32_16x16x32_bf16 v[60:63], a[204:207], a[148:151], v[60:63]
v_add_f32 v241, 1.0, v241
v_rcp_f32 v241, v241
v_mfma_f32_16x16x32_bf16 v[168:171], a[204:207], a[152:155], v[168:171]
ds_read_b64_tr_b16 a[198:199], v227 offset:16256
v_mul_f32 v32, v40, v238
v_add_f32 v242, 1.0, v242
v_mfma_f32_16x16x32_bf16 v[172:175], a[204:207], a[156:159], v[172:175]
s_waitcnt lgkmcnt(8)
v_rcp_f32 v242, v242
v_mul_f32 v33, v41, v239
v_mfma_f32_16x16x32_bf16 v[48:51], a[208:211], a[0:3], v[48:51]
ds_read_b64_tr_b16 a[200:201], v227 offset:7296
v_add_f32 v243, 1.0, v243
v_mul_f32 v34, v42, v240
v_mfma_f32_16x16x32_bf16 v[52:55], a[208:211], a[4:7], v[52:55]
v_rcp_f32 v243, v243
v_add_f32 v244, 1.0, v244
v_mfma_f32_16x16x32_bf16 v[160:163], a[208:211], a[8:11], v[160:163]
ds_read_b64_tr_b16 a[202:203], v227 offset:9088
v_rcp_f32 v244, v244
v_mfma_f32_16x16x32_bf16 v[164:167], a[208:211], a[12:15], v[164:167]
v_mul_f32 v35, v43, v241
v_add_f32 v245, 1.0, v245
v_mul_f32 v36, v44, v242
v_mfma_f32_16x16x32_bf16 v[56:59], a[212:215], a[0:3], v[56:59]
ds_read_b64_tr_b16 a[204:205], v227 offset:21632
v_rcp_f32 v245, v245
v_mfma_f32_16x16x32_bf16 v[60:63], a[212:215], a[4:7], v[60:63]
v_mul_f32 v37, v45, v243
v_mul_f32 v38, v46, v244
v_mul_f32 v39, v47, v245
v_mfma_f32_16x16x32_bf16 v[168:171], a[212:215], a[8:11], v[168:171]
ds_read_b64_tr_b16 a[206:207], v227 offset:23424
v_cvt_pk_bf16_f32 v40, v32, v33
v_cvt_pk_bf16_f32 v41, v34, v35
v_mfma_f32_16x16x32_bf16 v[172:175], a[212:215], a[12:15], v[172:175]
s_waitcnt lgkmcnt(8)
v_cvt_pk_bf16_f32 v42, v36, v37
v_cvt_pk_bf16_f32 v43, v38, v39
s_nop 1
v_mfma_f32_16x16x32_bf16 v[48:51], a[216:219], a[16:19], v[48:51]
ds_read_b64_tr_b16 a[208:209], v227 offset:28800
v_permlane16_swap_b32 v40, v42
v_permlane16_swap_b32 v41, v43
v_mfma_f32_16x16x32_bf16 v[52:55], a[216:219], a[20:23], v[52:55]
buffer_store_dwordx4 v[40:43], v225, s[20:23], s44 offen offset:2048 sc1
v_mfma_f32_16x16x32_bf16 v[160:163], a[216:219], a[24:27], v[160:163]
ds_read_b64_tr_b16 a[210:211], v227 offset:30592
v_mul_f32 v246, v144, v144
v_mul_f32 v247, v145, v145
v_mfma_f32_16x16x32_bf16 v[164:167], a[216:219], a[28:31], v[164:167]
v_mul_f32 v248, v146, v146
v_mul_f32 v249, v147, v147
v_mul_f32 v250, v148, v148
v_mfma_f32_16x16x32_bf16 v[56:59], a[220:223], a[16:19], v[56:59]
ds_read_b64_tr_b16 a[212:213], v227 offset:43136
v_mul_f32 v251, v149, v149
v_mul_f32 v252, v150, v150
v_mfma_f32_16x16x32_bf16 v[60:63], a[220:223], a[20:23], v[60:63]
v_mul_f32 v253, v151, v151
v_fma_f32 v246, v246, s51, v237
v_fma_f32 v247, v247, s51, v237
v_mfma_f32_16x16x32_bf16 v[168:171], a[220:223], a[24:27], v[168:171]
ds_read_b64_tr_b16 a[214:215], v227 offset:44928
v_fma_f32 v248, v248, s51, v237
v_fma_f32 v249, v249, s51, v237
v_mfma_f32_16x16x32_bf16 v[172:175], a[220:223], a[28:31], v[172:175]
s_waitcnt lgkmcnt(8)
v_fma_f32 v250, v250, s51, v237
v_fma_f32 v251, v251, s51, v237
v_fma_f32 v252, v252, s51, v237
v_mfma_f32_16x16x32_bf16 v[64:67], a[192:195], a[64:67], v[64:67]
ds_read_b64_tr_b16 a[216:217], v227 offset:35968
v_fma_f32 v253, v253, s51, v237
v_mul_f32 v246, v246, v144
v_mfma_f32_16x16x32_bf16 v[68:71], a[192:195], a[68:71], v[68:71]
v_exp_f32 v246, v246
v_mul_f32 v152, v144, v152
v_mfma_f32_16x16x32_bf16 v[176:179], a[192:195], a[72:75], v[176:179]
ds_read_b64_tr_b16 a[218:219], v227 offset:37760
v_mul_f32 v247, v247, v145
v_mul_f32 v153, v145, v153
v_mfma_f32_16x16x32_bf16 v[180:183], a[192:195], a[76:79], v[180:183]
v_exp_f32 v247, v247
v_mul_f32 v248, v248, v146
v_mfma_f32_16x16x32_bf16 v[72:75], a[196:199], a[64:67], v[72:75]
ds_read_b64_tr_b16 a[220:221], v227 offset:50304
v_exp_f32 v248, v248
v_mfma_f32_16x16x32_bf16 v[76:79], a[196:199], a[68:71], v[76:79]
v_mul_f32 v154, v146, v154
v_mul_f32 v249, v249, v147
v_mul_f32 v155, v147, v155
v_mfma_f32_16x16x32_bf16 v[184:187], a[196:199], a[72:75], v[184:187]
ds_read_b64_tr_b16 a[222:223], v227 offset:52096
v_exp_f32 v249, v249
v_mfma_f32_16x16x32_bf16 v[188:191], a[196:199], a[76:79], v[188:191]
s_waitcnt lgkmcnt(8)
v_mul_f32 v250, v250, v148
v_exp_f32 v250, v250
v_mfma_f32_16x16x32_bf16 v[64:67], a[200:203], a[80:83], v[64:67]
ds_read_b64_tr_b16 a[192:193], v228 offset:128
v_mul_f32 v156, v148, v156
v_mul_f32 v251, v251, v149
v_mfma_f32_16x16x32_bf16 v[68:71], a[200:203], a[84:87], v[68:71]
v_exp_f32 v251, v251
v_mul_f32 v157, v149, v157
v_mfma_f32_16x16x32_bf16 v[176:179], a[200:203], a[88:91], v[176:179]
ds_read_b64_tr_b16 a[194:195], v228 offset:1920
v_mul_f32 v252, v252, v150
v_mul_f32 v158, v150, v158
v_mfma_f32_16x16x32_bf16 v[180:183], a[200:203], a[92:95], v[180:183]
v_exp_f32 v252, v252
v_mul_f32 v253, v253, v151
v_mfma_f32_16x16x32_bf16 v[72:75], a[204:207], a[80:83], v[72:75]
ds_read_b64_tr_b16 a[196:197], v228 offset:14464
v_exp_f32 v253, v253
v_mfma_f32_16x16x32_bf16 v[76:79], a[204:207], a[84:87], v[76:79]
v_mul_f32 v159, v151, v159
v_add_f32 v246, 1.0, v246
v_add_f32 v247, 1.0, v247
v_mfma_f32_16x16x32_bf16 v[184:187], a[204:207], a[88:91], v[184:187]
ds_read_b64_tr_b16 a[198:199], v228 offset:16256
v_rcp_f32 v246, v246
v_mfma_f32_16x16x32_bf16 v[188:191], a[204:207], a[92:95], v[188:191]
s_waitcnt lgkmcnt(8)
v_rcp_f32 v247, v247
v_add_f32 v248, 1.0, v248
v_mfma_f32_16x16x32_bf16 v[64:67], a[208:211], a[96:99], v[64:67]
ds_read_b64_tr_b16 a[200:201], v228 offset:7296
v_rcp_f32 v248, v248
v_mfma_f32_16x16x32_bf16 v[68:71], a[208:211], a[100:103], v[68:71]
v_add_f32 v249, 1.0, v249
v_rcp_f32 v249, v249
v_mfma_f32_16x16x32_bf16 v[176:179], a[208:211], a[104:107], v[176:179]
ds_read_b64_tr_b16 a[202:203], v228 offset:9088
v_mul_f32 v144, v152, v246
v_add_f32 v250, 1.0, v250
v_mfma_f32_16x16x32_bf16 v[180:183], a[208:211], a[108:111], v[180:183]
v_rcp_f32 v250, v250
v_mul_f32 v145, v153, v247
v_mfma_f32_16x16x32_bf16 v[72:75], a[212:215], a[96:99], v[72:75]
ds_read_b64_tr_b16 a[204:205], v228 offset:21632
v_add_f32 v251, 1.0, v251
v_mul_f32 v146, v154, v248
v_mfma_f32_16x16x32_bf16 v[76:79], a[212:215], a[100:103], v[76:79]
v_rcp_f32 v251, v251
v_add_f32 v252, 1.0, v252
v_mfma_f32_16x16x32_bf16 v[184:187], a[212:215], a[104:107], v[184:187]
ds_read_b64_tr_b16 a[206:207], v228 offset:23424
v_rcp_f32 v252, v252
v_mfma_f32_16x16x32_bf16 v[188:191], a[212:215], a[108:111], v[188:191]
s_waitcnt lgkmcnt(8)
v_mul_f32 v147, v155, v249
v_add_f32 v253, 1.0, v253
v_mul_f32 v148, v156, v250
v_mfma_f32_16x16x32_bf16 v[64:67], a[216:219], a[112:115], v[64:67]
ds_read_b64_tr_b16 a[208:209], v226 offset:128
v_rcp_f32 v253, v253
v_mfma_f32_16x16x32_bf16 v[68:71], a[216:219], a[116:119], v[68:71]
v_mul_f32 v149, v157, v251
v_mul_f32 v150, v158, v252
v_mul_f32 v151, v159, v253
v_mfma_f32_16x16x32_bf16 v[176:179], a[216:219], a[120:123], v[176:179]
ds_read_b64_tr_b16 a[210:211], v226 offset:1920
v_cvt_pk_bf16_f32 v152, v144, v145
v_cvt_pk_bf16_f32 v153, v146, v147
v_mfma_f32_16x16x32_bf16 v[180:183], a[216:219], a[124:127], v[180:183]
v_cvt_pk_bf16_f32 v154, v148, v149
v_cvt_pk_bf16_f32 v155, v150, v151
s_nop 1
v_mfma_f32_16x16x32_bf16 v[72:75], a[220:223], a[112:115], v[72:75]
ds_read_b64_tr_b16 a[212:213], v226 offset:14464
v_permlane16_swap_b32 v152, v154
v_permlane16_swap_b32 v153, v155
v_mfma_f32_16x16x32_bf16 v[76:79], a[220:223], a[116:119], v[76:79]
buffer_store_dwordx4 v[152:155], v225, s[20:23], s45 offen offset:2048 sc1
v_mfma_f32_16x16x32_bf16 v[184:187], a[220:223], a[120:123], v[184:187]
ds_read_b64_tr_b16 a[214:215], v226 offset:16256
v_mul_f32 v238, v48, v48
v_mul_f32 v239, v49, v49
v_mfma_f32_16x16x32_bf16 v[188:191], a[220:223], a[124:127], v[188:191]
s_waitcnt lgkmcnt(8)
v_mul_f32 v240, v50, v50
v_mul_f32 v241, v51, v51
v_mul_f32 v242, v52, v52
v_mfma_f32_16x16x32_bf16 v[64:67], a[192:195], a[128:131], v[64:67]
ds_read_b64_tr_b16 a[216:217], v226 offset:7296
v_mul_f32 v243, v53, v53
v_mul_f32 v244, v54, v54
v_mfma_f32_16x16x32_bf16 v[68:71], a[192:195], a[132:135], v[68:71]
v_mul_f32 v245, v55, v55
v_fma_f32 v238, v238, s51, v237
v_fma_f32 v239, v239, s51, v237
v_mfma_f32_16x16x32_bf16 v[176:179], a[192:195], a[136:139], v[176:179]
ds_read_b64_tr_b16 a[218:219], v226 offset:9088
v_fma_f32 v240, v240, s51, v237
v_fma_f32 v241, v241, s51, v237
v_mfma_f32_16x16x32_bf16 v[180:183], a[192:195], a[140:143], v[180:183]
v_fma_f32 v242, v242, s51, v237
v_fma_f32 v243, v243, s51, v237
v_fma_f32 v244, v244, s51, v237
v_mfma_f32_16x16x32_bf16 v[72:75], a[196:199], a[128:131], v[72:75]
ds_read_b64_tr_b16 a[220:221], v226 offset:21632
v_fma_f32 v245, v245, s51, v237
v_mul_f32 v238, v238, v48
v_mfma_f32_16x16x32_bf16 v[76:79], a[196:199], a[132:135], v[76:79]
v_exp_f32 v238, v238
v_mul_f32 v56, v48, v56
v_mfma_f32_16x16x32_bf16 v[184:187], a[196:199], a[136:139], v[184:187]
ds_read_b64_tr_b16 a[222:223], v226 offset:23424
v_mul_f32 v239, v239, v49
v_mul_f32 v57, v49, v57
v_mfma_f32_16x16x32_bf16 v[188:191], a[196:199], a[140:143], v[188:191]
s_waitcnt lgkmcnt(8)
v_exp_f32 v239, v239
v_mul_f32 v240, v240, v50
v_mfma_f32_16x16x32_bf16 v[64:67], a[200:203], a[144:147], v[64:67]
ds_read_b64_tr_b16 a[192:193], v227 offset:160
v_exp_f32 v240, v240
v_mfma_f32_16x16x32_bf16 v[68:71], a[200:203], a[148:151], v[68:71]
v_mul_f32 v58, v50, v58
v_mul_f32 v241, v241, v51
v_mul_f32 v59, v51, v59
v_mfma_f32_16x16x32_bf16 v[176:179], a[200:203], a[152:155], v[176:179]
ds_read_b64_tr_b16 a[194:195], v227 offset:1952
v_exp_f32 v241, v241
v_mfma_f32_16x16x32_bf16 v[180:183], a[200:203], a[156:159], v[180:183]
v_mul_f32 v242, v242, v52
v_exp_f32 v242, v242
v_mfma_f32_16x16x32_bf16 v[72:75], a[204:207], a[144:147], v[72:75]
ds_read_b64_tr_b16 a[196:197], v227 offset:14496
v_mul_f32 v60, v52, v60
v_mul_f32 v243, v243, v53
v_mfma_f32_16x16x32_bf16 v[76:79], a[204:207], a[148:151], v[76:79]
v_exp_f32 v243, v243
v_mul_f32 v61, v53, v61
v_mfma_f32_16x16x32_bf16 v[184:187], a[204:207], a[152:155], v[184:187]
ds_read_b64_tr_b16 a[198:199], v227 offset:16288
v_mul_f32 v244, v244, v54
v_mul_f32 v62, v54, v62
v_mfma_f32_16x16x32_bf16 v[188:191], a[204:207], a[156:159], v[188:191]
s_waitcnt lgkmcnt(8)
v_exp_f32 v244, v244
v_mul_f32 v245, v245, v55
v_mfma_f32_16x16x32_bf16 v[64:67], a[208:211], a[0:3], v[64:67]
ds_read_b64_tr_b16 a[200:201], v227 offset:7328
v_exp_f32 v245, v245
v_mfma_f32_16x16x32_bf16 v[68:71], a[208:211], a[4:7], v[68:71]
v_mul_f32 v63, v55, v63
v_add_f32 v238, 1.0, v238
v_add_f32 v239, 1.0, v239
v_mfma_f32_16x16x32_bf16 v[176:179], a[208:211], a[8:11], v[176:179]
ds_read_b64_tr_b16 a[202:203], v227 offset:9120
v_rcp_f32 v238, v238
v_mfma_f32_16x16x32_bf16 v[180:183], a[208:211], a[12:15], v[180:183]
v_rcp_f32 v239, v239
v_add_f32 v240, 1.0, v240
v_mfma_f32_16x16x32_bf16 v[72:75], a[212:215], a[0:3], v[72:75]
ds_read_b64_tr_b16 a[204:205], v227 offset:21664
v_rcp_f32 v240, v240
v_mfma_f32_16x16x32_bf16 v[76:79], a[212:215], a[4:7], v[76:79]
v_add_f32 v241, 1.0, v241
v_rcp_f32 v241, v241
v_mfma_f32_16x16x32_bf16 v[184:187], a[212:215], a[8:11], v[184:187]
ds_read_b64_tr_b16 a[206:207], v227 offset:23456
v_mul_f32 v48, v56, v238
v_add_f32 v242, 1.0, v242
v_mfma_f32_16x16x32_bf16 v[188:191], a[212:215], a[12:15], v[188:191]
s_waitcnt lgkmcnt(8)
v_rcp_f32 v242, v242
v_mul_f32 v49, v57, v239
v_mfma_f32_16x16x32_bf16 v[64:67], a[216:219], a[16:19], v[64:67]
ds_read_b64_tr_b16 a[208:209], v227 offset:28832
v_add_f32 v243, 1.0, v243
v_mul_f32 v50, v58, v240
v_mfma_f32_16x16x32_bf16 v[68:71], a[216:219], a[20:23], v[68:71]
v_rcp_f32 v243, v243
v_add_f32 v244, 1.0, v244
v_mfma_f32_16x16x32_bf16 v[176:179], a[216:219], a[24:27], v[176:179]
ds_read_b64_tr_b16 a[210:211], v227 offset:30624
v_rcp_f32 v244, v244
v_mfma_f32_16x16x32_bf16 v[180:183], a[216:219], a[28:31], v[180:183]
v_mul_f32 v51, v59, v241
v_add_f32 v245, 1.0, v245
v_mul_f32 v52, v60, v242
v_mfma_f32_16x16x32_bf16 v[72:75], a[220:223], a[16:19], v[72:75]
ds_read_b64_tr_b16 a[212:213], v227 offset:43168
v_rcp_f32 v245, v245
v_mfma_f32_16x16x32_bf16 v[76:79], a[220:223], a[20:23], v[76:79]
v_mul_f32 v53, v61, v243
v_mul_f32 v54, v62, v244
v_mul_f32 v55, v63, v245
v_mfma_f32_16x16x32_bf16 v[184:187], a[220:223], a[24:27], v[184:187]
ds_read_b64_tr_b16 a[214:215], v227 offset:44960
v_cvt_pk_bf16_f32 v56, v48, v49
v_cvt_pk_bf16_f32 v57, v50, v51
v_mfma_f32_16x16x32_bf16 v[188:191], a[220:223], a[28:31], v[188:191]
s_waitcnt lgkmcnt(8)
v_cvt_pk_bf16_f32 v58, v52, v53
v_cvt_pk_bf16_f32 v59, v54, v55
s_nop 1
v_mfma_f32_16x16x32_bf16 v[80:83], a[192:195], a[64:67], v[80:83]
ds_read_b64_tr_b16 a[216:217], v227 offset:36000
v_permlane16_swap_b32 v56, v58
v_permlane16_swap_b32 v57, v59
v_mfma_f32_16x16x32_bf16 v[84:87], a[192:195], a[68:71], v[84:87]
buffer_store_dwordx4 v[56:59], v225, s[20:23], s44 offen offset:3072 sc1
v_mfma_f32_16x16x32_bf16 v[192:195], a[192:195], a[72:75], v[192:195]
ds_read_b64_tr_b16 a[218:219], v227 offset:37792
v_mul_f32 v246, v160, v160
v_mul_f32 v247, v161, v161
v_mfma_f32_16x16x32_bf16 v[196:199], a[192:195], a[76:79], v[196:199]
v_mul_f32 v248, v162, v162
v_mul_f32 v249, v163, v163
v_mul_f32 v250, v164, v164
v_mfma_f32_16x16x32_bf16 v[88:91], a[196:199], a[64:67], v[88:91]
ds_read_b64_tr_b16 a[220:221], v227 offset:50336
v_mul_f32 v251, v165, v165
v_mul_f32 v252, v166, v166
v_mfma_f32_16x16x32_bf16 v[92:95], a[196:199], a[68:71], v[92:95]
v_mul_f32 v253, v167, v167
v_fma_f32 v246, v246, s51, v237
v_fma_f32 v247, v247, s51, v237
v_mfma_f32_16x16x32_bf16 v[200:203], a[196:199], a[72:75], v[200:203]
ds_read_b64_tr_b16 a[222:223], v227 offset:52128
v_fma_f32 v248, v248, s51, v237
v_fma_f32 v249, v249, s51, v237
v_mfma_f32_16x16x32_bf16 v[204:207], a[196:199], a[76:79], v[204:207]
s_waitcnt lgkmcnt(8)
v_fma_f32 v250, v250, s51, v237
v_fma_f32 v251, v251, s51, v237
v_fma_f32 v252, v252, s51, v237
v_mfma_f32_16x16x32_bf16 v[80:83], a[200:203], a[80:83], v[80:83]
ds_read_b64_tr_b16 a[192:193], v228 offset:160
v_fma_f32 v253, v253, s51, v237
v_mul_f32 v246, v246, v160
v_mfma_f32_16x16x32_bf16 v[84:87], a[200:203], a[84:87], v[84:87]
v_exp_f32 v246, v246
v_mul_f32 v168, v160, v168
v_mfma_f32_16x16x32_bf16 v[192:195], a[200:203], a[88:91], v[192:195]
ds_read_b64_tr_b16 a[194:195], v228 offset:1952
v_mul_f32 v247, v247, v161
v_mul_f32 v169, v161, v169
v_mfma_f32_16x16x32_bf16 v[196:199], a[200:203], a[92:95], v[196:199]
v_exp_f32 v247, v247
v_mul_f32 v248, v248, v162
v_mfma_f32_16x16x32_bf16 v[88:91], a[204:207], a[80:83], v[88:91]
ds_read_b64_tr_b16 a[196:197], v228 offset:14496
v_exp_f32 v248, v248
v_mfma_f32_16x16x32_bf16 v[92:95], a[204:207], a[84:87], v[92:95]
v_mul_f32 v170, v162, v170
v_mul_f32 v249, v249, v163
v_mul_f32 v171, v163, v171
v_mfma_f32_16x16x32_bf16 v[200:203], a[204:207], a[88:91], v[200:203]
ds_read_b64_tr_b16 a[198:199], v228 offset:16288
v_exp_f32 v249, v249
v_mfma_f32_16x16x32_bf16 v[204:207], a[204:207], a[92:95], v[204:207]
s_waitcnt lgkmcnt(8)
v_mul_f32 v250, v250, v164
v_exp_f32 v250, v250
v_mfma_f32_16x16x32_bf16 v[80:83], a[208:211], a[96:99], v[80:83]
ds_read_b64_tr_b16 a[200:201], v228 offset:7328
v_mul_f32 v172, v164, v172
v_mul_f32 v251, v251, v165
v_mfma_f32_16x16x32_bf16 v[84:87], a[208:211], a[100:103], v[84:87]
v_exp_f32 v251, v251
v_mul_f32 v173, v165, v173
v_mfma_f32_16x16x32_bf16 v[192:195], a[208:211], a[104:107], v[192:195]
ds_read_b64_tr_b16 a[202:203], v228 offset:9120
v_mul_f32 v252, v252, v166
v_mul_f32 v174, v166, v174
v_mfma_f32_16x16x32_bf16 v[196:199], a[208:211], a[108:111], v[196:199]
v_exp_f32 v252, v252
v_mul_f32 v253, v253, v167
v_mfma_f32_16x16x32_bf16 v[88:91], a[212:215], a[96:99], v[88:91]
ds_read_b64_tr_b16 a[204:205], v228 offset:21664
v_exp_f32 v253, v253
v_mfma_f32_16x16x32_bf16 v[92:95], a[212:215], a[100:103], v[92:95]
v_mul_f32 v175, v167, v175
v_add_f32 v246, 1.0, v246
v_add_f32 v247, 1.0, v247
v_mfma_f32_16x16x32_bf16 v[200:203], a[212:215], a[104:107], v[200:203]
ds_read_b64_tr_b16 a[206:207], v228 offset:23456
v_rcp_f32 v246, v246
v_mfma_f32_16x16x32_bf16 v[204:207], a[212:215], a[108:111], v[204:207]
s_waitcnt lgkmcnt(8)
v_rcp_f32 v247, v247
v_add_f32 v248, 1.0, v248
v_mfma_f32_16x16x32_bf16 v[80:83], a[216:219], a[112:115], v[80:83]
ds_read_b64_tr_b16 a[208:209], v226 offset:160
v_rcp_f32 v248, v248
v_mfma_f32_16x16x32_bf16 v[84:87], a[216:219], a[116:119], v[84:87]
v_add_f32 v249, 1.0, v249
v_rcp_f32 v249, v249
v_mfma_f32_16x16x32_bf16 v[192:195], a[216:219], a[120:123], v[192:195]
ds_read_b64_tr_b16 a[210:211], v226 offset:1952
v_mul_f32 v160, v168, v246
v_add_f32 v250, 1.0, v250
v_mfma_f32_16x16x32_bf16 v[196:199], a[216:219], a[124:127], v[196:199]
v_rcp_f32 v250, v250
v_mul_f32 v161, v169, v247
v_mfma_f32_16x16x32_bf16 v[88:91], a[220:223], a[112:115], v[88:91]
ds_read_b64_tr_b16 a[212:213], v226 offset:14496
v_add_f32 v251, 1.0, v251
v_mul_f32 v162, v170, v248
v_mfma_f32_16x16x32_bf16 v[92:95], a[220:223], a[116:119], v[92:95]
v_rcp_f32 v251, v251
v_add_f32 v252, 1.0, v252
v_mfma_f32_16x16x32_bf16 v[200:203], a[220:223], a[120:123], v[200:203]
ds_read_b64_tr_b16 a[214:215], v226 offset:16288
v_rcp_f32 v252, v252
v_mfma_f32_16x16x32_bf16 v[204:207], a[220:223], a[124:127], v[204:207]
s_waitcnt lgkmcnt(8)
v_mul_f32 v163, v171, v249
v_add_f32 v253, 1.0, v253
v_mul_f32 v164, v172, v250
v_mfma_f32_16x16x32_bf16 v[80:83], a[192:195], a[128:131], v[80:83]
ds_read_b64_tr_b16 a[216:217], v226 offset:7328
v_rcp_f32 v253, v253
v_mfma_f32_16x16x32_bf16 v[84:87], a[192:195], a[132:135], v[84:87]
v_mul_f32 v165, v173, v251
v_mul_f32 v166, v174, v252
v_mul_f32 v167, v175, v253
v_mfma_f32_16x16x32_bf16 v[192:195], a[192:195], a[136:139], v[192:195]
ds_read_b64_tr_b16 a[218:219], v226 offset:9120
v_cvt_pk_bf16_f32 v168, v160, v161
v_cvt_pk_bf16_f32 v169, v162, v163
v_mfma_f32_16x16x32_bf16 v[196:199], a[192:195], a[140:143], v[196:199]
v_cvt_pk_bf16_f32 v170, v164, v165
v_cvt_pk_bf16_f32 v171, v166, v167
s_nop 1
v_mfma_f32_16x16x32_bf16 v[88:91], a[196:199], a[128:131], v[88:91]
ds_read_b64_tr_b16 a[220:221], v226 offset:21664
v_permlane16_swap_b32 v168, v170
v_permlane16_swap_b32 v169, v171
v_mfma_f32_16x16x32_bf16 v[92:95], a[196:199], a[132:135], v[92:95]
buffer_store_dwordx4 v[168:171], v225, s[20:23], s45 offen offset:3072 sc1
v_mfma_f32_16x16x32_bf16 v[200:203], a[196:199], a[136:139], v[200:203]
ds_read_b64_tr_b16 a[222:223], v226 offset:23456
v_mul_f32 v238, v64, v64
v_mul_f32 v239, v65, v65
v_mfma_f32_16x16x32_bf16 v[204:207], a[196:199], a[140:143], v[204:207]
s_waitcnt lgkmcnt(8)
v_mul_f32 v240, v66, v66
v_mul_f32 v241, v67, v67
v_mul_f32 v242, v68, v68
v_mfma_f32_16x16x32_bf16 v[80:83], a[200:203], a[144:147], v[80:83]
ds_read_b64_tr_b16 a[192:193], v227 offset:192
v_mul_f32 v243, v69, v69
v_mul_f32 v244, v70, v70
v_mfma_f32_16x16x32_bf16 v[84:87], a[200:203], a[148:151], v[84:87]
v_mul_f32 v245, v71, v71
v_fma_f32 v238, v238, s51, v237
v_fma_f32 v239, v239, s51, v237
v_mfma_f32_16x16x32_bf16 v[192:195], a[200:203], a[152:155], v[192:195]
ds_read_b64_tr_b16 a[194:195], v227 offset:1984
v_fma_f32 v240, v240, s51, v237
v_fma_f32 v241, v241, s51, v237
v_mfma_f32_16x16x32_bf16 v[196:199], a[200:203], a[156:159], v[196:199]
v_fma_f32 v242, v242, s51, v237
v_fma_f32 v243, v243, s51, v237
v_fma_f32 v244, v244, s51, v237
v_mfma_f32_16x16x32_bf16 v[88:91], a[204:207], a[144:147], v[88:91]
ds_read_b64_tr_b16 a[196:197], v227 offset:14528
v_fma_f32 v245, v245, s51, v237
v_mul_f32 v238, v238, v64
v_mfma_f32_16x16x32_bf16 v[92:95], a[204:207], a[148:151], v[92:95]
v_exp_f32 v238, v238
v_mul_f32 v72, v64, v72
v_mfma_f32_16x16x32_bf16 v[200:203], a[204:207], a[152:155], v[200:203]
ds_read_b64_tr_b16 a[198:199], v227 offset:16320
v_mul_f32 v239, v239, v65
v_mul_f32 v73, v65, v73
v_mfma_f32_16x16x32_bf16 v[204:207], a[204:207], a[156:159], v[204:207]
s_waitcnt lgkmcnt(8)
v_exp_f32 v239, v239
v_mul_f32 v240, v240, v66
v_mfma_f32_16x16x32_bf16 v[80:83], a[208:211], a[0:3], v[80:83]
ds_read_b64_tr_b16 a[200:201], v227 offset:7360
v_exp_f32 v240, v240
v_mfma_f32_16x16x32_bf16 v[84:87], a[208:211], a[4:7], v[84:87]
v_mul_f32 v74, v66, v74
v_mul_f32 v241, v241, v67
v_mul_f32 v75, v67, v75
v_mfma_f32_16x16x32_bf16 v[192:195], a[208:211], a[8:11], v[192:195]
ds_read_b64_tr_b16 a[202:203], v227 offset:9152
v_exp_f32 v241, v241
v_mfma_f32_16x16x32_bf16 v[196:199], a[208:211], a[12:15], v[196:199]
v_mul_f32 v242, v242, v68
v_exp_f32 v242, v242
v_mfma_f32_16x16x32_bf16 v[88:91], a[212:215], a[0:3], v[88:91]
ds_read_b64_tr_b16 a[204:205], v227 offset:21696
v_mul_f32 v76, v68, v76
v_mul_f32 v243, v243, v69
v_mfma_f32_16x16x32_bf16 v[92:95], a[212:215], a[4:7], v[92:95]
v_exp_f32 v243, v243
v_mul_f32 v77, v69, v77
v_mfma_f32_16x16x32_bf16 v[200:203], a[212:215], a[8:11], v[200:203]
ds_read_b64_tr_b16 a[206:207], v227 offset:23488
v_mul_f32 v244, v244, v70
v_mul_f32 v78, v70, v78
v_mfma_f32_16x16x32_bf16 v[204:207], a[212:215], a[12:15], v[204:207]
s_waitcnt lgkmcnt(8)
v_exp_f32 v244, v244
v_mul_f32 v245, v245, v71
v_mfma_f32_16x16x32_bf16 v[80:83], a[216:219], a[16:19], v[80:83]
ds_read_b64_tr_b16 a[208:209], v227 offset:28864
v_exp_f32 v245, v245
v_mfma_f32_16x16x32_bf16 v[84:87], a[216:219], a[20:23], v[84:87]
v_mul_f32 v79, v71, v79
v_add_f32 v238, 1.0, v238
v_add_f32 v239, 1.0, v239
v_mfma_f32_16x16x32_bf16 v[192:195], a[216:219], a[24:27], v[192:195]
ds_read_b64_tr_b16 a[210:211], v227 offset:30656
v_rcp_f32 v238, v238
v_mfma_f32_16x16x32_bf16 v[196:199], a[216:219], a[28:31], v[196:199]
v_rcp_f32 v239, v239
v_add_f32 v240, 1.0, v240
v_mfma_f32_16x16x32_bf16 v[88:91], a[220:223], a[16:19], v[88:91]
ds_read_b64_tr_b16 a[212:213], v227 offset:43200
v_rcp_f32 v240, v240
v_mfma_f32_16x16x32_bf16 v[92:95], a[220:223], a[20:23], v[92:95]
v_add_f32 v241, 1.0, v241
v_rcp_f32 v241, v241
v_mfma_f32_16x16x32_bf16 v[200:203], a[220:223], a[24:27], v[200:203]
ds_read_b64_tr_b16 a[214:215], v227 offset:44992
v_mul_f32 v64, v72, v238
v_add_f32 v242, 1.0, v242
v_mfma_f32_16x16x32_bf16 v[204:207], a[220:223], a[28:31], v[204:207]
s_waitcnt lgkmcnt(8)
v_rcp_f32 v242, v242
v_mul_f32 v65, v73, v239
v_mfma_f32_16x16x32_bf16 v[96:99], a[192:195], a[64:67], v[96:99]
ds_read_b64_tr_b16 a[216:217], v227 offset:36032
v_add_f32 v243, 1.0, v243
v_mul_f32 v66, v74, v240
v_mfma_f32_16x16x32_bf16 v[100:103], a[192:195], a[68:71], v[100:103]
v_rcp_f32 v243, v243
v_add_f32 v244, 1.0, v244
v_mfma_f32_16x16x32_bf16 v[208:211], a[192:195], a[72:75], v[208:211]
ds_read_b64_tr_b16 a[218:219], v227 offset:37824
v_rcp_f32 v244, v244
v_mfma_f32_16x16x32_bf16 v[212:215], a[192:195], a[76:79], v[212:215]
v_mul_f32 v67, v75, v241
v_add_f32 v245, 1.0, v245
v_mul_f32 v68, v76, v242
v_mfma_f32_16x16x32_bf16 v[104:107], a[196:199], a[64:67], v[104:107]
ds_read_b64_tr_b16 a[220:221], v227 offset:50368
v_rcp_f32 v245, v245
v_mfma_f32_16x16x32_bf16 v[108:111], a[196:199], a[68:71], v[108:111]
v_mul_f32 v69, v77, v243
v_mul_f32 v70, v78, v244
v_mul_f32 v71, v79, v245
v_mfma_f32_16x16x32_bf16 v[216:219], a[196:199], a[72:75], v[216:219]
ds_read_b64_tr_b16 a[222:223], v227 offset:52160
v_cvt_pk_bf16_f32 v72, v64, v65
v_cvt_pk_bf16_f32 v73, v66, v67
v_mfma_f32_16x16x32_bf16 v[220:223], a[196:199], a[76:79], v[220:223]
s_waitcnt lgkmcnt(8)
v_cvt_pk_bf16_f32 v74, v68, v69
v_cvt_pk_bf16_f32 v75, v70, v71
s_nop 1
v_mfma_f32_16x16x32_bf16 v[96:99], a[200:203], a[80:83], v[96:99]
ds_read_b64_tr_b16 a[192:193], v228 offset:192
v_permlane16_swap_b32 v72, v74
v_permlane16_swap_b32 v73, v75
v_mfma_f32_16x16x32_bf16 v[100:103], a[200:203], a[84:87], v[100:103]
buffer_store_dwordx4 v[72:75], v225, s[20:23], s47 offen offset:0 sc1
v_mfma_f32_16x16x32_bf16 v[208:211], a[200:203], a[88:91], v[208:211]
ds_read_b64_tr_b16 a[194:195], v228 offset:1984
v_mul_f32 v246, v176, v176
v_mul_f32 v247, v177, v177
v_mfma_f32_16x16x32_bf16 v[212:215], a[200:203], a[92:95], v[212:215]
v_mul_f32 v248, v178, v178
v_mul_f32 v249, v179, v179
v_mul_f32 v250, v180, v180
v_mfma_f32_16x16x32_bf16 v[104:107], a[204:207], a[80:83], v[104:107]
ds_read_b64_tr_b16 a[196:197], v228 offset:14528
v_mul_f32 v251, v181, v181
v_mul_f32 v252, v182, v182
v_mfma_f32_16x16x32_bf16 v[108:111], a[204:207], a[84:87], v[108:111]
v_mul_f32 v253, v183, v183
v_fma_f32 v246, v246, s51, v237
v_fma_f32 v247, v247, s51, v237
v_mfma_f32_16x16x32_bf16 v[216:219], a[204:207], a[88:91], v[216:219]
ds_read_b64_tr_b16 a[198:199], v228 offset:16320
v_fma_f32 v248, v248, s51, v237
v_fma_f32 v249, v249, s51, v237
v_mfma_f32_16x16x32_bf16 v[220:223], a[204:207], a[92:95], v[220:223]
s_waitcnt lgkmcnt(8)
v_fma_f32 v250, v250, s51, v237
v_fma_f32 v251, v251, s51, v237
v_fma_f32 v252, v252, s51, v237
v_mfma_f32_16x16x32_bf16 v[96:99], a[208:211], a[96:99], v[96:99]
ds_read_b64_tr_b16 a[200:201], v228 offset:7360
v_fma_f32 v253, v253, s51, v237
v_mul_f32 v246, v246, v176
v_mfma_f32_16x16x32_bf16 v[100:103], a[208:211], a[100:103], v[100:103]
v_exp_f32 v246, v246
v_mul_f32 v184, v176, v184
v_mfma_f32_16x16x32_bf16 v[208:211], a[208:211], a[104:107], v[208:211]
ds_read_b64_tr_b16 a[202:203], v228 offset:9152
v_mul_f32 v247, v247, v177
v_mul_f32 v185, v177, v185
v_mfma_f32_16x16x32_bf16 v[212:215], a[208:211], a[108:111], v[212:215]
v_exp_f32 v247, v247
v_mul_f32 v248, v248, v178
v_mfma_f32_16x16x32_bf16 v[104:107], a[212:215], a[96:99], v[104:107]
ds_read_b64_tr_b16 a[204:205], v228 offset:21696
v_exp_f32 v248, v248
v_mfma_f32_16x16x32_bf16 v[108:111], a[212:215], a[100:103], v[108:111]
v_mul_f32 v186, v178, v186
v_mul_f32 v249, v249, v179
v_mul_f32 v187, v179, v187
v_mfma_f32_16x16x32_bf16 v[216:219], a[212:215], a[104:107], v[216:219]
ds_read_b64_tr_b16 a[206:207], v228 offset:23488
v_exp_f32 v249, v249
v_mfma_f32_16x16x32_bf16 v[220:223], a[212:215], a[108:111], v[220:223]
s_waitcnt lgkmcnt(8)
v_mul_f32 v250, v250, v180
v_exp_f32 v250, v250
v_mfma_f32_16x16x32_bf16 v[96:99], a[216:219], a[112:115], v[96:99]
ds_read_b64_tr_b16 a[208:209], v226 offset:192
v_mul_f32 v188, v180, v188
v_mul_f32 v251, v251, v181
v_mfma_f32_16x16x32_bf16 v[100:103], a[216:219], a[116:119], v[100:103]
v_exp_f32 v251, v251
v_mul_f32 v189, v181, v189
v_mfma_f32_16x16x32_bf16 v[208:211], a[216:219], a[120:123], v[208:211]
ds_read_b64_tr_b16 a[210:211], v226 offset:1984
v_mul_f32 v252, v252, v182
v_mul_f32 v190, v182, v190
v_mfma_f32_16x16x32_bf16 v[212:215], a[216:219], a[124:127], v[212:215]
v_exp_f32 v252, v252
v_mul_f32 v253, v253, v183
v_mfma_f32_16x16x32_bf16 v[104:107], a[220:223], a[112:115], v[104:107]
ds_read_b64_tr_b16 a[212:213], v226 offset:14528
v_exp_f32 v253, v253
v_mfma_f32_16x16x32_bf16 v[108:111], a[220:223], a[116:119], v[108:111]
v_mul_f32 v191, v183, v191
v_add_f32 v246, 1.0, v246
v_add_f32 v247, 1.0, v247
v_mfma_f32_16x16x32_bf16 v[216:219], a[220:223], a[120:123], v[216:219]
ds_read_b64_tr_b16 a[214:215], v226 offset:16320
v_rcp_f32 v246, v246
v_mfma_f32_16x16x32_bf16 v[220:223], a[220:223], a[124:127], v[220:223]
s_waitcnt lgkmcnt(8)
v_rcp_f32 v247, v247
v_add_f32 v248, 1.0, v248
v_mfma_f32_16x16x32_bf16 v[96:99], a[192:195], a[128:131], v[96:99]
ds_read_b64_tr_b16 a[216:217], v226 offset:7360
v_rcp_f32 v248, v248
v_mfma_f32_16x16x32_bf16 v[100:103], a[192:195], a[132:135], v[100:103]
v_add_f32 v249, 1.0, v249
v_rcp_f32 v249, v249
v_mfma_f32_16x16x32_bf16 v[208:211], a[192:195], a[136:139], v[208:211]
ds_read_b64_tr_b16 a[218:219], v226 offset:9152
v_mul_f32 v176, v184, v246
v_add_f32 v250, 1.0, v250
v_mfma_f32_16x16x32_bf16 v[212:215], a[192:195], a[140:143], v[212:215]
v_rcp_f32 v250, v250
v_mul_f32 v177, v185, v247
v_mfma_f32_16x16x32_bf16 v[104:107], a[196:199], a[128:131], v[104:107]
ds_read_b64_tr_b16 a[220:221], v226 offset:21696
v_add_f32 v251, 1.0, v251
v_mul_f32 v178, v186, v248
v_mfma_f32_16x16x32_bf16 v[108:111], a[196:199], a[132:135], v[108:111]
v_rcp_f32 v251, v251
v_add_f32 v252, 1.0, v252
v_mfma_f32_16x16x32_bf16 v[216:219], a[196:199], a[136:139], v[216:219]
ds_read_b64_tr_b16 a[222:223], v226 offset:23488
v_rcp_f32 v252, v252
v_mfma_f32_16x16x32_bf16 v[220:223], a[196:199], a[140:143], v[220:223]
s_waitcnt lgkmcnt(8)
v_mul_f32 v179, v187, v249
v_add_f32 v253, 1.0, v253
v_mul_f32 v180, v188, v250
v_mfma_f32_16x16x32_bf16 v[96:99], a[200:203], a[144:147], v[96:99]
v_rcp_f32 v253, v253
v_mul_f32 v181, v189, v251
v_mfma_f32_16x16x32_bf16 v[100:103], a[200:203], a[148:151], v[100:103]
v_mul_f32 v182, v190, v252
v_mul_f32 v183, v191, v253
v_cvt_pk_bf16_f32 v184, v176, v177
v_mfma_f32_16x16x32_bf16 v[208:211], a[200:203], a[152:155], v[208:211]
v_cvt_pk_bf16_f32 v185, v178, v179
v_cvt_pk_bf16_f32 v186, v180, v181
v_cvt_pk_bf16_f32 v187, v182, v183
v_mfma_f32_16x16x32_bf16 v[212:215], a[200:203], a[156:159], v[212:215]
s_nop 1
v_permlane16_swap_b32 v184, v186
v_mfma_f32_16x16x32_bf16 v[104:107], a[204:207], a[144:147], v[104:107]
v_permlane16_swap_b32 v185, v187
v_mfma_f32_16x16x32_bf16 v[108:111], a[204:207], a[148:151], v[108:111]
buffer_store_dwordx4 v[184:187], v225, s[20:23], s48 offen offset:0 sc1
v_mfma_f32_16x16x32_bf16 v[216:219], a[204:207], a[152:155], v[216:219]
v_mul_f32 v238, v80, v80
v_mul_f32 v239, v81, v81
v_mul_f32 v240, v82, v82
v_mfma_f32_16x16x32_bf16 v[220:223], a[204:207], a[156:159], v[220:223]
s_waitcnt lgkmcnt(4)
v_mul_f32 v241, v83, v83
v_mul_f32 v242, v84, v84
v_mul_f32 v243, v85, v85
v_mfma_f32_16x16x32_bf16 v[96:99], a[208:211], a[0:3], v[96:99]
v_mul_f32 v244, v86, v86
v_mul_f32 v245, v87, v87
v_fma_f32 v238, v238, s51, v237
v_mfma_f32_16x16x32_bf16 v[100:103], a[208:211], a[4:7], v[100:103]
v_fma_f32 v239, v239, s51, v237
v_fma_f32 v240, v240, s51, v237
v_fma_f32 v241, v241, s51, v237
v_mfma_f32_16x16x32_bf16 v[208:211], a[208:211], a[8:11], v[208:211]
v_fma_f32 v242, v242, s51, v237
v_fma_f32 v243, v243, s51, v237
v_fma_f32 v244, v244, s51, v237
v_mfma_f32_16x16x32_bf16 v[212:215], a[208:211], a[12:15], v[212:215]
v_fma_f32 v245, v245, s51, v237
v_mul_f32 v238, v238, v80
v_mul_f32 v88, v80, v88
v_mfma_f32_16x16x32_bf16 v[104:107], a[212:215], a[0:3], v[104:107]
v_exp_f32 v238, v238
v_mul_f32 v239, v239, v81
v_mfma_f32_16x16x32_bf16 v[108:111], a[212:215], a[4:7], v[108:111]
v_exp_f32 v239, v239
v_mul_f32 v89, v81, v89
v_mfma_f32_16x16x32_bf16 v[216:219], a[212:215], a[8:11], v[216:219]
v_mul_f32 v240, v240, v82
v_exp_f32 v240, v240
v_mfma_f32_16x16x32_bf16 v[220:223], a[212:215], a[12:15], v[220:223]
s_waitcnt lgkmcnt(0)
v_mul_f32 v90, v82, v90
v_mul_f32 v241, v241, v83
v_mul_f32 v91, v83, v91
v_mfma_f32_16x16x32_bf16 v[96:99], a[216:219], a[16:19], v[96:99]
v_exp_f32 v241, v241
v_mul_f32 v242, v242, v84
v_mfma_f32_16x16x32_bf16 v[100:103], a[216:219], a[20:23], v[100:103]
v_exp_f32 v242, v242
v_mul_f32 v92, v84, v92
v_mfma_f32_16x16x32_bf16 v[208:211], a[216:219], a[24:27], v[208:211]
v_mul_f32 v243, v243, v85
v_exp_f32 v243, v243
v_mfma_f32_16x16x32_bf16 v[212:215], a[216:219], a[28:31], v[212:215]
v_mul_f32 v93, v85, v93
v_mul_f32 v244, v244, v86
v_mul_f32 v94, v86, v94
v_mfma_f32_16x16x32_bf16 v[104:107], a[220:223], a[16:19], v[104:107]
v_exp_f32 v244, v244
v_mul_f32 v245, v245, v87
v_mfma_f32_16x16x32_bf16 v[108:111], a[220:223], a[20:23], v[108:111]
v_exp_f32 v245, v245
v_mul_f32 v95, v87, v95
v_mfma_f32_16x16x32_bf16 v[216:219], a[220:223], a[24:27], v[216:219]
v_add_f32 v238, 1.0, v238
v_rcp_f32 v238, v238
v_mfma_f32_16x16x32_bf16 v[220:223], a[220:223], a[28:31], v[220:223]
v_add_f32 v239, 1.0, v239
v_rcp_f32 v239, v239
s_nop 15
v_add_f32 v240, 1.0, v240
v_add_f32 v241, 1.0, v241
v_rcp_f32 v240, v240
v_mul_f32 v80, v88, v238
v_add_f32 v242, 1.0, v242
v_rcp_f32 v241, v241
v_mul_f32 v81, v89, v239
v_add_f32 v243, 1.0, v243
v_rcp_f32 v242, v242
v_mul_f32 v82, v90, v240
v_add_f32 v244, 1.0, v244
v_rcp_f32 v243, v243
v_mul_f32 v83, v91, v241
v_add_f32 v245, 1.0, v245
v_rcp_f32 v244, v244
v_mul_f32 v84, v92, v242
v_rcp_f32 v245, v245
v_mul_f32 v85, v93, v243
v_mul_f32 v86, v94, v244
v_mul_f32 v87, v95, v245
v_cvt_pk_bf16_f32 v88, v80, v81
v_cvt_pk_bf16_f32 v89, v82, v83
v_cvt_pk_bf16_f32 v90, v84, v85
v_cvt_pk_bf16_f32 v91, v86, v87
s_nop 1
v_permlane16_swap_b32 v88, v90
v_permlane16_swap_b32 v89, v91
buffer_store_dwordx4 v[88:91], v225, s[20:23], s47 offen offset:1024 sc1
v_mul_f32 v246, v192, v192
v_mul_f32 v247, v193, v193
v_mul_f32 v248, v194, v194
v_mul_f32 v249, v195, v195
v_mul_f32 v250, v196, v196
v_mul_f32 v251, v197, v197
v_mul_f32 v252, v198, v198
v_mul_f32 v253, v199, v199
v_fma_f32 v246, v246, s51, v237
v_fma_f32 v247, v247, s51, v237
v_fma_f32 v248, v248, s51, v237
v_fma_f32 v249, v249, s51, v237
v_fma_f32 v250, v250, s51, v237
v_fma_f32 v251, v251, s51, v237
v_fma_f32 v252, v252, s51, v237
v_fma_f32 v253, v253, s51, v237
v_mul_f32 v246, v246, v192
v_mul_f32 v200, v192, v200
v_mul_f32 v247, v247, v193
v_exp_f32 v246, v246
v_mul_f32 v201, v193, v201
v_mul_f32 v248, v248, v194
v_exp_f32 v247, v247
v_mul_f32 v202, v194, v202
v_mul_f32 v249, v249, v195
v_exp_f32 v248, v248
v_mul_f32 v203, v195, v203
v_mul_f32 v250, v250, v196
v_exp_f32 v249, v249
v_mul_f32 v204, v196, v204
v_mul_f32 v251, v251, v197
v_exp_f32 v250, v250
v_mul_f32 v205, v197, v205
v_mul_f32 v252, v252, v198
v_exp_f32 v251, v251
v_mul_f32 v206, v198, v206
v_mul_f32 v253, v253, v199
v_exp_f32 v252, v252
v_mul_f32 v207, v199, v207
v_exp_f32 v253, v253
v_add_f32 v246, 1.0, v246
v_add_f32 v247, 1.0, v247
v_rcp_f32 v246, v246
v_add_f32 v248, 1.0, v248
v_rcp_f32 v247, v247
v_add_f32 v249, 1.0, v249
v_rcp_f32 v248, v248
v_mul_f32 v192, v200, v246
v_add_f32 v250, 1.0, v250
v_rcp_f32 v249, v249
v_mul_f32 v193, v201, v247
v_add_f32 v251, 1.0, v251
v_rcp_f32 v250, v250
v_mul_f32 v194, v202, v248
v_add_f32 v252, 1.0, v252
v_rcp_f32 v251, v251
v_mul_f32 v195, v203, v249
v_add_f32 v253, 1.0, v253
v_rcp_f32 v252, v252
v_mul_f32 v196, v204, v250
v_rcp_f32 v253, v253
v_mul_f32 v197, v205, v251
v_mul_f32 v198, v206, v252
v_mul_f32 v199, v207, v253
v_cvt_pk_bf16_f32 v200, v192, v193
v_cvt_pk_bf16_f32 v201, v194, v195
v_cvt_pk_bf16_f32 v202, v196, v197
v_cvt_pk_bf16_f32 v203, v198, v199
s_nop 1
v_permlane16_swap_b32 v200, v202
v_permlane16_swap_b32 v201, v203
buffer_store_dwordx4 v[200:203], v225, s[20:23], s48 offen offset:1024 sc1
v_mul_f32 v238, v96, v96
v_mul_f32 v239, v97, v97
v_mul_f32 v240, v98, v98
v_mul_f32 v241, v99, v99
v_mul_f32 v242, v100, v100
v_mul_f32 v243, v101, v101
v_mul_f32 v244, v102, v102
v_mul_f32 v245, v103, v103
v_fma_f32 v238, v238, s51, v237
v_fma_f32 v239, v239, s51, v237
v_fma_f32 v240, v240, s51, v237
v_fma_f32 v241, v241, s51, v237
v_fma_f32 v242, v242, s51, v237
v_fma_f32 v243, v243, s51, v237
v_fma_f32 v244, v244, s51, v237
v_fma_f32 v245, v245, s51, v237
v_mul_f32 v238, v238, v96
v_mul_f32 v104, v96, v104
v_mul_f32 v239, v239, v97
v_exp_f32 v238, v238
v_mul_f32 v105, v97, v105
v_mul_f32 v240, v240, v98
v_exp_f32 v239, v239
v_mul_f32 v106, v98, v106
v_mul_f32 v241, v241, v99
v_exp_f32 v240, v240
v_mul_f32 v107, v99, v107
v_mul_f32 v242, v242, v100
v_exp_f32 v241, v241
v_mul_f32 v108, v100, v108
v_mul_f32 v243, v243, v101
v_exp_f32 v242, v242
v_mul_f32 v109, v101, v109
v_mul_f32 v244, v244, v102
v_exp_f32 v243, v243
v_mul_f32 v110, v102, v110
v_mul_f32 v245, v245, v103
v_exp_f32 v244, v244
v_mul_f32 v111, v103, v111
v_exp_f32 v245, v245
v_add_f32 v238, 1.0, v238
v_add_f32 v239, 1.0, v239
v_rcp_f32 v238, v238
v_add_f32 v240, 1.0, v240
v_rcp_f32 v239, v239
v_add_f32 v241, 1.0, v241
v_rcp_f32 v240, v240
v_mul_f32 v96, v104, v238
v_add_f32 v242, 1.0, v242
v_rcp_f32 v241, v241
v_mul_f32 v97, v105, v239
v_add_f32 v243, 1.0, v243
v_rcp_f32 v242, v242
v_mul_f32 v98, v106, v240
v_add_f32 v244, 1.0, v244
v_rcp_f32 v243, v243
v_mul_f32 v99, v107, v241
v_add_f32 v245, 1.0, v245
v_rcp_f32 v244, v244
v_mul_f32 v100, v108, v242
v_rcp_f32 v245, v245
v_mul_f32 v101, v109, v243
v_mul_f32 v102, v110, v244
v_mul_f32 v103, v111, v245
v_cvt_pk_bf16_f32 v104, v96, v97
v_cvt_pk_bf16_f32 v105, v98, v99
v_cvt_pk_bf16_f32 v106, v100, v101
v_cvt_pk_bf16_f32 v107, v102, v103
s_nop 1
v_permlane16_swap_b32 v104, v106
v_permlane16_swap_b32 v105, v107
buffer_store_dwordx4 v[104:107], v225, s[20:23], s47 offen offset:2048 sc1
v_mul_f32 v246, v208, v208
v_mul_f32 v247, v209, v209
v_mul_f32 v248, v210, v210
v_mul_f32 v249, v211, v211
v_mul_f32 v250, v212, v212
v_mul_f32 v251, v213, v213
v_mul_f32 v252, v214, v214
v_mul_f32 v253, v215, v215
v_fma_f32 v246, v246, s51, v237
v_fma_f32 v247, v247, s51, v237
v_fma_f32 v248, v248, s51, v237
v_fma_f32 v249, v249, s51, v237
v_fma_f32 v250, v250, s51, v237
v_fma_f32 v251, v251, s51, v237
v_fma_f32 v252, v252, s51, v237
v_fma_f32 v253, v253, s51, v237
v_mul_f32 v246, v246, v208
v_mul_f32 v216, v208, v216
v_mul_f32 v247, v247, v209
v_exp_f32 v246, v246
v_mul_f32 v217, v209, v217
v_mul_f32 v248, v248, v210
v_exp_f32 v247, v247
v_mul_f32 v218, v210, v218
v_mul_f32 v249, v249, v211
v_exp_f32 v248, v248
v_mul_f32 v219, v211, v219
v_mul_f32 v250, v250, v212
v_exp_f32 v249, v249
v_mul_f32 v220, v212, v220
v_mul_f32 v251, v251, v213
v_exp_f32 v250, v250
v_mul_f32 v221, v213, v221
v_mul_f32 v252, v252, v214
v_exp_f32 v251, v251
v_mul_f32 v222, v214, v222
v_mul_f32 v253, v253, v215
v_exp_f32 v252, v252
v_mul_f32 v223, v215, v223
v_exp_f32 v253, v253
v_add_f32 v246, 1.0, v246
v_add_f32 v247, 1.0, v247
v_rcp_f32 v246, v246
v_add_f32 v248, 1.0, v248
v_rcp_f32 v247, v247
v_add_f32 v249, 1.0, v249
v_rcp_f32 v248, v248
v_mul_f32 v208, v216, v246
v_add_f32 v250, 1.0, v250
v_rcp_f32 v249, v249
v_mul_f32 v209, v217, v247
v_add_f32 v251, 1.0, v251
v_rcp_f32 v250, v250
v_mul_f32 v210, v218, v248
v_add_f32 v252, 1.0, v252
v_rcp_f32 v251, v251
v_mul_f32 v211, v219, v249
v_add_f32 v253, 1.0, v253
v_rcp_f32 v252, v252
v_mul_f32 v212, v220, v250
v_rcp_f32 v253, v253
v_mul_f32 v213, v221, v251
v_mul_f32 v214, v222, v252
v_mul_f32 v215, v223, v253
v_cvt_pk_bf16_f32 v216, v208, v209
v_cvt_pk_bf16_f32 v217, v210, v211
v_cvt_pk_bf16_f32 v218, v212, v213
v_cvt_pk_bf16_f32 v219, v214, v215
s_nop 1
v_permlane16_swap_b32 v216, v218
v_permlane16_swap_b32 v217, v219
buffer_store_dwordx4 v[216:219], v225, s[20:23], s48 offen offset:2048 sc1
L_gateup_end:
s_endpgm
.text
.globl down_kernel
.p2align 8
.type down_kernel,@function
down_kernel:
s_cmp_ge_u32 s2, 256
s_cbranch_scc1 L_down_end
s_load_dwordx2 s[4:5], s[0:1], 64
s_load_dwordx2 s[8:9], s[0:1], 104
s_load_dwordx2 s[6:7], s[0:1], 88
v_and_b32 v128, 63, v0
v_lshrrev_b32 v152, 6, v0
v_lshlrev_b32 v129, 4, v128
v_readfirstlane_b32 s33, v152
s_and_b32 s30, s2, 7
s_lshr_b32 s31, s2, 3
s_and_b32 s38, s30, 3
s_lshr_b32 s34, s30, 2
s_lshl_b32 s34, s34, 2
s_and_b32 s36, s31, 3
s_add_u32 s34, s34, s36
s_lshr_b32 s35, s31, 2
s_lshl_b32 s37, s34, 3
s_lshl_b32 s36, s33, 1
s_add_u32 s37, s37, s36
s_mul_i32 s40, s37, 229376
s_mul_i32 s36, s38, 57344
s_add_u32 s40, s40, s36
s_add_u32 s41, s40, 229376
v_lshrrev_b32 v152, 4, v128
v_and_b32 v153, 15, v128
v_lshlrev_b32 v154, 1, v152
v_xor_b32 v154, v154, v153
v_lshlrev_b32 v154, 4, v154
v_lshl_add_u32 v130, v152, 11, v154
v_add_u32 v131, 7168, v130
v_xor_b32 v132, 128, v130
v_add_u32 v133, 21504, v132
v_add_u32 v132, 14336, v132
v_lshrrev_b32 v152, 4, v128
v_and_b32 v134, 15, v128
v_lshlrev_b32 v134, 4, v134
v_lshl_add_u32 v134, v152, 9, v134
s_lshl_b32 s42, s35, 8
s_lshl_b32 s36, s33, 15
s_add_u32 s42, s42, s36
s_mul_i32 s36, s38, 1835008
s_add_u32 s42, s42, s36
s_lshl_b32 s43, s33, 12
s_waitcnt lgkmcnt(0)
s_mov_b32 s12, s4
s_and_b32 s13, s5, 0xffff
s_mov_b32 s14, 7340032
s_mov_b32 s15, 0x20000
s_add_u32 s16, s8, 8388608
s_addc_u32 s17, s9, 0
s_and_b32 s17, s17, 0xffff
s_mov_b32 s18, 14680064
s_mov_b32 s19, 0x20000
s_add_u32 s60, s40, 49152
s_add_u32 s61, s41, 49152
s_add_u32 m0, s43, 0
s_nop 0
buffer_load_dwordx4 v130, s[12:15], s42 offen offset:0 lds
buffer_load_dwordx4 v131, s[12:15], s42 offen offset:1024 lds
buffer_load_dwordx4 v132, s[12:15], s42 offen offset:2048 lds
buffer_load_dwordx4 v133, s[12:15], s42 offen offset:3072 lds
s_add_u32 s42, s42, 131072
s_add_u32 m0, s43, 16384
s_nop 0
buffer_load_dwordx4 v130, s[12:15], s42 offen offset:0 lds
buffer_load_dwordx4 v131, s[12:15], s42 offen offset:1024 lds
s_xor_b32 s43, s43, 0x8000
buffer_load_dwordx4 v132, s[12:15], s42 offen offset:2048 lds
buffer_load_dwordx4 v133, s[12:15], s42 offen offset:3072 lds
s_add_u32 s42, s42, 131072
buffer_load_dwordx4 a[0:3], v134, s[16:19], s40 offen offset:0
buffer_load_dwordx4 a[4:7], v134, s[16:19], s40 offen offset:256
buffer_load_dwordx4 a[8:11], v134, s[16:19], s41 offen offset:0
buffer_load_dwordx4 a[12:15], v134, s[16:19], s41 offen offset:256
buffer_load_dwordx4 a[16:19], v134, s[16:19], s40 offen offset:2048
buffer_load_dwordx4 a[20:23], v134, s[16:19], s40 offen offset:2304
s_add_u32 s40, s40, 4096
buffer_load_dwordx4 a[24:27], v134, s[16:19], s41 offen offset:2048
buffer_load_dwordx4 a[28:31], v134, s[16:19], s41 offen offset:2304
s_add_u32 s41, s41, 4096
buffer_load_dwordx4 a[32:35], v134, s[16:19], s40 offen offset:0
buffer_load_dwordx4 a[36:39], v134, s[16:19], s40 offen offset:256
buffer_load_dwordx4 a[40:43], v134, s[16:19], s41 offen offset:0
buffer_load_dwordx4 a[44:47], v134, s[16:19], s41 offen offset:256
s_add_u32 s39, s38, 1
s_and_b32 s39, s39, 3
s_lshl_b32 s49, s39, 1
v_lshrrev_b32 v152, 4, v128
v_bfe_u32 v153, v128, 2, 2
v_lshl_add_u32 v154, v152, 3, v153
v_and_b32 v155, 3, v128
v_lshlrev_b32 v155, 3, v155
v_lshl_add_u32 v154, v154, 8, v155
v_bfe_u32 v155, v128, 2, 3
s_add_u32 s36, s49, 0
s_and_b32 s36, s36, 7
v_xor_b32 v156, s36, v155
v_lshl_add_u32 v136, v156, 5, v154
s_add_u32 s36, s49, 1
s_and_b32 s36, s36, 7
v_xor_b32 v156, s36, v155
v_lshl_add_u32 v137, v156, 5, v154
s_add_u32 s36, s49, 2
s_and_b32 s36, s36, 7
v_xor_b32 v156, s36, v155
v_lshl_add_u32 v138, v156, 5, v154
s_add_u32 s36, s49, 3
s_and_b32 s36, s36, 7
v_xor_b32 v156, s36, v155
v_lshl_add_u32 v139, v156, 5, v154
s_add_u32 s36, s49, 4
s_and_b32 s36, s36, 7
v_xor_b32 v156, s36, v155
v_lshl_add_u32 v140, v156, 5, v154
s_add_u32 s36, s49, 5
s_and_b32 s36, s36, 7
v_xor_b32 v156, s36, v155
v_lshl_add_u32 v141, v156, 5, v154
s_add_u32 s36, s49, 6
s_and_b32 s36, s36, 7
v_xor_b32 v156, s36, v155
v_lshl_add_u32 v142, v156, 5, v154
s_add_u32 s36, s49, 7
s_and_b32 s36, s36, 7
v_xor_b32 v156, s36, v155
v_lshl_add_u32 v143, v156, 5, v154
s_add_u32 s20, s8, 30408704
s_addc_u32 s21, s9, 0
s_and_b32 s21, s21, 0xffff
s_mov_b32 s22, 17039360
s_mov_b32 s23, 0x20000
s_mul_i32 s45, s37, 66560
s_lshl_b32 s36, s35, 13
s_add_u32 s45, s45, s36
s_mul_i32 s44, s38, 4259840
s_add_u32 s44, s44, s45
s_add_u32 s36, s39, 0
s_and_b32 s36, s36, 3
s_lshl_b32 s62, s36, 11
s_add_u32 s62, s62, s44
s_add_u32 s63, s62, 66560
s_mul_i32 s84, s36, 4259840
s_add_u32 s84, s84, s45
s_lshl_b32 s36, s38, 11
s_add_u32 s84, s84, s36
s_add_u32 s85, s84, 66560
s_add_u32 s36, s39, 1
s_and_b32 s36, s36, 3
s_lshl_b32 s64, s36, 11
s_add_u32 s64, s64, s44
s_add_u32 s65, s64, 66560
s_mul_i32 s86, s36, 4259840
s_add_u32 s86, s86, s45
s_lshl_b32 s36, s38, 11
s_add_u32 s86, s86, s36
s_add_u32 s87, s86, 66560
s_add_u32 s36, s39, 2
s_and_b32 s36, s36, 3
s_lshl_b32 s66, s36, 11
s_add_u32 s66, s66, s44
s_add_u32 s67, s66, 66560
s_mul_i32 s88, s36, 4259840
s_add_u32 s88, s88, s45
s_lshl_b32 s36, s38, 11
s_add_u32 s88, s88, s36
s_add_u32 s89, s88, 66560
s_add_u32 s24, s8, 26214400
s_addc_u32 s25, s9, 0
s_and_b32 s25, s25, 0xffff
s_mov_b32 s26, 4194304
s_mov_b32 s27, 0x20000
s_mov_b32 s52, s8
s_and_b32 s53, s9, 0xffff
s_mov_b32 s54, 24576
s_mov_b32 s55, 0x20000
s_mov_b32 s56, s6
s_and_b32 s57, s7, 0xffff
s_mov_b32 s58, 4194304
s_mov_b32 s59, 0x20000
s_lshl_b32 s47, s37, 16
s_lshl_b32 s36, s35, 13
s_add_u32 s47, s47, s36
s_lshl_b32 s36, s38, 11
s_add_u32 s47, s47, s36
s_add_u32 s48, s47, 65536
s_lshl_b32 s50, s35, 9
s_lshl_b32 s36, s38, 7
s_add_u32 s50, s50, s36
s_add_u32 s50, s50, 20480
s_lshl_b32 s44, s37, 16
s_lshl_b32 s36, s35, 8
s_add_u32 s44, s44, s36
s_lshl_b32 s36, s38, 6
s_add_u32 s44, s44, s36
s_add_u32 s45, s44, 65536
s_lshl_b32 s51, s34, 3
s_add_u32 s51, s51, s35
s_lshl_b32 s51, s51, 2
s_add_u32 s51, s51, s33
s_lshl_b32 s51, s51, 7
v_lshrrev_b32 v152, 5, v128
v_lshlrev_b32 v135, 5, v152
v_and_b32 v159, 31, v128
v_lshlrev_b32 v159, 11, v159
v_lshl_add_u32 v159, v152, 4, v159
s_waitcnt vmcnt(16)
s_barrier
ds_read_b64_tr_b16 a[192:193], v136 offset:0
ds_read_b64_tr_b16 a[194:195], v136 offset:1024
ds_read_b64_tr_b16 a[196:197], v137 offset:0
ds_read_b64_tr_b16 a[198:199], v137 offset:1024
ds_read_b64_tr_b16 a[200:201], v138 offset:0
ds_read_b64_tr_b16 a[202:203], v138 offset:1024
ds_read_b64_tr_b16 a[204:205], v139 offset:0
ds_read_b64_tr_b16 a[206:207], v139 offset:1024
ds_read_b64_tr_b16 a[208:209], v140 offset:0
ds_read_b64_tr_b16 a[210:211], v140 offset:1024
ds_read_b64_tr_b16 a[212:213], v141 offset:0
ds_read_b64_tr_b16 a[214:215], v141 offset:1024
s_waitcnt vmcnt(8) lgkmcnt(8)
v_mfma_f32_16x16x32_bf16 v[0:3], a[192:195], a[0:3], 0
ds_read_b64_tr_b16 a[216:217], v142 offset:0
v_mfma_f32_16x16x32_bf16 v[4:7], a[192:195], a[4:7], 0
buffer_load_dwordx4 a[48:51], v134, s[16:19], s40 offen offset:2048
v_mfma_f32_16x16x32_bf16 v[64:67], a[192:195], a[8:11], 0
ds_read_b64_tr_b16 a[218:219], v142 offset:1024
v_mfma_f32_16x16x32_bf16 v[68:71], a[192:195], a[12:15], 0
v_mfma_f32_16x16x32_bf16 v[8:11], a[196:199], a[0:3], 0
ds_read_b64_tr_b16 a[220:221], v143 offset:0
v_mfma_f32_16x16x32_bf16 v[12:15], a[196:199], a[4:7], 0
buffer_load_dwordx4 a[52:55], v134, s[16:19], s40 offen offset:2304
v_mfma_f32_16x16x32_bf16 v[72:75], a[196:199], a[8:11], 0
ds_read_b64_tr_b16 a[222:223], v143 offset:1024
v_mfma_f32_16x16x32_bf16 v[76:79], a[196:199], a[12:15], 0
s_waitcnt lgkmcnt(8)
s_add_u32 s40, s40, 4096
v_mfma_f32_16x16x32_bf16 v[16:19], a[200:203], a[0:3], 0
ds_read_b64_tr_b16 a[192:193], v136 offset:8192
v_mfma_f32_16x16x32_bf16 v[20:23], a[200:203], a[4:7], 0
buffer_load_dwordx4 a[56:59], v134, s[16:19], s41 offen offset:2048
v_mfma_f32_16x16x32_bf16 v[80:83], a[200:203], a[8:11], 0
ds_read_b64_tr_b16 a[194:195], v136 offset:9216
v_mfma_f32_16x16x32_bf16 v[84:87], a[200:203], a[12:15], 0
v_mfma_f32_16x16x32_bf16 v[24:27], a[204:207], a[0:3], 0
ds_read_b64_tr_b16 a[196:197], v137 offset:8192
v_mfma_f32_16x16x32_bf16 v[28:31], a[204:207], a[4:7], 0
buffer_load_dwordx4 a[60:63], v134, s[16:19], s41 offen offset:2304
v_mfma_f32_16x16x32_bf16 v[88:91], a[204:207], a[8:11], 0
ds_read_b64_tr_b16 a[198:199], v137 offset:9216
v_mfma_f32_16x16x32_bf16 v[92:95], a[204:207], a[12:15], 0
s_waitcnt lgkmcnt(8)
s_add_u32 s41, s41, 4096
s_add_u32 m0, s43, 0
v_mfma_f32_16x16x32_bf16 v[32:35], a[208:211], a[0:3], 0
ds_read_b64_tr_b16 a[200:201], v138 offset:8192
v_mfma_f32_16x16x32_bf16 v[36:39], a[208:211], a[4:7], 0
buffer_load_dwordx4 v130, s[12:15], s42 offen offset:0 lds
v_mfma_f32_16x16x32_bf16 v[96:99], a[208:211], a[8:11], 0
ds_read_b64_tr_b16 a[202:203], v138 offset:9216
v_mfma_f32_16x16x32_bf16 v[100:103], a[208:211], a[12:15], 0
v_mfma_f32_16x16x32_bf16 v[40:43], a[212:215], a[0:3], 0
ds_read_b64_tr_b16 a[204:205], v139 offset:8192
v_mfma_f32_16x16x32_bf16 v[44:47], a[212:215], a[4:7], 0
buffer_load_dwordx4 v131, s[12:15], s42 offen offset:1024 lds
v_mfma_f32_16x16x32_bf16 v[104:107], a[212:215], a[8:11], 0
ds_read_b64_tr_b16 a[206:207], v139 offset:9216
v_mfma_f32_16x16x32_bf16 v[108:111], a[212:215], a[12:15], 0
s_waitcnt lgkmcnt(8)
v_mfma_f32_16x16x32_bf16 v[48:51], a[216:219], a[0:3], 0
ds_read_b64_tr_b16 a[208:209], v140 offset:8192
v_mfma_f32_16x16x32_bf16 v[52:55], a[216:219], a[4:7], 0
buffer_load_dwordx4 v132, s[12:15], s42 offen offset:2048 lds
v_mfma_f32_16x16x32_bf16 v[112:115], a[216:219], a[8:11], 0
ds_read_b64_tr_b16 a[210:211], v140 offset:9216
v_mfma_f32_16x16x32_bf16 v[116:119], a[216:219], a[12:15], 0
v_mfma_f32_16x16x32_bf16 v[56:59], a[220:223], a[0:3], 0
ds_read_b64_tr_b16 a[212:213], v141 offset:8192
v_mfma_f32_16x16x32_bf16 v[60:63], a[220:223], a[4:7], 0
buffer_load_dwordx4 v133, s[12:15], s42 offen offset:3072 lds
v_mfma_f32_16x16x32_bf16 v[120:123], a[220:223], a[8:11], 0
ds_read_b64_tr_b16 a[214:215], v141 offset:9216
v_mfma_f32_16x16x32_bf16 v[124:127], a[220:223], a[12:15], 0
s_waitcnt vmcnt(12) lgkmcnt(8)
s_add_u32 s42, s42, 131072
v_mfma_f32_16x16x32_bf16 v[0:3], a[192:195], a[16:19], v[0:3]
ds_read_b64_tr_b16 a[216:217], v142 offset:8192
v_mfma_f32_16x16x32_bf16 v[4:7], a[192:195], a[20:23], v[4:7]
buffer_load_dwordx4 a[0:3], v134, s[16:19], s40 offen offset:0
v_mfma_f32_16x16x32_bf16 v[64:67], a[192:195], a[24:27], v[64:67]
ds_read_b64_tr_b16 a[218:219], v142 offset:9216
v_mfma_f32_16x16x32_bf16 v[68:71], a[192:195], a[28:31], v[68:71]
v_mfma_f32_16x16x32_bf16 v[8:11], a[196:199], a[16:19], v[8:11]
ds_read_b64_tr_b16 a[220:221], v143 offset:8192
v_mfma_f32_16x16x32_bf16 v[12:15], a[196:199], a[20:23], v[12:15]
buffer_load_dwordx4 a[4:7], v134, s[16:19], s40 offen offset:256
v_mfma_f32_16x16x32_bf16 v[72:75], a[196:199], a[24:27], v[72:75]
ds_read_b64_tr_b16 a[222:223], v143 offset:9216
v_mfma_f32_16x16x32_bf16 v[76:79], a[196:199], a[28:31], v[76:79]
s_waitcnt lgkmcnt(8)
s_barrier
v_mfma_f32_16x16x32_bf16 v[16:19], a[200:203], a[16:19], v[16:19]
ds_read_b64_tr_b16 a[192:193], v136 offset:16384
v_mfma_f32_16x16x32_bf16 v[20:23], a[200:203], a[20:23], v[20:23]
buffer_load_dwordx4 a[8:11], v134, s[16:19], s41 offen offset:0
v_mfma_f32_16x16x32_bf16 v[80:83], a[200:203], a[24:27], v[80:83]
ds_read_b64_tr_b16 a[194:195], v136 offset:17408
v_mfma_f32_16x16x32_bf16 v[84:87], a[200:203], a[28:31], v[84:87]
v_mfma_f32_16x16x32_bf16 v[24:27], a[204:207], a[16:19], v[24:27]
ds_read_b64_tr_b16 a[196:197], v137 offset:16384
v_mfma_f32_16x16x32_bf16 v[28:31], a[204:207], a[20:23], v[28:31]
buffer_load_dwordx4 a[12:15], v134, s[16:19], s41 offen offset:256
v_mfma_f32_16x16x32_bf16 v[88:91], a[204:207], a[24:27], v[88:91]
ds_read_b64_tr_b16 a[198:199], v137 offset:17408
v_mfma_f32_16x16x32_bf16 v[92:95], a[204:207], a[28:31], v[92:95]
s_waitcnt lgkmcnt(8)
s_add_u32 m0, s43, 16384
v_mfma_f32_16x16x32_bf16 v[32:35], a[208:211], a[16:19], v[32:35]
ds_read_b64_tr_b16 a[200:201], v138 offset:16384
v_mfma_f32_16x16x32_bf16 v[36:39], a[208:211], a[20:23], v[36:39]
buffer_load_dwordx4 v130, s[12:15], s42 offen offset:0 lds
v_mfma_f32_16x16x32_bf16 v[96:99], a[208:211], a[24:27], v[96:99]
ds_read_b64_tr_b16 a[202:203], v138 offset:17408
v_mfma_f32_16x16x32_bf16 v[100:103], a[208:211], a[28:31], v[100:103]
v_mfma_f32_16x16x32_bf16 v[40:43], a[212:215], a[16:19], v[40:43]
ds_read_b64_tr_b16 a[204:205], v139 offset:16384
v_mfma_f32_16x16x32_bf16 v[44:47], a[212:215], a[20:23], v[44:47]
buffer_load_dwordx4 v131, s[12:15], s42 offen offset:1024 lds
v_mfma_f32_16x16x32_bf16 v[104:107], a[212:215], a[24:27], v[104:107]
ds_read_b64_tr_b16 a[206:207], v139 offset:17408
v_mfma_f32_16x16x32_bf16 v[108:111], a[212:215], a[28:31], v[108:111]
s_waitcnt lgkmcnt(8)
s_xor_b32 s43, s43, 0x8000
v_mfma_f32_16x16x32_bf16 v[48:51], a[216:219], a[16:19], v[48:51]
ds_read_b64_tr_b16 a[208:209], v140 offset:16384
v_mfma_f32_16x16x32_bf16 v[52:55], a[216:219], a[20:23], v[52:55]
buffer_load_dwordx4 v132, s[12:15], s42 offen offset:2048 lds
v_mfma_f32_16x16x32_bf16 v[112:115], a[216:219], a[24:27], v[112:115]
ds_read_b64_tr_b16 a[210:211], v140 offset:17408
v_mfma_f32_16x16x32_bf16 v[116:119], a[216:219], a[28:31], v[116:119]
v_mfma_f32_16x16x32_bf16 v[56:59], a[220:223], a[16:19], v[56:59]
ds_read_b64_tr_b16 a[212:213], v141 offset:16384
v_mfma_f32_16x16x32_bf16 v[60:63], a[220:223], a[20:23], v[60:63]
buffer_load_dwordx4 v133, s[12:15], s42 offen offset:3072 lds
v_mfma_f32_16x16x32_bf16 v[120:123], a[220:223], a[24:27], v[120:123]
ds_read_b64_tr_b16 a[214:215], v141 offset:17408
v_mfma_f32_16x16x32_bf16 v[124:127], a[220:223], a[28:31], v[124:127]
s_waitcnt vmcnt(16) lgkmcnt(8)
s_add_u32 s42, s42, 131072
v_mfma_f32_16x16x32_bf16 v[0:3], a[192:195], a[32:35], v[0:3]
ds_read_b64_tr_b16 a[216:217], v142 offset:16384
v_mfma_f32_16x16x32_bf16 v[4:7], a[192:195], a[36:39], v[4:7]
buffer_load_dwordx4 a[16:19], v134, s[16:19], s40 offen offset:2048
v_mfma_f32_16x16x32_bf16 v[64:67], a[192:195], a[40:43], v[64:67]
ds_read_b64_tr_b16 a[218:219], v142 offset:17408
v_mfma_f32_16x16x32_bf16 v[68:71], a[192:195], a[44:47], v[68:71]
v_mfma_f32_16x16x32_bf16 v[8:11], a[196:199], a[32:35], v[8:11]
ds_read_b64_tr_b16 a[220:221], v143 offset:16384
v_mfma_f32_16x16x32_bf16 v[12:15], a[196:199], a[36:39], v[12:15]
buffer_load_dwordx4 a[20:23], v134, s[16:19], s40 offen offset:2304
v_mfma_f32_16x16x32_bf16 v[72:75], a[196:199], a[40:43], v[72:75]
ds_read_b64_tr_b16 a[222:223], v143 offset:17408
v_mfma_f32_16x16x32_bf16 v[76:79], a[196:199], a[44:47], v[76:79]
s_waitcnt lgkmcnt(8)
s_add_u32 s40, s40, 4096
v_mfma_f32_16x16x32_bf16 v[16:19], a[200:203], a[32:35], v[16:19]
ds_read_b64_tr_b16 a[192:193], v136 offset:24576
v_mfma_f32_16x16x32_bf16 v[20:23], a[200:203], a[36:39], v[20:23]
buffer_load_dwordx4 a[24:27], v134, s[16:19], s41 offen offset:2048
v_mfma_f32_16x16x32_bf16 v[80:83], a[200:203], a[40:43], v[80:83]
ds_read_b64_tr_b16 a[194:195], v136 offset:25600
v_mfma_f32_16x16x32_bf16 v[84:87], a[200:203], a[44:47], v[84:87]
v_xor_b32 v136, 0x8000, v136
v_mfma_f32_16x16x32_bf16 v[24:27], a[204:207], a[32:35], v[24:27]
ds_read_b64_tr_b16 a[196:197], v137 offset:24576
v_mfma_f32_16x16x32_bf16 v[28:31], a[204:207], a[36:39], v[28:31]
buffer_load_dwordx4 a[28:31], v134, s[16:19], s41 offen offset:2304
v_mfma_f32_16x16x32_bf16 v[88:91], a[204:207], a[40:43], v[88:91]
ds_read_b64_tr_b16 a[198:199], v137 offset:25600
v_mfma_f32_16x16x32_bf16 v[92:95], a[204:207], a[44:47], v[92:95]
s_waitcnt lgkmcnt(8)
v_xor_b32 v137, 0x8000, v137
s_add_u32 s41, s41, 4096
v_mfma_f32_16x16x32_bf16 v[32:35], a[208:211], a[32:35], v[32:35]
ds_read_b64_tr_b16 a[200:201], v138 offset:24576
v_mfma_f32_16x16x32_bf16 v[36:39], a[208:211], a[36:39], v[36:39]
v_mfma_f32_16x16x32_bf16 v[96:99], a[208:211], a[40:43], v[96:99]
ds_read_b64_tr_b16 a[202:203], v138 offset:25600
v_mfma_f32_16x16x32_bf16 v[100:103], a[208:211], a[44:47], v[100:103]
v_xor_b32 v138, 0x8000, v138
v_mfma_f32_16x16x32_bf16 v[40:43], a[212:215], a[32:35], v[40:43]
ds_read_b64_tr_b16 a[204:205], v139 offset:24576
v_mfma_f32_16x16x32_bf16 v[44:47], a[212:215], a[36:39], v[44:47]
v_mfma_f32_16x16x32_bf16 v[104:107], a[212:215], a[40:43], v[104:107]
ds_read_b64_tr_b16 a[206:207], v139 offset:25600
v_mfma_f32_16x16x32_bf16 v[108:111], a[212:215], a[44:47], v[108:111]
s_waitcnt lgkmcnt(8)
v_xor_b32 v139, 0x8000, v139
v_mfma_f32_16x16x32_bf16 v[48:51], a[216:219], a[32:35], v[48:51]
ds_read_b64_tr_b16 a[208:209], v140 offset:24576
v_mfma_f32_16x16x32_bf16 v[52:55], a[216:219], a[36:39], v[52:55]
v_mfma_f32_16x16x32_bf16 v[112:115], a[216:219], a[40:43], v[112:115]
ds_read_b64_tr_b16 a[210:211], v140 offset:25600
v_mfma_f32_16x16x32_bf16 v[116:119], a[216:219], a[44:47], v[116:119]
v_xor_b32 v140, 0x8000, v140
v_mfma_f32_16x16x32_bf16 v[56:59], a[220:223], a[32:35], v[56:59]
ds_read_b64_tr_b16 a[212:213], v141 offset:24576
v_mfma_f32_16x16x32_bf16 v[60:63], a[220:223], a[36:39], v[60:63]
v_mfma_f32_16x16x32_bf16 v[120:123], a[220:223], a[40:43], v[120:123]
ds_read_b64_tr_b16 a[214:215], v141 offset:25600
v_mfma_f32_16x16x32_bf16 v[124:127], a[220:223], a[44:47], v[124:127]
s_waitcnt vmcnt(16) lgkmcnt(8)
v_xor_b32 v141, 0x8000, v141
v_mfma_f32_16x16x32_bf16 v[0:3], a[192:195], a[48:51], v[0:3]
ds_read_b64_tr_b16 a[216:217], v142 offset:24576
v_mfma_f32_16x16x32_bf16 v[4:7], a[192:195], a[52:55], v[4:7]
buffer_load_dwordx4 a[32:35], v134, s[16:19], s40 offen offset:0
v_mfma_f32_16x16x32_bf16 v[64:67], a[192:195], a[56:59], v[64:67]
ds_read_b64_tr_b16 a[218:219], v142 offset:25600
v_mfma_f32_16x16x32_bf16 v[68:71], a[192:195], a[60:63], v[68:71]
v_xor_b32 v142, 0x8000, v142
v_mfma_f32_16x16x32_bf16 v[8:11], a[196:199], a[48:51], v[8:11]
ds_read_b64_tr_b16 a[220:221], v143 offset:24576
v_mfma_f32_16x16x32_bf16 v[12:15], a[196:199], a[52:55], v[12:15]
buffer_load_dwordx4 a[36:39], v134, s[16:19], s40 offen offset:256
v_mfma_f32_16x16x32_bf16 v[72:75], a[196:199], a[56:59], v[72:75]
ds_read_b64_tr_b16 a[222:223], v143 offset:25600
v_mfma_f32_16x16x32_bf16 v[76:79], a[196:199], a[60:63], v[76:79]
s_waitcnt lgkmcnt(8)
s_waitcnt vmcnt(14)
s_barrier
v_xor_b32 v143, 0x8000, v143
v_mfma_f32_16x16x32_bf16 v[16:19], a[200:203], a[48:51], v[16:19]
ds_read_b64_tr_b16 a[192:193], v136 offset:0
v_mfma_f32_16x16x32_bf16 v[20:23], a[200:203], a[52:55], v[20:23]
buffer_load_dwordx4 a[40:43], v134, s[16:19], s41 offen offset:0
v_mfma_f32_16x16x32_bf16 v[80:83], a[200:203], a[56:59], v[80:83]
ds_read_b64_tr_b16 a[194:195], v136 offset:1024
v_mfma_f32_16x16x32_bf16 v[84:87], a[200:203], a[60:63], v[84:87]
v_mfma_f32_16x16x32_bf16 v[24:27], a[204:207], a[48:51], v[24:27]
ds_read_b64_tr_b16 a[196:197], v137 offset:0
v_mfma_f32_16x16x32_bf16 v[28:31], a[204:207], a[52:55], v[28:31]
buffer_load_dwordx4 a[44:47], v134, s[16:19], s41 offen offset:256
v_mfma_f32_16x16x32_bf16 v[88:91], a[204:207], a[56:59], v[88:91]
ds_read_b64_tr_b16 a[198:199], v137 offset:1024
v_mfma_f32_16x16x32_bf16 v[92:95], a[204:207], a[60:63], v[92:95]
s_waitcnt lgkmcnt(8)
s_add_u32 m0, s43, 0
v_mfma_f32_16x16x32_bf16 v[32:35], a[208:211], a[48:51], v[32:35]
ds_read_b64_tr_b16 a[200:201], v138 offset:0
v_mfma_f32_16x16x32_bf16 v[36:39], a[208:211], a[52:55], v[36:39]
buffer_load_dwordx4 v130, s[12:15], s42 offen offset:0 lds
v_mfma_f32_16x16x32_bf16 v[96:99], a[208:211], a[56:59], v[96:99]
ds_read_b64_tr_b16 a[202:203], v138 offset:1024
v_mfma_f32_16x16x32_bf16 v[100:103], a[208:211], a[60:63], v[100:103]
v_mfma_f32_16x16x32_bf16 v[40:43], a[212:215], a[48:51], v[40:43]
ds_read_b64_tr_b16 a[204:205], v139 offset:0
v_mfma_f32_16x16x32_bf16 v[44:47], a[212:215], a[52:55], v[44:47]
buffer_load_dwordx4 v131, s[12:15], s42 offen offset:1024 lds
v_mfma_f32_16x16x32_bf16 v[104:107], a[212:215], a[56:59], v[104:107]
ds_read_b64_tr_b16 a[206:207], v139 offset:1024
v_mfma_f32_16x16x32_bf16 v[108:111], a[212:215], a[60:63], v[108:111]
s_waitcnt lgkmcnt(8)
v_mfma_f32_16x16x32_bf16 v[48:51], a[216:219], a[48:51], v[48:51]
ds_read_b64_tr_b16 a[208:209], v140 offset:0
v_mfma_f32_16x16x32_bf16 v[52:55], a[216:219], a[52:55], v[52:55]
buffer_load_dwordx4 v132, s[12:15], s42 offen offset:2048 lds
v_mfma_f32_16x16x32_bf16 v[112:115], a[216:219], a[56:59], v[112:115]
ds_read_b64_tr_b16 a[210:211], v140 offset:1024
v_mfma_f32_16x16x32_bf16 v[116:119], a[216:219], a[60:63], v[116:119]
v_mfma_f32_16x16x32_bf16 v[56:59], a[220:223], a[48:51], v[56:59]
ds_read_b64_tr_b16 a[212:213], v141 offset:0
v_mfma_f32_16x16x32_bf16 v[60:63], a[220:223], a[52:55], v[60:63]
buffer_load_dwordx4 v133, s[12:15], s42 offen offset:3072 lds
v_mfma_f32_16x16x32_bf16 v[120:123], a[220:223], a[56:59], v[120:123]
ds_read_b64_tr_b16 a[214:215], v141 offset:1024
v_mfma_f32_16x16x32_bf16 v[124:127], a[220:223], a[60:63], v[124:127]
s_waitcnt vmcnt(16) lgkmcnt(8)
s_add_u32 s42, s42, 131072
s_mov_b32 s46, 4
.p2align 6
L_down_loop:
v_mfma_f32_16x16x32_bf16 v[0:3], a[192:195], a[0:3], v[0:3]
ds_read_b64_tr_b16 a[216:217], v142 offset:0
v_mfma_f32_16x16x32_bf16 v[4:7], a[192:195], a[4:7], v[4:7]
buffer_load_dwordx4 a[48:51], v134, s[16:19], s40 offen offset:2048
v_mfma_f32_16x16x32_bf16 v[64:67], a[192:195], a[8:11], v[64:67]
ds_read_b64_tr_b16 a[218:219], v142 offset:1024
v_mfma_f32_16x16x32_bf16 v[68:71], a[192:195], a[12:15], v[68:71]
v_mfma_f32_16x16x32_bf16 v[8:11], a[196:199], a[0:3], v[8:11]
ds_read_b64_tr_b16 a[220:221], v143 offset:0
v_mfma_f32_16x16x32_bf16 v[12:15], a[196:199], a[4:7], v[12:15]
buffer_load_dwordx4 a[52:55], v134, s[16:19], s40 offen offset:2304
v_mfma_f32_16x16x32_bf16 v[72:75], a[196:199], a[8:11], v[72:75]
ds_read_b64_tr_b16 a[222:223], v143 offset:1024
v_mfma_f32_16x16x32_bf16 v[76:79], a[196:199], a[12:15], v[76:79]
s_waitcnt lgkmcnt(8)
s_add_u32 s40, s40, 4096
v_mfma_f32_16x16x32_bf16 v[16:19], a[200:203], a[0:3], v[16:19]
ds_read_b64_tr_b16 a[192:193], v136 offset:8192
v_mfma_f32_16x16x32_bf16 v[20:23], a[200:203], a[4:7], v[20:23]
buffer_load_dwordx4 a[56:59], v134, s[16:19], s41 offen offset:2048
v_mfma_f32_16x16x32_bf16 v[80:83], a[200:203], a[8:11], v[80:83]
ds_read_b64_tr_b16 a[194:195], v136 offset:9216
v_mfma_f32_16x16x32_bf16 v[84:87], a[200:203], a[12:15], v[84:87]
v_mfma_f32_16x16x32_bf16 v[24:27], a[204:207], a[0:3], v[24:27]
ds_read_b64_tr_b16 a[196:197], v137 offset:8192
v_mfma_f32_16x16x32_bf16 v[28:31], a[204:207], a[4:7], v[28:31]
buffer_load_dwordx4 a[60:63], v134, s[16:19], s41 offen offset:2304
v_mfma_f32_16x16x32_bf16 v[88:91], a[204:207], a[8:11], v[88:91]
ds_read_b64_tr_b16 a[198:199], v137 offset:9216
v_mfma_f32_16x16x32_bf16 v[92:95], a[204:207], a[12:15], v[92:95]
s_waitcnt lgkmcnt(8)
s_add_u32 s41, s41, 4096
v_mfma_f32_16x16x32_bf16 v[32:35], a[208:211], a[0:3], v[32:35]
ds_read_b64_tr_b16 a[200:201], v138 offset:8192
v_mfma_f32_16x16x32_bf16 v[36:39], a[208:211], a[4:7], v[36:39]
v_mfma_f32_16x16x32_bf16 v[96:99], a[208:211], a[8:11], v[96:99]
ds_read_b64_tr_b16 a[202:203], v138 offset:9216
v_mfma_f32_16x16x32_bf16 v[100:103], a[208:211], a[12:15], v[100:103]
v_mfma_f32_16x16x32_bf16 v[40:43], a[212:215], a[0:3], v[40:43]
ds_read_b64_tr_b16 a[204:205], v139 offset:8192
v_mfma_f32_16x16x32_bf16 v[44:47], a[212:215], a[4:7], v[44:47]
v_mfma_f32_16x16x32_bf16 v[104:107], a[212:215], a[8:11], v[104:107]
ds_read_b64_tr_b16 a[206:207], v139 offset:9216
v_mfma_f32_16x16x32_bf16 v[108:111], a[212:215], a[12:15], v[108:111]
s_waitcnt lgkmcnt(8)
v_mfma_f32_16x16x32_bf16 v[48:51], a[216:219], a[0:3], v[48:51]
ds_read_b64_tr_b16 a[208:209], v140 offset:8192
v_mfma_f32_16x16x32_bf16 v[52:55], a[216:219], a[4:7], v[52:55]
v_mfma_f32_16x16x32_bf16 v[112:115], a[216:219], a[8:11], v[112:115]
ds_read_b64_tr_b16 a[210:211], v140 offset:9216
v_mfma_f32_16x16x32_bf16 v[116:119], a[216:219], a[12:15], v[116:119]
v_mfma_f32_16x16x32_bf16 v[56:59], a[220:223], a[0:3], v[56:59]
ds_read_b64_tr_b16 a[212:213], v141 offset:8192
v_mfma_f32_16x16x32_bf16 v[60:63], a[220:223], a[4:7], v[60:63]
v_mfma_f32_16x16x32_bf16 v[120:123], a[220:223], a[8:11], v[120:123]
ds_read_b64_tr_b16 a[214:215], v141 offset:9216
v_mfma_f32_16x16x32_bf16 v[124:127], a[220:223], a[12:15], v[124:127]
s_waitcnt vmcnt(12) lgkmcnt(8)
v_mfma_f32_16x16x32_bf16 v[0:3], a[192:195], a[16:19], v[0:3]
ds_read_b64_tr_b16 a[216:217], v142 offset:8192
v_mfma_f32_16x16x32_bf16 v[4:7], a[192:195], a[20:23], v[4:7]
buffer_load_dwordx4 a[0:3], v134, s[16:19], s40 offen offset:0
v_mfma_f32_16x16x32_bf16 v[64:67], a[192:195], a[24:27], v[64:67]
ds_read_b64_tr_b16 a[218:219], v142 offset:9216
v_mfma_f32_16x16x32_bf16 v[68:71], a[192:195], a[28:31], v[68:71]
v_mfma_f32_16x16x32_bf16 v[8:11], a[196:199], a[16:19], v[8:11]
ds_read_b64_tr_b16 a[220:221], v143 offset:8192
v_mfma_f32_16x16x32_bf16 v[12:15], a[196:199], a[20:23], v[12:15]
buffer_load_dwordx4 a[4:7], v134, s[16:19], s40 offen offset:256
v_mfma_f32_16x16x32_bf16 v[72:75], a[196:199], a[24:27], v[72:75]
ds_read_b64_tr_b16 a[222:223], v143 offset:9216
v_mfma_f32_16x16x32_bf16 v[76:79], a[196:199], a[28:31], v[76:79]
s_waitcnt lgkmcnt(8)
s_barrier
v_mfma_f32_16x16x32_bf16 v[16:19], a[200:203], a[16:19], v[16:19]
ds_read_b64_tr_b16 a[192:193], v136 offset:16384
v_mfma_f32_16x16x32_bf16 v[20:23], a[200:203], a[20:23], v[20:23]
buffer_load_dwordx4 a[8:11], v134, s[16:19], s41 offen offset:0
v_mfma_f32_16x16x32_bf16 v[80:83], a[200:203], a[24:27], v[80:83]
ds_read_b64_tr_b16 a[194:195], v136 offset:17408
v_mfma_f32_16x16x32_bf16 v[84:87], a[200:203], a[28:31], v[84:87]
v_mfma_f32_16x16x32_bf16 v[24:27], a[204:207], a[16:19], v[24:27]
ds_read_b64_tr_b16 a[196:197], v137 offset:16384
v_mfma_f32_16x16x32_bf16 v[28:31], a[204:207], a[20:23], v[28:31]
buffer_load_dwordx4 a[12:15], v134, s[16:19], s41 offen offset:256
v_mfma_f32_16x16x32_bf16 v[88:91], a[204:207], a[24:27], v[88:91]
ds_read_b64_tr_b16 a[198:199], v137 offset:17408
v_mfma_f32_16x16x32_bf16 v[92:95], a[204:207], a[28:31], v[92:95]
s_waitcnt lgkmcnt(8)
s_add_u32 m0, s43, 16384
v_mfma_f32_16x16x32_bf16 v[32:35], a[208:211], a[16:19], v[32:35]
ds_read_b64_tr_b16 a[200:201], v138 offset:16384
v_mfma_f32_16x16x32_bf16 v[36:39], a[208:211], a[20:23], v[36:39]
buffer_load_dwordx4 v130, s[12:15], s42 offen offset:0 lds
v_mfma_f32_16x16x32_bf16 v[96:99], a[208:211], a[24:27], v[96:99]
ds_read_b64_tr_b16 a[202:203], v138 offset:17408
v_mfma_f32_16x16x32_bf16 v[100:103], a[208:211], a[28:31], v[100:103]
v_mfma_f32_16x16x32_bf16 v[40:43], a[212:215], a[16:19], v[40:43]
ds_read_b64_tr_b16 a[204:205], v139 offset:16384
v_mfma_f32_16x16x32_bf16 v[44:47], a[212:215], a[20:23], v[44:47]
buffer_load_dwordx4 v131, s[12:15], s42 offen offset:1024 lds
v_mfma_f32_16x16x32_bf16 v[104:107], a[212:215], a[24:27], v[104:107]
ds_read_b64_tr_b16 a[206:207], v139 offset:17408
v_mfma_f32_16x16x32_bf16 v[108:111], a[212:215], a[28:31], v[108:111]
s_waitcnt lgkmcnt(8)
s_xor_b32 s43, s43, 0x8000
v_mfma_f32_16x16x32_bf16 v[48:51], a[216:219], a[16:19], v[48:51]
ds_read_b64_tr_b16 a[208:209], v140 offset:16384
v_mfma_f32_16x16x32_bf16 v[52:55], a[216:219], a[20:23], v[52:55]
buffer_load_dwordx4 v132, s[12:15], s42 offen offset:2048 lds
v_mfma_f32_16x16x32_bf16 v[112:115], a[216:219], a[24:27], v[112:115]
ds_read_b64_tr_b16 a[210:211], v140 offset:17408
v_mfma_f32_16x16x32_bf16 v[116:119], a[216:219], a[28:31], v[116:119]
v_mfma_f32_16x16x32_bf16 v[56:59], a[220:223], a[16:19], v[56:59]
ds_read_b64_tr_b16 a[212:213], v141 offset:16384
v_mfma_f32_16x16x32_bf16 v[60:63], a[220:223], a[20:23], v[60:63]
buffer_load_dwordx4 v133, s[12:15], s42 offen offset:3072 lds
v_mfma_f32_16x16x32_bf16 v[120:123], a[220:223], a[24:27], v[120:123]
ds_read_b64_tr_b16 a[214:215], v141 offset:17408
v_mfma_f32_16x16x32_bf16 v[124:127], a[220:223], a[28:31], v[124:127]
s_waitcnt vmcnt(16) lgkmcnt(8)
s_add_u32 s42, s42, 131072
v_mfma_f32_16x16x32_bf16 v[0:3], a[192:195], a[32:35], v[0:3]
ds_read_b64_tr_b16 a[216:217], v142 offset:16384
v_mfma_f32_16x16x32_bf16 v[4:7], a[192:195], a[36:39], v[4:7]
buffer_load_dwordx4 a[16:19], v134, s[16:19], s40 offen offset:2048
v_mfma_f32_16x16x32_bf16 v[64:67], a[192:195], a[40:43], v[64:67]
ds_read_b64_tr_b16 a[218:219], v142 offset:17408
v_mfma_f32_16x16x32_bf16 v[68:71], a[192:195], a[44:47], v[68:71]
v_mfma_f32_16x16x32_bf16 v[8:11], a[196:199], a[32:35], v[8:11]
ds_read_b64_tr_b16 a[220:221], v143 offset:16384
v_mfma_f32_16x16x32_bf16 v[12:15], a[196:199], a[36:39], v[12:15]
buffer_load_dwordx4 a[20:23], v134, s[16:19], s40 offen offset:2304
v_mfma_f32_16x16x32_bf16 v[72:75], a[196:199], a[40:43], v[72:75]
ds_read_b64_tr_b16 a[222:223], v143 offset:17408
v_mfma_f32_16x16x32_bf16 v[76:79], a[196:199], a[44:47], v[76:79]
s_waitcnt lgkmcnt(8)
s_add_u32 s40, s40, 4096
v_mfma_f32_16x16x32_bf16 v[16:19], a[200:203], a[32:35], v[16:19]
ds_read_b64_tr_b16 a[192:193], v136 offset:24576
v_mfma_f32_16x16x32_bf16 v[20:23], a[200:203], a[36:39], v[20:23]
buffer_load_dwordx4 a[24:27], v134, s[16:19], s41 offen offset:2048
v_mfma_f32_16x16x32_bf16 v[80:83], a[200:203], a[40:43], v[80:83]
ds_read_b64_tr_b16 a[194:195], v136 offset:25600
v_mfma_f32_16x16x32_bf16 v[84:87], a[200:203], a[44:47], v[84:87]
v_xor_b32 v136, 0x8000, v136
v_mfma_f32_16x16x32_bf16 v[24:27], a[204:207], a[32:35], v[24:27]
ds_read_b64_tr_b16 a[196:197], v137 offset:24576
v_mfma_f32_16x16x32_bf16 v[28:31], a[204:207], a[36:39], v[28:31]
buffer_load_dwordx4 a[28:31], v134, s[16:19], s41 offen offset:2304
v_mfma_f32_16x16x32_bf16 v[88:91], a[204:207], a[40:43], v[88:91]
ds_read_b64_tr_b16 a[198:199], v137 offset:25600
v_mfma_f32_16x16x32_bf16 v[92:95], a[204:207], a[44:47], v[92:95]
s_waitcnt lgkmcnt(8)
v_xor_b32 v137, 0x8000, v137
s_add_u32 s41, s41, 4096
v_mfma_f32_16x16x32_bf16 v[32:35], a[208:211], a[32:35], v[32:35]
ds_read_b64_tr_b16 a[200:201], v138 offset:24576
v_mfma_f32_16x16x32_bf16 v[36:39], a[208:211], a[36:39], v[36:39]
v_mfma_f32_16x16x32_bf16 v[96:99], a[208:211], a[40:43], v[96:99]
ds_read_b64_tr_b16 a[202:203], v138 offset:25600
v_mfma_f32_16x16x32_bf16 v[100:103], a[208:211], a[44:47], v[100:103]
v_xor_b32 v138, 0x8000, v138
v_mfma_f32_16x16x32_bf16 v[40:43], a[212:215], a[32:35], v[40:43]
ds_read_b64_tr_b16 a[204:205], v139 offset:24576
v_mfma_f32_16x16x32_bf16 v[44:47], a[212:215], a[36:39], v[44:47]
v_mfma_f32_16x16x32_bf16 v[104:107], a[212:215], a[40:43], v[104:107]
ds_read_b64_tr_b16 a[206:207], v139 offset:25600
v_mfma_f32_16x16x32_bf16 v[108:111], a[212:215], a[44:47], v[108:111]
s_waitcnt lgkmcnt(8)
v_xor_b32 v139, 0x8000, v139
v_mfma_f32_16x16x32_bf16 v[48:51], a[216:219], a[32:35], v[48:51]
ds_read_b64_tr_b16 a[208:209], v140 offset:24576
v_mfma_f32_16x16x32_bf16 v[52:55], a[216:219], a[36:39], v[52:55]
v_mfma_f32_16x16x32_bf16 v[112:115], a[216:219], a[40:43], v[112:115]
ds_read_b64_tr_b16 a[210:211], v140 offset:25600
v_mfma_f32_16x16x32_bf16 v[116:119], a[216:219], a[44:47], v[116:119]
v_xor_b32 v140, 0x8000, v140
v_mfma_f32_16x16x32_bf16 v[56:59], a[220:223], a[32:35], v[56:59]
ds_read_b64_tr_b16 a[212:213], v141 offset:24576
v_mfma_f32_16x16x32_bf16 v[60:63], a[220:223], a[36:39], v[60:63]
v_mfma_f32_16x16x32_bf16 v[120:123], a[220:223], a[40:43], v[120:123]
ds_read_b64_tr_b16 a[214:215], v141 offset:25600
v_mfma_f32_16x16x32_bf16 v[124:127], a[220:223], a[44:47], v[124:127]
s_waitcnt vmcnt(12) lgkmcnt(8)
v_xor_b32 v141, 0x8000, v141
v_mfma_f32_16x16x32_bf16 v[0:3], a[192:195], a[48:51], v[0:3]
ds_read_b64_tr_b16 a[216:217], v142 offset:24576
v_mfma_f32_16x16x32_bf16 v[4:7], a[192:195], a[52:55], v[4:7]
buffer_load_dwordx4 a[32:35], v134, s[16:19], s40 offen offset:0
v_mfma_f32_16x16x32_bf16 v[64:67], a[192:195], a[56:59], v[64:67]
ds_read_b64_tr_b16 a[218:219], v142 offset:25600
v_mfma_f32_16x16x32_bf16 v[68:71], a[192:195], a[60:63], v[68:71]
v_xor_b32 v142, 0x8000, v142
v_mfma_f32_16x16x32_bf16 v[8:11], a[196:199], a[48:51], v[8:11]
ds_read_b64_tr_b16 a[220:221], v143 offset:24576
v_mfma_f32_16x16x32_bf16 v[12:15], a[196:199], a[52:55], v[12:15]
buffer_load_dwordx4 a[36:39], v134, s[16:19], s40 offen offset:256
v_mfma_f32_16x16x32_bf16 v[72:75], a[196:199], a[56:59], v[72:75]
ds_read_b64_tr_b16 a[222:223], v143 offset:25600
v_mfma_f32_16x16x32_bf16 v[76:79], a[196:199], a[60:63], v[76:79]
s_waitcnt lgkmcnt(8)
s_barrier
v_xor_b32 v143, 0x8000, v143
v_mfma_f32_16x16x32_bf16 v[16:19], a[200:203], a[48:51], v[16:19]
ds_read_b64_tr_b16 a[192:193], v136 offset:0
v_mfma_f32_16x16x32_bf16 v[20:23], a[200:203], a[52:55], v[20:23]
buffer_load_dwordx4 a[40:43], v134, s[16:19], s41 offen offset:0
v_mfma_f32_16x16x32_bf16 v[80:83], a[200:203], a[56:59], v[80:83]
ds_read_b64_tr_b16 a[194:195], v136 offset:1024
v_mfma_f32_16x16x32_bf16 v[84:87], a[200:203], a[60:63], v[84:87]
v_mfma_f32_16x16x32_bf16 v[24:27], a[204:207], a[48:51], v[24:27]
ds_read_b64_tr_b16 a[196:197], v137 offset:0
v_mfma_f32_16x16x32_bf16 v[28:31], a[204:207], a[52:55], v[28:31]
buffer_load_dwordx4 a[44:47], v134, s[16:19], s41 offen offset:256
v_mfma_f32_16x16x32_bf16 v[88:91], a[204:207], a[56:59], v[88:91]
ds_read_b64_tr_b16 a[198:199], v137 offset:1024
v_mfma_f32_16x16x32_bf16 v[92:95], a[204:207], a[60:63], v[92:95]
s_waitcnt lgkmcnt(8)
s_add_u32 m0, s43, 0
v_mfma_f32_16x16x32_bf16 v[32:35], a[208:211], a[48:51], v[32:35]
ds_read_b64_tr_b16 a[200:201], v138 offset:0
v_mfma_f32_16x16x32_bf16 v[36:39], a[208:211], a[52:55], v[36:39]
buffer_load_dwordx4 v130, s[12:15], s42 offen offset:0 lds
v_mfma_f32_16x16x32_bf16 v[96:99], a[208:211], a[56:59], v[96:99]
ds_read_b64_tr_b16 a[202:203], v138 offset:1024
v_mfma_f32_16x16x32_bf16 v[100:103], a[208:211], a[60:63], v[100:103]
v_mfma_f32_16x16x32_bf16 v[40:43], a[212:215], a[48:51], v[40:43]
ds_read_b64_tr_b16 a[204:205], v139 offset:0
v_mfma_f32_16x16x32_bf16 v[44:47], a[212:215], a[52:55], v[44:47]
buffer_load_dwordx4 v131, s[12:15], s42 offen offset:1024 lds
v_mfma_f32_16x16x32_bf16 v[104:107], a[212:215], a[56:59], v[104:107]
ds_read_b64_tr_b16 a[206:207], v139 offset:1024
v_mfma_f32_16x16x32_bf16 v[108:111], a[212:215], a[60:63], v[108:111]
s_waitcnt lgkmcnt(8)
v_mfma_f32_16x16x32_bf16 v[48:51], a[216:219], a[48:51], v[48:51]
ds_read_b64_tr_b16 a[208:209], v140 offset:0
v_mfma_f32_16x16x32_bf16 v[52:55], a[216:219], a[52:55], v[52:55]
buffer_load_dwordx4 v132, s[12:15], s42 offen offset:2048 lds
v_mfma_f32_16x16x32_bf16 v[112:115], a[216:219], a[56:59], v[112:115]
ds_read_b64_tr_b16 a[210:211], v140 offset:1024
v_mfma_f32_16x16x32_bf16 v[116:119], a[216:219], a[60:63], v[116:119]
v_mfma_f32_16x16x32_bf16 v[56:59], a[220:223], a[48:51], v[56:59]
ds_read_b64_tr_b16 a[212:213], v141 offset:0
v_mfma_f32_16x16x32_bf16 v[60:63], a[220:223], a[52:55], v[60:63]
buffer_load_dwordx4 v133, s[12:15], s42 offen offset:3072 lds
v_mfma_f32_16x16x32_bf16 v[120:123], a[220:223], a[56:59], v[120:123]
ds_read_b64_tr_b16 a[214:215], v141 offset:1024
v_mfma_f32_16x16x32_bf16 v[124:127], a[220:223], a[60:63], v[124:127]
s_waitcnt vmcnt(16) lgkmcnt(8)
s_add_u32 s42, s42, 131072
s_sub_u32 s46, s46, 1
s_cmp_lg_u32 s46, 0
s_cbranch_scc1 L_down_loop
v_mfma_f32_16x16x32_bf16 v[0:3], a[192:195], a[0:3], v[0:3]
ds_read_b64_tr_b16 a[216:217], v142 offset:0
v_mfma_f32_16x16x32_bf16 v[4:7], a[192:195], a[4:7], v[4:7]
buffer_load_dwordx4 a[48:51], v134, s[16:19], s40 offen offset:2048
v_mfma_f32_16x16x32_bf16 v[64:67], a[192:195], a[8:11], v[64:67]
ds_read_b64_tr_b16 a[218:219], v142 offset:1024
v_mfma_f32_16x16x32_bf16 v[68:71], a[192:195], a[12:15], v[68:71]
v_mfma_f32_16x16x32_bf16 v[8:11], a[196:199], a[0:3], v[8:11]
ds_read_b64_tr_b16 a[220:221], v143 offset:0
v_mfma_f32_16x16x32_bf16 v[12:15], a[196:199], a[4:7], v[12:15]
buffer_load_dwordx4 a[52:55], v134, s[16:19], s40 offen offset:2304
v_mfma_f32_16x16x32_bf16 v[72:75], a[196:199], a[8:11], v[72:75]
ds_read_b64_tr_b16 a[222:223], v143 offset:1024
v_mfma_f32_16x16x32_bf16 v[76:79], a[196:199], a[12:15], v[76:79]
s_waitcnt lgkmcnt(8)
s_add_u32 s40, s40, 4096
v_mfma_f32_16x16x32_bf16 v[16:19], a[200:203], a[0:3], v[16:19]
ds_read_b64_tr_b16 a[192:193], v136 offset:8192
v_mfma_f32_16x16x32_bf16 v[20:23], a[200:203], a[4:7], v[20:23]
buffer_load_dwordx4 a[56:59], v134, s[16:19], s41 offen offset:2048
v_mfma_f32_16x16x32_bf16 v[80:83], a[200:203], a[8:11], v[80:83]
ds_read_b64_tr_b16 a[194:195], v136 offset:9216
v_mfma_f32_16x16x32_bf16 v[84:87], a[200:203], a[12:15], v[84:87]
v_mfma_f32_16x16x32_bf16 v[24:27], a[204:207], a[0:3], v[24:27]
ds_read_b64_tr_b16 a[196:197], v137 offset:8192
v_mfma_f32_16x16x32_bf16 v[28:31], a[204:207], a[4:7], v[28:31]
buffer_load_dwordx4 a[60:63], v134, s[16:19], s41 offen offset:2304
v_mfma_f32_16x16x32_bf16 v[88:91], a[204:207], a[8:11], v[88:91]
ds_read_b64_tr_b16 a[198:199], v137 offset:9216
v_mfma_f32_16x16x32_bf16 v[92:95], a[204:207], a[12:15], v[92:95]
s_waitcnt lgkmcnt(8)
s_add_u32 s41, s41, 4096
v_mfma_f32_16x16x32_bf16 v[32:35], a[208:211], a[0:3], v[32:35]
ds_read_b64_tr_b16 a[200:201], v138 offset:8192
v_mfma_f32_16x16x32_bf16 v[36:39], a[208:211], a[4:7], v[36:39]
buffer_load_dwordx4 a[64:67], v134, s[16:19], s60 offen offset:0
v_mfma_f32_16x16x32_bf16 v[96:99], a[208:211], a[8:11], v[96:99]
ds_read_b64_tr_b16 a[202:203], v138 offset:9216
v_mfma_f32_16x16x32_bf16 v[100:103], a[208:211], a[12:15], v[100:103]
v_mfma_f32_16x16x32_bf16 v[40:43], a[212:215], a[0:3], v[40:43]
ds_read_b64_tr_b16 a[204:205], v139 offset:8192
v_mfma_f32_16x16x32_bf16 v[44:47], a[212:215], a[4:7], v[44:47]
buffer_load_dwordx4 a[68:71], v134, s[16:19], s60 offen offset:256
v_mfma_f32_16x16x32_bf16 v[104:107], a[212:215], a[8:11], v[104:107]
ds_read_b64_tr_b16 a[206:207], v139 offset:9216
v_mfma_f32_16x16x32_bf16 v[108:111], a[212:215], a[12:15], v[108:111]
s_waitcnt lgkmcnt(8)
v_mfma_f32_16x16x32_bf16 v[48:51], a[216:219], a[0:3], v[48:51]
ds_read_b64_tr_b16 a[208:209], v140 offset:8192
v_mfma_f32_16x16x32_bf16 v[52:55], a[216:219], a[4:7], v[52:55]
buffer_load_dwordx4 a[72:75], v134, s[16:19], s61 offen offset:0
v_mfma_f32_16x16x32_bf16 v[112:115], a[216:219], a[8:11], v[112:115]
ds_read_b64_tr_b16 a[210:211], v140 offset:9216
v_mfma_f32_16x16x32_bf16 v[116:119], a[216:219], a[12:15], v[116:119]
v_mfma_f32_16x16x32_bf16 v[56:59], a[220:223], a[0:3], v[56:59]
ds_read_b64_tr_b16 a[212:213], v141 offset:8192
v_mfma_f32_16x16x32_bf16 v[60:63], a[220:223], a[4:7], v[60:63]
buffer_load_dwordx4 a[76:79], v134, s[16:19], s61 offen offset:256
v_mfma_f32_16x16x32_bf16 v[120:123], a[220:223], a[8:11], v[120:123]
ds_read_b64_tr_b16 a[214:215], v141 offset:9216
v_mfma_f32_16x16x32_bf16 v[124:127], a[220:223], a[12:15], v[124:127]
s_waitcnt vmcnt(16) lgkmcnt(8)
v_mfma_f32_16x16x32_bf16 v[0:3], a[192:195], a[16:19], v[0:3]
ds_read_b64_tr_b16 a[216:217], v142 offset:8192
v_mfma_f32_16x16x32_bf16 v[4:7], a[192:195], a[20:23], v[4:7]
buffer_load_dwordx4 a[80:83], v134, s[16:19], s60 offen offset:2048
v_mfma_f32_16x16x32_bf16 v[64:67], a[192:195], a[24:27], v[64:67]
ds_read_b64_tr_b16 a[218:219], v142 offset:9216
v_mfma_f32_16x16x32_bf16 v[68:71], a[192:195], a[28:31], v[68:71]
v_mfma_f32_16x16x32_bf16 v[8:11], a[196:199], a[16:19], v[8:11]
ds_read_b64_tr_b16 a[220:221], v143 offset:8192
v_mfma_f32_16x16x32_bf16 v[12:15], a[196:199], a[20:23], v[12:15]
buffer_load_dwordx4 a[84:87], v134, s[16:19], s60 offen offset:2304
v_mfma_f32_16x16x32_bf16 v[72:75], a[196:199], a[24:27], v[72:75]
ds_read_b64_tr_b16 a[222:223], v143 offset:9216
v_mfma_f32_16x16x32_bf16 v[76:79], a[196:199], a[28:31], v[76:79]
s_waitcnt lgkmcnt(8)
s_barrier
s_add_u32 s60, s60, 4096
v_mfma_f32_16x16x32_bf16 v[16:19], a[200:203], a[16:19], v[16:19]
ds_read_b64_tr_b16 a[192:193], v136 offset:16384
v_mfma_f32_16x16x32_bf16 v[20:23], a[200:203], a[20:23], v[20:23]
buffer_load_dwordx4 a[88:91], v134, s[16:19], s61 offen offset:2048
v_mfma_f32_16x16x32_bf16 v[80:83], a[200:203], a[24:27], v[80:83]
ds_read_b64_tr_b16 a[194:195], v136 offset:17408
v_mfma_f32_16x16x32_bf16 v[84:87], a[200:203], a[28:31], v[84:87]
s_add_u32 m0, s43, 16384
v_mfma_f32_16x16x32_bf16 v[24:27], a[204:207], a[16:19], v[24:27]
ds_read_b64_tr_b16 a[196:197], v137 offset:16384
v_mfma_f32_16x16x32_bf16 v[28:31], a[204:207], a[20:23], v[28:31]
buffer_load_dwordx4 v130, s[12:15], s42 offen offset:0 lds
v_mfma_f32_16x16x32_bf16 v[88:91], a[204:207], a[24:27], v[88:91]
ds_read_b64_tr_b16 a[198:199], v137 offset:17408
v_mfma_f32_16x16x32_bf16 v[92:95], a[204:207], a[28:31], v[92:95]
s_waitcnt lgkmcnt(8)
v_mfma_f32_16x16x32_bf16 v[32:35], a[208:211], a[16:19], v[32:35]
ds_read_b64_tr_b16 a[200:201], v138 offset:16384
v_mfma_f32_16x16x32_bf16 v[36:39], a[208:211], a[20:23], v[36:39]
buffer_load_dwordx4 v131, s[12:15], s42 offen offset:1024 lds
v_mfma_f32_16x16x32_bf16 v[96:99], a[208:211], a[24:27], v[96:99]
ds_read_b64_tr_b16 a[202:203], v138 offset:17408
v_mfma_f32_16x16x32_bf16 v[100:103], a[208:211], a[28:31], v[100:103]
s_xor_b32 s43, s43, 0x8000
v_mfma_f32_16x16x32_bf16 v[40:43], a[212:215], a[16:19], v[40:43]
ds_read_b64_tr_b16 a[204:205], v139 offset:16384
v_mfma_f32_16x16x32_bf16 v[44:47], a[212:215], a[20:23], v[44:47]
buffer_load_dwordx4 v132, s[12:15], s42 offen offset:2048 lds
v_mfma_f32_16x16x32_bf16 v[104:107], a[212:215], a[24:27], v[104:107]
ds_read_b64_tr_b16 a[206:207], v139 offset:17408
v_mfma_f32_16x16x32_bf16 v[108:111], a[212:215], a[28:31], v[108:111]
s_waitcnt lgkmcnt(8)
v_mfma_f32_16x16x32_bf16 v[48:51], a[216:219], a[16:19], v[48:51]
ds_read_b64_tr_b16 a[208:209], v140 offset:16384
v_mfma_f32_16x16x32_bf16 v[52:55], a[216:219], a[20:23], v[52:55]
buffer_load_dwordx4 v133, s[12:15], s42 offen offset:3072 lds
v_mfma_f32_16x16x32_bf16 v[112:115], a[216:219], a[24:27], v[112:115]
ds_read_b64_tr_b16 a[210:211], v140 offset:17408
v_mfma_f32_16x16x32_bf16 v[116:119], a[216:219], a[28:31], v[116:119]
s_add_u32 s42, s42, 131072
v_mfma_f32_16x16x32_bf16 v[56:59], a[220:223], a[16:19], v[56:59]
ds_read_b64_tr_b16 a[212:213], v141 offset:16384
v_mfma_f32_16x16x32_bf16 v[60:63], a[220:223], a[20:23], v[60:63]
buffer_load_dwordx4 a[92:95], v134, s[16:19], s61 offen offset:2304
v_mfma_f32_16x16x32_bf16 v[120:123], a[220:223], a[24:27], v[120:123]
ds_read_b64_tr_b16 a[214:215], v141 offset:17408
v_mfma_f32_16x16x32_bf16 v[124:127], a[220:223], a[28:31], v[124:127]
s_waitcnt vmcnt(20) lgkmcnt(8)
s_add_u32 s61, s61, 4096
v_mfma_f32_16x16x32_bf16 v[0:3], a[192:195], a[32:35], v[0:3]
ds_read_b64_tr_b16 a[216:217], v142 offset:16384
v_mfma_f32_16x16x32_bf16 v[4:7], a[192:195], a[36:39], v[4:7]
buffer_load_dwordx4 a[96:99], v134, s[16:19], s60 offen offset:0
v_mfma_f32_16x16x32_bf16 v[64:67], a[192:195], a[40:43], v[64:67]
ds_read_b64_tr_b16 a[218:219], v142 offset:17408
v_mfma_f32_16x16x32_bf16 v[68:71], a[192:195], a[44:47], v[68:71]
v_mfma_f32_16x16x32_bf16 v[8:11], a[196:199], a[32:35], v[8:11]
ds_read_b64_tr_b16 a[220:221], v143 offset:16384
v_mfma_f32_16x16x32_bf16 v[12:15], a[196:199], a[36:39], v[12:15]
buffer_load_dwordx4 a[100:103], v134, s[16:19], s60 offen offset:256
v_mfma_f32_16x16x32_bf16 v[72:75], a[196:199], a[40:43], v[72:75]
ds_read_b64_tr_b16 a[222:223], v143 offset:17408
v_mfma_f32_16x16x32_bf16 v[76:79], a[196:199], a[44:47], v[76:79]
s_waitcnt lgkmcnt(8)
v_mfma_f32_16x16x32_bf16 v[16:19], a[200:203], a[32:35], v[16:19]
ds_read_b64_tr_b16 a[192:193], v136 offset:24576
v_mfma_f32_16x16x32_bf16 v[20:23], a[200:203], a[36:39], v[20:23]
buffer_load_dwordx4 a[104:107], v134, s[16:19], s61 offen offset:0
v_mfma_f32_16x16x32_bf16 v[80:83], a[200:203], a[40:43], v[80:83]
ds_read_b64_tr_b16 a[194:195], v136 offset:25600
v_mfma_f32_16x16x32_bf16 v[84:87], a[200:203], a[44:47], v[84:87]
v_xor_b32 v136, 0x8000, v136
v_mfma_f32_16x16x32_bf16 v[24:27], a[204:207], a[32:35], v[24:27]
ds_read_b64_tr_b16 a[196:197], v137 offset:24576
v_mfma_f32_16x16x32_bf16 v[28:31], a[204:207], a[36:39], v[28:31]
buffer_load_dwordx4 a[108:111], v134, s[16:19], s61 offen offset:256
v_mfma_f32_16x16x32_bf16 v[88:91], a[204:207], a[40:43], v[88:91]
ds_read_b64_tr_b16 a[198:199], v137 offset:25600
v_mfma_f32_16x16x32_bf16 v[92:95], a[204:207], a[44:47], v[92:95]
s_waitcnt lgkmcnt(8)
v_xor_b32 v137, 0x8000, v137
v_mfma_f32_16x16x32_bf16 v[32:35], a[208:211], a[32:35], v[32:35]
ds_read_b64_tr_b16 a[200:201], v138 offset:24576
v_mfma_f32_16x16x32_bf16 v[36:39], a[208:211], a[36:39], v[36:39]
buffer_load_dwordx4 a[112:115], v134, s[16:19], s60 offen offset:2048
v_mfma_f32_16x16x32_bf16 v[96:99], a[208:211], a[40:43], v[96:99]
ds_read_b64_tr_b16 a[202:203], v138 offset:25600
v_mfma_f32_16x16x32_bf16 v[100:103], a[208:211], a[44:47], v[100:103]
v_xor_b32 v138, 0x8000, v138
v_mfma_f32_16x16x32_bf16 v[40:43], a[212:215], a[32:35], v[40:43]
ds_read_b64_tr_b16 a[204:205], v139 offset:24576
v_mfma_f32_16x16x32_bf16 v[44:47], a[212:215], a[36:39], v[44:47]
buffer_load_dwordx4 a[116:119], v134, s[16:19], s60 offen offset:2304
v_mfma_f32_16x16x32_bf16 v[104:107], a[212:215], a[40:43], v[104:107]
ds_read_b64_tr_b16 a[206:207], v139 offset:25600
v_mfma_f32_16x16x32_bf16 v[108:111], a[212:215], a[44:47], v[108:111]
s_waitcnt lgkmcnt(8)
v_xor_b32 v139, 0x8000, v139
s_add_u32 s60, s60, 4096
v_mfma_f32_16x16x32_bf16 v[48:51], a[216:219], a[32:35], v[48:51]
ds_read_b64_tr_b16 a[208:209], v140 offset:24576
v_mfma_f32_16x16x32_bf16 v[52:55], a[216:219], a[36:39], v[52:55]
buffer_load_dwordx4 a[120:123], v134, s[16:19], s61 offen offset:2048
v_mfma_f32_16x16x32_bf16 v[112:115], a[216:219], a[40:43], v[112:115]
ds_read_b64_tr_b16 a[210:211], v140 offset:25600
v_mfma_f32_16x16x32_bf16 v[116:119], a[216:219], a[44:47], v[116:119]
v_xor_b32 v140, 0x8000, v140
v_mfma_f32_16x16x32_bf16 v[56:59], a[220:223], a[32:35], v[56:59]
ds_read_b64_tr_b16 a[212:213], v141 offset:24576
v_mfma_f32_16x16x32_bf16 v[60:63], a[220:223], a[36:39], v[60:63]
buffer_load_dwordx4 a[124:127], v134, s[16:19], s61 offen offset:2304
v_mfma_f32_16x16x32_bf16 v[120:123], a[220:223], a[40:43], v[120:123]
ds_read_b64_tr_b16 a[214:215], v141 offset:25600
v_mfma_f32_16x16x32_bf16 v[124:127], a[220:223], a[44:47], v[124:127]
s_waitcnt vmcnt(20) lgkmcnt(8)
v_xor_b32 v141, 0x8000, v141
s_add_u32 s61, s61, 4096
v_mfma_f32_16x16x32_bf16 v[0:3], a[192:195], a[48:51], v[0:3]
ds_read_b64_tr_b16 a[216:217], v142 offset:24576
v_mfma_f32_16x16x32_bf16 v[4:7], a[192:195], a[52:55], v[4:7]
buffer_load_dwordx4 v[160:163], v129, s[24:27], s47 offen offset:0
v_mfma_f32_16x16x32_bf16 v[64:67], a[192:195], a[56:59], v[64:67]
ds_read_b64_tr_b16 a[218:219], v142 offset:25600
v_mfma_f32_16x16x32_bf16 v[68:71], a[192:195], a[60:63], v[68:71]
v_xor_b32 v142, 0x8000, v142
v_mfma_f32_16x16x32_bf16 v[8:11], a[196:199], a[48:51], v[8:11]
ds_read_b64_tr_b16 a[220:221], v143 offset:24576
v_mfma_f32_16x16x32_bf16 v[12:15], a[196:199], a[52:55], v[12:15]
buffer_load_dwordx4 v[164:167], v129, s[24:27], s47 offen offset:1024
v_mfma_f32_16x16x32_bf16 v[72:75], a[196:199], a[56:59], v[72:75]
ds_read_b64_tr_b16 a[222:223], v143 offset:25600
v_mfma_f32_16x16x32_bf16 v[76:79], a[196:199], a[60:63], v[76:79]
s_waitcnt lgkmcnt(8)
s_barrier
v_xor_b32 v143, 0x8000, v143
v_mfma_f32_16x16x32_bf16 v[16:19], a[200:203], a[48:51], v[16:19]
ds_read_b64_tr_b16 a[192:193], v136 offset:0
v_mfma_f32_16x16x32_bf16 v[20:23], a[200:203], a[52:55], v[20:23]
buffer_load_dwordx4 v[168:171], v129, s[24:27], s48 offen offset:0
v_mfma_f32_16x16x32_bf16 v[80:83], a[200:203], a[56:59], v[80:83]
ds_read_b64_tr_b16 a[194:195], v136 offset:1024
v_mfma_f32_16x16x32_bf16 v[84:87], a[200:203], a[60:63], v[84:87]
v_mfma_f32_16x16x32_bf16 v[24:27], a[204:207], a[48:51], v[24:27]
ds_read_b64_tr_b16 a[196:197], v137 offset:0
v_mfma_f32_16x16x32_bf16 v[28:31], a[204:207], a[52:55], v[28:31]
buffer_load_dwordx4 v[172:175], v129, s[24:27], s48 offen offset:1024
v_mfma_f32_16x16x32_bf16 v[88:91], a[204:207], a[56:59], v[88:91]
ds_read_b64_tr_b16 a[198:199], v137 offset:1024
v_mfma_f32_16x16x32_bf16 v[92:95], a[204:207], a[60:63], v[92:95]
s_waitcnt lgkmcnt(8)
v_mfma_f32_16x16x32_bf16 v[32:35], a[208:211], a[48:51], v[32:35]
ds_read_b64_tr_b16 a[200:201], v136 offset:8192
v_mfma_f32_16x16x32_bf16 v[36:39], a[208:211], a[52:55], v[36:39]
buffer_load_dwordx4 v[176:179], v135, s[52:55], s50 offen offset:0
v_mfma_f32_16x16x32_bf16 v[96:99], a[208:211], a[56:59], v[96:99]
ds_read_b64_tr_b16 a[202:203], v136 offset:9216
v_mfma_f32_16x16x32_bf16 v[100:103], a[208:211], a[60:63], v[100:103]
v_mfma_f32_16x16x32_bf16 v[40:43], a[212:215], a[48:51], v[40:43]
ds_read_b64_tr_b16 a[204:205], v137 offset:8192
v_mfma_f32_16x16x32_bf16 v[44:47], a[212:215], a[52:55], v[44:47]
buffer_load_dwordx4 v[180:183], v135, s[52:55], s50 offen offset:16
v_mfma_f32_16x16x32_bf16 v[104:107], a[212:215], a[56:59], v[104:107]
ds_read_b64_tr_b16 a[206:207], v137 offset:9216
v_mfma_f32_16x16x32_bf16 v[108:111], a[212:215], a[60:63], v[108:111]
s_waitcnt lgkmcnt(8)
s_waitcnt vmcnt(15)
s_barrier
v_mfma_f32_16x16x32_bf16 v[48:51], a[216:219], a[48:51], v[48:51]
ds_read_b64_tr_b16 a[208:209], v136 offset:16384
v_mfma_f32_16x16x32_bf16 v[52:55], a[216:219], a[52:55], v[52:55]
buffer_load_dwordx4 v[184:187], v135, s[52:55], s50 offen offset:64
v_mfma_f32_16x16x32_bf16 v[112:115], a[216:219], a[56:59], v[112:115]
ds_read_b64_tr_b16 a[210:211], v136 offset:17408
v_mfma_f32_16x16x32_bf16 v[116:119], a[216:219], a[60:63], v[116:119]
v_mfma_f32_16x16x32_bf16 v[56:59], a[220:223], a[48:51], v[56:59]
ds_read_b64_tr_b16 a[212:213], v137 offset:16384
v_mfma_f32_16x16x32_bf16 v[60:63], a[220:223], a[52:55], v[60:63]
buffer_load_dwordx4 v[188:191], v135, s[52:55], s50 offen offset:80
v_mfma_f32_16x16x32_bf16 v[120:123], a[220:223], a[56:59], v[120:123]
ds_read_b64_tr_b16 a[214:215], v137 offset:17408
v_mfma_f32_16x16x32_bf16 v[124:127], a[220:223], a[60:63], v[124:127]
s_waitcnt lgkmcnt(8)
v_mfma_f32_16x16x32_bf16 v[0:3], a[192:195], a[64:67], v[0:3]
ds_read_b64_tr_b16 a[216:217], v136 offset:24576
v_mfma_f32_16x16x32_bf16 v[4:7], a[192:195], a[68:71], v[4:7]
v_mfma_f32_16x16x32_bf16 v[64:67], a[192:195], a[72:75], v[64:67]
ds_read_b64_tr_b16 a[218:219], v136 offset:25600
v_mfma_f32_16x16x32_bf16 v[68:71], a[192:195], a[76:79], v[68:71]
v_xor_b32 v136, 0x8000, v136
v_mfma_f32_16x16x32_bf16 v[8:11], a[196:199], a[64:67], v[8:11]
ds_read_b64_tr_b16 a[220:221], v137 offset:24576
v_mfma_f32_16x16x32_bf16 v[12:15], a[196:199], a[68:71], v[12:15]
v_mfma_f32_16x16x32_bf16 v[72:75], a[196:199], a[72:75], v[72:75]
ds_read_b64_tr_b16 a[222:223], v137 offset:25600
v_mfma_f32_16x16x32_bf16 v[76:79], a[196:199], a[76:79], v[76:79]
s_waitcnt vmcnt(16) lgkmcnt(8)
v_xor_b32 v137, 0x8000, v137
v_mfma_f32_16x16x32_bf16 v[0:3], a[200:203], a[80:83], v[0:3]
ds_read_b64_tr_b16 a[192:193], v138 offset:0
v_mfma_f32_16x16x32_bf16 v[4:7], a[200:203], a[84:87], v[4:7]
v_mfma_f32_16x16x32_bf16 v[64:67], a[200:203], a[88:91], v[64:67]
ds_read_b64_tr_b16 a[194:195], v138 offset:1024
v_mfma_f32_16x16x32_bf16 v[68:71], a[200:203], a[92:95], v[68:71]
v_mfma_f32_16x16x32_bf16 v[8:11], a[204:207], a[80:83], v[8:11]
ds_read_b64_tr_b16 a[196:197], v139 offset:0
v_mfma_f32_16x16x32_bf16 v[12:15], a[204:207], a[84:87], v[12:15]
v_mfma_f32_16x16x32_bf16 v[72:75], a[204:207], a[88:91], v[72:75]
ds_read_b64_tr_b16 a[198:199], v139 offset:1024
v_mfma_f32_16x16x32_bf16 v[76:79], a[204:207], a[92:95], v[76:79]
s_waitcnt vmcnt(12) lgkmcnt(8)
v_mfma_f32_16x16x32_bf16 v[0:3], a[208:211], a[96:99], v[0:3]
ds_read_b64_tr_b16 a[200:201], v138 offset:8192
v_mfma_f32_16x16x32_bf16 v[4:7], a[208:211], a[100:103], v[4:7]
v_mfma_f32_16x16x32_bf16 v[64:67], a[208:211], a[104:107], v[64:67]
ds_read_b64_tr_b16 a[202:203], v138 offset:9216
v_mfma_f32_16x16x32_bf16 v[68:71], a[208:211], a[108:111], v[68:71]
v_mfma_f32_16x16x32_bf16 v[8:11], a[212:215], a[96:99], v[8:11]
ds_read_b64_tr_b16 a[204:205], v139 offset:8192
v_mfma_f32_16x16x32_bf16 v[12:15], a[212:215], a[100:103], v[12:15]
v_mfma_f32_16x16x32_bf16 v[72:75], a[212:215], a[104:107], v[72:75]
ds_read_b64_tr_b16 a[206:207], v139 offset:9216
v_mfma_f32_16x16x32_bf16 v[76:79], a[212:215], a[108:111], v[76:79]
s_waitcnt vmcnt(8) lgkmcnt(8)
v_mfma_f32_16x16x32_bf16 v[0:3], a[216:219], a[112:115], v[0:3]
ds_read_b64_tr_b16 a[208:209], v138 offset:16384
v_mfma_f32_16x16x32_bf16 v[4:7], a[216:219], a[116:119], v[4:7]
v_mfma_f32_16x16x32_bf16 v[64:67], a[216:219], a[120:123], v[64:67]
ds_read_b64_tr_b16 a[210:211], v138 offset:17408
v_mfma_f32_16x16x32_bf16 v[68:71], a[216:219], a[124:127], v[68:71]
v_mfma_f32_16x16x32_bf16 v[8:11], a[220:223], a[112:115], v[8:11]
ds_read_b64_tr_b16 a[212:213], v139 offset:16384
v_mfma_f32_16x16x32_bf16 v[12:15], a[220:223], a[116:119], v[12:15]
v_mfma_f32_16x16x32_bf16 v[72:75], a[220:223], a[120:123], v[72:75]
ds_read_b64_tr_b16 a[214:215], v139 offset:17408
v_mfma_f32_16x16x32_bf16 v[76:79], a[220:223], a[124:127], v[76:79]
s_waitcnt lgkmcnt(8)
v_mfma_f32_16x16x32_bf16 v[16:19], a[192:195], a[64:67], v[16:19]
ds_read_b64_tr_b16 a[216:217], v138 offset:24576
v_mfma_f32_16x16x32_bf16 v[20:23], a[192:195], a[68:71], v[20:23]
v_mfma_f32_16x16x32_bf16 v[80:83], a[192:195], a[72:75], v[80:83]
ds_read_b64_tr_b16 a[218:219], v138 offset:25600
v_mfma_f32_16x16x32_bf16 v[84:87], a[192:195], a[76:79], v[84:87]
v_xor_b32 v138, 0x8000, v138
v_mfma_f32_16x16x32_bf16 v[24:27], a[196:199], a[64:67], v[24:27]
ds_read_b64_tr_b16 a[220:221], v139 offset:24576
v_mfma_f32_16x16x32_bf16 v[28:31], a[196:199], a[68:71], v[28:31]
v_cvt_pk_bf16_f32 v0, v0, v1
v_cvt_pk_bf16_f32 v1, v2, v3
v_mfma_f32_16x16x32_bf16 v[88:91], a[196:199], a[72:75], v[88:91]
ds_read_b64_tr_b16 a[222:223], v139 offset:25600
v_cvt_pk_bf16_f32 v2, v4, v5
v_mfma_f32_16x16x32_bf16 v[92:95], a[196:199], a[76:79], v[92:95]
s_waitcnt lgkmcnt(8)
v_xor_b32 v139, 0x8000, v139
v_cvt_pk_bf16_f32 v3, v6, v7
v_mfma_f32_16x16x32_bf16 v[16:19], a[200:203], a[80:83], v[16:19]
ds_read_b64_tr_b16 a[192:193], v140 offset:0
v_cvt_pk_bf16_f32 v8, v8, v9
v_mfma_f32_16x16x32_bf16 v[20:23], a[200:203], a[84:87], v[20:23]
v_cvt_pk_bf16_f32 v9, v10, v11
v_cvt_pk_bf16_f32 v10, v12, v13
v_mfma_f32_16x16x32_bf16 v[80:83], a[200:203], a[88:91], v[80:83]
ds_read_b64_tr_b16 a[194:195], v140 offset:1024
v_cvt_pk_bf16_f32 v11, v14, v15
v_mfma_f32_16x16x32_bf16 v[84:87], a[200:203], a[92:95], v[84:87]
v_permlane16_swap_b32 v0, v2
v_permlane16_swap_b32 v1, v3
v_mfma_f32_16x16x32_bf16 v[24:27], a[204:207], a[80:83], v[24:27]
ds_read_b64_tr_b16 a[196:197], v141 offset:0
v_mfma_f32_16x16x32_bf16 v[28:31], a[204:207], a[84:87], v[28:31]
buffer_store_dwordx4 v[0:3], v129, s[20:23], s62 offen offset:0 sc1
v_mfma_f32_16x16x32_bf16 v[88:91], a[204:207], a[88:91], v[88:91]
ds_read_b64_tr_b16 a[198:199], v141 offset:1024
s_nop 0
v_mfma_f32_16x16x32_bf16 v[92:95], a[204:207], a[92:95], v[92:95]
s_waitcnt lgkmcnt(8)
v_permlane16_swap_b32 v8, v10
v_permlane16_swap_b32 v9, v11
v_mfma_f32_16x16x32_bf16 v[16:19], a[208:211], a[96:99], v[16:19]
ds_read_b64_tr_b16 a[200:201], v140 offset:8192
v_mfma_f32_16x16x32_bf16 v[20:23], a[208:211], a[100:103], v[20:23]
buffer_store_dwordx4 v[8:11], v129, s[20:23], s62 offen offset:1024 sc1
v_mfma_f32_16x16x32_bf16 v[80:83], a[208:211], a[104:107], v[80:83]
ds_read_b64_tr_b16 a[202:203], v140 offset:9216
v_cvt_pk_bf16_f32 v64, v64, v65
v_mfma_f32_16x16x32_bf16 v[84:87], a[208:211], a[108:111], v[84:87]
v_cvt_pk_bf16_f32 v65, v66, v67
v_cvt_pk_bf16_f32 v66, v68, v69
v_mfma_f32_16x16x32_bf16 v[24:27], a[212:215], a[96:99], v[24:27]
ds_read_b64_tr_b16 a[204:205], v141 offset:8192
v_cvt_pk_bf16_f32 v67, v70, v71
v_mfma_f32_16x16x32_bf16 v[28:31], a[212:215], a[100:103], v[28:31]
v_cvt_pk_bf16_f32 v72, v72, v73
v_cvt_pk_bf16_f32 v73, v74, v75
v_mfma_f32_16x16x32_bf16 v[88:91], a[212:215], a[104:107], v[88:91]
ds_read_b64_tr_b16 a[206:207], v141 offset:9216
v_cvt_pk_bf16_f32 v74, v76, v77
v_mfma_f32_16x16x32_bf16 v[92:95], a[212:215], a[108:111], v[92:95]
s_waitcnt lgkmcnt(8)
v_cvt_pk_bf16_f32 v75, v78, v79
v_permlane16_swap_b32 v64, v66
v_mfma_f32_16x16x32_bf16 v[16:19], a[216:219], a[112:115], v[16:19]
ds_read_b64_tr_b16 a[208:209], v140 offset:16384
v_permlane16_swap_b32 v65, v67
v_mfma_f32_16x16x32_bf16 v[20:23], a[216:219], a[116:119], v[20:23]
buffer_store_dwordx4 v[64:67], v129, s[20:23], s63 offen offset:0 sc1
v_mfma_f32_16x16x32_bf16 v[80:83], a[216:219], a[120:123], v[80:83]
ds_read_b64_tr_b16 a[210:211], v140 offset:17408
s_nop 0
v_mfma_f32_16x16x32_bf16 v[84:87], a[216:219], a[124:127], v[84:87]
v_permlane16_swap_b32 v72, v74
v_permlane16_swap_b32 v73, v75
v_mfma_f32_16x16x32_bf16 v[24:27], a[220:223], a[112:115], v[24:27]
ds_read_b64_tr_b16 a[212:213], v141 offset:16384
v_mfma_f32_16x16x32_bf16 v[28:31], a[220:223], a[116:119], v[28:31]
buffer_store_dwordx4 v[72:75], v129, s[20:23], s63 offen offset:1024 sc1
v_mfma_f32_16x16x32_bf16 v[88:91], a[220:223], a[120:123], v[88:91]
ds_read_b64_tr_b16 a[214:215], v141 offset:17408
v_mfma_f32_16x16x32_bf16 v[92:95], a[220:223], a[124:127], v[92:95]
s_waitcnt lgkmcnt(8)
v_mfma_f32_16x16x32_bf16 v[32:35], a[192:195], a[64:67], v[32:35]
ds_read_b64_tr_b16 a[216:217], v140 offset:24576
v_mfma_f32_16x16x32_bf16 v[36:39], a[192:195], a[68:71], v[36:39]
v_mfma_f32_16x16x32_bf16 v[96:99], a[192:195], a[72:75], v[96:99]
ds_read_b64_tr_b16 a[218:219], v140 offset:25600
v_mfma_f32_16x16x32_bf16 v[100:103], a[192:195], a[76:79], v[100:103]
v_xor_b32 v140, 0x8000, v140
v_mfma_f32_16x16x32_bf16 v[40:43], a[196:199], a[64:67], v[40:43]
ds_read_b64_tr_b16 a[220:221], v141 offset:24576
v_mfma_f32_16x16x32_bf16 v[44:47], a[196:199], a[68:71], v[44:47]
v_cvt_pk_bf16_f32 v16, v16, v17
v_cvt_pk_bf16_f32 v17, v18, v19
v_mfma_f32_16x16x32_bf16 v[104:107], a[196:199], a[72:75], v[104:107]
ds_read_b64_tr_b16 a[222:223], v141 offset:25600
v_cvt_pk_bf16_f32 v18, v20, v21
v_mfma_f32_16x16x32_bf16 v[108:111], a[196:199], a[76:79], v[108:111]
s_waitcnt lgkmcnt(8)
v_xor_b32 v141, 0x8000, v141
v_cvt_pk_bf16_f32 v19, v22, v23
v_mfma_f32_16x16x32_bf16 v[32:35], a[200:203], a[80:83], v[32:35]
ds_read_b64_tr_b16 a[192:193], v142 offset:0
v_cvt_pk_bf16_f32 v24, v24, v25
v_mfma_f32_16x16x32_bf16 v[36:39], a[200:203], a[84:87], v[36:39]
v_cvt_pk_bf16_f32 v25, v26, v27
v_cvt_pk_bf16_f32 v26, v28, v29
v_mfma_f32_16x16x32_bf16 v[96:99], a[200:203], a[88:91], v[96:99]
ds_read_b64_tr_b16 a[194:195], v142 offset:1024
v_cvt_pk_bf16_f32 v27, v30, v31
v_mfma_f32_16x16x32_bf16 v[100:103], a[200:203], a[92:95], v[100:103]
v_permlane16_swap_b32 v16, v18
v_permlane16_swap_b32 v17, v19
v_mfma_f32_16x16x32_bf16 v[40:43], a[204:207], a[80:83], v[40:43]
ds_read_b64_tr_b16 a[196:197], v143 offset:0
v_mfma_f32_16x16x32_bf16 v[44:47], a[204:207], a[84:87], v[44:47]
buffer_store_dwordx4 v[16:19], v129, s[20:23], s64 offen offset:0 sc1
v_mfma_f32_16x16x32_bf16 v[104:107], a[204:207], a[88:91], v[104:107]
ds_read_b64_tr_b16 a[198:199], v143 offset:1024
s_nop 0
v_mfma_f32_16x16x32_bf16 v[108:111], a[204:207], a[92:95], v[108:111]
s_waitcnt lgkmcnt(8)
v_permlane16_swap_b32 v24, v26
v_permlane16_swap_b32 v25, v27
v_mfma_f32_16x16x32_bf16 v[32:35], a[208:211], a[96:99], v[32:35]
ds_read_b64_tr_b16 a[200:201], v142 offset:8192
v_mfma_f32_16x16x32_bf16 v[36:39], a[208:211], a[100:103], v[36:39]
buffer_store_dwordx4 v[24:27], v129, s[20:23], s64 offen offset:1024 sc1
v_mfma_f32_16x16x32_bf16 v[96:99], a[208:211], a[104:107], v[96:99]
ds_read_b64_tr_b16 a[202:203], v142 offset:9216
v_cvt_pk_bf16_f32 v80, v80, v81
v_mfma_f32_16x16x32_bf16 v[100:103], a[208:211], a[108:111], v[100:103]
v_cvt_pk_bf16_f32 v81, v82, v83
v_cvt_pk_bf16_f32 v82, v84, v85
v_mfma_f32_16x16x32_bf16 v[40:43], a[212:215], a[96:99], v[40:43]
ds_read_b64_tr_b16 a[204:205], v143 offset:8192
v_cvt_pk_bf16_f32 v83, v86, v87
v_mfma_f32_16x16x32_bf16 v[44:47], a[212:215], a[100:103], v[44:47]
v_cvt_pk_bf16_f32 v88, v88, v89
v_cvt_pk_bf16_f32 v89, v90, v91
v_mfma_f32_16x16x32_bf16 v[104:107], a[212:215], a[104:107], v[104:107]
ds_read_b64_tr_b16 a[206:207], v143 offset:9216
v_cvt_pk_bf16_f32 v90, v92, v93
v_mfma_f32_16x16x32_bf16 v[108:111], a[212:215], a[108:111], v[108:111]
s_waitcnt lgkmcnt(8)
v_cvt_pk_bf16_f32 v91, v94, v95
v_permlane16_swap_b32 v80, v82
v_mfma_f32_16x16x32_bf16 v[32:35], a[216:219], a[112:115], v[32:35]
ds_read_b64_tr_b16 a[208:209], v142 offset:16384
v_permlane16_swap_b32 v81, v83
v_mfma_f32_16x16x32_bf16 v[36:39], a[216:219], a[116:119], v[36:39]
buffer_store_dwordx4 v[80:83], v129, s[20:23], s65 offen offset:0 sc1
v_mfma_f32_16x16x32_bf16 v[96:99], a[216:219], a[120:123], v[96:99]
ds_read_b64_tr_b16 a[210:211], v142 offset:17408
s_nop 0
v_mfma_f32_16x16x32_bf16 v[100:103], a[216:219], a[124:127], v[100:103]
v_permlane16_swap_b32 v88, v90
v_permlane16_swap_b32 v89, v91
v_mfma_f32_16x16x32_bf16 v[40:43], a[220:223], a[112:115], v[40:43]
ds_read_b64_tr_b16 a[212:213], v143 offset:16384
v_mfma_f32_16x16x32_bf16 v[44:47], a[220:223], a[116:119], v[44:47]
buffer_store_dwordx4 v[88:91], v129, s[20:23], s65 offen offset:1024 sc1
v_mfma_f32_16x16x32_bf16 v[104:107], a[220:223], a[120:123], v[104:107]
ds_read_b64_tr_b16 a[214:215], v143 offset:17408
v_mfma_f32_16x16x32_bf16 v[108:111], a[220:223], a[124:127], v[108:111]
s_waitcnt lgkmcnt(8)
v_mfma_f32_16x16x32_bf16 v[48:51], a[192:195], a[64:67], v[48:51]
ds_read_b64_tr_b16 a[216:217], v142 offset:24576
v_mfma_f32_16x16x32_bf16 v[52:55], a[192:195], a[68:71], v[52:55]
v_mfma_f32_16x16x32_bf16 v[112:115], a[192:195], a[72:75], v[112:115]
ds_read_b64_tr_b16 a[218:219], v142 offset:25600
v_mfma_f32_16x16x32_bf16 v[116:119], a[192:195], a[76:79], v[116:119]
v_xor_b32 v142, 0x8000, v142
v_mfma_f32_16x16x32_bf16 v[56:59], a[196:199], a[64:67], v[56:59]
ds_read_b64_tr_b16 a[220:221], v143 offset:24576
v_mfma_f32_16x16x32_bf16 v[60:63], a[196:199], a[68:71], v[60:63]
v_cvt_pk_bf16_f32 v32, v32, v33
v_cvt_pk_bf16_f32 v33, v34, v35
v_mfma_f32_16x16x32_bf16 v[120:123], a[196:199], a[72:75], v[120:123]
ds_read_b64_tr_b16 a[222:223], v143 offset:25600
v_cvt_pk_bf16_f32 v34, v36, v37
v_mfma_f32_16x16x32_bf16 v[124:127], a[196:199], a[76:79], v[124:127]
s_waitcnt lgkmcnt(8)
v_xor_b32 v143, 0x8000, v143
v_cvt_pk_bf16_f32 v35, v38, v39
v_mfma_f32_16x16x32_bf16 v[48:51], a[200:203], a[80:83], v[48:51]
v_cvt_pk_bf16_f32 v40, v40, v41
v_cvt_pk_bf16_f32 v41, v42, v43
v_mfma_f32_16x16x32_bf16 v[52:55], a[200:203], a[84:87], v[52:55]
v_cvt_pk_bf16_f32 v42, v44, v45
v_cvt_pk_bf16_f32 v43, v46, v47
v_mfma_f32_16x16x32_bf16 v[112:115], a[200:203], a[88:91], v[112:115]
v_permlane16_swap_b32 v32, v34
v_permlane16_swap_b32 v33, v35
v_mfma_f32_16x16x32_bf16 v[116:119], a[200:203], a[92:95], v[116:119]
buffer_store_dwordx4 v[32:35], v129, s[20:23], s66 offen offset:0 sc1
v_mfma_f32_16x16x32_bf16 v[56:59], a[204:207], a[80:83], v[56:59]
s_nop 0
v_permlane16_swap_b32 v40, v42
v_mfma_f32_16x16x32_bf16 v[60:63], a[204:207], a[84:87], v[60:63]
v_permlane16_swap_b32 v41, v43
v_mfma_f32_16x16x32_bf16 v[120:123], a[204:207], a[88:91], v[120:123]
buffer_store_dwordx4 v[40:43], v129, s[20:23], s66 offen offset:1024 sc1
v_mfma_f32_16x16x32_bf16 v[124:127], a[204:207], a[92:95], v[124:127]
s_waitcnt lgkmcnt(4)
v_cvt_pk_bf16_f32 v96, v96, v97
v_cvt_pk_bf16_f32 v97, v98, v99
v_mfma_f32_16x16x32_bf16 v[48:51], a[208:211], a[96:99], v[48:51]
v_cvt_pk_bf16_f32 v98, v100, v101
v_cvt_pk_bf16_f32 v99, v102, v103
v_mfma_f32_16x16x32_bf16 v[52:55], a[208:211], a[100:103], v[52:55]
v_cvt_pk_bf16_f32 v104, v104, v105
v_cvt_pk_bf16_f32 v105, v106, v107
v_mfma_f32_16x16x32_bf16 v[112:115], a[208:211], a[104:107], v[112:115]
v_cvt_pk_bf16_f32 v106, v108, v109
v_cvt_pk_bf16_f32 v107, v110, v111
v_mfma_f32_16x16x32_bf16 v[116:119], a[208:211], a[108:111], v[116:119]
v_permlane16_swap_b32 v96, v98
v_permlane16_swap_b32 v97, v99
v_mfma_f32_16x16x32_bf16 v[56:59], a[212:215], a[96:99], v[56:59]
buffer_store_dwordx4 v[96:99], v129, s[20:23], s67 offen offset:0 sc1
v_mfma_f32_16x16x32_bf16 v[60:63], a[212:215], a[100:103], v[60:63]
s_nop 0
v_permlane16_swap_b32 v104, v106
v_mfma_f32_16x16x32_bf16 v[120:123], a[212:215], a[104:107], v[120:123]
v_permlane16_swap_b32 v105, v107
v_mfma_f32_16x16x32_bf16 v[124:127], a[212:215], a[108:111], v[124:127]
s_waitcnt lgkmcnt(0)
v_mfma_f32_16x16x32_bf16 v[48:51], a[216:219], a[112:115], v[48:51]
buffer_store_dwordx4 v[104:107], v129, s[20:23], s67 offen offset:1024 sc1
v_mfma_f32_16x16x32_bf16 v[52:55], a[216:219], a[116:119], v[52:55]
v_mfma_f32_16x16x32_bf16 v[112:115], a[216:219], a[120:123], v[112:115]
v_mfma_f32_16x16x32_bf16 v[116:119], a[216:219], a[124:127], v[116:119]
v_mfma_f32_16x16x32_bf16 v[56:59], a[220:223], a[112:115], v[56:59]
v_mfma_f32_16x16x32_bf16 v[60:63], a[220:223], a[116:119], v[60:63]
v_mfma_f32_16x16x32_bf16 v[120:123], a[220:223], a[120:123], v[120:123]
v_mfma_f32_16x16x32_bf16 v[124:127], a[220:223], a[124:127], v[124:127]
s_nop 15
v_permlane16_swap_b32 v48, v52
v_permlane16_swap_b32 v49, v53
v_permlane16_swap_b32 v50, v54
v_permlane16_swap_b32 v51, v55
v_permlane16_swap_b32 v56, v60
v_permlane16_swap_b32 v57, v61
v_permlane16_swap_b32 v58, v62
v_permlane16_swap_b32 v59, v63
v_permlane16_swap_b32 v112, v116
v_permlane16_swap_b32 v113, v117
v_permlane16_swap_b32 v114, v118
v_permlane16_swap_b32 v115, v119
v_permlane16_swap_b32 v120, v124
v_permlane16_swap_b32 v121, v125
v_permlane16_swap_b32 v122, v126
v_permlane16_swap_b32 v123, v127
s_add_u32 s12, s8, 196608
s_addc_u32 s13, s9, 0
s_and_b32 s13, s13, 0xffff
s_mov_b32 s14, 65536
s_mov_b32 s15, 0x20000
s_lshl_b32 s36, s38, 2
s_add_u32 s36, s36, s51
v_mov_b32 v152, 1
v_mov_b32 v153, 0
v_and_b32 v154, 3, v128
v_lshlrev_b32 v154, 2, v154
s_mov_b32 s46, 0x20000
s_waitcnt vmcnt(0)
s_mov_b64 exec, 1
buffer_store_dword v152, v153, s[12:15], s36 offen sc1
s_mov_b64 exec, -1
L_down_poll:
buffer_load_dword v155, v154, s[12:15], s51 offen sc1
s_waitcnt vmcnt(0)
v_cmp_ne_u32 vcc, 1, v155
s_cbranch_vccz L_down_got
s_sleep 1
s_sub_u32 s46, s46, 1
s_cmp_lg_u32 s46, 0
s_cbranch_scc1 L_down_poll
L_down_got:
buffer_load_dwordx4 v[0:3], v129, s[20:23], s84 offen offset:0 sc1
buffer_load_dwordx4 v[4:7], v129, s[20:23], s86 offen offset:0 sc1
buffer_load_dwordx4 v[8:11], v129, s[20:23], s88 offen offset:0 sc1
buffer_load_dwordx4 v[12:15], v129, s[20:23], s84 offen offset:1024 sc1
buffer_load_dwordx4 v[16:19], v129, s[20:23], s86 offen offset:1024 sc1
buffer_load_dwordx4 v[20:23], v129, s[20:23], s88 offen offset:1024 sc1
buffer_load_dwordx4 v[64:67], v129, s[20:23], s85 offen offset:0 sc1
buffer_load_dwordx4 v[68:71], v129, s[20:23], s87 offen offset:0 sc1
buffer_load_dwordx4 v[72:75], v129, s[20:23], s89 offen offset:0 sc1
buffer_load_dwordx4 v[76:79], v129, s[20:23], s85 offen offset:1024 sc1
buffer_load_dwordx4 v[80:83], v129, s[20:23], s87 offen offset:1024 sc1
buffer_load_dwordx4 v[84:87], v129, s[20:23], s89 offen offset:1024 sc1
s_mov_b32 s36, 0xffff0000
s_waitcnt vmcnt(9)
v_lshlrev_b32 v24, 16, v0
v_and_b32 v25, s36, v0
v_lshlrev_b32 v26, 16, v1
v_and_b32 v27, s36, v1
v_lshlrev_b32 v28, 16, v2
v_and_b32 v29, s36, v2
v_lshlrev_b32 v30, 16, v3
v_and_b32 v31, s36, v3
v_add_f32 v48, v48, v24
v_add_f32 v49, v49, v25
v_add_f32 v50, v50, v26
v_add_f32 v51, v51, v27
v_add_f32 v52, v52, v28
v_add_f32 v53, v53, v29
v_add_f32 v54, v54, v30
v_add_f32 v55, v55, v31
v_lshlrev_b32 v24, 16, v4
v_and_b32 v25, s36, v4
v_lshlrev_b32 v26, 16, v5
v_and_b32 v27, s36, v5
v_lshlrev_b32 v28, 16, v6
v_and_b32 v29, s36, v6
v_lshlrev_b32 v30, 16, v7
v_and_b32 v31, s36, v7
v_add_f32 v48, v48, v24
v_add_f32 v49, v49, v25
v_add_f32 v50, v50, v26
v_add_f32 v51, v51, v27
v_add_f32 v52, v52, v28
v_add_f32 v53, v53, v29
v_add_f32 v54, v54, v30
v_add_f32 v55, v55, v31
v_lshlrev_b32 v24, 16, v8
v_and_b32 v25, s36, v8
v_lshlrev_b32 v26, 16, v9
v_and_b32 v27, s36, v9
v_lshlrev_b32 v28, 16, v10
v_and_b32 v29, s36, v10
v_lshlrev_b32 v30, 16, v11
v_and_b32 v31, s36, v11
v_add_f32 v48, v48, v24
v_add_f32 v49, v49, v25
v_add_f32 v50, v50, v26
v_add_f32 v51, v51, v27
v_add_f32 v52, v52, v28
v_add_f32 v53, v53, v29
v_add_f32 v54, v54, v30
v_add_f32 v55, v55, v31
v_cvt_pk_bf16_f32 v48, 0, v48
v_cvt_pk_bf16_f32 v49, 0, v49
v_cvt_pk_bf16_f32 v50, 0, v50
v_cvt_pk_bf16_f32 v51, 0, v51
v_cvt_pk_bf16_f32 v52, 0, v52
v_cvt_pk_bf16_f32 v53, 0, v53
v_cvt_pk_bf16_f32 v54, 0, v54
v_cvt_pk_bf16_f32 v55, 0, v55
v_mul_f32 v48, v176, v48
v_mul_f32 v49, v177, v49
v_mul_f32 v50, v178, v50
v_mul_f32 v51, v179, v51
v_mul_f32 v52, v180, v52
v_mul_f32 v53, v181, v53
v_mul_f32 v54, v182, v54
v_mul_f32 v55, v183, v55
v_cvt_pk_bf16_f32 v48, 0, v48
v_cvt_pk_bf16_f32 v49, 0, v49
v_cvt_pk_bf16_f32 v50, 0, v50
v_cvt_pk_bf16_f32 v51, 0, v51
v_cvt_pk_bf16_f32 v52, 0, v52
v_cvt_pk_bf16_f32 v53, 0, v53
v_cvt_pk_bf16_f32 v54, 0, v54
v_cvt_pk_bf16_f32 v55, 0, v55
v_lshlrev_b32 v24, 16, v160
v_and_b32 v25, s36, v160
v_lshlrev_b32 v26, 16, v161
v_and_b32 v27, s36, v161
v_lshlrev_b32 v28, 16, v162
v_and_b32 v29, s36, v162
v_lshlrev_b32 v30, 16, v163
v_and_b32 v31, s36, v163
v_add_f32 v48, v48, v24
v_add_f32 v49, v49, v25
v_add_f32 v50, v50, v26
v_add_f32 v51, v51, v27
v_add_f32 v52, v52, v28
v_add_f32 v53, v53, v29
v_add_f32 v54, v54, v30
v_add_f32 v55, v55, v31
v_cvt_pk_bf16_f32 v160, v48, v49
v_cvt_pk_bf16_f32 v161, v50, v51
v_cvt_pk_bf16_f32 v162, v52, v53
v_cvt_pk_bf16_f32 v163, v54, v55
buffer_store_dwordx4 v[160:163], v159, s[56:59], s44 offen offset:0 sc0
s_waitcnt vmcnt(7)
v_lshlrev_b32 v24, 16, v12
v_and_b32 v25, s36, v12
v_lshlrev_b32 v26, 16, v13
v_and_b32 v27, s36, v13
v_lshlrev_b32 v28, 16, v14
v_and_b32 v29, s36, v14
v_lshlrev_b32 v30, 16, v15
v_and_b32 v31, s36, v15
v_add_f32 v56, v56, v24
v_add_f32 v57, v57, v25
v_add_f32 v58, v58, v26
v_add_f32 v59, v59, v27
v_add_f32 v60, v60, v28
v_add_f32 v61, v61, v29
v_add_f32 v62, v62, v30
v_add_f32 v63, v63, v31
v_lshlrev_b32 v24, 16, v16
v_and_b32 v25, s36, v16
v_lshlrev_b32 v26, 16, v17
v_and_b32 v27, s36, v17
v_lshlrev_b32 v28, 16, v18
v_and_b32 v29, s36, v18
v_lshlrev_b32 v30, 16, v19
v_and_b32 v31, s36, v19
v_add_f32 v56, v56, v24
v_add_f32 v57, v57, v25
v_add_f32 v58, v58, v26
v_add_f32 v59, v59, v27
v_add_f32 v60, v60, v28
v_add_f32 v61, v61, v29
v_add_f32 v62, v62, v30
v_add_f32 v63, v63, v31
v_lshlrev_b32 v24, 16, v20
v_and_b32 v25, s36, v20
v_lshlrev_b32 v26, 16, v21
v_and_b32 v27, s36, v21
v_lshlrev_b32 v28, 16, v22
v_and_b32 v29, s36, v22
v_lshlrev_b32 v30, 16, v23
v_and_b32 v31, s36, v23
v_add_f32 v56, v56, v24
v_add_f32 v57, v57, v25
v_add_f32 v58, v58, v26
v_add_f32 v59, v59, v27
v_add_f32 v60, v60, v28
v_add_f32 v61, v61, v29
v_add_f32 v62, v62, v30
v_add_f32 v63, v63, v31
v_cvt_pk_bf16_f32 v56, 0, v56
v_cvt_pk_bf16_f32 v57, 0, v57
v_cvt_pk_bf16_f32 v58, 0, v58
v_cvt_pk_bf16_f32 v59, 0, v59
v_cvt_pk_bf16_f32 v60, 0, v60
v_cvt_pk_bf16_f32 v61, 0, v61
v_cvt_pk_bf16_f32 v62, 0, v62
v_cvt_pk_bf16_f32 v63, 0, v63
v_mul_f32 v56, v184, v56
v_mul_f32 v57, v185, v57
v_mul_f32 v58, v186, v58
v_mul_f32 v59, v187, v59
v_mul_f32 v60, v188, v60
v_mul_f32 v61, v189, v61
v_mul_f32 v62, v190, v62
v_mul_f32 v63, v191, v63
v_cvt_pk_bf16_f32 v56, 0, v56
v_cvt_pk_bf16_f32 v57, 0, v57
v_cvt_pk_bf16_f32 v58, 0, v58
v_cvt_pk_bf16_f32 v59, 0, v59
v_cvt_pk_bf16_f32 v60, 0, v60
v_cvt_pk_bf16_f32 v61, 0, v61
v_cvt_pk_bf16_f32 v62, 0, v62
v_cvt_pk_bf16_f32 v63, 0, v63
v_lshlrev_b32 v24, 16, v164
v_and_b32 v25, s36, v164
v_lshlrev_b32 v26, 16, v165
v_and_b32 v27, s36, v165
v_lshlrev_b32 v28, 16, v166
v_and_b32 v29, s36, v166
v_lshlrev_b32 v30, 16, v167
v_and_b32 v31, s36, v167
v_add_f32 v56, v56, v24
v_add_f32 v57, v57, v25
v_add_f32 v58, v58, v26
v_add_f32 v59, v59, v27
v_add_f32 v60, v60, v28
v_add_f32 v61, v61, v29
v_add_f32 v62, v62, v30
v_add_f32 v63, v63, v31
v_cvt_pk_bf16_f32 v164, v56, v57
v_cvt_pk_bf16_f32 v165, v58, v59
v_cvt_pk_bf16_f32 v166, v60, v61
v_cvt_pk_bf16_f32 v167, v62, v63
buffer_store_dwordx4 v[164:167], v159, s[56:59], s44 offen offset:32 sc0
s_waitcnt vmcnt(5)
v_lshlrev_b32 v88, 16, v64
v_and_b32 v89, s36, v64
v_lshlrev_b32 v90, 16, v65
v_and_b32 v91, s36, v65
v_lshlrev_b32 v92, 16, v66
v_and_b32 v93, s36, v66
v_lshlrev_b32 v94, 16, v67
v_and_b32 v95, s36, v67
v_add_f32 v112, v112, v88
v_add_f32 v113, v113, v89
v_add_f32 v114, v114, v90
v_add_f32 v115, v115, v91
v_add_f32 v116, v116, v92
v_add_f32 v117, v117, v93
v_add_f32 v118, v118, v94
v_add_f32 v119, v119, v95
v_lshlrev_b32 v88, 16, v68
v_and_b32 v89, s36, v68
v_lshlrev_b32 v90, 16, v69
v_and_b32 v91, s36, v69
v_lshlrev_b32 v92, 16, v70
v_and_b32 v93, s36, v70
v_lshlrev_b32 v94, 16, v71
v_and_b32 v95, s36, v71
v_add_f32 v112, v112, v88
v_add_f32 v113, v113, v89
v_add_f32 v114, v114, v90
v_add_f32 v115, v115, v91
v_add_f32 v116, v116, v92
v_add_f32 v117, v117, v93
v_add_f32 v118, v118, v94
v_add_f32 v119, v119, v95
v_lshlrev_b32 v88, 16, v72
v_and_b32 v89, s36, v72
v_lshlrev_b32 v90, 16, v73
v_and_b32 v91, s36, v73
v_lshlrev_b32 v92, 16, v74
v_and_b32 v93, s36, v74
v_lshlrev_b32 v94, 16, v75
v_and_b32 v95, s36, v75
v_add_f32 v112, v112, v88
v_add_f32 v113, v113, v89
v_add_f32 v114, v114, v90
v_add_f32 v115, v115, v91
v_add_f32 v116, v116, v92
v_add_f32 v117, v117, v93
v_add_f32 v118, v118, v94
v_add_f32 v119, v119, v95
v_cvt_pk_bf16_f32 v112, 0, v112
v_cvt_pk_bf16_f32 v113, 0, v113
v_cvt_pk_bf16_f32 v114, 0, v114
v_cvt_pk_bf16_f32 v115, 0, v115
v_cvt_pk_bf16_f32 v116, 0, v116
v_cvt_pk_bf16_f32 v117, 0, v117
v_cvt_pk_bf16_f32 v118, 0, v118
v_cvt_pk_bf16_f32 v119, 0, v119
v_mul_f32 v112, v176, v112
v_mul_f32 v113, v177, v113
v_mul_f32 v114, v178, v114
v_mul_f32 v115, v179, v115
v_mul_f32 v116, v180, v116
v_mul_f32 v117, v181, v117
v_mul_f32 v118, v182, v118
v_mul_f32 v119, v183, v119
v_cvt_pk_bf16_f32 v112, 0, v112
v_cvt_pk_bf16_f32 v113, 0, v113
v_cvt_pk_bf16_f32 v114, 0, v114
v_cvt_pk_bf16_f32 v115, 0, v115
v_cvt_pk_bf16_f32 v116, 0, v116
v_cvt_pk_bf16_f32 v117, 0, v117
v_cvt_pk_bf16_f32 v118, 0, v118
v_cvt_pk_bf16_f32 v119, 0, v119
v_lshlrev_b32 v88, 16, v168
v_and_b32 v89, s36, v168
v_lshlrev_b32 v90, 16, v169
v_and_b32 v91, s36, v169
v_lshlrev_b32 v92, 16, v170
v_and_b32 v93, s36, v170
v_lshlrev_b32 v94, 16, v171
v_and_b32 v95, s36, v171
v_add_f32 v112, v112, v88
v_add_f32 v113, v113, v89
v_add_f32 v114, v114, v90
v_add_f32 v115, v115, v91
v_add_f32 v116, v116, v92
v_add_f32 v117, v117, v93
v_add_f32 v118, v118, v94
v_add_f32 v119, v119, v95
v_cvt_pk_bf16_f32 v168, v112, v113
v_cvt_pk_bf16_f32 v169, v114, v115
v_cvt_pk_bf16_f32 v170, v116, v117
v_cvt_pk_bf16_f32 v171, v118, v119
buffer_store_dwordx4 v[168:171], v159, s[56:59], s45 offen offset:0 sc0
s_waitcnt vmcnt(3)
v_lshlrev_b32 v88, 16, v76
v_and_b32 v89, s36, v76
v_lshlrev_b32 v90, 16, v77
v_and_b32 v91, s36, v77
v_lshlrev_b32 v92, 16, v78
v_and_b32 v93, s36, v78
v_lshlrev_b32 v94, 16, v79
v_and_b32 v95, s36, v79
v_add_f32 v120, v120, v88
v_add_f32 v121, v121, v89
v_add_f32 v122, v122, v90
v_add_f32 v123, v123, v91
v_add_f32 v124, v124, v92
v_add_f32 v125, v125, v93
v_add_f32 v126, v126, v94
v_add_f32 v127, v127, v95
v_lshlrev_b32 v88, 16, v80
v_and_b32 v89, s36, v80
v_lshlrev_b32 v90, 16, v81
v_and_b32 v91, s36, v81
v_lshlrev_b32 v92, 16, v82
v_and_b32 v93, s36, v82
v_lshlrev_b32 v94, 16, v83
v_and_b32 v95, s36, v83
v_add_f32 v120, v120, v88
v_add_f32 v121, v121, v89
v_add_f32 v122, v122, v90
v_add_f32 v123, v123, v91
v_add_f32 v124, v124, v92
v_add_f32 v125, v125, v93
v_add_f32 v126, v126, v94
v_add_f32 v127, v127, v95
v_lshlrev_b32 v88, 16, v84
v_and_b32 v89, s36, v84
v_lshlrev_b32 v90, 16, v85
v_and_b32 v91, s36, v85
v_lshlrev_b32 v92, 16, v86
v_and_b32 v93, s36, v86
v_lshlrev_b32 v94, 16, v87
v_and_b32 v95, s36, v87
v_add_f32 v120, v120, v88
v_add_f32 v121, v121, v89
v_add_f32 v122, v122, v90
v_add_f32 v123, v123, v91
v_add_f32 v124, v124, v92
v_add_f32 v125, v125, v93
v_add_f32 v126, v126, v94
v_add_f32 v127, v127, v95
v_cvt_pk_bf16_f32 v120, 0, v120
v_cvt_pk_bf16_f32 v121, 0, v121
v_cvt_pk_bf16_f32 v122, 0, v122
v_cvt_pk_bf16_f32 v123, 0, v123
v_cvt_pk_bf16_f32 v124, 0, v124
v_cvt_pk_bf16_f32 v125, 0, v125
v_cvt_pk_bf16_f32 v126, 0, v126
v_cvt_pk_bf16_f32 v127, 0, v127
v_mul_f32 v120, v184, v120
v_mul_f32 v121, v185, v121
v_mul_f32 v122, v186, v122
v_mul_f32 v123, v187, v123
v_mul_f32 v124, v188, v124
v_mul_f32 v125, v189, v125
v_mul_f32 v126, v190, v126
v_mul_f32 v127, v191, v127
v_cvt_pk_bf16_f32 v120, 0, v120
v_cvt_pk_bf16_f32 v121, 0, v121
v_cvt_pk_bf16_f32 v122, 0, v122
v_cvt_pk_bf16_f32 v123, 0, v123
v_cvt_pk_bf16_f32 v124, 0, v124
v_cvt_pk_bf16_f32 v125, 0, v125
v_cvt_pk_bf16_f32 v126, 0, v126
v_cvt_pk_bf16_f32 v127, 0, v127
v_lshlrev_b32 v88, 16, v172
v_and_b32 v89, s36, v172
v_lshlrev_b32 v90, 16, v173
v_and_b32 v91, s36, v173
v_lshlrev_b32 v92, 16, v174
v_and_b32 v93, s36, v174
v_lshlrev_b32 v94, 16, v175
v_and_b32 v95, s36, v175
v_add_f32 v120, v120, v88
v_add_f32 v121, v121, v89
v_add_f32 v122, v122, v90
v_add_f32 v123, v123, v91
v_add_f32 v124, v124, v92
v_add_f32 v125, v125, v93
v_add_f32 v126, v126, v94
v_add_f32 v127, v127, v95
v_cvt_pk_bf16_f32 v172, v120, v121
v_cvt_pk_bf16_f32 v173, v122, v123
v_cvt_pk_bf16_f32 v174, v124, v125
v_cvt_pk_bf16_f32 v175, v126, v127
buffer_store_dwordx4 v[172:175], v159, s[56:59], s45 offen offset:32 sc0
L_down_end:
s_endpgm
L_text_end:
.section .rodata,"a"
.p2align 6
.amdhsa_kernel mod_kernel
  .amdhsa_next_free_vgpr 72
  .amdhsa_next_free_sgpr 96
  .amdhsa_accum_offset 72
  .amdhsa_group_segment_fixed_size 0
  .amdhsa_kernarg_size 112
  .amdhsa_user_sgpr_count 2
  .amdhsa_user_sgpr_kernarg_segment_ptr 1
  .amdhsa_system_sgpr_workgroup_id_x 1
  .amdhsa_float_denorm_mode_32 3
  .amdhsa_float_denorm_mode_16_64 3
.end_amdhsa_kernel
.p2align 6
.amdhsa_kernel lna_kernel
  .amdhsa_next_free_vgpr 160
  .amdhsa_next_free_sgpr 96
  .amdhsa_accum_offset 160
  .amdhsa_group_segment_fixed_size 0
  .amdhsa_kernarg_size 112
  .amdhsa_user_sgpr_count 2
  .amdhsa_user_sgpr_kernarg_segment_ptr 1
  .amdhsa_system_sgpr_workgroup_id_x 1
  .amdhsa_float_denorm_mode_32 3
  .amdhsa_float_denorm_mode_16_64 3
.end_amdhsa_kernel
.p2align 6
.amdhsa_kernel attn_kernel
  .amdhsa_next_free_vgpr 512
  .amdhsa_next_free_sgpr 96
  .amdhsa_accum_offset 256
  .amdhsa_group_segment_fixed_size 0
  .amdhsa_kernarg_size 112
  .amdhsa_user_sgpr_count 2
  .amdhsa_user_sgpr_kernarg_segment_ptr 1
  .amdhsa_system_sgpr_workgroup_id_x 1
  .amdhsa_float_denorm_mode_32 3
  .amdhsa_float_denorm_mode_16_64 3
.end_amdhsa_kernel
.p2align 6
.amdhsa_kernel oproj_kernel
  .amdhsa_next_free_vgpr 416
  .amdhsa_next_free_sgpr 96
  .amdhsa_accum_offset 192
  .amdhsa_group_segment_fixed_size 0
  .amdhsa_kernarg_size 112
  .amdhsa_user_sgpr_count 2
  .amdhsa_user_sgpr_kernarg_segment_ptr 1
  .amdhsa_system_sgpr_workgroup_id_x 1
  .amdhsa_float_denorm_mode_32 3
  .amdhsa_float_denorm_mode_16_64 3
.end_amdhsa_kernel
.p2align 6
.amdhsa_kernel lnb_kernel
  .amdhsa_next_free_vgpr 160
  .amdhsa_next_free_sgpr 96
  .amdhsa_accum_offset 160
  .amdhsa_group_segment_fixed_size 0
  .amdhsa_kernarg_size 112
  .amdhsa_user_sgpr_count 2
  .amdhsa_user_sgpr_kernarg_segment_ptr 1
  .amdhsa_system_sgpr_workgroup_id_x 1
  .amdhsa_float_denorm_mode_32 3
  .amdhsa_float_denorm_mode_16_64 3
.end_amdhsa_kernel
.p2align 6
.amdhsa_kernel gateup_kernel
  .amdhsa_next_free_vgpr 512
  .amdhsa_next_free_sgpr 96
  .amdhsa_accum_offset 256
  .amdhsa_group_segment_fixed_size 0
  .amdhsa_kernarg_size 112
  .amdhsa_user_sgpr_count 2
  .amdhsa_user_sgpr_kernarg_segment_ptr 1
  .amdhsa_system_sgpr_workgroup_id_x 1
  .amdhsa_float_denorm_mode_32 3
  .amdhsa_float_denorm_mode_16_64 3
.end_amdhsa_kernel
.p2align 6
.amdhsa_kernel down_kernel
  .amdhsa_next_free_vgpr 416
  .amdhsa_next_free_sgpr 96
  .amdhsa_accum_offset 192
  .amdhsa_group_segment_fixed_size 0
  .amdhsa_kernarg_size 112
  .amdhsa_user_sgpr_count 2
  .amdhsa_user_sgpr_kernarg_segment_ptr 1
  .amdhsa_system_sgpr_workgroup_id_x 1
  .amdhsa_float_denorm_mode_32 3
  .amdhsa_float_denorm_mode_16_64 3
.end_amdhsa_kernel
```
